```python
import torch

def _softmax(x, axis=-1):
    return torch.softmax(x, dim=axis)
def _gelu(x):
    return torch.nn.functional.gelu(x, approximate="tanh")
def _silu(x):
    return torch.nn.functional.silu(x)
def _sigmoid(x):
    return torch.sigmoid(x)
def _layernorm(x, axis=-1, eps=1e-5):
    m = x.mean(dim=axis, keepdim=True)
    v = x.var(dim=axis, keepdim=True, unbiased=False)
    return (x - m) / torch.sqrt(v + eps)
def _scatter_add(tgt, idx, src, axis=0):
    return tgt.clone().index_add_(axis, idx, src)
def _segment_sum(src, seg, n):
    out = torch.zeros((n,) + src.shape[1:], dtype=src.dtype)
    return out.index_add_(0, seg, src)
def _pad(x, pw):
    flat = tuple(v for pair in reversed(pw) for v in pair)
    return torch.nn.functional.pad(x, flat)

kernel_name = 'concat_heads__ssm_conv_s4d__compressed_kv_cla__prompt'

def setup_inputs():

    _w = (lambda a: (lambda t: t.to(torch.bfloat16) if t.is_floating_point() else t)(torch.as_tensor(a)))
    def _A_setup():
        Bsz, L, D, N = 1, 2048, 512, 128
        return {
            "u": _w((lambda *s: torch.randn(*s, dtype=torch.bfloat16) * 0.05)(Bsz, L, D)),
            "log_A_real": _w((lambda *s: torch.randn(*s, dtype=torch.bfloat16) * 6.4)(D, N) * 0.5),
            "A_imag": _w((lambda *s: torch.randn(*s, dtype=torch.bfloat16) * 0.05)(D, N) * 3.14),
            "C_real": _w((lambda *s: torch.randn(*s, dtype=torch.bfloat16) * 0.05)(D, N) / N ** 0.5),
            "C_imag": _w((lambda *s: torch.randn(*s, dtype=torch.bfloat16) * 0.05)(D, N) / N ** 0.5),
            "log_dt": _w((lambda *s: torch.randn(*s, dtype=torch.bfloat16) * 0.05)(D) * 0.5 - 4.0),
            "D_skip": _w((lambda *s: torch.randn(*s, dtype=torch.bfloat16) * 0.05)(D)),
        }
    _A_in = _A_setup()

    def _B_setup():
        B, H, Sq, Sk, D, M = 1, 32, 2048, 2048, 128, 512
        Dc = 4 * D
        return {
            "x": _w((lambda *s: torch.randn(*s, dtype=torch.bfloat16) * 0.8)(B, Sq, M)),
            "c_kv": _w((lambda *s: torch.randn(*s, dtype=torch.bfloat16) * 0.2)(B, Sk, Dc)),
            "w_q": _w((lambda *s: torch.randn(*s, dtype=torch.bfloat16) * 3.2)(M, H, D) * (M ** -0.5)),
            "w_uk": _w((lambda *s: torch.randn(*s, dtype=torch.bfloat16) * 3.2)(Dc, H, D) * (Dc ** -0.5)),
            "w_uv": _w((lambda *s: torch.randn(*s, dtype=torch.bfloat16) * 0.2)(Dc, H, D) * (Dc ** -0.5)),
            "w_o": _w((lambda *s: torch.randn(*s, dtype=torch.bfloat16) * 0.2)(H, D, M) * ((H * D) ** -0.5)),
        }
    _B_in = _B_setup()

    return {
        "A_u": _A_in["u"],
        "A_log_A_real": _A_in["log_A_real"],
        "A_A_imag": _A_in["A_imag"],
        "A_C_real": _A_in["C_real"],
        "A_C_imag": _A_in["C_imag"],
        "A_log_dt": _A_in["log_dt"],
        "A_D_skip": _A_in["D_skip"],
        "B_x": _B_in["x"],
        "B_c_kv": _B_in["c_kv"],
        "B_w_q": _B_in["w_q"],
        "B_w_uk": _B_in["w_uk"],
        "B_w_uv": _B_in["w_uv"],
        "B_w_o": _B_in["w_o"],
    }

def reference(A_u, A_log_A_real, A_A_imag, A_C_real, A_C_imag, A_log_dt, A_D_skip, B_x, B_c_kv, B_w_q, B_w_uk, B_w_uv, B_w_o):
    def _A_ref(u, log_A_real, A_imag, C_real, C_imag, log_dt, D_skip):
        L = u.shape[1]
        dt = torch.exp(log_dt)
        A = -torch.exp(log_A_real) + 1j * A_imag
        C = (C_real + 1j * C_imag) * dt[:, None]
        pos = (lambda x, dt: x.to(dt))(torch.arange(L), log_dt.dtype)
        P = torch.exp((A * dt[:, None])[:, :, None] * pos[None, None, :])
        K = 2.0 * torch.einsum("dn,dnl->dl", C, P).real
        L2 = 2 * L
        u_t = (lambda x, *d: x.permute(*d))(u, 0, 2, 1)
        Kf = (lambda x, *a, **k: torch.fft.rfft(x.float(), *a, **k))(K, L2)
        Uf = (lambda x, *a, **k: torch.fft.rfft(x.float(), *a, **k))(u_t, L2)
        y = (lambda x, *a, **k: torch.fft.irfft(x, *a, **k).to(torch.bfloat16))(Uf * Kf[None, :, :], L2)[:, :, :L]
        y = (lambda x, *d: x.permute(*d))(y, 0, 2, 1)
        return y + u * D_skip[None, None, :]

    def _B_ref(x, c_kv, w_q, w_uk, w_uv, w_o):
        B, Sq, M = x.shape[0], x.shape[1], x.shape[2]
        Sk = c_kv.shape[1]
        H, D = w_q.shape[1], w_q.shape[2]
        q = torch.einsum("bqm,mhd->bhqd", x, w_q)
        k = torch.einsum("bkc,chd->bhkd", c_kv, w_uk)
        v = torch.einsum("bkc,chd->bhkd", c_kv, w_uv)
        scores = torch.einsum("bhqd,bhkd->bhqk", q, k) * (D ** -0.5)
        off = Sk - Sq
        qi = torch.arange(Sq)[:, None]
        kj = torch.arange(Sk)[None, :]
        cmask = kj <= (qi + off)
        scores = torch.where(cmask[None, None], scores, -1e9)
        p = _softmax(scores, axis=-1)
        ctx = torch.einsum("bhqk,bhkd->bhqd", p, v)
        return torch.einsum("bhqd,hdm->bqm", ctx, w_o)

    a = _A_ref(A_u, A_log_A_real, A_A_imag, A_C_real, A_C_imag, A_log_dt, A_D_skip)
    b = _B_ref(B_x, B_c_kv, B_w_q, B_w_uk, B_w_uv, B_w_o)
    return torch.concatenate([a, b], axis=-1)
```

```asm
; @launch kernel=k1_kernel grid=(256,1,1) block=(512,1,1) lds=163840
; @launch kernel=k2_kernel grid=(256,1,1) block=(512,1,1) lds=158976
; @launch kernel=k3_kernel grid=(512,1,1) block=(256,1,1) lds=65536
.amdgcn_target "amdgcn-amd-amdhsa--gfx950"
.text
.globl k1_kernel
.p2align 8
.type k1_kernel,@function
k1_kernel:
    s_cmp_ge_u32 s2, 256
    s_cbranch_scc1 k1_kernel_done
    s_load_dwordx2 s[4:5], s[0:1], 64
    s_load_dwordx4 s[36:39], s[0:1], 80
    s_load_dwordx2 s[6:7], s[0:1], 120
    s_load_dwordx2 s[40:41], s[0:1], 56
    s_load_dwordx2 s[56:57], s[0:1], 0
    s_load_dwordx2 s[60:61], s[0:1], 72
    s_load_dwordx8 s[64:71], s[0:1], 8
    s_load_dwordx2 s[72:73], s[0:1], 40
    v_lshrrev_b32 v241, 6, v0
    v_and_b32 v242, 63, v0
    v_readfirstlane_b32 s24, v241
    v_lshlrev_b32 v232, 4, v242
    s_waitcnt lgkmcnt(0)
    s_mov_b32 s8, s4
    s_mov_b32 s9, s5
    s_mov_b32 s10, 0x200000
    s_mov_b32 s11, 0x00020000
    v_mov_b32 v240, v242
    s_lshr_b32 s74, s2, 3
    s_lshl_b32 s74, s74, 3
    s_add_u32 s74, s74, s24
    s_cmp_lt_u32 s74, 128
    s_cselect_b32 s64, s36, s38
    s_cselect_b32 s65, s37, s39
    s_mov_b32 s66, 0x400000
    s_mov_b32 s67, 0x00020000
    v_bfe_u32 v241, v232, 7, 1
    v_lshlrev_b32 v241, 13, v241
    v_bfe_u32 v242, v232, 4, 3
    v_lshl_add_u32 v241, v242, 7, v241
    s_and_b32 s75, s74, 127
    s_lshl_b32 s75, s75, 14
    s_and_b32 s74, s2, 7
    s_lshl_b32 s74, s74, 10
    s_add_u32 s75, s75, s74
    s_add_u32 s75, s75, 0
    buffer_load_dword v254, v241, s[64:67], s75 offen
    s_lshr_b32 s74, s2, 3
    s_lshl_b32 s74, s74, 3
    s_add_u32 s74, s74, s24
    s_and_b32 s75, s2, 7
    s_mul_i32 s75, s75, 37
    s_add_u32 s74, s74, s75
    s_and_b32 s74, s74, 255
    v_and_b32 v242, 0xf0, v232
    v_lshlrev_b32 v242, 3, v242
    s_lshr_b32 s75, s74, 5
    s_lshl_b32 s75, s75, 18
    s_and_b32 s74, s74, 31
    s_lshl_b32 s74, s74, 11
    s_add_u32 s75, s75, s74
    s_add_u32 s75, s75, 0
    buffer_load_dword v255, v242, s[8:11], s75 offen
    v_mov_b32 v242, v240
    s_and_b32 s42, s2, 7
    s_lshr_b32 s43, s2, 3
    s_and_b32 s44, s43, 3
    s_lshr_b32 s30, s43, 2
    s_lshr_b32 s29, s44, 1
    s_lshl_b32 s45, s42, 2
    s_and_b32 s46, s44, 1
    s_lshl_b32 s46, s46, 1
    s_add_u32 s45, s45, s46
    s_lshr_b32 s46, s24, 2
    s_add_u32 s31, s45, s46
    s_and_b32 s47, s24, 3
    v_and_b32 v239, 15, v242
    v_lshlrev_b32 v233, 8, v239
    v_lshrrev_b32 v241, 4, v242
    v_xor_b32 v239, v241, v239
    v_lshl_add_u32 v233, v239, 4, v233
    v_lshlrev_b32 v239, 4, v239
    v_xor_b32 v243, 0, v239
    v_lshl_add_u32 v243, v241, 10, v243
    v_xor_b32 v244, 64, v239
    v_lshl_add_u32 v244, v241, 10, v244
    v_add_u32 v244, 3072, v244
    v_xor_b32 v245, 128, v239
    v_lshl_add_u32 v245, v241, 10, v245
    v_add_u32 v245, 6144, v245
    v_xor_b32 v246, 192, v239
    v_lshl_add_u32 v246, v241, 10, v246
    v_add_u32 v246, 9216, v246
    v_lshrrev_b32 v241, 2, v242
    v_lshlrev_b32 v236, 13, v241
    v_lshrrev_b32 v241, 5, v242
    v_lshlrev_b32 v241, 1, v241
    v_and_b32 v239, 3, v242
    v_xor_b32 v241, v241, v239
    v_lshl_add_u32 v236, v241, 4, v236
    s_lshl_b32 s48, s31, 8
    s_lshl_b32 s49, s47, 6
    s_add_u32 s48, s48, s49
    v_add_u32 v236, s48, v236
    s_lshl_b32 s35, s24, 13
    s_add_u32 s35, s35, 98304
    v_lshrrev_b32 v241, 4, v242
    v_lshlrev_b32 v238, 9, v241
    v_bfe_u32 v241, v242, 2, 2
    v_lshl_add_u32 v238, v241, 6, v238
    v_bfe_u32 v241, v242, 4, 1
    v_lshl_add_u32 v238, v241, 5, v238
    v_and_b32 v241, 3, v242
    v_lshl_add_u32 v238, v241, 3, v238
    v_add_u32 v238, s35, v238
    v_xor_b32 v237, 32, v238
    v_lshrrev_b32 v241, 4, v242
    v_lshlrev_b32 v239, 10, v241
    v_and_b32 v241, 15, v242
    v_lshl_add_u32 v239, v241, 4, v239
    s_lshr_b32 s48, s2, 2
    s_lshl_b32 s48, s48, 15
    s_lshl_b32 s49, s24, 12
    s_add_u32 s48, s48, s49
    s_and_b32 s49, s2, 3
    s_lshl_b32 s49, s49, 8
    s_add_u32 s59, s48, s49
    v_and_b32 v241, 15, v242
    v_lshlrev_b32 v240, 8, v241
    v_lshrrev_b32 v241, 4, v242
    v_lshl_add_u32 v240, v241, 4, v240
    s_lshr_b32 s48, s24, 2
    s_lshl_b32 s48, s48, 12
    s_lshl_b32 s49, s47, 6
    s_add_u32 s48, s48, s49
    s_add_u32 s48, s48, 98304
    v_add_u32 v240, s48, v240
    s_lshr_b32 s48, s2, 2
    s_lshl_b32 s48, s48, 1
    s_lshr_b32 s49, s24, 2
    s_add_u32 s48, s48, s49
    s_lshl_b32 s48, s48, 2
    s_and_b32 s49, s2, 3
    s_lshl_b32 s49, s49, 9
    s_add_u32 s48, s48, s49
    s_add_u32 s48, s48, s47
    s_lshl_b32 s48, s48, 10
    s_add_u32 s33, s48, 33554432
    v_lshrrev_b32 v241, 3, v242
    v_lshlrev_b32 v247, 10, v241
    v_and_b32 v241, 7, v242
    v_lshl_add_u32 v247, v241, 4, v247
    s_lshl_b32 s48, s43, 16
    s_lshl_b32 s49, s24, 13
    s_add_u32 s48, s48, s49
    s_lshl_b32 s49, s42, 7
    s_add_u32 s55, s48, s49
    v_lshrrev_b32 v241, 4, v242
    v_lshlrev_b32 v252, 10, v241
    v_bfe_u32 v241, v242, 2, 2
    v_lshl_add_u32 v252, v241, 7, v252
    v_and_b32 v241, 3, v242
    v_lshl_add_u32 v252, v241, 3, v252
    s_lshr_b32 s48, s24, 2
    s_lshl_b32 s48, s48, 12
    s_lshl_b32 s49, s47, 5
    s_add_u32 s48, s48, s49
    s_add_u32 s48, s48, 106496
    v_add_u32 v252, s48, v252
    v_and_b32 v241, 15, v242
    v_lshlrev_b32 v253, 12, v241
    v_lshrrev_b32 v241, 4, v242
    v_lshl_add_u32 v253, v241, 4, v253
    s_lshl_b32 s48, s42, 18
    s_lshl_b32 s49, s47, 16
    s_add_u32 s48, s48, s49
    s_lshl_b32 s49, s43, 7
    s_add_u32 s48, s48, s49
    s_lshr_b32 s49, s24, 2
    s_lshl_b32 s49, s49, 6
    s_add_u32 s48, s48, s49
    s_add_u32 s58, s48, 35651584
    s_lshl_b32 s26, s30, 18
    s_and_b32 s48, s24, 1
    s_lshl_b32 s48, s48, 14
    s_add_u32 s26, s26, s48
    s_lshr_b32 s34, s24, 1
    s_lshl_b32 s48, s34, 15
    s_add_u32 s52, s26, s48
    s_and_b32 s48, s34, 1
    s_lshl_b32 s48, s48, 15
    s_lshr_b32 s49, s34, 1
    s_lshl_b32 s49, s49, 8
    s_add_u32 s48, s48, s49
    s_add_u32 s53, s26, s48
    s_lshl_b32 s48, s34, 8
    s_add_u32 s54, s26, s48
    s_lshl_b32 s27, s31, 19
    s_lshl_b32 s48, s30, 16
    s_add_u32 s27, s27, s48
    s_lshl_b32 s48, s47, 11
    s_add_u32 s27, s27, s48
    s_lshl_b32 s48, s29, 24
    s_add_u32 s27, s27, s48
    s_lshl_b32 s28, s24, 12
    s_waitcnt lgkmcnt(0)
    s_mov_b32 s8, s4
    s_mov_b32 s9, s5
    s_mov_b32 s10, 0x200000
    s_mov_b32 s11, 0x00020000
    s_cmp_eq_u32 s29, 0
    s_cselect_b32 s12, s36, s38
    s_cselect_b32 s13, s37, s39
    s_mov_b32 s14, 0x400000
    s_mov_b32 s15, 0x00020000
    s_mov_b32 s16, s6
    s_mov_b32 s17, s7
    s_mov_b32 s18, 0x10000000
    s_mov_b32 s19, 0x00020000
    s_mov_b32 s20, s40
    s_mov_b32 s21, s41
    s_mov_b32 s22, 0x200000
    s_mov_b32 s23, 0x00020000
    s_mov_b32 s44, s56
    s_mov_b32 s45, s57
    s_mov_b32 s46, 0x200000
    s_mov_b32 s47, 0x00020000
    s_mov_b32 s62, 0x400000
    s_mov_b32 s63, 0x00020000
    s_add_u32 s25, s53, 0
    s_add_u32 m0, s28, 0
    s_nop 0
    buffer_load_dwordx4 v243, s[8:11], s25 offen offset:0 lds
    s_add_u32 m0, s28, 0
    s_nop 0
    buffer_load_dwordx4 v244, s[8:11], s25 offen offset:1024 lds
    s_add_u32 m0, s28, 0
    s_nop 0
    buffer_load_dwordx4 v245, s[8:11], s25 offen offset:2048 lds
    s_add_u32 m0, s28, 0
    s_nop 0
    buffer_load_dwordx4 v246, s[8:11], s25 offen offset:3072 lds
    s_add_u32 m0, s35, 0
    s_mov_b32 s32, 0
    buffer_load_dwordx4 v236, s[12:15], s32 offen lds
    s_add_u32 m0, s35, 1024
    s_mov_b32 s32, 131072
    buffer_load_dwordx4 v236, s[12:15], s32 offen lds
    s_add_u32 m0, s35, 2048
    s_mov_b32 s32, 262144
    buffer_load_dwordx4 v236, s[12:15], s32 offen lds
    s_add_u32 m0, s35, 3072
    s_mov_b32 s32, 393216
    buffer_load_dwordx4 v236, s[12:15], s32 offen lds
    s_add_u32 m0, s35, 4096
    s_mov_b32 s32, 524288
    buffer_load_dwordx4 v236, s[12:15], s32 offen lds
    s_add_u32 m0, s35, 5120
    s_mov_b32 s32, 655360
    buffer_load_dwordx4 v236, s[12:15], s32 offen lds
    s_add_u32 m0, s35, 6144
    s_mov_b32 s32, 786432
    buffer_load_dwordx4 v236, s[12:15], s32 offen lds
    s_add_u32 m0, s35, 7168
    s_mov_b32 s32, 917504
    buffer_load_dwordx4 v236, s[12:15], s32 offen lds
    s_waitcnt vmcnt(8)
    s_barrier
    s_lshr_b32 s74, s2, 3
    s_lshl_b32 s74, s74, 3
    s_add_u32 s74, s74, s24
    s_cmp_lt_u32 s74, 128
    s_cselect_b32 s64, s36, s38
    s_cselect_b32 s65, s37, s39
    s_mov_b32 s66, 0x400000
    s_mov_b32 s67, 0x00020000
    v_bfe_u32 v241, v232, 7, 1
    v_lshlrev_b32 v241, 13, v241
    v_bfe_u32 v242, v232, 4, 3
    v_lshl_add_u32 v241, v242, 7, v241
    s_and_b32 s75, s74, 127
    s_lshl_b32 s75, s75, 14
    s_and_b32 s74, s2, 7
    s_lshl_b32 s74, s74, 10
    s_add_u32 s75, s75, s74
    s_add_u32 s75, s75, 2097152
    buffer_load_dword v251, v241, s[64:67], s75 offen
    s_cmp_eq_u32 s29, 1
    s_cbranch_scc1 k1_kernel_vpart
    s_waitcnt vmcnt(7)
    ds_read_b64_tr_b16 v[0:1], v238 offset:0
    ds_read_b64_tr_b16 v[2:3], v238 offset:256
    ds_read_b64_tr_b16 v[4:5], v237 offset:0
    ds_read_b64_tr_b16 v[6:7], v237 offset:256
    v_xor_b32 v235, 0, v233
    ds_read_b128 v[192:195], v235 offset:0
    s_waitcnt lgkmcnt(0)
    v_mfma_f32_16x16x32_bf16 v[128:131], v[0:3], v[192:195], 0
    v_mfma_f32_16x16x32_bf16 v[132:135], v[4:7], v[192:195], 0
    ds_read_b128 v[196:199], v235 offset:4096
    ds_read_b128 v[200:203], v235 offset:8192
    ds_read_b128 v[204:207], v235 offset:12288
    v_xor_b32 v234, 64, v233
    ds_read_b128 v[208:211], v234 offset:0
    ds_read_b128 v[212:215], v234 offset:4096
    ds_read_b128 v[216:219], v234 offset:8192
    s_waitcnt vmcnt(5)
    ds_read_b64_tr_b16 v[8:9], v238 offset:2048
    ds_read_b64_tr_b16 v[10:11], v238 offset:2304
    ds_read_b64_tr_b16 v[12:13], v237 offset:2048
    ds_read_b64_tr_b16 v[14:15], v237 offset:2304
    s_waitcnt lgkmcnt(9)
    v_mfma_f32_16x16x32_bf16 v[136:139], v[0:3], v[196:199], 0
    v_mfma_f32_16x16x32_bf16 v[140:143], v[4:7], v[196:199], 0
    ds_read_b128 v[220:223], v234 offset:12288
    s_waitcnt lgkmcnt(9)
    v_mfma_f32_16x16x32_bf16 v[144:147], v[0:3], v[200:203], 0
    v_mfma_f32_16x16x32_bf16 v[148:151], v[4:7], v[200:203], 0
    v_xor_b32 v235, 128, v233
    ds_read_b128 v[192:195], v235 offset:0
    s_add_u32 m0, s35, 0
    s_mov_b32 s32, 1048576
    buffer_load_dwordx4 v236, s[12:15], s32 offen lds
    s_add_u32 m0, s35, 1024
    s_mov_b32 s32, 1179648
    buffer_load_dwordx4 v236, s[12:15], s32 offen lds
    s_add_u32 s25, s53, 512
    s_waitcnt lgkmcnt(9)
    v_mfma_f32_16x16x32_bf16 v[152:155], v[0:3], v[204:207], 0
    v_mfma_f32_16x16x32_bf16 v[156:159], v[4:7], v[204:207], 0
    ds_read_b128 v[196:199], v235 offset:4096
    s_add_u32 m0, s28, 32768
    s_nop 0
    buffer_load_dwordx4 v243, s[8:11], s25 offen offset:0 lds
    s_waitcnt lgkmcnt(5)
    v_mfma_f32_16x16x32_bf16 v[128:131], v[8:11], v[208:211], v[128:131]
    s_waitcnt lgkmcnt(3)
    v_mfma_f32_16x16x32_bf16 v[132:135], v[12:15], v[208:211], v[132:135]
    ds_read_b128 v[200:203], v235 offset:8192
    s_waitcnt vmcnt(6)
    ds_read_b64_tr_b16 v[16:17], v238 offset:4096
    ds_read_b64_tr_b16 v[18:19], v238 offset:4352
    ds_read_b64_tr_b16 v[20:21], v237 offset:4096
    ds_read_b64_tr_b16 v[22:23], v237 offset:4352
    s_add_u32 m0, s28, 32768
    s_nop 0
    buffer_load_dwordx4 v244, s[8:11], s25 offen offset:1024 lds
    v_mfma_f32_16x16x32_bf16 v[136:139], v[8:11], v[212:215], v[136:139]
    v_mfma_f32_16x16x32_bf16 v[140:143], v[12:15], v[212:215], v[140:143]
    ds_read_b128 v[204:207], v235 offset:12288
    s_add_u32 m0, s28, 32768
    s_nop 0
    buffer_load_dwordx4 v245, s[8:11], s25 offen offset:2048 lds
    v_mfma_f32_16x16x32_bf16 v[144:147], v[8:11], v[216:219], v[144:147]
    v_mfma_f32_16x16x32_bf16 v[148:151], v[12:15], v[216:219], v[148:151]
    v_xor_b32 v234, 192, v233
    ds_read_b128 v[208:211], v234 offset:0
    s_add_u32 m0, s35, 2048
    s_mov_b32 s32, 1310720
    buffer_load_dwordx4 v236, s[12:15], s32 offen lds
    s_add_u32 m0, s35, 3072
    s_mov_b32 s32, 1441792
    buffer_load_dwordx4 v236, s[12:15], s32 offen lds
    s_add_u32 m0, s28, 32768
    s_nop 0
    buffer_load_dwordx4 v246, s[8:11], s25 offen offset:3072 lds
    s_waitcnt lgkmcnt(9)
    v_mfma_f32_16x16x32_bf16 v[152:155], v[8:11], v[220:223], v[152:155]
    v_mfma_f32_16x16x32_bf16 v[156:159], v[12:15], v[220:223], v[156:159]
    ds_read_b128 v[212:215], v234 offset:4096
    s_waitcnt lgkmcnt(5)
    v_mfma_f32_16x16x32_bf16 v[128:131], v[16:19], v[192:195], v[128:131]
    s_waitcnt lgkmcnt(3)
    v_mfma_f32_16x16x32_bf16 v[132:135], v[20:23], v[192:195], v[132:135]
    ds_read_b128 v[216:219], v234 offset:8192
    s_waitcnt vmcnt(9)
    ds_read_b64_tr_b16 v[24:25], v238 offset:6144
    ds_read_b64_tr_b16 v[26:27], v238 offset:6400
    ds_read_b64_tr_b16 v[28:29], v237 offset:6144
    ds_read_b64_tr_b16 v[30:31], v237 offset:6400
    s_lshr_b32 s74, s2, 3
    s_lshl_b32 s74, s74, 3
    s_add_u32 s74, s74, s24
    v_mfma_f32_16x16x32_bf16 v[136:139], v[16:19], v[196:199], v[136:139]
    v_mfma_f32_16x16x32_bf16 v[140:143], v[20:23], v[196:199], v[140:143]
    ds_read_b128 v[220:223], v234 offset:12288
    v_mfma_f32_16x16x32_bf16 v[144:147], v[16:19], v[200:203], v[144:147]
    v_mfma_f32_16x16x32_bf16 v[148:151], v[20:23], v[200:203], v[148:151]
    v_xor_b32 v235, 0, v233
    ds_read_b128 v[192:195], v235 offset:16384
    s_add_u32 m0, s35, 4096
    s_mov_b32 s32, 1572864
    buffer_load_dwordx4 v236, s[12:15], s32 offen lds
    s_add_u32 m0, s35, 5120
    s_mov_b32 s32, 1703936
    buffer_load_dwordx4 v236, s[12:15], s32 offen lds
    s_waitcnt lgkmcnt(9)
    v_mfma_f32_16x16x32_bf16 v[152:155], v[16:19], v[204:207], v[152:155]
    v_mfma_f32_16x16x32_bf16 v[156:159], v[20:23], v[204:207], v[156:159]
    ds_read_b128 v[196:199], v235 offset:20480
    s_and_b32 s75, s2, 7
    s_mul_i32 s75, s75, 37
    s_add_u32 s74, s74, s75
    s_and_b32 s74, s74, 255
    s_waitcnt lgkmcnt(5)
    v_mfma_f32_16x16x32_bf16 v[128:131], v[24:27], v[208:211], v[128:131]
    s_waitcnt lgkmcnt(3)
    v_mfma_f32_16x16x32_bf16 v[132:135], v[28:31], v[208:211], v[132:135]
    ds_read_b128 v[200:203], v235 offset:24576
    s_waitcnt vmcnt(8)
    ds_read_b64_tr_b16 v[32:33], v238 offset:0
    ds_read_b64_tr_b16 v[34:35], v238 offset:256
    ds_read_b64_tr_b16 v[36:37], v237 offset:0
    ds_read_b64_tr_b16 v[38:39], v237 offset:256
    v_mfma_f32_16x16x32_bf16 v[136:139], v[24:27], v[212:215], v[136:139]
    v_mfma_f32_16x16x32_bf16 v[140:143], v[28:31], v[212:215], v[140:143]
    ds_read_b128 v[204:207], v235 offset:28672
    v_mfma_f32_16x16x32_bf16 v[144:147], v[24:27], v[216:219], v[144:147]
    v_mfma_f32_16x16x32_bf16 v[148:151], v[28:31], v[216:219], v[148:151]
    v_xor_b32 v234, 64, v233
    ds_read_b128 v[208:211], v234 offset:16384
    s_add_u32 m0, s35, 6144
    s_mov_b32 s32, 1835008
    buffer_load_dwordx4 v236, s[12:15], s32 offen lds
    s_add_u32 m0, s35, 7168
    s_mov_b32 s32, 1966080
    buffer_load_dwordx4 v236, s[12:15], s32 offen lds
    s_waitcnt lgkmcnt(9)
    v_mfma_f32_16x16x32_bf16 v[152:155], v[24:27], v[220:223], v[152:155]
    v_mfma_f32_16x16x32_bf16 v[156:159], v[28:31], v[220:223], v[156:159]
    ds_read_b128 v[212:215], v234 offset:20480
    v_and_b32 v242, 0xf0, v232
    v_lshlrev_b32 v242, 3, v242
    s_waitcnt lgkmcnt(5)
    v_mfma_f32_16x16x32_bf16 v[128:131], v[32:35], v[192:195], v[128:131]
    s_waitcnt lgkmcnt(3)
    v_mfma_f32_16x16x32_bf16 v[132:135], v[36:39], v[192:195], v[132:135]
    ds_read_b128 v[216:219], v234 offset:24576
    s_waitcnt vmcnt(5)
    ds_read_b64_tr_b16 v[40:41], v238 offset:2048
    ds_read_b64_tr_b16 v[42:43], v238 offset:2304
    ds_read_b64_tr_b16 v[44:45], v237 offset:2048
    ds_read_b64_tr_b16 v[46:47], v237 offset:2304
    v_mfma_f32_16x16x32_bf16 v[136:139], v[32:35], v[196:199], v[136:139]
    v_mfma_f32_16x16x32_bf16 v[140:143], v[36:39], v[196:199], v[140:143]
    ds_read_b128 v[220:223], v234 offset:28672
    v_mfma_f32_16x16x32_bf16 v[144:147], v[32:35], v[200:203], v[144:147]
    v_mfma_f32_16x16x32_bf16 v[148:151], v[36:39], v[200:203], v[148:151]
    v_xor_b32 v235, 128, v233
    ds_read_b128 v[192:195], v235 offset:16384
    s_add_u32 m0, s35, 0
    s_mov_b32 s32, 2097152
    buffer_load_dwordx4 v236, s[12:15], s32 offen lds
    s_add_u32 m0, s35, 1024
    s_mov_b32 s32, 2228224
    buffer_load_dwordx4 v236, s[12:15], s32 offen lds
    s_lshr_b32 s75, s74, 5
    s_lshl_b32 s75, s75, 18
    s_and_b32 s74, s74, 31
    s_lshl_b32 s74, s74, 11
    s_add_u32 s75, s75, s74
    s_add_u32 s75, s75, 65536
    s_waitcnt lgkmcnt(9)
    v_mfma_f32_16x16x32_bf16 v[152:155], v[32:35], v[204:207], v[152:155]
    v_mfma_f32_16x16x32_bf16 v[156:159], v[36:39], v[204:207], v[156:159]
    ds_read_b128 v[196:199], v235 offset:20480
    s_waitcnt lgkmcnt(5)
    v_mfma_f32_16x16x32_bf16 v[128:131], v[40:43], v[208:211], v[128:131]
    s_waitcnt lgkmcnt(3)
    v_mfma_f32_16x16x32_bf16 v[132:135], v[44:47], v[208:211], v[132:135]
    ds_read_b128 v[200:203], v235 offset:24576
    s_waitcnt vmcnt(4)
    ds_read_b64_tr_b16 v[48:49], v238 offset:4096
    ds_read_b64_tr_b16 v[50:51], v238 offset:4352
    ds_read_b64_tr_b16 v[52:53], v237 offset:4096
    ds_read_b64_tr_b16 v[54:55], v237 offset:4352
    v_mfma_f32_16x16x32_bf16 v[136:139], v[40:43], v[212:215], v[136:139]
    v_mfma_f32_16x16x32_bf16 v[140:143], v[44:47], v[212:215], v[140:143]
    ds_read_b128 v[204:207], v235 offset:28672
    v_mfma_f32_16x16x32_bf16 v[144:147], v[40:43], v[216:219], v[144:147]
    v_mfma_f32_16x16x32_bf16 v[148:151], v[44:47], v[216:219], v[148:151]
    v_xor_b32 v234, 192, v233
    ds_read_b128 v[208:211], v234 offset:16384
    s_add_u32 m0, s35, 2048
    s_mov_b32 s32, 2359296
    buffer_load_dwordx4 v236, s[12:15], s32 offen lds
    s_add_u32 m0, s35, 3072
    s_mov_b32 s32, 2490368
    buffer_load_dwordx4 v236, s[12:15], s32 offen lds
    buffer_load_dword v255, v242, s[8:11], s75 offen
    s_waitcnt lgkmcnt(9)
    v_mfma_f32_16x16x32_bf16 v[152:155], v[40:43], v[220:223], v[152:155]
    v_mfma_f32_16x16x32_bf16 v[156:159], v[44:47], v[220:223], v[156:159]
    ds_read_b128 v[212:215], v234 offset:20480
    s_waitcnt lgkmcnt(5)
    v_mfma_f32_16x16x32_bf16 v[128:131], v[48:51], v[192:195], v[128:131]
    s_waitcnt lgkmcnt(3)
    v_mfma_f32_16x16x32_bf16 v[132:135], v[52:55], v[192:195], v[132:135]
    ds_read_b128 v[216:219], v234 offset:24576
    s_waitcnt vmcnt(5)
    ds_read_b64_tr_b16 v[56:57], v238 offset:6144
    ds_read_b64_tr_b16 v[58:59], v238 offset:6400
    ds_read_b64_tr_b16 v[60:61], v237 offset:6144
    ds_read_b64_tr_b16 v[62:63], v237 offset:6400
    v_mfma_f32_16x16x32_bf16 v[136:139], v[48:51], v[196:199], v[136:139]
    v_mfma_f32_16x16x32_bf16 v[140:143], v[52:55], v[196:199], v[140:143]
    ds_read_b128 v[220:223], v234 offset:28672
    s_barrier
    v_mfma_f32_16x16x32_bf16 v[144:147], v[48:51], v[200:203], v[144:147]
    v_mfma_f32_16x16x32_bf16 v[148:151], v[52:55], v[200:203], v[148:151]
    v_xor_b32 v235, 0, v233
    ds_read_b128 v[192:195], v235 offset:32768
    s_add_u32 m0, s35, 4096
    s_mov_b32 s32, 2621440
    buffer_load_dwordx4 v236, s[12:15], s32 offen lds
    s_add_u32 m0, s35, 5120
    s_mov_b32 s32, 2752512
    buffer_load_dwordx4 v236, s[12:15], s32 offen lds
    s_add_u32 s25, s54, 65536
    s_waitcnt lgkmcnt(9)
    v_mfma_f32_16x16x32_bf16 v[152:155], v[48:51], v[204:207], v[152:155]
    v_mfma_f32_16x16x32_bf16 v[156:159], v[52:55], v[204:207], v[156:159]
    ds_read_b128 v[196:199], v235 offset:36864
    s_add_u32 m0, s28, 65536
    s_nop 0
    buffer_load_dwordx4 v243, s[8:11], s25 offen offset:0 lds
    s_waitcnt lgkmcnt(5)
    v_mfma_f32_16x16x32_bf16 v[128:131], v[56:59], v[208:211], v[128:131]
    s_waitcnt lgkmcnt(3)
    v_mfma_f32_16x16x32_bf16 v[132:135], v[60:63], v[208:211], v[132:135]
    ds_read_b128 v[200:203], v235 offset:40960
    s_waitcnt vmcnt(6)
    ds_read_b64_tr_b16 v[64:65], v238 offset:0
    ds_read_b64_tr_b16 v[66:67], v238 offset:256
    ds_read_b64_tr_b16 v[68:69], v237 offset:0
    ds_read_b64_tr_b16 v[70:71], v237 offset:256
    s_add_u32 m0, s28, 65536
    s_nop 0
    buffer_load_dwordx4 v244, s[8:11], s25 offen offset:1024 lds
    v_mfma_f32_16x16x32_bf16 v[136:139], v[56:59], v[212:215], v[136:139]
    v_mfma_f32_16x16x32_bf16 v[140:143], v[60:63], v[212:215], v[140:143]
    ds_read_b128 v[204:207], v235 offset:45056
    s_add_u32 m0, s28, 65536
    s_nop 0
    buffer_load_dwordx4 v245, s[8:11], s25 offen offset:2048 lds
    v_mfma_f32_16x16x32_bf16 v[144:147], v[56:59], v[216:219], v[144:147]
    v_mfma_f32_16x16x32_bf16 v[148:151], v[60:63], v[216:219], v[148:151]
    v_xor_b32 v234, 64, v233
    ds_read_b128 v[208:211], v234 offset:32768
    s_add_u32 m0, s35, 6144
    s_mov_b32 s32, 2883584
    buffer_load_dwordx4 v236, s[12:15], s32 offen lds
    s_add_u32 m0, s35, 7168
    s_mov_b32 s32, 3014656
    buffer_load_dwordx4 v236, s[12:15], s32 offen lds
    s_add_u32 m0, s28, 65536
    s_nop 0
    buffer_load_dwordx4 v246, s[8:11], s25 offen offset:3072 lds
    s_waitcnt lgkmcnt(9)
    v_mfma_f32_16x16x32_bf16 v[152:155], v[56:59], v[220:223], v[152:155]
    v_mfma_f32_16x16x32_bf16 v[156:159], v[60:63], v[220:223], v[156:159]
    ds_read_b128 v[212:215], v234 offset:36864
    s_waitcnt lgkmcnt(5)
    v_mfma_f32_16x16x32_bf16 v[128:131], v[64:67], v[192:195], v[128:131]
    s_waitcnt lgkmcnt(3)
    v_mfma_f32_16x16x32_bf16 v[132:135], v[68:71], v[192:195], v[132:135]
    ds_read_b128 v[216:219], v234 offset:40960
    s_waitcnt vmcnt(9)
    ds_read_b64_tr_b16 v[72:73], v238 offset:2048
    ds_read_b64_tr_b16 v[74:75], v238 offset:2304
    ds_read_b64_tr_b16 v[76:77], v237 offset:2048
    ds_read_b64_tr_b16 v[78:79], v237 offset:2304
    v_mfma_f32_16x16x32_bf16 v[136:139], v[64:67], v[196:199], v[136:139]
    v_mfma_f32_16x16x32_bf16 v[140:143], v[68:71], v[196:199], v[140:143]
    ds_read_b128 v[220:223], v234 offset:45056
    v_mfma_f32_16x16x32_bf16 v[144:147], v[64:67], v[200:203], v[144:147]
    v_mfma_f32_16x16x32_bf16 v[148:151], v[68:71], v[200:203], v[148:151]
    v_xor_b32 v235, 128, v233
    ds_read_b128 v[192:195], v235 offset:32768
    s_add_u32 m0, s35, 0
    s_mov_b32 s32, 3145728
    buffer_load_dwordx4 v236, s[12:15], s32 offen lds
    s_add_u32 m0, s35, 1024
    s_mov_b32 s32, 3276800
    buffer_load_dwordx4 v236, s[12:15], s32 offen lds
    s_waitcnt lgkmcnt(9)
    v_mfma_f32_16x16x32_bf16 v[152:155], v[64:67], v[204:207], v[152:155]
    v_mfma_f32_16x16x32_bf16 v[156:159], v[68:71], v[204:207], v[156:159]
    ds_read_b128 v[196:199], v235 offset:36864
    s_waitcnt lgkmcnt(5)
    v_mfma_f32_16x16x32_bf16 v[128:131], v[72:75], v[208:211], v[128:131]
    s_waitcnt lgkmcnt(3)
    v_mfma_f32_16x16x32_bf16 v[132:135], v[76:79], v[208:211], v[132:135]
    ds_read_b128 v[200:203], v235 offset:40960
    s_waitcnt vmcnt(8)
    ds_read_b64_tr_b16 v[80:81], v238 offset:4096
    ds_read_b64_tr_b16 v[82:83], v238 offset:4352
    ds_read_b64_tr_b16 v[84:85], v237 offset:4096
    ds_read_b64_tr_b16 v[86:87], v237 offset:4352
    v_mfma_f32_16x16x32_bf16 v[136:139], v[72:75], v[212:215], v[136:139]
    v_mfma_f32_16x16x32_bf16 v[140:143], v[76:79], v[212:215], v[140:143]
    ds_read_b128 v[204:207], v235 offset:45056
    v_mfma_f32_16x16x32_bf16 v[144:147], v[72:75], v[216:219], v[144:147]
    v_mfma_f32_16x16x32_bf16 v[148:151], v[76:79], v[216:219], v[148:151]
    v_xor_b32 v234, 192, v233
    ds_read_b128 v[208:211], v234 offset:32768
    s_add_u32 m0, s35, 2048
    s_mov_b32 s32, 3407872
    buffer_load_dwordx4 v236, s[12:15], s32 offen lds
    s_add_u32 m0, s35, 3072
    s_mov_b32 s32, 3538944
    buffer_load_dwordx4 v236, s[12:15], s32 offen lds
    s_waitcnt lgkmcnt(9)
    v_mfma_f32_16x16x32_bf16 v[152:155], v[72:75], v[220:223], v[152:155]
    v_mfma_f32_16x16x32_bf16 v[156:159], v[76:79], v[220:223], v[156:159]
    ds_read_b128 v[212:215], v234 offset:36864
    s_waitcnt lgkmcnt(5)
    v_mfma_f32_16x16x32_bf16 v[128:131], v[80:83], v[192:195], v[128:131]
    s_waitcnt lgkmcnt(3)
    v_mfma_f32_16x16x32_bf16 v[132:135], v[84:87], v[192:195], v[132:135]
    ds_read_b128 v[216:219], v234 offset:40960
    s_waitcnt vmcnt(5)
    ds_read_b64_tr_b16 v[88:89], v238 offset:6144
    ds_read_b64_tr_b16 v[90:91], v238 offset:6400
    ds_read_b64_tr_b16 v[92:93], v237 offset:6144
    ds_read_b64_tr_b16 v[94:95], v237 offset:6400
    s_lshr_b32 s74, s2, 3
    s_lshl_b32 s74, s74, 3
    s_add_u32 s74, s74, s24
    v_mfma_f32_16x16x32_bf16 v[136:139], v[80:83], v[196:199], v[136:139]
    v_mfma_f32_16x16x32_bf16 v[140:143], v[84:87], v[196:199], v[140:143]
    ds_read_b128 v[220:223], v234 offset:45056
    v_mfma_f32_16x16x32_bf16 v[144:147], v[80:83], v[200:203], v[144:147]
    v_mfma_f32_16x16x32_bf16 v[148:151], v[84:87], v[200:203], v[148:151]
    v_xor_b32 v235, 0, v233
    ds_read_b128 v[192:195], v235 offset:49152
    s_add_u32 m0, s35, 4096
    s_mov_b32 s32, 3670016
    buffer_load_dwordx4 v236, s[12:15], s32 offen lds
    s_add_u32 m0, s35, 5120
    s_mov_b32 s32, 3801088
    buffer_load_dwordx4 v236, s[12:15], s32 offen lds
    s_waitcnt lgkmcnt(9)
    v_mfma_f32_16x16x32_bf16 v[152:155], v[80:83], v[204:207], v[152:155]
    v_mfma_f32_16x16x32_bf16 v[156:159], v[84:87], v[204:207], v[156:159]
    ds_read_b128 v[196:199], v235 offset:53248
    s_and_b32 s75, s2, 7
    s_mul_i32 s75, s75, 37
    s_add_u32 s74, s74, s75
    s_and_b32 s74, s74, 255
    s_waitcnt lgkmcnt(5)
    v_mfma_f32_16x16x32_bf16 v[128:131], v[88:91], v[208:211], v[128:131]
    s_waitcnt lgkmcnt(3)
    v_mfma_f32_16x16x32_bf16 v[132:135], v[92:95], v[208:211], v[132:135]
    ds_read_b128 v[200:203], v235 offset:57344
    s_waitcnt vmcnt(4)
    ds_read_b64_tr_b16 v[96:97], v238 offset:0
    ds_read_b64_tr_b16 v[98:99], v238 offset:256
    ds_read_b64_tr_b16 v[100:101], v237 offset:0
    ds_read_b64_tr_b16 v[102:103], v237 offset:256
    v_mfma_f32_16x16x32_bf16 v[136:139], v[88:91], v[212:215], v[136:139]
    v_mfma_f32_16x16x32_bf16 v[140:143], v[92:95], v[212:215], v[140:143]
    ds_read_b128 v[204:207], v235 offset:61440
    v_mfma_f32_16x16x32_bf16 v[144:147], v[88:91], v[216:219], v[144:147]
    v_mfma_f32_16x16x32_bf16 v[148:151], v[92:95], v[216:219], v[148:151]
    v_xor_b32 v234, 64, v233
    ds_read_b128 v[208:211], v234 offset:49152
    s_add_u32 m0, s35, 6144
    s_mov_b32 s32, 3932160
    buffer_load_dwordx4 v236, s[12:15], s32 offen lds
    s_add_u32 m0, s35, 7168
    s_mov_b32 s32, 4063232
    buffer_load_dwordx4 v236, s[12:15], s32 offen lds
    s_waitcnt lgkmcnt(9)
    v_mfma_f32_16x16x32_bf16 v[152:155], v[88:91], v[220:223], v[152:155]
    v_mfma_f32_16x16x32_bf16 v[156:159], v[92:95], v[220:223], v[156:159]
    ds_read_b128 v[212:215], v234 offset:53248
    v_and_b32 v242, 0xf0, v232
    v_lshlrev_b32 v242, 3, v242
    s_waitcnt lgkmcnt(5)
    v_mfma_f32_16x16x32_bf16 v[128:131], v[96:99], v[192:195], v[128:131]
    s_waitcnt lgkmcnt(3)
    v_mfma_f32_16x16x32_bf16 v[132:135], v[100:103], v[192:195], v[132:135]
    ds_read_b128 v[216:219], v234 offset:57344
    s_waitcnt vmcnt(4)
    ds_read_b64_tr_b16 v[104:105], v238 offset:2048
    ds_read_b64_tr_b16 v[106:107], v238 offset:2304
    ds_read_b64_tr_b16 v[108:109], v237 offset:2048
    ds_read_b64_tr_b16 v[110:111], v237 offset:2304
    v_mfma_f32_16x16x32_bf16 v[136:139], v[96:99], v[196:199], v[136:139]
    v_mfma_f32_16x16x32_bf16 v[140:143], v[100:103], v[196:199], v[140:143]
    ds_read_b128 v[220:223], v234 offset:61440
    v_mfma_f32_16x16x32_bf16 v[144:147], v[96:99], v[200:203], v[144:147]
    v_mfma_f32_16x16x32_bf16 v[148:151], v[100:103], v[200:203], v[148:151]
    v_xor_b32 v235, 128, v233
    ds_read_b128 v[192:195], v235 offset:49152
    s_lshr_b32 s75, s74, 5
    s_lshl_b32 s75, s75, 18
    s_and_b32 s74, s74, 31
    s_lshl_b32 s74, s74, 11
    s_add_u32 s75, s75, s74
    s_add_u32 s75, s75, 131072
    s_waitcnt lgkmcnt(9)
    v_mfma_f32_16x16x32_bf16 v[152:155], v[96:99], v[204:207], v[152:155]
    v_mfma_f32_16x16x32_bf16 v[156:159], v[100:103], v[204:207], v[156:159]
    ds_read_b128 v[196:199], v235 offset:53248
    s_waitcnt lgkmcnt(5)
    v_mfma_f32_16x16x32_bf16 v[128:131], v[104:107], v[208:211], v[128:131]
    s_waitcnt lgkmcnt(3)
    v_mfma_f32_16x16x32_bf16 v[132:135], v[108:111], v[208:211], v[132:135]
    ds_read_b128 v[200:203], v235 offset:57344
    s_waitcnt vmcnt(2)
    ds_read_b64_tr_b16 v[112:113], v238 offset:4096
    ds_read_b64_tr_b16 v[114:115], v238 offset:4352
    ds_read_b64_tr_b16 v[116:117], v237 offset:4096
    ds_read_b64_tr_b16 v[118:119], v237 offset:4352
    v_mfma_f32_16x16x32_bf16 v[136:139], v[104:107], v[212:215], v[136:139]
    v_mfma_f32_16x16x32_bf16 v[140:143], v[108:111], v[212:215], v[140:143]
    ds_read_b128 v[204:207], v235 offset:61440
    v_mfma_f32_16x16x32_bf16 v[144:147], v[104:107], v[216:219], v[144:147]
    v_mfma_f32_16x16x32_bf16 v[148:151], v[108:111], v[216:219], v[148:151]
    v_xor_b32 v234, 192, v233
    ds_read_b128 v[208:211], v234 offset:49152
    buffer_load_dword v255, v242, s[8:11], s75 offen
    s_waitcnt lgkmcnt(9)
    v_mfma_f32_16x16x32_bf16 v[152:155], v[104:107], v[220:223], v[152:155]
    v_mfma_f32_16x16x32_bf16 v[156:159], v[108:111], v[220:223], v[156:159]
    ds_read_b128 v[212:215], v234 offset:53248
    s_waitcnt lgkmcnt(5)
    v_mfma_f32_16x16x32_bf16 v[128:131], v[112:115], v[192:195], v[128:131]
    s_waitcnt lgkmcnt(3)
    v_mfma_f32_16x16x32_bf16 v[132:135], v[116:119], v[192:195], v[132:135]
    ds_read_b128 v[216:219], v234 offset:57344
    s_waitcnt vmcnt(1)
    ds_read_b64_tr_b16 v[120:121], v238 offset:6144
    ds_read_b64_tr_b16 v[122:123], v238 offset:6400
    ds_read_b64_tr_b16 v[124:125], v237 offset:6144
    ds_read_b64_tr_b16 v[126:127], v237 offset:6400
    v_mfma_f32_16x16x32_bf16 v[136:139], v[112:115], v[196:199], v[136:139]
    v_mfma_f32_16x16x32_bf16 v[140:143], v[116:119], v[196:199], v[140:143]
    ds_read_b128 v[220:223], v234 offset:61440
    s_barrier
    v_mfma_f32_16x16x32_bf16 v[144:147], v[112:115], v[200:203], v[144:147]
    v_mfma_f32_16x16x32_bf16 v[148:151], v[116:119], v[200:203], v[148:151]
    v_xor_b32 v235, 65536, v233
    ds_read_b128 v[192:195], v235 offset:0
    s_add_u32 s25, s54, 98304
    s_waitcnt lgkmcnt(9)
    v_mfma_f32_16x16x32_bf16 v[152:155], v[112:115], v[204:207], v[152:155]
    v_mfma_f32_16x16x32_bf16 v[156:159], v[116:119], v[204:207], v[156:159]
    ds_read_b128 v[196:199], v235 offset:4096
    s_add_u32 m0, s28, 0
    s_nop 0
    buffer_load_dwordx4 v243, s[8:11], s25 offen offset:0 lds
    s_waitcnt lgkmcnt(5)
    v_mfma_f32_16x16x32_bf16 v[128:131], v[120:123], v[208:211], v[128:131]
    s_waitcnt lgkmcnt(3)
    v_mfma_f32_16x16x32_bf16 v[132:135], v[124:127], v[208:211], v[132:135]
    ds_read_b128 v[200:203], v235 offset:8192
    s_add_u32 m0, s28, 0
    s_nop 0
    buffer_load_dwordx4 v244, s[8:11], s25 offen offset:1024 lds
    v_mfma_f32_16x16x32_bf16 v[136:139], v[120:123], v[212:215], v[136:139]
    v_mfma_f32_16x16x32_bf16 v[140:143], v[124:127], v[212:215], v[140:143]
    ds_read_b128 v[204:207], v235 offset:12288
    s_add_u32 m0, s28, 0
    s_nop 0
    buffer_load_dwordx4 v245, s[8:11], s25 offen offset:2048 lds
    v_mfma_f32_16x16x32_bf16 v[144:147], v[120:123], v[216:219], v[144:147]
    v_mfma_f32_16x16x32_bf16 v[148:151], v[124:127], v[216:219], v[148:151]
    ds_read_b128 v[208:211], v235 offset:16384
    s_add_u32 m0, s28, 0
    s_nop 0
    buffer_load_dwordx4 v246, s[8:11], s25 offen offset:3072 lds
    s_waitcnt lgkmcnt(5)
    v_mfma_f32_16x16x32_bf16 v[152:155], v[120:123], v[220:223], v[152:155]
    v_mfma_f32_16x16x32_bf16 v[156:159], v[124:127], v[220:223], v[156:159]
    ds_read_b128 v[212:215], v235 offset:20480
    s_waitcnt lgkmcnt(5)
    v_mfma_f32_16x16x32_bf16 v[160:163], v[0:3], v[192:195], 0
    v_mfma_f32_16x16x32_bf16 v[164:167], v[4:7], v[192:195], 0
    ds_read_b128 v[216:219], v235 offset:24576
    s_waitcnt lgkmcnt(5)
    v_mfma_f32_16x16x32_bf16 v[168:171], v[0:3], v[196:199], 0
    v_mfma_f32_16x16x32_bf16 v[172:175], v[4:7], v[196:199], 0
    ds_read_b128 v[220:223], v235 offset:28672
    s_waitcnt lgkmcnt(5)
    v_mfma_f32_16x16x32_bf16 v[160:163], v[32:35], v[200:203], v[160:163]
    v_mfma_f32_16x16x32_bf16 v[164:167], v[36:39], v[200:203], v[164:167]
    v_xor_b32 v234, 65600, v233
    ds_read_b128 v[192:195], v234 offset:0
    s_lshr_b32 s74, s2, 3
    s_lshl_b32 s74, s74, 3
    s_add_u32 s74, s74, s24
    s_and_b32 s75, s2, 7
    s_mul_i32 s75, s75, 37
    s_add_u32 s74, s74, s75
    s_and_b32 s74, s74, 255
    v_and_b32 v242, 0xf0, v232
    v_lshlrev_b32 v242, 3, v242
    s_lshr_b32 s75, s74, 5
    s_lshl_b32 s75, s75, 18
    s_and_b32 s74, s74, 31
    s_lshl_b32 s74, s74, 11
    s_add_u32 s75, s75, s74
    s_add_u32 s75, s75, 196608
    s_waitcnt lgkmcnt(5)
    v_mfma_f32_16x16x32_bf16 v[168:171], v[32:35], v[204:207], v[168:171]
    v_mfma_f32_16x16x32_bf16 v[172:175], v[36:39], v[204:207], v[172:175]
    ds_read_b128 v[196:199], v234 offset:4096
    s_waitcnt vmcnt(4)
    buffer_load_dword v255, v242, s[8:11], s75 offen
    v_cvt_pk_bf16_f32 v176, v128, v129
    v_cvt_pk_bf16_f32 v177, v130, v131
    s_waitcnt lgkmcnt(5)
    v_mfma_f32_16x16x32_bf16 v[160:163], v[64:67], v[208:211], v[160:163]
    v_mfma_f32_16x16x32_bf16 v[164:167], v[68:71], v[208:211], v[164:167]
    ds_read_b128 v[200:203], v234 offset:8192
    v_cvt_pk_bf16_f32 v178, v132, v133
    v_cvt_pk_bf16_f32 v179, v134, v135
    v_cvt_pk_bf16_f32 v180, v136, v137
    v_cvt_pk_bf16_f32 v181, v138, v139
    s_waitcnt lgkmcnt(5)
    v_mfma_f32_16x16x32_bf16 v[168:171], v[64:67], v[212:215], v[168:171]
    v_mfma_f32_16x16x32_bf16 v[172:175], v[68:71], v[212:215], v[172:175]
    ds_read_b128 v[204:207], v234 offset:12288
    v_cvt_pk_bf16_f32 v182, v140, v141
    v_cvt_pk_bf16_f32 v183, v142, v143
    v_cvt_pk_bf16_f32 v224, v144, v145
    s_waitcnt lgkmcnt(5)
    v_mfma_f32_16x16x32_bf16 v[160:163], v[96:99], v[216:219], v[160:163]
    v_mfma_f32_16x16x32_bf16 v[164:167], v[100:103], v[216:219], v[164:167]
    ds_read_b128 v[208:211], v234 offset:16384
    v_cvt_pk_bf16_f32 v225, v146, v147
    v_cvt_pk_bf16_f32 v226, v148, v149
    v_cvt_pk_bf16_f32 v227, v150, v151
    v_cvt_pk_bf16_f32 v228, v152, v153
    s_waitcnt lgkmcnt(5)
    v_mfma_f32_16x16x32_bf16 v[168:171], v[96:99], v[220:223], v[168:171]
    v_mfma_f32_16x16x32_bf16 v[172:175], v[100:103], v[220:223], v[172:175]
    ds_read_b128 v[212:215], v234 offset:20480
    v_cvt_pk_bf16_f32 v229, v154, v155
    v_cvt_pk_bf16_f32 v230, v156, v157
    v_cvt_pk_bf16_f32 v231, v158, v159
    s_waitcnt lgkmcnt(5)
    v_mfma_f32_16x16x32_bf16 v[160:163], v[8:11], v[192:195], v[160:163]
    v_mfma_f32_16x16x32_bf16 v[164:167], v[12:15], v[192:195], v[164:167]
    ds_read_b128 v[216:219], v234 offset:24576
    s_add_u32 s51, s27, 0
    buffer_store_dwordx4 v[176:179], v232, s[16:19], s51 offen sc1
    s_waitcnt lgkmcnt(5)
    v_mfma_f32_16x16x32_bf16 v[168:171], v[8:11], v[196:199], v[168:171]
    v_mfma_f32_16x16x32_bf16 v[172:175], v[12:15], v[196:199], v[172:175]
    ds_read_b128 v[220:223], v234 offset:28672
    s_waitcnt lgkmcnt(5)
    v_mfma_f32_16x16x32_bf16 v[160:163], v[40:43], v[200:203], v[160:163]
    v_mfma_f32_16x16x32_bf16 v[164:167], v[44:47], v[200:203], v[164:167]
    v_xor_b32 v235, 65664, v233
    ds_read_b128 v[192:195], v235 offset:0
    s_waitcnt lgkmcnt(5)
    v_mfma_f32_16x16x32_bf16 v[168:171], v[40:43], v[204:207], v[168:171]
    v_mfma_f32_16x16x32_bf16 v[172:175], v[44:47], v[204:207], v[172:175]
    ds_read_b128 v[196:199], v235 offset:4096
    s_waitcnt lgkmcnt(5)
    v_mfma_f32_16x16x32_bf16 v[160:163], v[72:75], v[208:211], v[160:163]
    v_mfma_f32_16x16x32_bf16 v[164:167], v[76:79], v[208:211], v[164:167]
    ds_read_b128 v[200:203], v235 offset:8192
    s_waitcnt lgkmcnt(5)
    v_mfma_f32_16x16x32_bf16 v[168:171], v[72:75], v[212:215], v[168:171]
    v_mfma_f32_16x16x32_bf16 v[172:175], v[76:79], v[212:215], v[172:175]
    ds_read_b128 v[204:207], v235 offset:12288
    s_waitcnt lgkmcnt(5)
    v_mfma_f32_16x16x32_bf16 v[160:163], v[104:107], v[216:219], v[160:163]
    v_mfma_f32_16x16x32_bf16 v[164:167], v[108:111], v[216:219], v[164:167]
    ds_read_b128 v[208:211], v235 offset:16384
    s_add_u32 s51, s27, 0
    buffer_store_dwordx4 v[180:183], v232, s[16:19], s51 offen offset:1024 sc1
    s_waitcnt lgkmcnt(5)
    v_mfma_f32_16x16x32_bf16 v[168:171], v[104:107], v[220:223], v[168:171]
    v_mfma_f32_16x16x32_bf16 v[172:175], v[108:111], v[220:223], v[172:175]
    ds_read_b128 v[212:215], v235 offset:20480
    s_waitcnt lgkmcnt(5)
    v_mfma_f32_16x16x32_bf16 v[160:163], v[16:19], v[192:195], v[160:163]
    v_mfma_f32_16x16x32_bf16 v[164:167], v[20:23], v[192:195], v[164:167]
    ds_read_b128 v[216:219], v235 offset:24576
    s_waitcnt lgkmcnt(5)
    v_mfma_f32_16x16x32_bf16 v[168:171], v[16:19], v[196:199], v[168:171]
    v_mfma_f32_16x16x32_bf16 v[172:175], v[20:23], v[196:199], v[172:175]
    ds_read_b128 v[220:223], v235 offset:28672
    s_waitcnt lgkmcnt(5)
    v_mfma_f32_16x16x32_bf16 v[160:163], v[48:51], v[200:203], v[160:163]
    v_mfma_f32_16x16x32_bf16 v[164:167], v[52:55], v[200:203], v[164:167]
    v_xor_b32 v234, 65728, v233
    ds_read_b128 v[192:195], v234 offset:0
    s_waitcnt lgkmcnt(5)
    v_mfma_f32_16x16x32_bf16 v[168:171], v[48:51], v[204:207], v[168:171]
    v_mfma_f32_16x16x32_bf16 v[172:175], v[52:55], v[204:207], v[172:175]
    ds_read_b128 v[196:199], v234 offset:4096
    s_waitcnt lgkmcnt(5)
    v_mfma_f32_16x16x32_bf16 v[160:163], v[80:83], v[208:211], v[160:163]
    v_mfma_f32_16x16x32_bf16 v[164:167], v[84:87], v[208:211], v[164:167]
    ds_read_b128 v[200:203], v234 offset:8192
    s_add_u32 s51, s27, 8192
    buffer_store_dwordx4 v[224:227], v232, s[16:19], s51 offen sc1
    s_waitcnt lgkmcnt(5)
    v_mfma_f32_16x16x32_bf16 v[168:171], v[80:83], v[212:215], v[168:171]
    v_mfma_f32_16x16x32_bf16 v[172:175], v[84:87], v[212:215], v[172:175]
    ds_read_b128 v[204:207], v234 offset:12288
    s_waitcnt lgkmcnt(5)
    v_mfma_f32_16x16x32_bf16 v[160:163], v[112:115], v[216:219], v[160:163]
    v_mfma_f32_16x16x32_bf16 v[164:167], v[116:119], v[216:219], v[164:167]
    ds_read_b128 v[208:211], v234 offset:16384
    s_waitcnt lgkmcnt(5)
    v_mfma_f32_16x16x32_bf16 v[168:171], v[112:115], v[220:223], v[168:171]
    v_mfma_f32_16x16x32_bf16 v[172:175], v[116:119], v[220:223], v[172:175]
    ds_read_b128 v[212:215], v234 offset:20480
    s_waitcnt lgkmcnt(5)
    v_mfma_f32_16x16x32_bf16 v[160:163], v[24:27], v[192:195], v[160:163]
    v_mfma_f32_16x16x32_bf16 v[164:167], v[28:31], v[192:195], v[164:167]
    ds_read_b128 v[216:219], v234 offset:24576
    s_waitcnt lgkmcnt(5)
    v_mfma_f32_16x16x32_bf16 v[168:171], v[24:27], v[196:199], v[168:171]
    v_mfma_f32_16x16x32_bf16 v[172:175], v[28:31], v[196:199], v[172:175]
    ds_read_b128 v[220:223], v234 offset:28672
    s_waitcnt vmcnt(4)
    s_barrier
    s_waitcnt lgkmcnt(5)
    v_mfma_f32_16x16x32_bf16 v[160:163], v[56:59], v[200:203], v[160:163]
    v_mfma_f32_16x16x32_bf16 v[164:167], v[60:63], v[200:203], v[164:167]
    v_xor_b32 v235, 0, v233
    ds_read_b128 v[192:195], v235 offset:0
    s_add_u32 s25, s54, 131072
    s_waitcnt lgkmcnt(5)
    v_mfma_f32_16x16x32_bf16 v[168:171], v[56:59], v[204:207], v[168:171]
    v_mfma_f32_16x16x32_bf16 v[172:175], v[60:63], v[204:207], v[172:175]
    ds_read_b128 v[196:199], v235 offset:4096
    s_add_u32 m0, s28, 32768
    s_nop 0
    buffer_load_dwordx4 v243, s[8:11], s25 offen offset:0 lds
    s_waitcnt lgkmcnt(5)
    v_mfma_f32_16x16x32_bf16 v[160:163], v[88:91], v[208:211], v[160:163]
    v_mfma_f32_16x16x32_bf16 v[164:167], v[92:95], v[208:211], v[164:167]
    ds_read_b128 v[200:203], v235 offset:8192
    s_add_u32 m0, s28, 32768
    s_nop 0
    buffer_load_dwordx4 v244, s[8:11], s25 offen offset:1024 lds
    s_waitcnt lgkmcnt(5)
    v_mfma_f32_16x16x32_bf16 v[168:171], v[88:91], v[212:215], v[168:171]
    v_mfma_f32_16x16x32_bf16 v[172:175], v[92:95], v[212:215], v[172:175]
    ds_read_b128 v[204:207], v235 offset:12288
    s_add_u32 m0, s28, 32768
    s_nop 0
    buffer_load_dwordx4 v245, s[8:11], s25 offen offset:2048 lds
    s_waitcnt lgkmcnt(5)
    v_mfma_f32_16x16x32_bf16 v[160:163], v[120:123], v[216:219], v[160:163]
    v_mfma_f32_16x16x32_bf16 v[164:167], v[124:127], v[216:219], v[164:167]
    ds_read_b128 v[208:211], v235 offset:16384
    s_add_u32 m0, s28, 32768
    s_nop 0
    buffer_load_dwordx4 v246, s[8:11], s25 offen offset:3072 lds
    s_waitcnt lgkmcnt(5)
    v_mfma_f32_16x16x32_bf16 v[168:171], v[120:123], v[220:223], v[168:171]
    v_mfma_f32_16x16x32_bf16 v[172:175], v[124:127], v[220:223], v[172:175]
    ds_read_b128 v[212:215], v235 offset:20480
    s_waitcnt lgkmcnt(5)
    v_mfma_f32_16x16x32_bf16 v[128:131], v[0:3], v[192:195], 0
    v_mfma_f32_16x16x32_bf16 v[132:135], v[4:7], v[192:195], 0
    ds_read_b128 v[216:219], v235 offset:24576
    s_waitcnt lgkmcnt(5)
    v_mfma_f32_16x16x32_bf16 v[136:139], v[0:3], v[196:199], 0
    v_mfma_f32_16x16x32_bf16 v[140:143], v[4:7], v[196:199], 0
    ds_read_b128 v[220:223], v235 offset:28672
    s_waitcnt lgkmcnt(5)
    v_mfma_f32_16x16x32_bf16 v[128:131], v[32:35], v[200:203], v[128:131]
    v_mfma_f32_16x16x32_bf16 v[132:135], v[36:39], v[200:203], v[132:135]
    v_xor_b32 v234, 64, v233
    ds_read_b128 v[192:195], v234 offset:0
    s_add_u32 s51, s27, 8192
    buffer_store_dwordx4 v[228:231], v232, s[16:19], s51 offen offset:1024 sc1
    v_cvt_pk_bf16_f32 v176, v160, v161
    s_waitcnt lgkmcnt(5)
    v_mfma_f32_16x16x32_bf16 v[136:139], v[32:35], v[204:207], v[136:139]
    v_mfma_f32_16x16x32_bf16 v[140:143], v[36:39], v[204:207], v[140:143]
    ds_read_b128 v[196:199], v234 offset:4096
    v_cvt_pk_bf16_f32 v177, v162, v163
    s_waitcnt lgkmcnt(5)
    v_mfma_f32_16x16x32_bf16 v[128:131], v[64:67], v[208:211], v[128:131]
    v_mfma_f32_16x16x32_bf16 v[132:135], v[68:71], v[208:211], v[132:135]
    ds_read_b128 v[200:203], v234 offset:8192
    v_cvt_pk_bf16_f32 v178, v164, v165
    v_cvt_pk_bf16_f32 v179, v166, v167
    s_waitcnt lgkmcnt(5)
    v_mfma_f32_16x16x32_bf16 v[136:139], v[64:67], v[212:215], v[136:139]
    v_mfma_f32_16x16x32_bf16 v[140:143], v[68:71], v[212:215], v[140:143]
    ds_read_b128 v[204:207], v234 offset:12288
    v_cvt_pk_bf16_f32 v180, v168, v169
    s_waitcnt lgkmcnt(5)
    v_mfma_f32_16x16x32_bf16 v[128:131], v[96:99], v[216:219], v[128:131]
    v_mfma_f32_16x16x32_bf16 v[132:135], v[100:103], v[216:219], v[132:135]
    ds_read_b128 v[208:211], v234 offset:16384
    v_cvt_pk_bf16_f32 v181, v170, v171
    v_cvt_pk_bf16_f32 v182, v172, v173
    s_waitcnt lgkmcnt(5)
    v_mfma_f32_16x16x32_bf16 v[136:139], v[96:99], v[220:223], v[136:139]
    v_mfma_f32_16x16x32_bf16 v[140:143], v[100:103], v[220:223], v[140:143]
    ds_read_b128 v[212:215], v234 offset:20480
    v_cvt_pk_bf16_f32 v183, v174, v175
    s_waitcnt lgkmcnt(5)
    v_mfma_f32_16x16x32_bf16 v[128:131], v[8:11], v[192:195], v[128:131]
    v_mfma_f32_16x16x32_bf16 v[132:135], v[12:15], v[192:195], v[132:135]
    ds_read_b128 v[216:219], v234 offset:24576
    s_add_u32 s51, s27, 16384
    buffer_store_dwordx4 v[176:179], v232, s[16:19], s51 offen sc1
    s_waitcnt lgkmcnt(5)
    v_mfma_f32_16x16x32_bf16 v[136:139], v[8:11], v[196:199], v[136:139]
    v_mfma_f32_16x16x32_bf16 v[140:143], v[12:15], v[196:199], v[140:143]
    ds_read_b128 v[220:223], v234 offset:28672
    s_waitcnt lgkmcnt(5)
    v_mfma_f32_16x16x32_bf16 v[128:131], v[40:43], v[200:203], v[128:131]
    v_mfma_f32_16x16x32_bf16 v[132:135], v[44:47], v[200:203], v[132:135]
    v_xor_b32 v235, 128, v233
    ds_read_b128 v[192:195], v235 offset:0
    s_waitcnt lgkmcnt(5)
    v_mfma_f32_16x16x32_bf16 v[136:139], v[40:43], v[204:207], v[136:139]
    v_mfma_f32_16x16x32_bf16 v[140:143], v[44:47], v[204:207], v[140:143]
    ds_read_b128 v[196:199], v235 offset:4096
    s_waitcnt lgkmcnt(5)
    v_mfma_f32_16x16x32_bf16 v[128:131], v[72:75], v[208:211], v[128:131]
    v_mfma_f32_16x16x32_bf16 v[132:135], v[76:79], v[208:211], v[132:135]
    ds_read_b128 v[200:203], v235 offset:8192
    s_add_u32 s51, s27, 16384
    buffer_store_dwordx4 v[180:183], v232, s[16:19], s51 offen offset:1024 sc1
    s_waitcnt lgkmcnt(5)
    v_mfma_f32_16x16x32_bf16 v[136:139], v[72:75], v[212:215], v[136:139]
    v_mfma_f32_16x16x32_bf16 v[140:143], v[76:79], v[212:215], v[140:143]
    ds_read_b128 v[204:207], v235 offset:12288
    s_waitcnt lgkmcnt(5)
    v_mfma_f32_16x16x32_bf16 v[128:131], v[104:107], v[216:219], v[128:131]
    v_mfma_f32_16x16x32_bf16 v[132:135], v[108:111], v[216:219], v[132:135]
    ds_read_b128 v[208:211], v235 offset:16384
    s_waitcnt lgkmcnt(5)
    v_mfma_f32_16x16x32_bf16 v[136:139], v[104:107], v[220:223], v[136:139]
    v_mfma_f32_16x16x32_bf16 v[140:143], v[108:111], v[220:223], v[140:143]
    ds_read_b128 v[212:215], v235 offset:20480
    s_waitcnt lgkmcnt(5)
    v_mfma_f32_16x16x32_bf16 v[128:131], v[16:19], v[192:195], v[128:131]
    v_mfma_f32_16x16x32_bf16 v[132:135], v[20:23], v[192:195], v[132:135]
    ds_read_b128 v[216:219], v235 offset:24576
    s_waitcnt lgkmcnt(5)
    v_mfma_f32_16x16x32_bf16 v[136:139], v[16:19], v[196:199], v[136:139]
    v_mfma_f32_16x16x32_bf16 v[140:143], v[20:23], v[196:199], v[140:143]
    ds_read_b128 v[220:223], v235 offset:28672
    s_lshl_b32 s48, s24, 10
    s_add_u32 m0, s48, 98304
    s_nop 0
    buffer_load_dwordx4 v239, s[20:23], s59 offen lds
    s_waitcnt lgkmcnt(5)
    v_mfma_f32_16x16x32_bf16 v[128:131], v[48:51], v[200:203], v[128:131]
    v_mfma_f32_16x16x32_bf16 v[132:135], v[52:55], v[200:203], v[132:135]
    v_xor_b32 v234, 192, v233
    ds_read_b128 v[192:195], v234 offset:0
    s_waitcnt lgkmcnt(5)
    v_mfma_f32_16x16x32_bf16 v[136:139], v[48:51], v[204:207], v[136:139]
    v_mfma_f32_16x16x32_bf16 v[140:143], v[52:55], v[204:207], v[140:143]
    ds_read_b128 v[196:199], v234 offset:4096
    s_waitcnt lgkmcnt(5)
    v_mfma_f32_16x16x32_bf16 v[128:131], v[80:83], v[208:211], v[128:131]
    v_mfma_f32_16x16x32_bf16 v[132:135], v[84:87], v[208:211], v[132:135]
    ds_read_b128 v[200:203], v234 offset:8192
    s_waitcnt lgkmcnt(5)
    v_mfma_f32_16x16x32_bf16 v[136:139], v[80:83], v[212:215], v[136:139]
    v_mfma_f32_16x16x32_bf16 v[140:143], v[84:87], v[212:215], v[140:143]
    ds_read_b128 v[204:207], v234 offset:12288
    s_lshl_b32 s48, s24, 10
    s_add_u32 m0, s48, 106496
    s_nop 0
    buffer_load_dwordx4 v247, s[44:47], s55 offen lds
    s_waitcnt lgkmcnt(5)
    v_mfma_f32_16x16x32_bf16 v[128:131], v[112:115], v[216:219], v[128:131]
    v_mfma_f32_16x16x32_bf16 v[132:135], v[116:119], v[216:219], v[132:135]
    ds_read_b128 v[208:211], v234 offset:16384
    s_waitcnt lgkmcnt(5)
    v_mfma_f32_16x16x32_bf16 v[136:139], v[112:115], v[220:223], v[136:139]
    v_mfma_f32_16x16x32_bf16 v[140:143], v[116:119], v[220:223], v[140:143]
    ds_read_b128 v[212:215], v234 offset:20480
    s_waitcnt lgkmcnt(5)
    v_mfma_f32_16x16x32_bf16 v[128:131], v[24:27], v[192:195], v[128:131]
    v_mfma_f32_16x16x32_bf16 v[132:135], v[28:31], v[192:195], v[132:135]
    ds_read_b128 v[216:219], v234 offset:24576
    s_waitcnt lgkmcnt(5)
    v_mfma_f32_16x16x32_bf16 v[136:139], v[24:27], v[196:199], v[136:139]
    v_mfma_f32_16x16x32_bf16 v[140:143], v[28:31], v[196:199], v[140:143]
    ds_read_b128 v[220:223], v234 offset:28672
    s_waitcnt vmcnt(5)
    s_barrier
    s_waitcnt lgkmcnt(5)
    v_mfma_f32_16x16x32_bf16 v[128:131], v[56:59], v[200:203], v[128:131]
    v_mfma_f32_16x16x32_bf16 v[132:135], v[60:63], v[200:203], v[132:135]
    v_xor_b32 v235, 0, v233
    ds_read_b128 v[192:195], v235 offset:32768
    s_add_u32 s25, s54, 163840
    s_waitcnt lgkmcnt(5)
    v_mfma_f32_16x16x32_bf16 v[136:139], v[56:59], v[204:207], v[136:139]
    v_mfma_f32_16x16x32_bf16 v[140:143], v[60:63], v[204:207], v[140:143]
    ds_read_b128 v[196:199], v235 offset:36864
    s_add_u32 m0, s28, 65536
    s_nop 0
    buffer_load_dwordx4 v243, s[8:11], s25 offen offset:0 lds
    s_waitcnt lgkmcnt(5)
    v_mfma_f32_16x16x32_bf16 v[128:131], v[88:91], v[208:211], v[128:131]
    v_mfma_f32_16x16x32_bf16 v[132:135], v[92:95], v[208:211], v[132:135]
    ds_read_b128 v[200:203], v235 offset:40960
    s_add_u32 m0, s28, 65536
    s_nop 0
    buffer_load_dwordx4 v244, s[8:11], s25 offen offset:1024 lds
    s_waitcnt lgkmcnt(5)
    v_mfma_f32_16x16x32_bf16 v[136:139], v[88:91], v[212:215], v[136:139]
    v_mfma_f32_16x16x32_bf16 v[140:143], v[92:95], v[212:215], v[140:143]
    ds_read_b128 v[204:207], v235 offset:45056
    s_add_u32 m0, s28, 65536
    s_nop 0
    buffer_load_dwordx4 v245, s[8:11], s25 offen offset:2048 lds
    s_waitcnt lgkmcnt(5)
    v_mfma_f32_16x16x32_bf16 v[128:131], v[120:123], v[216:219], v[128:131]
    v_mfma_f32_16x16x32_bf16 v[132:135], v[124:127], v[216:219], v[132:135]
    ds_read_b128 v[208:211], v235 offset:49152
    s_add_u32 m0, s28, 65536
    s_nop 0
    buffer_load_dwordx4 v246, s[8:11], s25 offen offset:3072 lds
    s_waitcnt lgkmcnt(5)
    v_mfma_f32_16x16x32_bf16 v[136:139], v[120:123], v[220:223], v[136:139]
    v_mfma_f32_16x16x32_bf16 v[140:143], v[124:127], v[220:223], v[140:143]
    ds_read_b128 v[212:215], v235 offset:53248
    s_waitcnt lgkmcnt(5)
    v_mfma_f32_16x16x32_bf16 v[144:147], v[0:3], v[192:195], 0
    v_mfma_f32_16x16x32_bf16 v[148:151], v[4:7], v[192:195], 0
    ds_read_b128 v[216:219], v235 offset:57344
    s_waitcnt lgkmcnt(5)
    v_mfma_f32_16x16x32_bf16 v[152:155], v[0:3], v[196:199], 0
    v_mfma_f32_16x16x32_bf16 v[156:159], v[4:7], v[196:199], 0
    ds_read_b128 v[220:223], v235 offset:61440
    s_waitcnt lgkmcnt(5)
    v_mfma_f32_16x16x32_bf16 v[144:147], v[32:35], v[200:203], v[144:147]
    v_mfma_f32_16x16x32_bf16 v[148:151], v[36:39], v[200:203], v[148:151]
    v_xor_b32 v234, 64, v233
    ds_read_b128 v[192:195], v234 offset:32768
    v_cvt_pk_bf16_f32 v224, v128, v129
    v_cvt_pk_bf16_f32 v225, v130, v131
    s_waitcnt lgkmcnt(5)
    v_mfma_f32_16x16x32_bf16 v[152:155], v[32:35], v[204:207], v[152:155]
    v_mfma_f32_16x16x32_bf16 v[156:159], v[36:39], v[204:207], v[156:159]
    ds_read_b128 v[196:199], v234 offset:36864
    v_cvt_pk_bf16_f32 v226, v132, v133
    s_waitcnt lgkmcnt(5)
    v_mfma_f32_16x16x32_bf16 v[144:147], v[64:67], v[208:211], v[144:147]
    v_mfma_f32_16x16x32_bf16 v[148:151], v[68:71], v[208:211], v[148:151]
    ds_read_b128 v[200:203], v234 offset:40960
    v_cvt_pk_bf16_f32 v227, v134, v135
    s_waitcnt lgkmcnt(5)
    v_mfma_f32_16x16x32_bf16 v[152:155], v[64:67], v[212:215], v[152:155]
    v_mfma_f32_16x16x32_bf16 v[156:159], v[68:71], v[212:215], v[156:159]
    ds_read_b128 v[204:207], v234 offset:45056
    v_cvt_pk_bf16_f32 v228, v136, v137
    v_cvt_pk_bf16_f32 v229, v138, v139
    s_waitcnt lgkmcnt(5)
    v_mfma_f32_16x16x32_bf16 v[144:147], v[96:99], v[216:219], v[144:147]
    v_mfma_f32_16x16x32_bf16 v[148:151], v[100:103], v[216:219], v[148:151]
    ds_read_b128 v[208:211], v234 offset:49152
    v_cvt_pk_bf16_f32 v230, v140, v141
    s_waitcnt lgkmcnt(5)
    v_mfma_f32_16x16x32_bf16 v[152:155], v[96:99], v[220:223], v[152:155]
    v_mfma_f32_16x16x32_bf16 v[156:159], v[100:103], v[220:223], v[156:159]
    ds_read_b128 v[212:215], v234 offset:53248
    v_cvt_pk_bf16_f32 v231, v142, v143
    s_waitcnt lgkmcnt(5)
    v_mfma_f32_16x16x32_bf16 v[144:147], v[8:11], v[192:195], v[144:147]
    v_mfma_f32_16x16x32_bf16 v[148:151], v[12:15], v[192:195], v[148:151]
    ds_read_b128 v[216:219], v234 offset:57344
    s_add_u32 s51, s27, 24576
    buffer_store_dwordx4 v[224:227], v232, s[16:19], s51 offen sc1
    s_waitcnt lgkmcnt(5)
    v_mfma_f32_16x16x32_bf16 v[152:155], v[8:11], v[196:199], v[152:155]
    v_mfma_f32_16x16x32_bf16 v[156:159], v[12:15], v[196:199], v[156:159]
    ds_read_b128 v[220:223], v234 offset:61440
    s_waitcnt lgkmcnt(5)
    v_mfma_f32_16x16x32_bf16 v[144:147], v[40:43], v[200:203], v[144:147]
    v_mfma_f32_16x16x32_bf16 v[148:151], v[44:47], v[200:203], v[148:151]
    v_xor_b32 v235, 128, v233
    ds_read_b128 v[192:195], v235 offset:32768
    s_waitcnt lgkmcnt(5)
    v_mfma_f32_16x16x32_bf16 v[152:155], v[40:43], v[204:207], v[152:155]
    v_mfma_f32_16x16x32_bf16 v[156:159], v[44:47], v[204:207], v[156:159]
    ds_read_b128 v[196:199], v235 offset:36864
    s_waitcnt lgkmcnt(5)
    v_mfma_f32_16x16x32_bf16 v[144:147], v[72:75], v[208:211], v[144:147]
    v_mfma_f32_16x16x32_bf16 v[148:151], v[76:79], v[208:211], v[148:151]
    ds_read_b128 v[200:203], v235 offset:40960
    s_waitcnt lgkmcnt(5)
    v_mfma_f32_16x16x32_bf16 v[152:155], v[72:75], v[212:215], v[152:155]
    v_mfma_f32_16x16x32_bf16 v[156:159], v[76:79], v[212:215], v[156:159]
    ds_read_b128 v[204:207], v235 offset:45056
    s_waitcnt lgkmcnt(5)
    v_mfma_f32_16x16x32_bf16 v[144:147], v[104:107], v[216:219], v[144:147]
    v_mfma_f32_16x16x32_bf16 v[148:151], v[108:111], v[216:219], v[148:151]
    ds_read_b128 v[208:211], v235 offset:49152
    s_waitcnt lgkmcnt(5)
    v_mfma_f32_16x16x32_bf16 v[152:155], v[104:107], v[220:223], v[152:155]
    v_mfma_f32_16x16x32_bf16 v[156:159], v[108:111], v[220:223], v[156:159]
    ds_read_b128 v[212:215], v235 offset:53248
    s_waitcnt lgkmcnt(5)
    v_mfma_f32_16x16x32_bf16 v[144:147], v[16:19], v[192:195], v[144:147]
    v_mfma_f32_16x16x32_bf16 v[148:151], v[20:23], v[192:195], v[148:151]
    ds_read_b128 v[216:219], v235 offset:57344
    s_waitcnt lgkmcnt(5)
    v_mfma_f32_16x16x32_bf16 v[152:155], v[16:19], v[196:199], v[152:155]
    v_mfma_f32_16x16x32_bf16 v[156:159], v[20:23], v[196:199], v[156:159]
    ds_read_b128 v[220:223], v235 offset:61440
    s_add_u32 s51, s27, 24576
    buffer_store_dwordx4 v[228:231], v232, s[16:19], s51 offen offset:1024 sc1
    s_waitcnt lgkmcnt(5)
    v_mfma_f32_16x16x32_bf16 v[144:147], v[48:51], v[200:203], v[144:147]
    v_mfma_f32_16x16x32_bf16 v[148:151], v[52:55], v[200:203], v[148:151]
    v_xor_b32 v234, 192, v233
    ds_read_b128 v[192:195], v234 offset:32768
    s_waitcnt lgkmcnt(5)
    v_mfma_f32_16x16x32_bf16 v[152:155], v[48:51], v[204:207], v[152:155]
    v_mfma_f32_16x16x32_bf16 v[156:159], v[52:55], v[204:207], v[156:159]
    ds_read_b128 v[196:199], v234 offset:36864
    s_waitcnt lgkmcnt(5)
    v_mfma_f32_16x16x32_bf16 v[144:147], v[80:83], v[208:211], v[144:147]
    v_mfma_f32_16x16x32_bf16 v[148:151], v[84:87], v[208:211], v[148:151]
    ds_read_b128 v[200:203], v234 offset:40960
    s_waitcnt lgkmcnt(5)
    v_mfma_f32_16x16x32_bf16 v[152:155], v[80:83], v[212:215], v[152:155]
    v_mfma_f32_16x16x32_bf16 v[156:159], v[84:87], v[212:215], v[156:159]
    ds_read_b128 v[204:207], v234 offset:45056
    s_waitcnt lgkmcnt(5)
    v_mfma_f32_16x16x32_bf16 v[144:147], v[112:115], v[216:219], v[144:147]
    v_mfma_f32_16x16x32_bf16 v[148:151], v[116:119], v[216:219], v[148:151]
    ds_read_b128 v[208:211], v234 offset:49152
    s_waitcnt lgkmcnt(5)
    v_mfma_f32_16x16x32_bf16 v[152:155], v[112:115], v[220:223], v[152:155]
    v_mfma_f32_16x16x32_bf16 v[156:159], v[116:119], v[220:223], v[156:159]
    ds_read_b128 v[212:215], v234 offset:53248
    s_waitcnt lgkmcnt(5)
    v_mfma_f32_16x16x32_bf16 v[144:147], v[24:27], v[192:195], v[144:147]
    v_mfma_f32_16x16x32_bf16 v[148:151], v[28:31], v[192:195], v[148:151]
    ds_read_b128 v[216:219], v234 offset:57344
    s_waitcnt lgkmcnt(5)
    v_mfma_f32_16x16x32_bf16 v[152:155], v[24:27], v[196:199], v[152:155]
    v_mfma_f32_16x16x32_bf16 v[156:159], v[28:31], v[196:199], v[156:159]
    ds_read_b128 v[220:223], v234 offset:61440
    s_waitcnt vmcnt(2)
    s_barrier
    s_waitcnt lgkmcnt(5)
    v_mfma_f32_16x16x32_bf16 v[144:147], v[56:59], v[200:203], v[144:147]
    v_mfma_f32_16x16x32_bf16 v[148:151], v[60:63], v[200:203], v[148:151]
    v_xor_b32 v235, 65536, v233
    ds_read_b128 v[192:195], v235 offset:0
    s_add_u32 s25, s54, 196608
    s_waitcnt lgkmcnt(5)
    v_mfma_f32_16x16x32_bf16 v[152:155], v[56:59], v[204:207], v[152:155]
    v_mfma_f32_16x16x32_bf16 v[156:159], v[60:63], v[204:207], v[156:159]
    ds_read_b128 v[196:199], v235 offset:4096
    s_add_u32 m0, s28, 0
    s_nop 0
    buffer_load_dwordx4 v243, s[8:11], s25 offen offset:0 lds
    s_waitcnt lgkmcnt(5)
    v_mfma_f32_16x16x32_bf16 v[144:147], v[88:91], v[208:211], v[144:147]
    v_mfma_f32_16x16x32_bf16 v[148:151], v[92:95], v[208:211], v[148:151]
    ds_read_b128 v[200:203], v235 offset:8192
    s_add_u32 m0, s28, 0
    s_nop 0
    buffer_load_dwordx4 v244, s[8:11], s25 offen offset:1024 lds
    s_waitcnt lgkmcnt(5)
    v_mfma_f32_16x16x32_bf16 v[152:155], v[88:91], v[212:215], v[152:155]
    v_mfma_f32_16x16x32_bf16 v[156:159], v[92:95], v[212:215], v[156:159]
    ds_read_b128 v[204:207], v235 offset:12288
    s_add_u32 m0, s28, 0
    s_nop 0
    buffer_load_dwordx4 v245, s[8:11], s25 offen offset:2048 lds
    s_waitcnt lgkmcnt(5)
    v_mfma_f32_16x16x32_bf16 v[144:147], v[120:123], v[216:219], v[144:147]
    v_mfma_f32_16x16x32_bf16 v[148:151], v[124:127], v[216:219], v[148:151]
    ds_read_b128 v[208:211], v235 offset:16384
    s_add_u32 m0, s28, 0
    s_nop 0
    buffer_load_dwordx4 v246, s[8:11], s25 offen offset:3072 lds
    s_waitcnt lgkmcnt(5)
    v_mfma_f32_16x16x32_bf16 v[152:155], v[120:123], v[220:223], v[152:155]
    v_mfma_f32_16x16x32_bf16 v[156:159], v[124:127], v[220:223], v[156:159]
    ds_read_b128 v[212:215], v235 offset:20480
    s_waitcnt lgkmcnt(5)
    v_mfma_f32_16x16x32_bf16 v[160:163], v[0:3], v[192:195], 0
    v_mfma_f32_16x16x32_bf16 v[164:167], v[4:7], v[192:195], 0
    ds_read_b128 v[216:219], v235 offset:24576
    s_waitcnt lgkmcnt(5)
    v_mfma_f32_16x16x32_bf16 v[168:171], v[0:3], v[196:199], 0
    v_mfma_f32_16x16x32_bf16 v[172:175], v[4:7], v[196:199], 0
    ds_read_b128 v[220:223], v235 offset:28672
    s_waitcnt lgkmcnt(5)
    v_mfma_f32_16x16x32_bf16 v[160:163], v[32:35], v[200:203], v[160:163]
    v_mfma_f32_16x16x32_bf16 v[164:167], v[36:39], v[200:203], v[164:167]
    v_xor_b32 v234, 65600, v233
    ds_read_b128 v[192:195], v234 offset:0
    v_cvt_pk_bf16_f32 v176, v144, v145
    v_cvt_pk_bf16_f32 v177, v146, v147
    s_waitcnt lgkmcnt(5)
    v_mfma_f32_16x16x32_bf16 v[168:171], v[32:35], v[204:207], v[168:171]
    v_mfma_f32_16x16x32_bf16 v[172:175], v[36:39], v[204:207], v[172:175]
    ds_read_b128 v[196:199], v234 offset:4096
    v_cvt_pk_bf16_f32 v178, v148, v149
    v_cvt_pk_bf16_f32 v179, v150, v151
    s_waitcnt lgkmcnt(5)
    v_mfma_f32_16x16x32_bf16 v[160:163], v[64:67], v[208:211], v[160:163]
    v_mfma_f32_16x16x32_bf16 v[164:167], v[68:71], v[208:211], v[164:167]
    ds_read_b128 v[200:203], v234 offset:8192
    v_cvt_pk_bf16_f32 v180, v152, v153
    v_cvt_pk_bf16_f32 v181, v154, v155
    s_waitcnt lgkmcnt(5)
    v_mfma_f32_16x16x32_bf16 v[168:171], v[64:67], v[212:215], v[168:171]
    v_mfma_f32_16x16x32_bf16 v[172:175], v[68:71], v[212:215], v[172:175]
    ds_read_b128 v[204:207], v234 offset:12288
    v_cvt_pk_bf16_f32 v182, v156, v157
    v_cvt_pk_bf16_f32 v183, v158, v159
    s_waitcnt lgkmcnt(5)
    v_mfma_f32_16x16x32_bf16 v[160:163], v[96:99], v[216:219], v[160:163]
    v_mfma_f32_16x16x32_bf16 v[164:167], v[100:103], v[216:219], v[164:167]
    ds_read_b128 v[208:211], v234 offset:16384
    ds_read_b128 v[248:251], v240
    ds_read_b64_tr_b16 v[184:185], v252
    s_waitcnt lgkmcnt(7)
    v_mfma_f32_16x16x32_bf16 v[168:171], v[96:99], v[220:223], v[168:171]
    v_mfma_f32_16x16x32_bf16 v[172:175], v[100:103], v[220:223], v[172:175]
    ds_read_b128 v[212:215], v234 offset:20480
    ds_read_b64_tr_b16 v[186:187], v252 offset:512
    s_waitcnt lgkmcnt(8)
    v_mfma_f32_16x16x32_bf16 v[160:163], v[8:11], v[192:195], v[160:163]
    v_mfma_f32_16x16x32_bf16 v[164:167], v[12:15], v[192:195], v[164:167]
    ds_read_b128 v[216:219], v234 offset:24576
    s_add_u32 s51, s27, 32768
    buffer_store_dwordx4 v[176:179], v232, s[16:19], s51 offen sc1
    s_waitcnt lgkmcnt(8)
    v_mfma_f32_16x16x32_bf16 v[168:171], v[8:11], v[196:199], v[168:171]
    v_mfma_f32_16x16x32_bf16 v[172:175], v[12:15], v[196:199], v[172:175]
    ds_read_b128 v[220:223], v234 offset:28672
    s_waitcnt lgkmcnt(8)
    v_mfma_f32_16x16x32_bf16 v[160:163], v[40:43], v[200:203], v[160:163]
    v_mfma_f32_16x16x32_bf16 v[164:167], v[44:47], v[200:203], v[164:167]
    v_xor_b32 v235, 65664, v233
    ds_read_b128 v[192:195], v235 offset:0
    s_waitcnt lgkmcnt(8)
    v_mfma_f32_16x16x32_bf16 v[168:171], v[40:43], v[204:207], v[168:171]
    v_mfma_f32_16x16x32_bf16 v[172:175], v[44:47], v[204:207], v[172:175]
    ds_read_b128 v[196:199], v235 offset:4096
    s_waitcnt lgkmcnt(8)
    v_mfma_f32_16x16x32_bf16 v[160:163], v[72:75], v[208:211], v[160:163]
    v_mfma_f32_16x16x32_bf16 v[164:167], v[76:79], v[208:211], v[164:167]
    ds_read_b128 v[200:203], v235 offset:8192
    s_waitcnt lgkmcnt(6)
    v_mfma_f32_16x16x32_bf16 v[168:171], v[72:75], v[212:215], v[168:171]
    v_mfma_f32_16x16x32_bf16 v[172:175], v[76:79], v[212:215], v[172:175]
    ds_read_b128 v[204:207], v235 offset:12288
    s_waitcnt lgkmcnt(5)
    v_mfma_f32_16x16x32_bf16 v[160:163], v[104:107], v[216:219], v[160:163]
    v_mfma_f32_16x16x32_bf16 v[164:167], v[108:111], v[216:219], v[164:167]
    ds_read_b128 v[208:211], v235 offset:16384
    s_add_u32 s51, s27, 32768
    buffer_store_dwordx4 v[180:183], v232, s[16:19], s51 offen offset:1024 sc1
    s_waitcnt lgkmcnt(5)
    v_mfma_f32_16x16x32_bf16 v[168:171], v[104:107], v[220:223], v[168:171]
    v_mfma_f32_16x16x32_bf16 v[172:175], v[108:111], v[220:223], v[172:175]
    ds_read_b128 v[212:215], v235 offset:20480
    s_waitcnt lgkmcnt(5)
    v_mfma_f32_16x16x32_bf16 v[160:163], v[16:19], v[192:195], v[160:163]
    v_mfma_f32_16x16x32_bf16 v[164:167], v[20:23], v[192:195], v[164:167]
    ds_read_b128 v[216:219], v235 offset:24576
    s_waitcnt lgkmcnt(5)
    v_mfma_f32_16x16x32_bf16 v[168:171], v[16:19], v[196:199], v[168:171]
    v_mfma_f32_16x16x32_bf16 v[172:175], v[20:23], v[196:199], v[172:175]
    ds_read_b128 v[220:223], v235 offset:28672
    s_waitcnt lgkmcnt(5)
    v_mfma_f32_16x16x32_bf16 v[160:163], v[48:51], v[200:203], v[160:163]
    v_mfma_f32_16x16x32_bf16 v[164:167], v[52:55], v[200:203], v[164:167]
    v_xor_b32 v234, 65728, v233
    ds_read_b128 v[192:195], v234 offset:0
    s_waitcnt lgkmcnt(5)
    v_mfma_f32_16x16x32_bf16 v[168:171], v[48:51], v[204:207], v[168:171]
    v_mfma_f32_16x16x32_bf16 v[172:175], v[52:55], v[204:207], v[172:175]
    ds_read_b128 v[196:199], v234 offset:4096
    s_waitcnt lgkmcnt(5)
    v_mfma_f32_16x16x32_bf16 v[160:163], v[80:83], v[208:211], v[160:163]
    v_mfma_f32_16x16x32_bf16 v[164:167], v[84:87], v[208:211], v[164:167]
    ds_read_b128 v[200:203], v234 offset:8192
    buffer_store_dwordx4 v[248:251], v232, s[16:19], s33 offen sc1
    s_waitcnt lgkmcnt(5)
    v_mfma_f32_16x16x32_bf16 v[168:171], v[80:83], v[212:215], v[168:171]
    v_mfma_f32_16x16x32_bf16 v[172:175], v[84:87], v[212:215], v[172:175]
    ds_read_b128 v[204:207], v234 offset:12288
    s_waitcnt lgkmcnt(5)
    v_mfma_f32_16x16x32_bf16 v[160:163], v[112:115], v[216:219], v[160:163]
    v_mfma_f32_16x16x32_bf16 v[164:167], v[116:119], v[216:219], v[164:167]
    ds_read_b128 v[208:211], v234 offset:16384
    s_waitcnt lgkmcnt(5)
    v_mfma_f32_16x16x32_bf16 v[168:171], v[112:115], v[220:223], v[168:171]
    v_mfma_f32_16x16x32_bf16 v[172:175], v[116:119], v[220:223], v[172:175]
    ds_read_b128 v[212:215], v234 offset:20480
    s_waitcnt lgkmcnt(5)
    v_mfma_f32_16x16x32_bf16 v[160:163], v[24:27], v[192:195], v[160:163]
    v_mfma_f32_16x16x32_bf16 v[164:167], v[28:31], v[192:195], v[164:167]
    ds_read_b128 v[216:219], v234 offset:24576
    s_waitcnt lgkmcnt(5)
    v_mfma_f32_16x16x32_bf16 v[168:171], v[24:27], v[196:199], v[168:171]
    v_mfma_f32_16x16x32_bf16 v[172:175], v[28:31], v[196:199], v[172:175]
    ds_read_b128 v[220:223], v234 offset:28672
    s_waitcnt vmcnt(3)
    s_barrier
    s_waitcnt lgkmcnt(5)
    v_mfma_f32_16x16x32_bf16 v[160:163], v[56:59], v[200:203], v[160:163]
    v_mfma_f32_16x16x32_bf16 v[164:167], v[60:63], v[200:203], v[164:167]
    v_xor_b32 v235, 0, v233
    ds_read_b128 v[192:195], v235 offset:0
    s_add_u32 s25, s54, 229376
    s_waitcnt lgkmcnt(5)
    v_mfma_f32_16x16x32_bf16 v[168:171], v[56:59], v[204:207], v[168:171]
    v_mfma_f32_16x16x32_bf16 v[172:175], v[60:63], v[204:207], v[172:175]
    ds_read_b128 v[196:199], v235 offset:4096
    s_add_u32 m0, s28, 32768
    s_nop 0
    buffer_load_dwordx4 v243, s[8:11], s25 offen offset:0 lds
    s_waitcnt lgkmcnt(5)
    v_mfma_f32_16x16x32_bf16 v[160:163], v[88:91], v[208:211], v[160:163]
    v_mfma_f32_16x16x32_bf16 v[164:167], v[92:95], v[208:211], v[164:167]
    ds_read_b128 v[200:203], v235 offset:8192
    s_add_u32 m0, s28, 32768
    s_nop 0
    buffer_load_dwordx4 v244, s[8:11], s25 offen offset:1024 lds
    s_waitcnt lgkmcnt(5)
    v_mfma_f32_16x16x32_bf16 v[168:171], v[88:91], v[212:215], v[168:171]
    v_mfma_f32_16x16x32_bf16 v[172:175], v[92:95], v[212:215], v[172:175]
    ds_read_b128 v[204:207], v235 offset:12288
    s_add_u32 m0, s28, 32768
    s_nop 0
    buffer_load_dwordx4 v245, s[8:11], s25 offen offset:2048 lds
    s_waitcnt lgkmcnt(5)
    v_mfma_f32_16x16x32_bf16 v[160:163], v[120:123], v[216:219], v[160:163]
    v_mfma_f32_16x16x32_bf16 v[164:167], v[124:127], v[216:219], v[164:167]
    ds_read_b128 v[208:211], v235 offset:16384
    s_add_u32 m0, s28, 32768
    s_nop 0
    buffer_load_dwordx4 v246, s[8:11], s25 offen offset:3072 lds
    s_waitcnt lgkmcnt(5)
    v_mfma_f32_16x16x32_bf16 v[168:171], v[120:123], v[220:223], v[168:171]
    v_mfma_f32_16x16x32_bf16 v[172:175], v[124:127], v[220:223], v[172:175]
    ds_read_b128 v[212:215], v235 offset:20480
    s_waitcnt lgkmcnt(5)
    v_mfma_f32_16x16x32_bf16 v[128:131], v[0:3], v[192:195], 0
    v_mfma_f32_16x16x32_bf16 v[132:135], v[4:7], v[192:195], 0
    ds_read_b128 v[216:219], v235 offset:24576
    s_waitcnt lgkmcnt(5)
    v_mfma_f32_16x16x32_bf16 v[136:139], v[0:3], v[196:199], 0
    v_mfma_f32_16x16x32_bf16 v[140:143], v[4:7], v[196:199], 0
    ds_read_b128 v[220:223], v235 offset:28672
    s_waitcnt lgkmcnt(5)
    v_mfma_f32_16x16x32_bf16 v[128:131], v[32:35], v[200:203], v[128:131]
    v_mfma_f32_16x16x32_bf16 v[132:135], v[36:39], v[200:203], v[132:135]
    v_xor_b32 v234, 64, v233
    ds_read_b128 v[192:195], v234 offset:0
    v_cvt_pk_bf16_f32 v224, v160, v161
    v_cvt_pk_bf16_f32 v225, v162, v163
    s_waitcnt lgkmcnt(5)
    v_mfma_f32_16x16x32_bf16 v[136:139], v[32:35], v[204:207], v[136:139]
    v_mfma_f32_16x16x32_bf16 v[140:143], v[36:39], v[204:207], v[140:143]
    ds_read_b128 v[196:199], v234 offset:4096
    v_cvt_pk_bf16_f32 v226, v164, v165
    s_waitcnt lgkmcnt(5)
    v_mfma_f32_16x16x32_bf16 v[128:131], v[64:67], v[208:211], v[128:131]
    v_mfma_f32_16x16x32_bf16 v[132:135], v[68:71], v[208:211], v[132:135]
    ds_read_b128 v[200:203], v234 offset:8192
    v_cvt_pk_bf16_f32 v227, v166, v167
    s_waitcnt lgkmcnt(5)
    v_mfma_f32_16x16x32_bf16 v[136:139], v[64:67], v[212:215], v[136:139]
    v_mfma_f32_16x16x32_bf16 v[140:143], v[68:71], v[212:215], v[140:143]
    ds_read_b128 v[204:207], v234 offset:12288
    v_cvt_pk_bf16_f32 v228, v168, v169
    v_cvt_pk_bf16_f32 v229, v170, v171
    s_waitcnt lgkmcnt(5)
    v_mfma_f32_16x16x32_bf16 v[128:131], v[96:99], v[216:219], v[128:131]
    v_mfma_f32_16x16x32_bf16 v[132:135], v[100:103], v[216:219], v[132:135]
    ds_read_b128 v[208:211], v234 offset:16384
    v_cvt_pk_bf16_f32 v230, v172, v173
    s_waitcnt lgkmcnt(5)
    v_mfma_f32_16x16x32_bf16 v[136:139], v[96:99], v[220:223], v[136:139]
    v_mfma_f32_16x16x32_bf16 v[140:143], v[100:103], v[220:223], v[140:143]
    ds_read_b128 v[212:215], v234 offset:20480
    v_cvt_pk_bf16_f32 v231, v174, v175
    s_waitcnt lgkmcnt(5)
    v_mfma_f32_16x16x32_bf16 v[128:131], v[8:11], v[192:195], v[128:131]
    v_mfma_f32_16x16x32_bf16 v[132:135], v[12:15], v[192:195], v[132:135]
    ds_read_b128 v[216:219], v234 offset:24576
    s_add_u32 s51, s27, 40960
    buffer_store_dwordx4 v[224:227], v232, s[16:19], s51 offen sc1
    s_waitcnt lgkmcnt(5)
    v_mfma_f32_16x16x32_bf16 v[136:139], v[8:11], v[196:199], v[136:139]
    v_mfma_f32_16x16x32_bf16 v[140:143], v[12:15], v[196:199], v[140:143]
    ds_read_b128 v[220:223], v234 offset:28672
    s_waitcnt lgkmcnt(5)
    v_mfma_f32_16x16x32_bf16 v[128:131], v[40:43], v[200:203], v[128:131]
    v_mfma_f32_16x16x32_bf16 v[132:135], v[44:47], v[200:203], v[132:135]
    v_xor_b32 v235, 128, v233
    ds_read_b128 v[192:195], v235 offset:0
    s_waitcnt lgkmcnt(5)
    v_mfma_f32_16x16x32_bf16 v[136:139], v[40:43], v[204:207], v[136:139]
    v_mfma_f32_16x16x32_bf16 v[140:143], v[44:47], v[204:207], v[140:143]
    ds_read_b128 v[196:199], v235 offset:4096
    s_waitcnt lgkmcnt(5)
    v_mfma_f32_16x16x32_bf16 v[128:131], v[72:75], v[208:211], v[128:131]
    v_mfma_f32_16x16x32_bf16 v[132:135], v[76:79], v[208:211], v[132:135]
    ds_read_b128 v[200:203], v235 offset:8192
    s_waitcnt lgkmcnt(5)
    v_mfma_f32_16x16x32_bf16 v[136:139], v[72:75], v[212:215], v[136:139]
    v_mfma_f32_16x16x32_bf16 v[140:143], v[76:79], v[212:215], v[140:143]
    ds_read_b128 v[204:207], v235 offset:12288
    s_waitcnt lgkmcnt(5)
    v_mfma_f32_16x16x32_bf16 v[128:131], v[104:107], v[216:219], v[128:131]
    v_mfma_f32_16x16x32_bf16 v[132:135], v[108:111], v[216:219], v[132:135]
    ds_read_b128 v[208:211], v235 offset:16384
    s_add_u32 s51, s27, 40960
    buffer_store_dwordx4 v[228:231], v232, s[16:19], s51 offen offset:1024 sc1
    s_waitcnt lgkmcnt(5)
    v_mfma_f32_16x16x32_bf16 v[136:139], v[104:107], v[220:223], v[136:139]
    v_mfma_f32_16x16x32_bf16 v[140:143], v[108:111], v[220:223], v[140:143]
    ds_read_b128 v[212:215], v235 offset:20480
    s_waitcnt lgkmcnt(5)
    v_mfma_f32_16x16x32_bf16 v[128:131], v[16:19], v[192:195], v[128:131]
    v_mfma_f32_16x16x32_bf16 v[132:135], v[20:23], v[192:195], v[132:135]
    ds_read_b128 v[216:219], v235 offset:24576
    s_waitcnt lgkmcnt(5)
    v_mfma_f32_16x16x32_bf16 v[136:139], v[16:19], v[196:199], v[136:139]
    v_mfma_f32_16x16x32_bf16 v[140:143], v[20:23], v[196:199], v[140:143]
    ds_read_b128 v[220:223], v235 offset:28672
    s_waitcnt lgkmcnt(5)
    v_mfma_f32_16x16x32_bf16 v[128:131], v[48:51], v[200:203], v[128:131]
    v_mfma_f32_16x16x32_bf16 v[132:135], v[52:55], v[200:203], v[132:135]
    v_xor_b32 v234, 192, v233
    ds_read_b128 v[192:195], v234 offset:0
    s_waitcnt lgkmcnt(5)
    v_mfma_f32_16x16x32_bf16 v[136:139], v[48:51], v[204:207], v[136:139]
    v_mfma_f32_16x16x32_bf16 v[140:143], v[52:55], v[204:207], v[140:143]
    ds_read_b128 v[196:199], v234 offset:4096
    s_waitcnt lgkmcnt(5)
    v_mfma_f32_16x16x32_bf16 v[128:131], v[80:83], v[208:211], v[128:131]
    v_mfma_f32_16x16x32_bf16 v[132:135], v[84:87], v[208:211], v[132:135]
    ds_read_b128 v[200:203], v234 offset:8192
    buffer_store_dwordx4 v[184:187], v253, s[16:19], s58 offen sc1
    s_waitcnt lgkmcnt(5)
    v_mfma_f32_16x16x32_bf16 v[136:139], v[80:83], v[212:215], v[136:139]
    v_mfma_f32_16x16x32_bf16 v[140:143], v[84:87], v[212:215], v[140:143]
    ds_read_b128 v[204:207], v234 offset:12288
    s_waitcnt lgkmcnt(5)
    v_mfma_f32_16x16x32_bf16 v[128:131], v[112:115], v[216:219], v[128:131]
    v_mfma_f32_16x16x32_bf16 v[132:135], v[116:119], v[216:219], v[132:135]
    ds_read_b128 v[208:211], v234 offset:16384
    s_waitcnt lgkmcnt(5)
    v_mfma_f32_16x16x32_bf16 v[136:139], v[112:115], v[220:223], v[136:139]
    v_mfma_f32_16x16x32_bf16 v[140:143], v[116:119], v[220:223], v[140:143]
    ds_read_b128 v[212:215], v234 offset:20480
    s_waitcnt lgkmcnt(5)
    v_mfma_f32_16x16x32_bf16 v[128:131], v[24:27], v[192:195], v[128:131]
    v_mfma_f32_16x16x32_bf16 v[132:135], v[28:31], v[192:195], v[132:135]
    ds_read_b128 v[216:219], v234 offset:24576
    s_waitcnt lgkmcnt(5)
    v_mfma_f32_16x16x32_bf16 v[136:139], v[24:27], v[196:199], v[136:139]
    v_mfma_f32_16x16x32_bf16 v[140:143], v[28:31], v[196:199], v[140:143]
    ds_read_b128 v[220:223], v234 offset:28672
    s_waitcnt vmcnt(3)
    s_barrier
    s_waitcnt lgkmcnt(5)
    v_mfma_f32_16x16x32_bf16 v[128:131], v[56:59], v[200:203], v[128:131]
    v_mfma_f32_16x16x32_bf16 v[132:135], v[60:63], v[200:203], v[132:135]
    v_xor_b32 v235, 0, v233
    ds_read_b128 v[192:195], v235 offset:32768
    s_lshr_b32 s48, s2, 3
    s_lshl_b32 s48, s48, 3
    s_add_u32 s48, s48, s24
    v_bfe_u32 v240, v232, 7, 1
    v_lshlrev_b32 v240, 13, v240
    v_bfe_u32 v239, v232, 4, 3
    v_lshl_add_u32 v240, v239, 7, v240
    s_lshl_b32 s49, s48, 14
    s_and_b32 s48, s2, 7
    s_lshl_b32 s48, s48, 10
    s_add_u32 s49, s49, s48
    buffer_load_dword v242, v240, s[60:63], s49 offen
    s_waitcnt lgkmcnt(5)
    v_mfma_f32_16x16x32_bf16 v[136:139], v[56:59], v[204:207], v[136:139]
    v_mfma_f32_16x16x32_bf16 v[140:143], v[60:63], v[204:207], v[140:143]
    ds_read_b128 v[196:199], v235 offset:36864
    s_waitcnt lgkmcnt(5)
    v_mfma_f32_16x16x32_bf16 v[128:131], v[88:91], v[208:211], v[128:131]
    v_mfma_f32_16x16x32_bf16 v[132:135], v[92:95], v[208:211], v[132:135]
    ds_read_b128 v[200:203], v235 offset:40960
    s_waitcnt lgkmcnt(5)
    v_mfma_f32_16x16x32_bf16 v[136:139], v[88:91], v[212:215], v[136:139]
    v_mfma_f32_16x16x32_bf16 v[140:143], v[92:95], v[212:215], v[140:143]
    ds_read_b128 v[204:207], v235 offset:45056
    s_waitcnt lgkmcnt(5)
    v_mfma_f32_16x16x32_bf16 v[128:131], v[120:123], v[216:219], v[128:131]
    v_mfma_f32_16x16x32_bf16 v[132:135], v[124:127], v[216:219], v[132:135]
    ds_read_b128 v[208:211], v235 offset:49152
    s_waitcnt lgkmcnt(5)
    v_mfma_f32_16x16x32_bf16 v[136:139], v[120:123], v[220:223], v[136:139]
    v_mfma_f32_16x16x32_bf16 v[140:143], v[124:127], v[220:223], v[140:143]
    ds_read_b128 v[212:215], v235 offset:53248
    s_waitcnt lgkmcnt(5)
    v_mfma_f32_16x16x32_bf16 v[144:147], v[0:3], v[192:195], 0
    v_mfma_f32_16x16x32_bf16 v[148:151], v[4:7], v[192:195], 0
    ds_read_b128 v[216:219], v235 offset:57344
    s_waitcnt lgkmcnt(5)
    v_mfma_f32_16x16x32_bf16 v[152:155], v[0:3], v[196:199], 0
    v_mfma_f32_16x16x32_bf16 v[156:159], v[4:7], v[196:199], 0
    ds_read_b128 v[220:223], v235 offset:61440
    s_waitcnt lgkmcnt(5)
    v_mfma_f32_16x16x32_bf16 v[144:147], v[32:35], v[200:203], v[144:147]
    v_mfma_f32_16x16x32_bf16 v[148:151], v[36:39], v[200:203], v[148:151]
    v_xor_b32 v234, 64, v233
    ds_read_b128 v[192:195], v234 offset:32768
    v_cvt_pk_bf16_f32 v176, v128, v129
    v_cvt_pk_bf16_f32 v177, v130, v131
    s_waitcnt lgkmcnt(5)
    v_mfma_f32_16x16x32_bf16 v[152:155], v[32:35], v[204:207], v[152:155]
    v_mfma_f32_16x16x32_bf16 v[156:159], v[36:39], v[204:207], v[156:159]
    ds_read_b128 v[196:199], v234 offset:36864
    v_cvt_pk_bf16_f32 v178, v132, v133
    s_waitcnt lgkmcnt(5)
    v_mfma_f32_16x16x32_bf16 v[144:147], v[64:67], v[208:211], v[144:147]
    v_mfma_f32_16x16x32_bf16 v[148:151], v[68:71], v[208:211], v[148:151]
    ds_read_b128 v[200:203], v234 offset:40960
    v_cvt_pk_bf16_f32 v179, v134, v135
    s_waitcnt lgkmcnt(5)
    v_mfma_f32_16x16x32_bf16 v[152:155], v[64:67], v[212:215], v[152:155]
    v_mfma_f32_16x16x32_bf16 v[156:159], v[68:71], v[212:215], v[156:159]
    ds_read_b128 v[204:207], v234 offset:45056
    v_cvt_pk_bf16_f32 v180, v136, v137
    v_cvt_pk_bf16_f32 v181, v138, v139
    s_waitcnt lgkmcnt(5)
    v_mfma_f32_16x16x32_bf16 v[144:147], v[96:99], v[216:219], v[144:147]
    v_mfma_f32_16x16x32_bf16 v[148:151], v[100:103], v[216:219], v[148:151]
    ds_read_b128 v[208:211], v234 offset:49152
    v_cvt_pk_bf16_f32 v182, v140, v141
    s_waitcnt lgkmcnt(5)
    v_mfma_f32_16x16x32_bf16 v[152:155], v[96:99], v[220:223], v[152:155]
    v_mfma_f32_16x16x32_bf16 v[156:159], v[100:103], v[220:223], v[156:159]
    ds_read_b128 v[212:215], v234 offset:53248
    v_cvt_pk_bf16_f32 v183, v142, v143
    s_waitcnt lgkmcnt(5)
    v_mfma_f32_16x16x32_bf16 v[144:147], v[8:11], v[192:195], v[144:147]
    v_mfma_f32_16x16x32_bf16 v[148:151], v[12:15], v[192:195], v[148:151]
    ds_read_b128 v[216:219], v234 offset:57344
    s_add_u32 s51, s27, 49152
    buffer_store_dwordx4 v[176:179], v232, s[16:19], s51 offen sc1
    s_waitcnt lgkmcnt(5)
    v_mfma_f32_16x16x32_bf16 v[152:155], v[8:11], v[196:199], v[152:155]
    v_mfma_f32_16x16x32_bf16 v[156:159], v[12:15], v[196:199], v[156:159]
    ds_read_b128 v[220:223], v234 offset:61440
    s_waitcnt lgkmcnt(5)
    v_mfma_f32_16x16x32_bf16 v[144:147], v[40:43], v[200:203], v[144:147]
    v_mfma_f32_16x16x32_bf16 v[148:151], v[44:47], v[200:203], v[148:151]
    v_xor_b32 v235, 128, v233
    ds_read_b128 v[192:195], v235 offset:32768
    s_waitcnt lgkmcnt(5)
    v_mfma_f32_16x16x32_bf16 v[152:155], v[40:43], v[204:207], v[152:155]
    v_mfma_f32_16x16x32_bf16 v[156:159], v[44:47], v[204:207], v[156:159]
    ds_read_b128 v[196:199], v235 offset:36864
    s_waitcnt lgkmcnt(5)
    v_mfma_f32_16x16x32_bf16 v[144:147], v[72:75], v[208:211], v[144:147]
    v_mfma_f32_16x16x32_bf16 v[148:151], v[76:79], v[208:211], v[148:151]
    ds_read_b128 v[200:203], v235 offset:40960
    s_waitcnt lgkmcnt(5)
    v_mfma_f32_16x16x32_bf16 v[152:155], v[72:75], v[212:215], v[152:155]
    v_mfma_f32_16x16x32_bf16 v[156:159], v[76:79], v[212:215], v[156:159]
    ds_read_b128 v[204:207], v235 offset:45056
    s_waitcnt lgkmcnt(5)
    v_mfma_f32_16x16x32_bf16 v[144:147], v[104:107], v[216:219], v[144:147]
    v_mfma_f32_16x16x32_bf16 v[148:151], v[108:111], v[216:219], v[148:151]
    ds_read_b128 v[208:211], v235 offset:49152
    s_waitcnt lgkmcnt(5)
    v_mfma_f32_16x16x32_bf16 v[152:155], v[104:107], v[220:223], v[152:155]
    v_mfma_f32_16x16x32_bf16 v[156:159], v[108:111], v[220:223], v[156:159]
    ds_read_b128 v[212:215], v235 offset:53248
    s_waitcnt lgkmcnt(5)
    v_mfma_f32_16x16x32_bf16 v[144:147], v[16:19], v[192:195], v[144:147]
    v_mfma_f32_16x16x32_bf16 v[148:151], v[20:23], v[192:195], v[148:151]
    ds_read_b128 v[216:219], v235 offset:57344
    s_waitcnt lgkmcnt(5)
    v_mfma_f32_16x16x32_bf16 v[152:155], v[16:19], v[196:199], v[152:155]
    v_mfma_f32_16x16x32_bf16 v[156:159], v[20:23], v[196:199], v[156:159]
    ds_read_b128 v[220:223], v235 offset:61440
    s_add_u32 s51, s27, 49152
    buffer_store_dwordx4 v[180:183], v232, s[16:19], s51 offen offset:1024 sc1
    s_waitcnt lgkmcnt(5)
    v_mfma_f32_16x16x32_bf16 v[144:147], v[48:51], v[200:203], v[144:147]
    v_mfma_f32_16x16x32_bf16 v[148:151], v[52:55], v[200:203], v[148:151]
    v_xor_b32 v234, 192, v233
    ds_read_b128 v[192:195], v234 offset:32768
    s_waitcnt lgkmcnt(5)
    v_mfma_f32_16x16x32_bf16 v[152:155], v[48:51], v[204:207], v[152:155]
    v_mfma_f32_16x16x32_bf16 v[156:159], v[52:55], v[204:207], v[156:159]
    ds_read_b128 v[196:199], v234 offset:36864
    s_waitcnt lgkmcnt(5)
    v_mfma_f32_16x16x32_bf16 v[144:147], v[80:83], v[208:211], v[144:147]
    v_mfma_f32_16x16x32_bf16 v[148:151], v[84:87], v[208:211], v[148:151]
    ds_read_b128 v[200:203], v234 offset:40960
    s_waitcnt lgkmcnt(5)
    v_mfma_f32_16x16x32_bf16 v[152:155], v[80:83], v[212:215], v[152:155]
    v_mfma_f32_16x16x32_bf16 v[156:159], v[84:87], v[212:215], v[156:159]
    ds_read_b128 v[204:207], v234 offset:45056
    s_waitcnt lgkmcnt(5)
    v_mfma_f32_16x16x32_bf16 v[144:147], v[112:115], v[216:219], v[144:147]
    v_mfma_f32_16x16x32_bf16 v[148:151], v[116:119], v[216:219], v[148:151]
    ds_read_b128 v[208:211], v234 offset:49152
    s_waitcnt lgkmcnt(5)
    v_mfma_f32_16x16x32_bf16 v[152:155], v[112:115], v[220:223], v[152:155]
    v_mfma_f32_16x16x32_bf16 v[156:159], v[116:119], v[220:223], v[156:159]
    ds_read_b128 v[212:215], v234 offset:53248
    s_waitcnt lgkmcnt(5)
    v_mfma_f32_16x16x32_bf16 v[144:147], v[24:27], v[192:195], v[144:147]
    v_mfma_f32_16x16x32_bf16 v[148:151], v[28:31], v[192:195], v[148:151]
    ds_read_b128 v[216:219], v234 offset:57344
    s_waitcnt lgkmcnt(5)
    v_mfma_f32_16x16x32_bf16 v[152:155], v[24:27], v[196:199], v[152:155]
    v_mfma_f32_16x16x32_bf16 v[156:159], v[28:31], v[196:199], v[156:159]
    ds_read_b128 v[220:223], v234 offset:61440
    s_waitcnt lgkmcnt(5)
    v_mfma_f32_16x16x32_bf16 v[144:147], v[56:59], v[200:203], v[144:147]
    v_mfma_f32_16x16x32_bf16 v[148:151], v[60:63], v[200:203], v[148:151]
    s_waitcnt lgkmcnt(4)
    v_mfma_f32_16x16x32_bf16 v[152:155], v[56:59], v[204:207], v[152:155]
    v_mfma_f32_16x16x32_bf16 v[156:159], v[60:63], v[204:207], v[156:159]
    s_waitcnt lgkmcnt(3)
    v_mfma_f32_16x16x32_bf16 v[144:147], v[88:91], v[208:211], v[144:147]
    v_mfma_f32_16x16x32_bf16 v[148:151], v[92:95], v[208:211], v[148:151]
    s_waitcnt lgkmcnt(2)
    v_mfma_f32_16x16x32_bf16 v[152:155], v[88:91], v[212:215], v[152:155]
    v_mfma_f32_16x16x32_bf16 v[156:159], v[92:95], v[212:215], v[156:159]
    s_waitcnt lgkmcnt(1)
    v_mfma_f32_16x16x32_bf16 v[144:147], v[120:123], v[216:219], v[144:147]
    v_mfma_f32_16x16x32_bf16 v[148:151], v[124:127], v[216:219], v[148:151]
    s_waitcnt lgkmcnt(0)
    v_mfma_f32_16x16x32_bf16 v[152:155], v[120:123], v[220:223], v[152:155]
    v_mfma_f32_16x16x32_bf16 v[156:159], v[124:127], v[220:223], v[156:159]
    s_nop 3
    v_cvt_pk_bf16_f32 v168, v144, v145
    v_cvt_pk_bf16_f32 v169, v146, v147
    v_cvt_pk_bf16_f32 v170, v148, v149
    v_cvt_pk_bf16_f32 v171, v150, v151
    v_cvt_pk_bf16_f32 v172, v152, v153
    v_cvt_pk_bf16_f32 v173, v154, v155
    v_cvt_pk_bf16_f32 v174, v156, v157
    v_cvt_pk_bf16_f32 v175, v158, v159
    s_add_u32 s51, s27, 57344
    buffer_store_dwordx4 v[168:171], v232, s[16:19], s51 offen sc1
    s_add_u32 s51, s27, 57344
    buffer_store_dwordx4 v[172:175], v232, s[16:19], s51 offen offset:1024 sc1
    s_endpgm
k1_kernel_vpart:
    s_waitcnt vmcnt(7)
    ds_read_b64_tr_b16 v[0:1], v238 offset:0
    ds_read_b64_tr_b16 v[2:3], v238 offset:256
    ds_read_b64_tr_b16 v[4:5], v237 offset:0
    ds_read_b64_tr_b16 v[6:7], v237 offset:256
    v_xor_b32 v235, 0, v233
    ds_read_b128 v[192:195], v235 offset:0
    s_waitcnt lgkmcnt(0)
    v_mfma_f32_16x16x32_bf16 v[128:131], v[192:195], v[0:3], 0
    v_mfma_f32_16x16x32_bf16 v[136:139], v[192:195], v[4:7], 0
    ds_read_b128 v[196:199], v235 offset:4096
    ds_read_b128 v[200:203], v235 offset:8192
    ds_read_b128 v[204:207], v235 offset:12288
    v_xor_b32 v234, 64, v233
    ds_read_b128 v[208:211], v234 offset:0
    ds_read_b128 v[212:215], v234 offset:4096
    ds_read_b128 v[216:219], v234 offset:8192
    s_waitcnt vmcnt(5)
    ds_read_b64_tr_b16 v[8:9], v238 offset:2048
    ds_read_b64_tr_b16 v[10:11], v238 offset:2304
    ds_read_b64_tr_b16 v[12:13], v237 offset:2048
    ds_read_b64_tr_b16 v[14:15], v237 offset:2304
    s_waitcnt lgkmcnt(9)
    v_mfma_f32_16x16x32_bf16 v[132:135], v[196:199], v[0:3], 0
    v_mfma_f32_16x16x32_bf16 v[140:143], v[196:199], v[4:7], 0
    ds_read_b128 v[220:223], v234 offset:12288
    s_waitcnt lgkmcnt(9)
    v_mfma_f32_16x16x32_bf16 v[144:147], v[200:203], v[0:3], 0
    v_mfma_f32_16x16x32_bf16 v[152:155], v[200:203], v[4:7], 0
    v_xor_b32 v235, 128, v233
    ds_read_b128 v[192:195], v235 offset:0
    s_add_u32 m0, s35, 0
    s_mov_b32 s32, 1048576
    buffer_load_dwordx4 v236, s[12:15], s32 offen lds
    s_add_u32 m0, s35, 1024
    s_mov_b32 s32, 1179648
    buffer_load_dwordx4 v236, s[12:15], s32 offen lds
    s_add_u32 s25, s53, 512
    s_waitcnt lgkmcnt(9)
    v_mfma_f32_16x16x32_bf16 v[148:151], v[204:207], v[0:3], 0
    v_mfma_f32_16x16x32_bf16 v[156:159], v[204:207], v[4:7], 0
    ds_read_b128 v[196:199], v235 offset:4096
    s_add_u32 m0, s28, 32768
    s_nop 0
    buffer_load_dwordx4 v243, s[8:11], s25 offen offset:0 lds
    s_waitcnt lgkmcnt(5)
    v_mfma_f32_16x16x32_bf16 v[128:131], v[208:211], v[8:11], v[128:131]
    s_waitcnt lgkmcnt(3)
    v_mfma_f32_16x16x32_bf16 v[136:139], v[208:211], v[12:15], v[136:139]
    ds_read_b128 v[200:203], v235 offset:8192
    s_waitcnt vmcnt(6)
    ds_read_b64_tr_b16 v[16:17], v238 offset:4096
    ds_read_b64_tr_b16 v[18:19], v238 offset:4352
    ds_read_b64_tr_b16 v[20:21], v237 offset:4096
    ds_read_b64_tr_b16 v[22:23], v237 offset:4352
    s_add_u32 m0, s28, 32768
    s_nop 0
    buffer_load_dwordx4 v244, s[8:11], s25 offen offset:1024 lds
    v_mfma_f32_16x16x32_bf16 v[132:135], v[212:215], v[8:11], v[132:135]
    v_mfma_f32_16x16x32_bf16 v[140:143], v[212:215], v[12:15], v[140:143]
    ds_read_b128 v[204:207], v235 offset:12288
    s_add_u32 m0, s28, 32768
    s_nop 0
    buffer_load_dwordx4 v245, s[8:11], s25 offen offset:2048 lds
    v_mfma_f32_16x16x32_bf16 v[144:147], v[216:219], v[8:11], v[144:147]
    v_mfma_f32_16x16x32_bf16 v[152:155], v[216:219], v[12:15], v[152:155]
    v_xor_b32 v234, 192, v233
    ds_read_b128 v[208:211], v234 offset:0
    s_add_u32 m0, s35, 2048
    s_mov_b32 s32, 1310720
    buffer_load_dwordx4 v236, s[12:15], s32 offen lds
    s_add_u32 m0, s35, 3072
    s_mov_b32 s32, 1441792
    buffer_load_dwordx4 v236, s[12:15], s32 offen lds
    s_add_u32 m0, s28, 32768
    s_nop 0
    buffer_load_dwordx4 v246, s[8:11], s25 offen offset:3072 lds
    s_waitcnt lgkmcnt(9)
    v_mfma_f32_16x16x32_bf16 v[148:151], v[220:223], v[8:11], v[148:151]
    v_mfma_f32_16x16x32_bf16 v[156:159], v[220:223], v[12:15], v[156:159]
    ds_read_b128 v[212:215], v234 offset:4096
    s_waitcnt lgkmcnt(5)
    v_mfma_f32_16x16x32_bf16 v[128:131], v[192:195], v[16:19], v[128:131]
    s_waitcnt lgkmcnt(3)
    v_mfma_f32_16x16x32_bf16 v[136:139], v[192:195], v[20:23], v[136:139]
    ds_read_b128 v[216:219], v234 offset:8192
    s_waitcnt vmcnt(9)
    ds_read_b64_tr_b16 v[24:25], v238 offset:6144
    ds_read_b64_tr_b16 v[26:27], v238 offset:6400
    ds_read_b64_tr_b16 v[28:29], v237 offset:6144
    ds_read_b64_tr_b16 v[30:31], v237 offset:6400
    s_lshr_b32 s74, s2, 3
    s_lshl_b32 s74, s74, 3
    s_add_u32 s74, s74, s24
    v_mfma_f32_16x16x32_bf16 v[132:135], v[196:199], v[16:19], v[132:135]
    v_mfma_f32_16x16x32_bf16 v[140:143], v[196:199], v[20:23], v[140:143]
    ds_read_b128 v[220:223], v234 offset:12288
    v_mfma_f32_16x16x32_bf16 v[144:147], v[200:203], v[16:19], v[144:147]
    v_mfma_f32_16x16x32_bf16 v[152:155], v[200:203], v[20:23], v[152:155]
    v_xor_b32 v235, 0, v233
    ds_read_b128 v[192:195], v235 offset:16384
    s_add_u32 m0, s35, 4096
    s_mov_b32 s32, 1572864
    buffer_load_dwordx4 v236, s[12:15], s32 offen lds
    s_add_u32 m0, s35, 5120
    s_mov_b32 s32, 1703936
    buffer_load_dwordx4 v236, s[12:15], s32 offen lds
    s_waitcnt lgkmcnt(9)
    v_mfma_f32_16x16x32_bf16 v[148:151], v[204:207], v[16:19], v[148:151]
    v_mfma_f32_16x16x32_bf16 v[156:159], v[204:207], v[20:23], v[156:159]
    ds_read_b128 v[196:199], v235 offset:20480
    s_and_b32 s75, s2, 7
    s_mul_i32 s75, s75, 37
    s_add_u32 s74, s74, s75
    s_and_b32 s74, s74, 255
    s_waitcnt lgkmcnt(5)
    v_mfma_f32_16x16x32_bf16 v[128:131], v[208:211], v[24:27], v[128:131]
    s_waitcnt lgkmcnt(3)
    v_mfma_f32_16x16x32_bf16 v[136:139], v[208:211], v[28:31], v[136:139]
    ds_read_b128 v[200:203], v235 offset:24576
    s_waitcnt vmcnt(8)
    ds_read_b64_tr_b16 v[32:33], v238 offset:0
    ds_read_b64_tr_b16 v[34:35], v238 offset:256
    ds_read_b64_tr_b16 v[36:37], v237 offset:0
    ds_read_b64_tr_b16 v[38:39], v237 offset:256
    v_mfma_f32_16x16x32_bf16 v[132:135], v[212:215], v[24:27], v[132:135]
    v_mfma_f32_16x16x32_bf16 v[140:143], v[212:215], v[28:31], v[140:143]
    ds_read_b128 v[204:207], v235 offset:28672
    v_mfma_f32_16x16x32_bf16 v[144:147], v[216:219], v[24:27], v[144:147]
    v_mfma_f32_16x16x32_bf16 v[152:155], v[216:219], v[28:31], v[152:155]
    v_xor_b32 v234, 64, v233
    ds_read_b128 v[208:211], v234 offset:16384
    s_add_u32 m0, s35, 6144
    s_mov_b32 s32, 1835008
    buffer_load_dwordx4 v236, s[12:15], s32 offen lds
    s_add_u32 m0, s35, 7168
    s_mov_b32 s32, 1966080
    buffer_load_dwordx4 v236, s[12:15], s32 offen lds
    s_waitcnt lgkmcnt(9)
    v_mfma_f32_16x16x32_bf16 v[148:151], v[220:223], v[24:27], v[148:151]
    v_mfma_f32_16x16x32_bf16 v[156:159], v[220:223], v[28:31], v[156:159]
    ds_read_b128 v[212:215], v234 offset:20480
    v_and_b32 v242, 0xf0, v232
    v_lshlrev_b32 v242, 3, v242
    s_waitcnt lgkmcnt(5)
    v_mfma_f32_16x16x32_bf16 v[128:131], v[192:195], v[32:35], v[128:131]
    s_waitcnt lgkmcnt(3)
    v_mfma_f32_16x16x32_bf16 v[136:139], v[192:195], v[36:39], v[136:139]
    ds_read_b128 v[216:219], v234 offset:24576
    s_waitcnt vmcnt(5)
    ds_read_b64_tr_b16 v[40:41], v238 offset:2048
    ds_read_b64_tr_b16 v[42:43], v238 offset:2304
    ds_read_b64_tr_b16 v[44:45], v237 offset:2048
    ds_read_b64_tr_b16 v[46:47], v237 offset:2304
    v_mfma_f32_16x16x32_bf16 v[132:135], v[196:199], v[32:35], v[132:135]
    v_mfma_f32_16x16x32_bf16 v[140:143], v[196:199], v[36:39], v[140:143]
    ds_read_b128 v[220:223], v234 offset:28672
    v_mfma_f32_16x16x32_bf16 v[144:147], v[200:203], v[32:35], v[144:147]
    v_mfma_f32_16x16x32_bf16 v[152:155], v[200:203], v[36:39], v[152:155]
    v_xor_b32 v235, 128, v233
    ds_read_b128 v[192:195], v235 offset:16384
    s_add_u32 m0, s35, 0
    s_mov_b32 s32, 2097152
    buffer_load_dwordx4 v236, s[12:15], s32 offen lds
    s_add_u32 m0, s35, 1024
    s_mov_b32 s32, 2228224
    buffer_load_dwordx4 v236, s[12:15], s32 offen lds
    s_lshr_b32 s75, s74, 5
    s_lshl_b32 s75, s75, 18
    s_and_b32 s74, s74, 31
    s_lshl_b32 s74, s74, 11
    s_add_u32 s75, s75, s74
    s_add_u32 s75, s75, 65536
    s_waitcnt lgkmcnt(9)
    v_mfma_f32_16x16x32_bf16 v[148:151], v[204:207], v[32:35], v[148:151]
    v_mfma_f32_16x16x32_bf16 v[156:159], v[204:207], v[36:39], v[156:159]
    ds_read_b128 v[196:199], v235 offset:20480
    s_waitcnt lgkmcnt(5)
    v_mfma_f32_16x16x32_bf16 v[128:131], v[208:211], v[40:43], v[128:131]
    s_waitcnt lgkmcnt(3)
    v_mfma_f32_16x16x32_bf16 v[136:139], v[208:211], v[44:47], v[136:139]
    ds_read_b128 v[200:203], v235 offset:24576
    s_waitcnt vmcnt(4)
    ds_read_b64_tr_b16 v[48:49], v238 offset:4096
    ds_read_b64_tr_b16 v[50:51], v238 offset:4352
    ds_read_b64_tr_b16 v[52:53], v237 offset:4096
    ds_read_b64_tr_b16 v[54:55], v237 offset:4352
    v_mfma_f32_16x16x32_bf16 v[132:135], v[212:215], v[40:43], v[132:135]
    v_mfma_f32_16x16x32_bf16 v[140:143], v[212:215], v[44:47], v[140:143]
    ds_read_b128 v[204:207], v235 offset:28672
    v_mfma_f32_16x16x32_bf16 v[144:147], v[216:219], v[40:43], v[144:147]
    v_mfma_f32_16x16x32_bf16 v[152:155], v[216:219], v[44:47], v[152:155]
    v_xor_b32 v234, 192, v233
    ds_read_b128 v[208:211], v234 offset:16384
    s_add_u32 m0, s35, 2048
    s_mov_b32 s32, 2359296
    buffer_load_dwordx4 v236, s[12:15], s32 offen lds
    s_add_u32 m0, s35, 3072
    s_mov_b32 s32, 2490368
    buffer_load_dwordx4 v236, s[12:15], s32 offen lds
    buffer_load_dword v255, v242, s[8:11], s75 offen
    s_waitcnt lgkmcnt(9)
    v_mfma_f32_16x16x32_bf16 v[148:151], v[220:223], v[40:43], v[148:151]
    v_mfma_f32_16x16x32_bf16 v[156:159], v[220:223], v[44:47], v[156:159]
    ds_read_b128 v[212:215], v234 offset:20480
    s_waitcnt lgkmcnt(5)
    v_mfma_f32_16x16x32_bf16 v[128:131], v[192:195], v[48:51], v[128:131]
    s_waitcnt lgkmcnt(3)
    v_mfma_f32_16x16x32_bf16 v[136:139], v[192:195], v[52:55], v[136:139]
    ds_read_b128 v[216:219], v234 offset:24576
    s_waitcnt vmcnt(5)
    ds_read_b64_tr_b16 v[56:57], v238 offset:6144
    ds_read_b64_tr_b16 v[58:59], v238 offset:6400
    ds_read_b64_tr_b16 v[60:61], v237 offset:6144
    ds_read_b64_tr_b16 v[62:63], v237 offset:6400
    v_mfma_f32_16x16x32_bf16 v[132:135], v[196:199], v[48:51], v[132:135]
    v_mfma_f32_16x16x32_bf16 v[140:143], v[196:199], v[52:55], v[140:143]
    ds_read_b128 v[220:223], v234 offset:28672
    s_barrier
    v_mfma_f32_16x16x32_bf16 v[144:147], v[200:203], v[48:51], v[144:147]
    v_mfma_f32_16x16x32_bf16 v[152:155], v[200:203], v[52:55], v[152:155]
    v_xor_b32 v235, 0, v233
    ds_read_b128 v[192:195], v235 offset:32768
    s_add_u32 m0, s35, 4096
    s_mov_b32 s32, 2621440
    buffer_load_dwordx4 v236, s[12:15], s32 offen lds
    s_add_u32 m0, s35, 5120
    s_mov_b32 s32, 2752512
    buffer_load_dwordx4 v236, s[12:15], s32 offen lds
    s_add_u32 s25, s54, 65536
    s_waitcnt lgkmcnt(9)
    v_mfma_f32_16x16x32_bf16 v[148:151], v[204:207], v[48:51], v[148:151]
    v_mfma_f32_16x16x32_bf16 v[156:159], v[204:207], v[52:55], v[156:159]
    ds_read_b128 v[196:199], v235 offset:36864
    s_add_u32 m0, s28, 65536
    s_nop 0
    buffer_load_dwordx4 v243, s[8:11], s25 offen offset:0 lds
    s_waitcnt lgkmcnt(5)
    v_mfma_f32_16x16x32_bf16 v[128:131], v[208:211], v[56:59], v[128:131]
    s_waitcnt lgkmcnt(3)
    v_mfma_f32_16x16x32_bf16 v[136:139], v[208:211], v[60:63], v[136:139]
    ds_read_b128 v[200:203], v235 offset:40960
    s_waitcnt vmcnt(6)
    ds_read_b64_tr_b16 v[64:65], v238 offset:0
    ds_read_b64_tr_b16 v[66:67], v238 offset:256
    ds_read_b64_tr_b16 v[68:69], v237 offset:0
    ds_read_b64_tr_b16 v[70:71], v237 offset:256
    s_add_u32 m0, s28, 65536
    s_nop 0
    buffer_load_dwordx4 v244, s[8:11], s25 offen offset:1024 lds
    v_mfma_f32_16x16x32_bf16 v[132:135], v[212:215], v[56:59], v[132:135]
    v_mfma_f32_16x16x32_bf16 v[140:143], v[212:215], v[60:63], v[140:143]
    ds_read_b128 v[204:207], v235 offset:45056
    s_add_u32 m0, s28, 65536
    s_nop 0
    buffer_load_dwordx4 v245, s[8:11], s25 offen offset:2048 lds
    v_mfma_f32_16x16x32_bf16 v[144:147], v[216:219], v[56:59], v[144:147]
    v_mfma_f32_16x16x32_bf16 v[152:155], v[216:219], v[60:63], v[152:155]
    v_xor_b32 v234, 64, v233
    ds_read_b128 v[208:211], v234 offset:32768
    s_add_u32 m0, s35, 6144
    s_mov_b32 s32, 2883584
    buffer_load_dwordx4 v236, s[12:15], s32 offen lds
    s_add_u32 m0, s35, 7168
    s_mov_b32 s32, 3014656
    buffer_load_dwordx4 v236, s[12:15], s32 offen lds
    s_add_u32 m0, s28, 65536
    s_nop 0
    buffer_load_dwordx4 v246, s[8:11], s25 offen offset:3072 lds
    s_waitcnt lgkmcnt(9)
    v_mfma_f32_16x16x32_bf16 v[148:151], v[220:223], v[56:59], v[148:151]
    v_mfma_f32_16x16x32_bf16 v[156:159], v[220:223], v[60:63], v[156:159]
    ds_read_b128 v[212:215], v234 offset:36864
    s_waitcnt lgkmcnt(5)
    v_mfma_f32_16x16x32_bf16 v[128:131], v[192:195], v[64:67], v[128:131]
    s_waitcnt lgkmcnt(3)
    v_mfma_f32_16x16x32_bf16 v[136:139], v[192:195], v[68:71], v[136:139]
    ds_read_b128 v[216:219], v234 offset:40960
    s_waitcnt vmcnt(9)
    ds_read_b64_tr_b16 v[72:73], v238 offset:2048
    ds_read_b64_tr_b16 v[74:75], v238 offset:2304
    ds_read_b64_tr_b16 v[76:77], v237 offset:2048
    ds_read_b64_tr_b16 v[78:79], v237 offset:2304
    v_mfma_f32_16x16x32_bf16 v[132:135], v[196:199], v[64:67], v[132:135]
    v_mfma_f32_16x16x32_bf16 v[140:143], v[196:199], v[68:71], v[140:143]
    ds_read_b128 v[220:223], v234 offset:45056
    v_mfma_f32_16x16x32_bf16 v[144:147], v[200:203], v[64:67], v[144:147]
    v_mfma_f32_16x16x32_bf16 v[152:155], v[200:203], v[68:71], v[152:155]
    v_xor_b32 v235, 128, v233
    ds_read_b128 v[192:195], v235 offset:32768
    s_add_u32 m0, s35, 0
    s_mov_b32 s32, 3145728
    buffer_load_dwordx4 v236, s[12:15], s32 offen lds
    s_add_u32 m0, s35, 1024
    s_mov_b32 s32, 3276800
    buffer_load_dwordx4 v236, s[12:15], s32 offen lds
    s_waitcnt lgkmcnt(9)
    v_mfma_f32_16x16x32_bf16 v[148:151], v[204:207], v[64:67], v[148:151]
    v_mfma_f32_16x16x32_bf16 v[156:159], v[204:207], v[68:71], v[156:159]
    ds_read_b128 v[196:199], v235 offset:36864
    s_waitcnt lgkmcnt(5)
    v_mfma_f32_16x16x32_bf16 v[128:131], v[208:211], v[72:75], v[128:131]
    s_waitcnt lgkmcnt(3)
    v_mfma_f32_16x16x32_bf16 v[136:139], v[208:211], v[76:79], v[136:139]
    ds_read_b128 v[200:203], v235 offset:40960
    s_waitcnt vmcnt(8)
    ds_read_b64_tr_b16 v[80:81], v238 offset:4096
    ds_read_b64_tr_b16 v[82:83], v238 offset:4352
    ds_read_b64_tr_b16 v[84:85], v237 offset:4096
    ds_read_b64_tr_b16 v[86:87], v237 offset:4352
    v_mfma_f32_16x16x32_bf16 v[132:135], v[212:215], v[72:75], v[132:135]
    v_mfma_f32_16x16x32_bf16 v[140:143], v[212:215], v[76:79], v[140:143]
    ds_read_b128 v[204:207], v235 offset:45056
    v_mfma_f32_16x16x32_bf16 v[144:147], v[216:219], v[72:75], v[144:147]
    v_mfma_f32_16x16x32_bf16 v[152:155], v[216:219], v[76:79], v[152:155]
    v_xor_b32 v234, 192, v233
    ds_read_b128 v[208:211], v234 offset:32768
    s_add_u32 m0, s35, 2048
    s_mov_b32 s32, 3407872
    buffer_load_dwordx4 v236, s[12:15], s32 offen lds
    s_add_u32 m0, s35, 3072
    s_mov_b32 s32, 3538944
    buffer_load_dwordx4 v236, s[12:15], s32 offen lds
    s_waitcnt lgkmcnt(9)
    v_mfma_f32_16x16x32_bf16 v[148:151], v[220:223], v[72:75], v[148:151]
    v_mfma_f32_16x16x32_bf16 v[156:159], v[220:223], v[76:79], v[156:159]
    ds_read_b128 v[212:215], v234 offset:36864
    s_waitcnt lgkmcnt(5)
    v_mfma_f32_16x16x32_bf16 v[128:131], v[192:195], v[80:83], v[128:131]
    s_waitcnt lgkmcnt(3)
    v_mfma_f32_16x16x32_bf16 v[136:139], v[192:195], v[84:87], v[136:139]
    ds_read_b128 v[216:219], v234 offset:40960
    s_waitcnt vmcnt(5)
    ds_read_b64_tr_b16 v[88:89], v238 offset:6144
    ds_read_b64_tr_b16 v[90:91], v238 offset:6400
    ds_read_b64_tr_b16 v[92:93], v237 offset:6144
    ds_read_b64_tr_b16 v[94:95], v237 offset:6400
    s_lshr_b32 s74, s2, 3
    s_lshl_b32 s74, s74, 3
    s_add_u32 s74, s74, s24
    v_mfma_f32_16x16x32_bf16 v[132:135], v[196:199], v[80:83], v[132:135]
    v_mfma_f32_16x16x32_bf16 v[140:143], v[196:199], v[84:87], v[140:143]
    ds_read_b128 v[220:223], v234 offset:45056
    v_mfma_f32_16x16x32_bf16 v[144:147], v[200:203], v[80:83], v[144:147]
    v_mfma_f32_16x16x32_bf16 v[152:155], v[200:203], v[84:87], v[152:155]
    v_xor_b32 v235, 0, v233
    ds_read_b128 v[192:195], v235 offset:49152
    s_add_u32 m0, s35, 4096
    s_mov_b32 s32, 3670016
    buffer_load_dwordx4 v236, s[12:15], s32 offen lds
    s_add_u32 m0, s35, 5120
    s_mov_b32 s32, 3801088
    buffer_load_dwordx4 v236, s[12:15], s32 offen lds
    s_waitcnt lgkmcnt(9)
    v_mfma_f32_16x16x32_bf16 v[148:151], v[204:207], v[80:83], v[148:151]
    v_mfma_f32_16x16x32_bf16 v[156:159], v[204:207], v[84:87], v[156:159]
    ds_read_b128 v[196:199], v235 offset:53248
    s_and_b32 s75, s2, 7
    s_mul_i32 s75, s75, 37
    s_add_u32 s74, s74, s75
    s_and_b32 s74, s74, 255
    s_waitcnt lgkmcnt(5)
    v_mfma_f32_16x16x32_bf16 v[128:131], v[208:211], v[88:91], v[128:131]
    s_waitcnt lgkmcnt(3)
    v_mfma_f32_16x16x32_bf16 v[136:139], v[208:211], v[92:95], v[136:139]
    ds_read_b128 v[200:203], v235 offset:57344
    s_waitcnt vmcnt(4)
    ds_read_b64_tr_b16 v[96:97], v238 offset:0
    ds_read_b64_tr_b16 v[98:99], v238 offset:256
    ds_read_b64_tr_b16 v[100:101], v237 offset:0
    ds_read_b64_tr_b16 v[102:103], v237 offset:256
    v_mfma_f32_16x16x32_bf16 v[132:135], v[212:215], v[88:91], v[132:135]
    v_mfma_f32_16x16x32_bf16 v[140:143], v[212:215], v[92:95], v[140:143]
    ds_read_b128 v[204:207], v235 offset:61440
    v_mfma_f32_16x16x32_bf16 v[144:147], v[216:219], v[88:91], v[144:147]
    v_mfma_f32_16x16x32_bf16 v[152:155], v[216:219], v[92:95], v[152:155]
    v_xor_b32 v234, 64, v233
    ds_read_b128 v[208:211], v234 offset:49152
    s_add_u32 m0, s35, 6144
    s_mov_b32 s32, 3932160
    buffer_load_dwordx4 v236, s[12:15], s32 offen lds
    s_add_u32 m0, s35, 7168
    s_mov_b32 s32, 4063232
    buffer_load_dwordx4 v236, s[12:15], s32 offen lds
    s_waitcnt lgkmcnt(9)
    v_mfma_f32_16x16x32_bf16 v[148:151], v[220:223], v[88:91], v[148:151]
    v_mfma_f32_16x16x32_bf16 v[156:159], v[220:223], v[92:95], v[156:159]
    ds_read_b128 v[212:215], v234 offset:53248
    v_and_b32 v242, 0xf0, v232
    v_lshlrev_b32 v242, 3, v242
    s_waitcnt lgkmcnt(5)
    v_mfma_f32_16x16x32_bf16 v[128:131], v[192:195], v[96:99], v[128:131]
    s_waitcnt lgkmcnt(3)
    v_mfma_f32_16x16x32_bf16 v[136:139], v[192:195], v[100:103], v[136:139]
    ds_read_b128 v[216:219], v234 offset:57344
    s_waitcnt vmcnt(4)
    ds_read_b64_tr_b16 v[104:105], v238 offset:2048
    ds_read_b64_tr_b16 v[106:107], v238 offset:2304
    ds_read_b64_tr_b16 v[108:109], v237 offset:2048
    ds_read_b64_tr_b16 v[110:111], v237 offset:2304
    v_mfma_f32_16x16x32_bf16 v[132:135], v[196:199], v[96:99], v[132:135]
    v_mfma_f32_16x16x32_bf16 v[140:143], v[196:199], v[100:103], v[140:143]
    ds_read_b128 v[220:223], v234 offset:61440
    v_mfma_f32_16x16x32_bf16 v[144:147], v[200:203], v[96:99], v[144:147]
    v_mfma_f32_16x16x32_bf16 v[152:155], v[200:203], v[100:103], v[152:155]
    v_xor_b32 v235, 128, v233
    ds_read_b128 v[192:195], v235 offset:49152
    s_lshr_b32 s75, s74, 5
    s_lshl_b32 s75, s75, 18
    s_and_b32 s74, s74, 31
    s_lshl_b32 s74, s74, 11
    s_add_u32 s75, s75, s74
    s_add_u32 s75, s75, 131072
    s_waitcnt lgkmcnt(9)
    v_mfma_f32_16x16x32_bf16 v[148:151], v[204:207], v[96:99], v[148:151]
    v_mfma_f32_16x16x32_bf16 v[156:159], v[204:207], v[100:103], v[156:159]
    ds_read_b128 v[196:199], v235 offset:53248
    s_waitcnt lgkmcnt(5)
    v_mfma_f32_16x16x32_bf16 v[128:131], v[208:211], v[104:107], v[128:131]
    s_waitcnt lgkmcnt(3)
    v_mfma_f32_16x16x32_bf16 v[136:139], v[208:211], v[108:111], v[136:139]
    ds_read_b128 v[200:203], v235 offset:57344
    s_waitcnt vmcnt(2)
    ds_read_b64_tr_b16 v[112:113], v238 offset:4096
    ds_read_b64_tr_b16 v[114:115], v238 offset:4352
    ds_read_b64_tr_b16 v[116:117], v237 offset:4096
    ds_read_b64_tr_b16 v[118:119], v237 offset:4352
    v_mfma_f32_16x16x32_bf16 v[132:135], v[212:215], v[104:107], v[132:135]
    v_mfma_f32_16x16x32_bf16 v[140:143], v[212:215], v[108:111], v[140:143]
    ds_read_b128 v[204:207], v235 offset:61440
    v_mfma_f32_16x16x32_bf16 v[144:147], v[216:219], v[104:107], v[144:147]
    v_mfma_f32_16x16x32_bf16 v[152:155], v[216:219], v[108:111], v[152:155]
    v_xor_b32 v234, 192, v233
    ds_read_b128 v[208:211], v234 offset:49152
    buffer_load_dword v255, v242, s[8:11], s75 offen
    s_waitcnt lgkmcnt(9)
    v_mfma_f32_16x16x32_bf16 v[148:151], v[220:223], v[104:107], v[148:151]
    v_mfma_f32_16x16x32_bf16 v[156:159], v[220:223], v[108:111], v[156:159]
    ds_read_b128 v[212:215], v234 offset:53248
    s_waitcnt lgkmcnt(5)
    v_mfma_f32_16x16x32_bf16 v[128:131], v[192:195], v[112:115], v[128:131]
    s_waitcnt lgkmcnt(3)
    v_mfma_f32_16x16x32_bf16 v[136:139], v[192:195], v[116:119], v[136:139]
    ds_read_b128 v[216:219], v234 offset:57344
    s_waitcnt vmcnt(1)
    ds_read_b64_tr_b16 v[120:121], v238 offset:6144
    ds_read_b64_tr_b16 v[122:123], v238 offset:6400
    ds_read_b64_tr_b16 v[124:125], v237 offset:6144
    ds_read_b64_tr_b16 v[126:127], v237 offset:6400
    v_mfma_f32_16x16x32_bf16 v[132:135], v[196:199], v[112:115], v[132:135]
    v_mfma_f32_16x16x32_bf16 v[140:143], v[196:199], v[116:119], v[140:143]
    ds_read_b128 v[220:223], v234 offset:61440
    s_barrier
    v_mfma_f32_16x16x32_bf16 v[144:147], v[200:203], v[112:115], v[144:147]
    v_mfma_f32_16x16x32_bf16 v[152:155], v[200:203], v[116:119], v[152:155]
    v_xor_b32 v235, 65536, v233
    ds_read_b128 v[192:195], v235 offset:0
    s_add_u32 s25, s54, 98304
    s_waitcnt lgkmcnt(9)
    v_mfma_f32_16x16x32_bf16 v[148:151], v[204:207], v[112:115], v[148:151]
    v_mfma_f32_16x16x32_bf16 v[156:159], v[204:207], v[116:119], v[156:159]
    ds_read_b128 v[196:199], v235 offset:4096
    s_add_u32 m0, s28, 0
    s_nop 0
    buffer_load_dwordx4 v243, s[8:11], s25 offen offset:0 lds
    s_waitcnt lgkmcnt(5)
    v_mfma_f32_16x16x32_bf16 v[128:131], v[208:211], v[120:123], v[128:131]
    s_waitcnt lgkmcnt(3)
    v_mfma_f32_16x16x32_bf16 v[136:139], v[208:211], v[124:127], v[136:139]
    ds_read_b128 v[200:203], v235 offset:8192
    s_add_u32 m0, s28, 0
    s_nop 0
    buffer_load_dwordx4 v244, s[8:11], s25 offen offset:1024 lds
    v_mfma_f32_16x16x32_bf16 v[132:135], v[212:215], v[120:123], v[132:135]
    v_mfma_f32_16x16x32_bf16 v[140:143], v[212:215], v[124:127], v[140:143]
    ds_read_b128 v[204:207], v235 offset:12288
    s_add_u32 m0, s28, 0
    s_nop 0
    buffer_load_dwordx4 v245, s[8:11], s25 offen offset:2048 lds
    v_mfma_f32_16x16x32_bf16 v[144:147], v[216:219], v[120:123], v[144:147]
    v_mfma_f32_16x16x32_bf16 v[152:155], v[216:219], v[124:127], v[152:155]
    ds_read_b128 v[208:211], v235 offset:16384
    s_add_u32 m0, s28, 0
    s_nop 0
    buffer_load_dwordx4 v246, s[8:11], s25 offen offset:3072 lds
    s_waitcnt lgkmcnt(5)
    v_mfma_f32_16x16x32_bf16 v[148:151], v[220:223], v[120:123], v[148:151]
    v_mfma_f32_16x16x32_bf16 v[156:159], v[220:223], v[124:127], v[156:159]
    ds_read_b128 v[212:215], v235 offset:20480
    s_waitcnt lgkmcnt(5)
    v_mfma_f32_16x16x32_bf16 v[160:163], v[192:195], v[0:3], 0
    v_mfma_f32_16x16x32_bf16 v[168:171], v[192:195], v[4:7], 0
    ds_read_b128 v[216:219], v235 offset:24576
    s_waitcnt lgkmcnt(5)
    v_mfma_f32_16x16x32_bf16 v[164:167], v[196:199], v[0:3], 0
    v_mfma_f32_16x16x32_bf16 v[172:175], v[196:199], v[4:7], 0
    ds_read_b128 v[220:223], v235 offset:28672
    s_waitcnt lgkmcnt(5)
    v_mfma_f32_16x16x32_bf16 v[160:163], v[200:203], v[32:35], v[160:163]
    v_mfma_f32_16x16x32_bf16 v[168:171], v[200:203], v[36:39], v[168:171]
    v_xor_b32 v234, 65600, v233
    ds_read_b128 v[192:195], v234 offset:0
    s_lshr_b32 s74, s2, 3
    s_lshl_b32 s74, s74, 3
    s_add_u32 s74, s74, s24
    s_and_b32 s75, s2, 7
    s_mul_i32 s75, s75, 37
    s_add_u32 s74, s74, s75
    s_and_b32 s74, s74, 255
    v_and_b32 v242, 0xf0, v232
    v_lshlrev_b32 v242, 3, v242
    s_lshr_b32 s75, s74, 5
    s_lshl_b32 s75, s75, 18
    s_and_b32 s74, s74, 31
    s_lshl_b32 s74, s74, 11
    s_add_u32 s75, s75, s74
    s_add_u32 s75, s75, 196608
    s_waitcnt lgkmcnt(5)
    v_mfma_f32_16x16x32_bf16 v[164:167], v[204:207], v[32:35], v[164:167]
    v_mfma_f32_16x16x32_bf16 v[172:175], v[204:207], v[36:39], v[172:175]
    ds_read_b128 v[196:199], v234 offset:4096
    s_waitcnt vmcnt(4)
    buffer_load_dword v255, v242, s[8:11], s75 offen
    v_cvt_pk_bf16_f32 v176, v128, v129
    v_cvt_pk_bf16_f32 v177, v130, v131
    s_waitcnt lgkmcnt(5)
    v_mfma_f32_16x16x32_bf16 v[160:163], v[208:211], v[64:67], v[160:163]
    v_mfma_f32_16x16x32_bf16 v[168:171], v[208:211], v[68:71], v[168:171]
    ds_read_b128 v[200:203], v234 offset:8192
    v_cvt_pk_bf16_f32 v178, v132, v133
    v_cvt_pk_bf16_f32 v179, v134, v135
    v_cvt_pk_bf16_f32 v180, v136, v137
    v_cvt_pk_bf16_f32 v181, v138, v139
    s_waitcnt lgkmcnt(5)
    v_mfma_f32_16x16x32_bf16 v[164:167], v[212:215], v[64:67], v[164:167]
    v_mfma_f32_16x16x32_bf16 v[172:175], v[212:215], v[68:71], v[172:175]
    ds_read_b128 v[204:207], v234 offset:12288
    v_cvt_pk_bf16_f32 v182, v140, v141
    v_cvt_pk_bf16_f32 v183, v142, v143
    v_cvt_pk_bf16_f32 v224, v144, v145
    s_waitcnt lgkmcnt(5)
    v_mfma_f32_16x16x32_bf16 v[160:163], v[216:219], v[96:99], v[160:163]
    v_mfma_f32_16x16x32_bf16 v[168:171], v[216:219], v[100:103], v[168:171]
    ds_read_b128 v[208:211], v234 offset:16384
    v_cvt_pk_bf16_f32 v225, v146, v147
    v_cvt_pk_bf16_f32 v226, v148, v149
    v_cvt_pk_bf16_f32 v227, v150, v151
    v_cvt_pk_bf16_f32 v228, v152, v153
    s_waitcnt lgkmcnt(5)
    v_mfma_f32_16x16x32_bf16 v[164:167], v[220:223], v[96:99], v[164:167]
    v_mfma_f32_16x16x32_bf16 v[172:175], v[220:223], v[100:103], v[172:175]
    ds_read_b128 v[212:215], v234 offset:20480
    v_cvt_pk_bf16_f32 v229, v154, v155
    v_cvt_pk_bf16_f32 v230, v156, v157
    v_cvt_pk_bf16_f32 v231, v158, v159
    s_waitcnt lgkmcnt(5)
    v_mfma_f32_16x16x32_bf16 v[160:163], v[192:195], v[8:11], v[160:163]
    v_mfma_f32_16x16x32_bf16 v[168:171], v[192:195], v[12:15], v[168:171]
    ds_read_b128 v[216:219], v234 offset:24576
    s_add_u32 s51, s27, 0
    buffer_store_dwordx4 v[176:179], v232, s[16:19], s51 offen sc1
    s_waitcnt lgkmcnt(5)
    v_mfma_f32_16x16x32_bf16 v[164:167], v[196:199], v[8:11], v[164:167]
    v_mfma_f32_16x16x32_bf16 v[172:175], v[196:199], v[12:15], v[172:175]
    ds_read_b128 v[220:223], v234 offset:28672
    s_waitcnt lgkmcnt(5)
    v_mfma_f32_16x16x32_bf16 v[160:163], v[200:203], v[40:43], v[160:163]
    v_mfma_f32_16x16x32_bf16 v[168:171], v[200:203], v[44:47], v[168:171]
    v_xor_b32 v235, 65664, v233
    ds_read_b128 v[192:195], v235 offset:0
    s_waitcnt lgkmcnt(5)
    v_mfma_f32_16x16x32_bf16 v[164:167], v[204:207], v[40:43], v[164:167]
    v_mfma_f32_16x16x32_bf16 v[172:175], v[204:207], v[44:47], v[172:175]
    ds_read_b128 v[196:199], v235 offset:4096
    s_waitcnt lgkmcnt(5)
    v_mfma_f32_16x16x32_bf16 v[160:163], v[208:211], v[72:75], v[160:163]
    v_mfma_f32_16x16x32_bf16 v[168:171], v[208:211], v[76:79], v[168:171]
    ds_read_b128 v[200:203], v235 offset:8192
    s_waitcnt lgkmcnt(5)
    v_mfma_f32_16x16x32_bf16 v[164:167], v[212:215], v[72:75], v[164:167]
    v_mfma_f32_16x16x32_bf16 v[172:175], v[212:215], v[76:79], v[172:175]
    ds_read_b128 v[204:207], v235 offset:12288
    s_waitcnt lgkmcnt(5)
    v_mfma_f32_16x16x32_bf16 v[160:163], v[216:219], v[104:107], v[160:163]
    v_mfma_f32_16x16x32_bf16 v[168:171], v[216:219], v[108:111], v[168:171]
    ds_read_b128 v[208:211], v235 offset:16384
    s_add_u32 s51, s27, 0
    buffer_store_dwordx4 v[180:183], v232, s[16:19], s51 offen offset:1024 sc1
    s_waitcnt lgkmcnt(5)
    v_mfma_f32_16x16x32_bf16 v[164:167], v[220:223], v[104:107], v[164:167]
    v_mfma_f32_16x16x32_bf16 v[172:175], v[220:223], v[108:111], v[172:175]
    ds_read_b128 v[212:215], v235 offset:20480
    s_waitcnt lgkmcnt(5)
    v_mfma_f32_16x16x32_bf16 v[160:163], v[192:195], v[16:19], v[160:163]
    v_mfma_f32_16x16x32_bf16 v[168:171], v[192:195], v[20:23], v[168:171]
    ds_read_b128 v[216:219], v235 offset:24576
    s_waitcnt lgkmcnt(5)
    v_mfma_f32_16x16x32_bf16 v[164:167], v[196:199], v[16:19], v[164:167]
    v_mfma_f32_16x16x32_bf16 v[172:175], v[196:199], v[20:23], v[172:175]
    ds_read_b128 v[220:223], v235 offset:28672
    s_waitcnt lgkmcnt(5)
    v_mfma_f32_16x16x32_bf16 v[160:163], v[200:203], v[48:51], v[160:163]
    v_mfma_f32_16x16x32_bf16 v[168:171], v[200:203], v[52:55], v[168:171]
    v_xor_b32 v234, 65728, v233
    ds_read_b128 v[192:195], v234 offset:0
    s_waitcnt lgkmcnt(5)
    v_mfma_f32_16x16x32_bf16 v[164:167], v[204:207], v[48:51], v[164:167]
    v_mfma_f32_16x16x32_bf16 v[172:175], v[204:207], v[52:55], v[172:175]
    ds_read_b128 v[196:199], v234 offset:4096
    s_waitcnt lgkmcnt(5)
    v_mfma_f32_16x16x32_bf16 v[160:163], v[208:211], v[80:83], v[160:163]
    v_mfma_f32_16x16x32_bf16 v[168:171], v[208:211], v[84:87], v[168:171]
    ds_read_b128 v[200:203], v234 offset:8192
    s_add_u32 s51, s27, 8192
    buffer_store_dwordx4 v[224:227], v232, s[16:19], s51 offen sc1
    s_waitcnt lgkmcnt(5)
    v_mfma_f32_16x16x32_bf16 v[164:167], v[212:215], v[80:83], v[164:167]
    v_mfma_f32_16x16x32_bf16 v[172:175], v[212:215], v[84:87], v[172:175]
    ds_read_b128 v[204:207], v234 offset:12288
    s_waitcnt lgkmcnt(5)
    v_mfma_f32_16x16x32_bf16 v[160:163], v[216:219], v[112:115], v[160:163]
    v_mfma_f32_16x16x32_bf16 v[168:171], v[216:219], v[116:119], v[168:171]
    ds_read_b128 v[208:211], v234 offset:16384
    s_waitcnt lgkmcnt(5)
    v_mfma_f32_16x16x32_bf16 v[164:167], v[220:223], v[112:115], v[164:167]
    v_mfma_f32_16x16x32_bf16 v[172:175], v[220:223], v[116:119], v[172:175]
    ds_read_b128 v[212:215], v234 offset:20480
    s_waitcnt lgkmcnt(5)
    v_mfma_f32_16x16x32_bf16 v[160:163], v[192:195], v[24:27], v[160:163]
    v_mfma_f32_16x16x32_bf16 v[168:171], v[192:195], v[28:31], v[168:171]
    ds_read_b128 v[216:219], v234 offset:24576
    s_waitcnt lgkmcnt(5)
    v_mfma_f32_16x16x32_bf16 v[164:167], v[196:199], v[24:27], v[164:167]
    v_mfma_f32_16x16x32_bf16 v[172:175], v[196:199], v[28:31], v[172:175]
    ds_read_b128 v[220:223], v234 offset:28672
    s_waitcnt vmcnt(4)
    s_barrier
    s_waitcnt lgkmcnt(5)
    v_mfma_f32_16x16x32_bf16 v[160:163], v[200:203], v[56:59], v[160:163]
    v_mfma_f32_16x16x32_bf16 v[168:171], v[200:203], v[60:63], v[168:171]
    v_xor_b32 v235, 0, v233
    ds_read_b128 v[192:195], v235 offset:0
    s_add_u32 s25, s54, 131072
    s_waitcnt lgkmcnt(5)
    v_mfma_f32_16x16x32_bf16 v[164:167], v[204:207], v[56:59], v[164:167]
    v_mfma_f32_16x16x32_bf16 v[172:175], v[204:207], v[60:63], v[172:175]
    ds_read_b128 v[196:199], v235 offset:4096
    s_add_u32 m0, s28, 32768
    s_nop 0
    buffer_load_dwordx4 v243, s[8:11], s25 offen offset:0 lds
    s_waitcnt lgkmcnt(5)
    v_mfma_f32_16x16x32_bf16 v[160:163], v[208:211], v[88:91], v[160:163]
    v_mfma_f32_16x16x32_bf16 v[168:171], v[208:211], v[92:95], v[168:171]
    ds_read_b128 v[200:203], v235 offset:8192
    s_add_u32 m0, s28, 32768
    s_nop 0
    buffer_load_dwordx4 v244, s[8:11], s25 offen offset:1024 lds
    s_waitcnt lgkmcnt(5)
    v_mfma_f32_16x16x32_bf16 v[164:167], v[212:215], v[88:91], v[164:167]
    v_mfma_f32_16x16x32_bf16 v[172:175], v[212:215], v[92:95], v[172:175]
    ds_read_b128 v[204:207], v235 offset:12288
    s_add_u32 m0, s28, 32768
    s_nop 0
    buffer_load_dwordx4 v245, s[8:11], s25 offen offset:2048 lds
    s_waitcnt lgkmcnt(5)
    v_mfma_f32_16x16x32_bf16 v[160:163], v[216:219], v[120:123], v[160:163]
    v_mfma_f32_16x16x32_bf16 v[168:171], v[216:219], v[124:127], v[168:171]
    ds_read_b128 v[208:211], v235 offset:16384
    s_add_u32 m0, s28, 32768
    s_nop 0
    buffer_load_dwordx4 v246, s[8:11], s25 offen offset:3072 lds
    s_waitcnt lgkmcnt(5)
    v_mfma_f32_16x16x32_bf16 v[164:167], v[220:223], v[120:123], v[164:167]
    v_mfma_f32_16x16x32_bf16 v[172:175], v[220:223], v[124:127], v[172:175]
    ds_read_b128 v[212:215], v235 offset:20480
    s_waitcnt lgkmcnt(5)
    v_mfma_f32_16x16x32_bf16 v[128:131], v[192:195], v[0:3], 0
    v_mfma_f32_16x16x32_bf16 v[136:139], v[192:195], v[4:7], 0
    ds_read_b128 v[216:219], v235 offset:24576
    s_waitcnt lgkmcnt(5)
    v_mfma_f32_16x16x32_bf16 v[132:135], v[196:199], v[0:3], 0
    v_mfma_f32_16x16x32_bf16 v[140:143], v[196:199], v[4:7], 0
    ds_read_b128 v[220:223], v235 offset:28672
    s_waitcnt lgkmcnt(5)
    v_mfma_f32_16x16x32_bf16 v[128:131], v[200:203], v[32:35], v[128:131]
    v_mfma_f32_16x16x32_bf16 v[136:139], v[200:203], v[36:39], v[136:139]
    v_xor_b32 v234, 64, v233
    ds_read_b128 v[192:195], v234 offset:0
    s_add_u32 s51, s27, 8192
    buffer_store_dwordx4 v[228:231], v232, s[16:19], s51 offen offset:1024 sc1
    v_cvt_pk_bf16_f32 v176, v160, v161
    s_waitcnt lgkmcnt(5)
    v_mfma_f32_16x16x32_bf16 v[132:135], v[204:207], v[32:35], v[132:135]
    v_mfma_f32_16x16x32_bf16 v[140:143], v[204:207], v[36:39], v[140:143]
    ds_read_b128 v[196:199], v234 offset:4096
    v_cvt_pk_bf16_f32 v177, v162, v163
    s_waitcnt lgkmcnt(5)
    v_mfma_f32_16x16x32_bf16 v[128:131], v[208:211], v[64:67], v[128:131]
    v_mfma_f32_16x16x32_bf16 v[136:139], v[208:211], v[68:71], v[136:139]
    ds_read_b128 v[200:203], v234 offset:8192
    v_cvt_pk_bf16_f32 v178, v164, v165
    v_cvt_pk_bf16_f32 v179, v166, v167
    s_waitcnt lgkmcnt(5)
    v_mfma_f32_16x16x32_bf16 v[132:135], v[212:215], v[64:67], v[132:135]
    v_mfma_f32_16x16x32_bf16 v[140:143], v[212:215], v[68:71], v[140:143]
    ds_read_b128 v[204:207], v234 offset:12288
    v_cvt_pk_bf16_f32 v180, v168, v169
    s_waitcnt lgkmcnt(5)
    v_mfma_f32_16x16x32_bf16 v[128:131], v[216:219], v[96:99], v[128:131]
    v_mfma_f32_16x16x32_bf16 v[136:139], v[216:219], v[100:103], v[136:139]
    ds_read_b128 v[208:211], v234 offset:16384
    v_cvt_pk_bf16_f32 v181, v170, v171
    v_cvt_pk_bf16_f32 v182, v172, v173
    s_waitcnt lgkmcnt(5)
    v_mfma_f32_16x16x32_bf16 v[132:135], v[220:223], v[96:99], v[132:135]
    v_mfma_f32_16x16x32_bf16 v[140:143], v[220:223], v[100:103], v[140:143]
    ds_read_b128 v[212:215], v234 offset:20480
    v_cvt_pk_bf16_f32 v183, v174, v175
    s_waitcnt lgkmcnt(5)
    v_mfma_f32_16x16x32_bf16 v[128:131], v[192:195], v[8:11], v[128:131]
    v_mfma_f32_16x16x32_bf16 v[136:139], v[192:195], v[12:15], v[136:139]
    ds_read_b128 v[216:219], v234 offset:24576
    s_add_u32 s51, s27, 16384
    buffer_store_dwordx4 v[176:179], v232, s[16:19], s51 offen sc1
    s_waitcnt lgkmcnt(5)
    v_mfma_f32_16x16x32_bf16 v[132:135], v[196:199], v[8:11], v[132:135]
    v_mfma_f32_16x16x32_bf16 v[140:143], v[196:199], v[12:15], v[140:143]
    ds_read_b128 v[220:223], v234 offset:28672
    s_waitcnt lgkmcnt(5)
    v_mfma_f32_16x16x32_bf16 v[128:131], v[200:203], v[40:43], v[128:131]
    v_mfma_f32_16x16x32_bf16 v[136:139], v[200:203], v[44:47], v[136:139]
    v_xor_b32 v235, 128, v233
    ds_read_b128 v[192:195], v235 offset:0
    s_waitcnt lgkmcnt(5)
    v_mfma_f32_16x16x32_bf16 v[132:135], v[204:207], v[40:43], v[132:135]
    v_mfma_f32_16x16x32_bf16 v[140:143], v[204:207], v[44:47], v[140:143]
    ds_read_b128 v[196:199], v235 offset:4096
    s_waitcnt lgkmcnt(5)
    v_mfma_f32_16x16x32_bf16 v[128:131], v[208:211], v[72:75], v[128:131]
    v_mfma_f32_16x16x32_bf16 v[136:139], v[208:211], v[76:79], v[136:139]
    ds_read_b128 v[200:203], v235 offset:8192
    s_add_u32 s51, s27, 16384
    buffer_store_dwordx4 v[180:183], v232, s[16:19], s51 offen offset:1024 sc1
    s_waitcnt lgkmcnt(5)
    v_mfma_f32_16x16x32_bf16 v[132:135], v[212:215], v[72:75], v[132:135]
    v_mfma_f32_16x16x32_bf16 v[140:143], v[212:215], v[76:79], v[140:143]
    ds_read_b128 v[204:207], v235 offset:12288
    s_waitcnt lgkmcnt(5)
    v_mfma_f32_16x16x32_bf16 v[128:131], v[216:219], v[104:107], v[128:131]
    v_mfma_f32_16x16x32_bf16 v[136:139], v[216:219], v[108:111], v[136:139]
    ds_read_b128 v[208:211], v235 offset:16384
    s_waitcnt lgkmcnt(5)
    v_mfma_f32_16x16x32_bf16 v[132:135], v[220:223], v[104:107], v[132:135]
    v_mfma_f32_16x16x32_bf16 v[140:143], v[220:223], v[108:111], v[140:143]
    ds_read_b128 v[212:215], v235 offset:20480
    s_waitcnt lgkmcnt(5)
    v_mfma_f32_16x16x32_bf16 v[128:131], v[192:195], v[16:19], v[128:131]
    v_mfma_f32_16x16x32_bf16 v[136:139], v[192:195], v[20:23], v[136:139]
    ds_read_b128 v[216:219], v235 offset:24576
    s_waitcnt lgkmcnt(5)
    v_mfma_f32_16x16x32_bf16 v[132:135], v[196:199], v[16:19], v[132:135]
    v_mfma_f32_16x16x32_bf16 v[140:143], v[196:199], v[20:23], v[140:143]
    ds_read_b128 v[220:223], v235 offset:28672
    s_lshl_b32 s48, s24, 10
    s_add_u32 m0, s48, 98304
    s_nop 0
    buffer_load_dwordx4 v239, s[20:23], s59 offen lds
    s_waitcnt lgkmcnt(5)
    v_mfma_f32_16x16x32_bf16 v[128:131], v[200:203], v[48:51], v[128:131]
    v_mfma_f32_16x16x32_bf16 v[136:139], v[200:203], v[52:55], v[136:139]
    v_xor_b32 v234, 192, v233
    ds_read_b128 v[192:195], v234 offset:0
    s_waitcnt lgkmcnt(5)
    v_mfma_f32_16x16x32_bf16 v[132:135], v[204:207], v[48:51], v[132:135]
    v_mfma_f32_16x16x32_bf16 v[140:143], v[204:207], v[52:55], v[140:143]
    ds_read_b128 v[196:199], v234 offset:4096
    s_waitcnt lgkmcnt(5)
    v_mfma_f32_16x16x32_bf16 v[128:131], v[208:211], v[80:83], v[128:131]
    v_mfma_f32_16x16x32_bf16 v[136:139], v[208:211], v[84:87], v[136:139]
    ds_read_b128 v[200:203], v234 offset:8192
    s_waitcnt lgkmcnt(5)
    v_mfma_f32_16x16x32_bf16 v[132:135], v[212:215], v[80:83], v[132:135]
    v_mfma_f32_16x16x32_bf16 v[140:143], v[212:215], v[84:87], v[140:143]
    ds_read_b128 v[204:207], v234 offset:12288
    s_lshl_b32 s48, s24, 10
    s_add_u32 m0, s48, 106496
    s_nop 0
    buffer_load_dwordx4 v247, s[44:47], s55 offen lds
    s_waitcnt lgkmcnt(5)
    v_mfma_f32_16x16x32_bf16 v[128:131], v[216:219], v[112:115], v[128:131]
    v_mfma_f32_16x16x32_bf16 v[136:139], v[216:219], v[116:119], v[136:139]
    ds_read_b128 v[208:211], v234 offset:16384
    s_waitcnt lgkmcnt(5)
    v_mfma_f32_16x16x32_bf16 v[132:135], v[220:223], v[112:115], v[132:135]
    v_mfma_f32_16x16x32_bf16 v[140:143], v[220:223], v[116:119], v[140:143]
    ds_read_b128 v[212:215], v234 offset:20480
    s_waitcnt lgkmcnt(5)
    v_mfma_f32_16x16x32_bf16 v[128:131], v[192:195], v[24:27], v[128:131]
    v_mfma_f32_16x16x32_bf16 v[136:139], v[192:195], v[28:31], v[136:139]
    ds_read_b128 v[216:219], v234 offset:24576
    s_waitcnt lgkmcnt(5)
    v_mfma_f32_16x16x32_bf16 v[132:135], v[196:199], v[24:27], v[132:135]
    v_mfma_f32_16x16x32_bf16 v[140:143], v[196:199], v[28:31], v[140:143]
    ds_read_b128 v[220:223], v234 offset:28672
    s_waitcnt vmcnt(5)
    s_barrier
    s_waitcnt lgkmcnt(5)
    v_mfma_f32_16x16x32_bf16 v[128:131], v[200:203], v[56:59], v[128:131]
    v_mfma_f32_16x16x32_bf16 v[136:139], v[200:203], v[60:63], v[136:139]
    v_xor_b32 v235, 0, v233
    ds_read_b128 v[192:195], v235 offset:32768
    s_add_u32 s25, s54, 163840
    s_waitcnt lgkmcnt(5)
    v_mfma_f32_16x16x32_bf16 v[132:135], v[204:207], v[56:59], v[132:135]
    v_mfma_f32_16x16x32_bf16 v[140:143], v[204:207], v[60:63], v[140:143]
    ds_read_b128 v[196:199], v235 offset:36864
    s_add_u32 m0, s28, 65536
    s_nop 0
    buffer_load_dwordx4 v243, s[8:11], s25 offen offset:0 lds
    s_waitcnt lgkmcnt(5)
    v_mfma_f32_16x16x32_bf16 v[128:131], v[208:211], v[88:91], v[128:131]
    v_mfma_f32_16x16x32_bf16 v[136:139], v[208:211], v[92:95], v[136:139]
    ds_read_b128 v[200:203], v235 offset:40960
    s_add_u32 m0, s28, 65536
    s_nop 0
    buffer_load_dwordx4 v244, s[8:11], s25 offen offset:1024 lds
    s_waitcnt lgkmcnt(5)
    v_mfma_f32_16x16x32_bf16 v[132:135], v[212:215], v[88:91], v[132:135]
    v_mfma_f32_16x16x32_bf16 v[140:143], v[212:215], v[92:95], v[140:143]
    ds_read_b128 v[204:207], v235 offset:45056
    s_add_u32 m0, s28, 65536
    s_nop 0
    buffer_load_dwordx4 v245, s[8:11], s25 offen offset:2048 lds
    s_waitcnt lgkmcnt(5)
    v_mfma_f32_16x16x32_bf16 v[128:131], v[216:219], v[120:123], v[128:131]
    v_mfma_f32_16x16x32_bf16 v[136:139], v[216:219], v[124:127], v[136:139]
    ds_read_b128 v[208:211], v235 offset:49152
    s_add_u32 m0, s28, 65536
    s_nop 0
    buffer_load_dwordx4 v246, s[8:11], s25 offen offset:3072 lds
    s_waitcnt lgkmcnt(5)
    v_mfma_f32_16x16x32_bf16 v[132:135], v[220:223], v[120:123], v[132:135]
    v_mfma_f32_16x16x32_bf16 v[140:143], v[220:223], v[124:127], v[140:143]
    ds_read_b128 v[212:215], v235 offset:53248
    s_waitcnt lgkmcnt(5)
    v_mfma_f32_16x16x32_bf16 v[144:147], v[192:195], v[0:3], 0
    v_mfma_f32_16x16x32_bf16 v[152:155], v[192:195], v[4:7], 0
    ds_read_b128 v[216:219], v235 offset:57344
    s_waitcnt lgkmcnt(5)
    v_mfma_f32_16x16x32_bf16 v[148:151], v[196:199], v[0:3], 0
    v_mfma_f32_16x16x32_bf16 v[156:159], v[196:199], v[4:7], 0
    ds_read_b128 v[220:223], v235 offset:61440
    s_waitcnt lgkmcnt(5)
    v_mfma_f32_16x16x32_bf16 v[144:147], v[200:203], v[32:35], v[144:147]
    v_mfma_f32_16x16x32_bf16 v[152:155], v[200:203], v[36:39], v[152:155]
    v_xor_b32 v234, 64, v233
    ds_read_b128 v[192:195], v234 offset:32768
    v_cvt_pk_bf16_f32 v224, v128, v129
    v_cvt_pk_bf16_f32 v225, v130, v131
    s_waitcnt lgkmcnt(5)
    v_mfma_f32_16x16x32_bf16 v[148:151], v[204:207], v[32:35], v[148:151]
    v_mfma_f32_16x16x32_bf16 v[156:159], v[204:207], v[36:39], v[156:159]
    ds_read_b128 v[196:199], v234 offset:36864
    v_cvt_pk_bf16_f32 v226, v132, v133
    s_waitcnt lgkmcnt(5)
    v_mfma_f32_16x16x32_bf16 v[144:147], v[208:211], v[64:67], v[144:147]
    v_mfma_f32_16x16x32_bf16 v[152:155], v[208:211], v[68:71], v[152:155]
    ds_read_b128 v[200:203], v234 offset:40960
    v_cvt_pk_bf16_f32 v227, v134, v135
    s_waitcnt lgkmcnt(5)
    v_mfma_f32_16x16x32_bf16 v[148:151], v[212:215], v[64:67], v[148:151]
    v_mfma_f32_16x16x32_bf16 v[156:159], v[212:215], v[68:71], v[156:159]
    ds_read_b128 v[204:207], v234 offset:45056
    v_cvt_pk_bf16_f32 v228, v136, v137
    v_cvt_pk_bf16_f32 v229, v138, v139
    s_waitcnt lgkmcnt(5)
    v_mfma_f32_16x16x32_bf16 v[144:147], v[216:219], v[96:99], v[144:147]
    v_mfma_f32_16x16x32_bf16 v[152:155], v[216:219], v[100:103], v[152:155]
    ds_read_b128 v[208:211], v234 offset:49152
    v_cvt_pk_bf16_f32 v230, v140, v141
    s_waitcnt lgkmcnt(5)
    v_mfma_f32_16x16x32_bf16 v[148:151], v[220:223], v[96:99], v[148:151]
    v_mfma_f32_16x16x32_bf16 v[156:159], v[220:223], v[100:103], v[156:159]
    ds_read_b128 v[212:215], v234 offset:53248
    v_cvt_pk_bf16_f32 v231, v142, v143
    s_waitcnt lgkmcnt(5)
    v_mfma_f32_16x16x32_bf16 v[144:147], v[192:195], v[8:11], v[144:147]
    v_mfma_f32_16x16x32_bf16 v[152:155], v[192:195], v[12:15], v[152:155]
    ds_read_b128 v[216:219], v234 offset:57344
    s_add_u32 s51, s27, 24576
    buffer_store_dwordx4 v[224:227], v232, s[16:19], s51 offen sc1
    s_waitcnt lgkmcnt(5)
    v_mfma_f32_16x16x32_bf16 v[148:151], v[196:199], v[8:11], v[148:151]
    v_mfma_f32_16x16x32_bf16 v[156:159], v[196:199], v[12:15], v[156:159]
    ds_read_b128 v[220:223], v234 offset:61440
    s_waitcnt lgkmcnt(5)
    v_mfma_f32_16x16x32_bf16 v[144:147], v[200:203], v[40:43], v[144:147]
    v_mfma_f32_16x16x32_bf16 v[152:155], v[200:203], v[44:47], v[152:155]
    v_xor_b32 v235, 128, v233
    ds_read_b128 v[192:195], v235 offset:32768
    s_waitcnt lgkmcnt(5)
    v_mfma_f32_16x16x32_bf16 v[148:151], v[204:207], v[40:43], v[148:151]
    v_mfma_f32_16x16x32_bf16 v[156:159], v[204:207], v[44:47], v[156:159]
    ds_read_b128 v[196:199], v235 offset:36864
    s_waitcnt lgkmcnt(5)
    v_mfma_f32_16x16x32_bf16 v[144:147], v[208:211], v[72:75], v[144:147]
    v_mfma_f32_16x16x32_bf16 v[152:155], v[208:211], v[76:79], v[152:155]
    ds_read_b128 v[200:203], v235 offset:40960
    s_waitcnt lgkmcnt(5)
    v_mfma_f32_16x16x32_bf16 v[148:151], v[212:215], v[72:75], v[148:151]
    v_mfma_f32_16x16x32_bf16 v[156:159], v[212:215], v[76:79], v[156:159]
    ds_read_b128 v[204:207], v235 offset:45056
    s_waitcnt lgkmcnt(5)
    v_mfma_f32_16x16x32_bf16 v[144:147], v[216:219], v[104:107], v[144:147]
    v_mfma_f32_16x16x32_bf16 v[152:155], v[216:219], v[108:111], v[152:155]
    ds_read_b128 v[208:211], v235 offset:49152
    s_waitcnt lgkmcnt(5)
    v_mfma_f32_16x16x32_bf16 v[148:151], v[220:223], v[104:107], v[148:151]
    v_mfma_f32_16x16x32_bf16 v[156:159], v[220:223], v[108:111], v[156:159]
    ds_read_b128 v[212:215], v235 offset:53248
    s_waitcnt lgkmcnt(5)
    v_mfma_f32_16x16x32_bf16 v[144:147], v[192:195], v[16:19], v[144:147]
    v_mfma_f32_16x16x32_bf16 v[152:155], v[192:195], v[20:23], v[152:155]
    ds_read_b128 v[216:219], v235 offset:57344
    s_waitcnt lgkmcnt(5)
    v_mfma_f32_16x16x32_bf16 v[148:151], v[196:199], v[16:19], v[148:151]
    v_mfma_f32_16x16x32_bf16 v[156:159], v[196:199], v[20:23], v[156:159]
    ds_read_b128 v[220:223], v235 offset:61440
    s_add_u32 s51, s27, 24576
    buffer_store_dwordx4 v[228:231], v232, s[16:19], s51 offen offset:1024 sc1
    s_waitcnt lgkmcnt(5)
    v_mfma_f32_16x16x32_bf16 v[144:147], v[200:203], v[48:51], v[144:147]
    v_mfma_f32_16x16x32_bf16 v[152:155], v[200:203], v[52:55], v[152:155]
    v_xor_b32 v234, 192, v233
    ds_read_b128 v[192:195], v234 offset:32768
    s_waitcnt lgkmcnt(5)
    v_mfma_f32_16x16x32_bf16 v[148:151], v[204:207], v[48:51], v[148:151]
    v_mfma_f32_16x16x32_bf16 v[156:159], v[204:207], v[52:55], v[156:159]
    ds_read_b128 v[196:199], v234 offset:36864
    s_waitcnt lgkmcnt(5)
    v_mfma_f32_16x16x32_bf16 v[144:147], v[208:211], v[80:83], v[144:147]
    v_mfma_f32_16x16x32_bf16 v[152:155], v[208:211], v[84:87], v[152:155]
    ds_read_b128 v[200:203], v234 offset:40960
    s_waitcnt lgkmcnt(5)
    v_mfma_f32_16x16x32_bf16 v[148:151], v[212:215], v[80:83], v[148:151]
    v_mfma_f32_16x16x32_bf16 v[156:159], v[212:215], v[84:87], v[156:159]
    ds_read_b128 v[204:207], v234 offset:45056
    s_waitcnt lgkmcnt(5)
    v_mfma_f32_16x16x32_bf16 v[144:147], v[216:219], v[112:115], v[144:147]
    v_mfma_f32_16x16x32_bf16 v[152:155], v[216:219], v[116:119], v[152:155]
    ds_read_b128 v[208:211], v234 offset:49152
    s_waitcnt lgkmcnt(5)
    v_mfma_f32_16x16x32_bf16 v[148:151], v[220:223], v[112:115], v[148:151]
    v_mfma_f32_16x16x32_bf16 v[156:159], v[220:223], v[116:119], v[156:159]
    ds_read_b128 v[212:215], v234 offset:53248
    s_waitcnt lgkmcnt(5)
    v_mfma_f32_16x16x32_bf16 v[144:147], v[192:195], v[24:27], v[144:147]
    v_mfma_f32_16x16x32_bf16 v[152:155], v[192:195], v[28:31], v[152:155]
    ds_read_b128 v[216:219], v234 offset:57344
    s_waitcnt lgkmcnt(5)
    v_mfma_f32_16x16x32_bf16 v[148:151], v[196:199], v[24:27], v[148:151]
    v_mfma_f32_16x16x32_bf16 v[156:159], v[196:199], v[28:31], v[156:159]
    ds_read_b128 v[220:223], v234 offset:61440
    s_waitcnt vmcnt(2)
    s_barrier
    s_waitcnt lgkmcnt(5)
    v_mfma_f32_16x16x32_bf16 v[144:147], v[200:203], v[56:59], v[144:147]
    v_mfma_f32_16x16x32_bf16 v[152:155], v[200:203], v[60:63], v[152:155]
    v_xor_b32 v235, 65536, v233
    ds_read_b128 v[192:195], v235 offset:0
    s_add_u32 s25, s54, 196608
    s_waitcnt lgkmcnt(5)
    v_mfma_f32_16x16x32_bf16 v[148:151], v[204:207], v[56:59], v[148:151]
    v_mfma_f32_16x16x32_bf16 v[156:159], v[204:207], v[60:63], v[156:159]
    ds_read_b128 v[196:199], v235 offset:4096
    s_add_u32 m0, s28, 0
    s_nop 0
    buffer_load_dwordx4 v243, s[8:11], s25 offen offset:0 lds
    s_waitcnt lgkmcnt(5)
    v_mfma_f32_16x16x32_bf16 v[144:147], v[208:211], v[88:91], v[144:147]
    v_mfma_f32_16x16x32_bf16 v[152:155], v[208:211], v[92:95], v[152:155]
    ds_read_b128 v[200:203], v235 offset:8192
    s_add_u32 m0, s28, 0
    s_nop 0
    buffer_load_dwordx4 v244, s[8:11], s25 offen offset:1024 lds
    s_waitcnt lgkmcnt(5)
    v_mfma_f32_16x16x32_bf16 v[148:151], v[212:215], v[88:91], v[148:151]
    v_mfma_f32_16x16x32_bf16 v[156:159], v[212:215], v[92:95], v[156:159]
    ds_read_b128 v[204:207], v235 offset:12288
    s_add_u32 m0, s28, 0
    s_nop 0
    buffer_load_dwordx4 v245, s[8:11], s25 offen offset:2048 lds
    s_waitcnt lgkmcnt(5)
    v_mfma_f32_16x16x32_bf16 v[144:147], v[216:219], v[120:123], v[144:147]
    v_mfma_f32_16x16x32_bf16 v[152:155], v[216:219], v[124:127], v[152:155]
    ds_read_b128 v[208:211], v235 offset:16384
    s_add_u32 m0, s28, 0
    s_nop 0
    buffer_load_dwordx4 v246, s[8:11], s25 offen offset:3072 lds
    s_waitcnt lgkmcnt(5)
    v_mfma_f32_16x16x32_bf16 v[148:151], v[220:223], v[120:123], v[148:151]
    v_mfma_f32_16x16x32_bf16 v[156:159], v[220:223], v[124:127], v[156:159]
    ds_read_b128 v[212:215], v235 offset:20480
    s_waitcnt lgkmcnt(5)
    v_mfma_f32_16x16x32_bf16 v[160:163], v[192:195], v[0:3], 0
    v_mfma_f32_16x16x32_bf16 v[168:171], v[192:195], v[4:7], 0
    ds_read_b128 v[216:219], v235 offset:24576
    s_waitcnt lgkmcnt(5)
    v_mfma_f32_16x16x32_bf16 v[164:167], v[196:199], v[0:3], 0
    v_mfma_f32_16x16x32_bf16 v[172:175], v[196:199], v[4:7], 0
    ds_read_b128 v[220:223], v235 offset:28672
    s_waitcnt lgkmcnt(5)
    v_mfma_f32_16x16x32_bf16 v[160:163], v[200:203], v[32:35], v[160:163]
    v_mfma_f32_16x16x32_bf16 v[168:171], v[200:203], v[36:39], v[168:171]
    v_xor_b32 v234, 65600, v233
    ds_read_b128 v[192:195], v234 offset:0
    v_cvt_pk_bf16_f32 v176, v144, v145
    v_cvt_pk_bf16_f32 v177, v146, v147
    s_waitcnt lgkmcnt(5)
    v_mfma_f32_16x16x32_bf16 v[164:167], v[204:207], v[32:35], v[164:167]
    v_mfma_f32_16x16x32_bf16 v[172:175], v[204:207], v[36:39], v[172:175]
    ds_read_b128 v[196:199], v234 offset:4096
    v_cvt_pk_bf16_f32 v178, v148, v149
    v_cvt_pk_bf16_f32 v179, v150, v151
    s_waitcnt lgkmcnt(5)
    v_mfma_f32_16x16x32_bf16 v[160:163], v[208:211], v[64:67], v[160:163]
    v_mfma_f32_16x16x32_bf16 v[168:171], v[208:211], v[68:71], v[168:171]
    ds_read_b128 v[200:203], v234 offset:8192
    v_cvt_pk_bf16_f32 v180, v152, v153
    v_cvt_pk_bf16_f32 v181, v154, v155
    s_waitcnt lgkmcnt(5)
    v_mfma_f32_16x16x32_bf16 v[164:167], v[212:215], v[64:67], v[164:167]
    v_mfma_f32_16x16x32_bf16 v[172:175], v[212:215], v[68:71], v[172:175]
    ds_read_b128 v[204:207], v234 offset:12288
    v_cvt_pk_bf16_f32 v182, v156, v157
    v_cvt_pk_bf16_f32 v183, v158, v159
    s_waitcnt lgkmcnt(5)
    v_mfma_f32_16x16x32_bf16 v[160:163], v[216:219], v[96:99], v[160:163]
    v_mfma_f32_16x16x32_bf16 v[168:171], v[216:219], v[100:103], v[168:171]
    ds_read_b128 v[208:211], v234 offset:16384
    ds_read_b128 v[248:251], v240
    ds_read_b64_tr_b16 v[184:185], v252
    s_waitcnt lgkmcnt(7)
    v_mfma_f32_16x16x32_bf16 v[164:167], v[220:223], v[96:99], v[164:167]
    v_mfma_f32_16x16x32_bf16 v[172:175], v[220:223], v[100:103], v[172:175]
    ds_read_b128 v[212:215], v234 offset:20480
    ds_read_b64_tr_b16 v[186:187], v252 offset:512
    s_waitcnt lgkmcnt(8)
    v_mfma_f32_16x16x32_bf16 v[160:163], v[192:195], v[8:11], v[160:163]
    v_mfma_f32_16x16x32_bf16 v[168:171], v[192:195], v[12:15], v[168:171]
    ds_read_b128 v[216:219], v234 offset:24576
    s_add_u32 s51, s27, 32768
    buffer_store_dwordx4 v[176:179], v232, s[16:19], s51 offen sc1
    s_waitcnt lgkmcnt(8)
    v_mfma_f32_16x16x32_bf16 v[164:167], v[196:199], v[8:11], v[164:167]
    v_mfma_f32_16x16x32_bf16 v[172:175], v[196:199], v[12:15], v[172:175]
    ds_read_b128 v[220:223], v234 offset:28672
    s_waitcnt lgkmcnt(8)
    v_mfma_f32_16x16x32_bf16 v[160:163], v[200:203], v[40:43], v[160:163]
    v_mfma_f32_16x16x32_bf16 v[168:171], v[200:203], v[44:47], v[168:171]
    v_xor_b32 v235, 65664, v233
    ds_read_b128 v[192:195], v235 offset:0
    s_waitcnt lgkmcnt(8)
    v_mfma_f32_16x16x32_bf16 v[164:167], v[204:207], v[40:43], v[164:167]
    v_mfma_f32_16x16x32_bf16 v[172:175], v[204:207], v[44:47], v[172:175]
    ds_read_b128 v[196:199], v235 offset:4096
    s_waitcnt lgkmcnt(8)
    v_mfma_f32_16x16x32_bf16 v[160:163], v[208:211], v[72:75], v[160:163]
    v_mfma_f32_16x16x32_bf16 v[168:171], v[208:211], v[76:79], v[168:171]
    ds_read_b128 v[200:203], v235 offset:8192
    s_waitcnt lgkmcnt(6)
    v_mfma_f32_16x16x32_bf16 v[164:167], v[212:215], v[72:75], v[164:167]
    v_mfma_f32_16x16x32_bf16 v[172:175], v[212:215], v[76:79], v[172:175]
    ds_read_b128 v[204:207], v235 offset:12288
    s_waitcnt lgkmcnt(5)
    v_mfma_f32_16x16x32_bf16 v[160:163], v[216:219], v[104:107], v[160:163]
    v_mfma_f32_16x16x32_bf16 v[168:171], v[216:219], v[108:111], v[168:171]
    ds_read_b128 v[208:211], v235 offset:16384
    s_add_u32 s51, s27, 32768
    buffer_store_dwordx4 v[180:183], v232, s[16:19], s51 offen offset:1024 sc1
    s_waitcnt lgkmcnt(5)
    v_mfma_f32_16x16x32_bf16 v[164:167], v[220:223], v[104:107], v[164:167]
    v_mfma_f32_16x16x32_bf16 v[172:175], v[220:223], v[108:111], v[172:175]
    ds_read_b128 v[212:215], v235 offset:20480
    s_waitcnt lgkmcnt(5)
    v_mfma_f32_16x16x32_bf16 v[160:163], v[192:195], v[16:19], v[160:163]
    v_mfma_f32_16x16x32_bf16 v[168:171], v[192:195], v[20:23], v[168:171]
    ds_read_b128 v[216:219], v235 offset:24576
    s_waitcnt lgkmcnt(5)
    v_mfma_f32_16x16x32_bf16 v[164:167], v[196:199], v[16:19], v[164:167]
    v_mfma_f32_16x16x32_bf16 v[172:175], v[196:199], v[20:23], v[172:175]
    ds_read_b128 v[220:223], v235 offset:28672
    s_waitcnt lgkmcnt(5)
    v_mfma_f32_16x16x32_bf16 v[160:163], v[200:203], v[48:51], v[160:163]
    v_mfma_f32_16x16x32_bf16 v[168:171], v[200:203], v[52:55], v[168:171]
    v_xor_b32 v234, 65728, v233
    ds_read_b128 v[192:195], v234 offset:0
    s_waitcnt lgkmcnt(5)
    v_mfma_f32_16x16x32_bf16 v[164:167], v[204:207], v[48:51], v[164:167]
    v_mfma_f32_16x16x32_bf16 v[172:175], v[204:207], v[52:55], v[172:175]
    ds_read_b128 v[196:199], v234 offset:4096
    s_waitcnt lgkmcnt(5)
    v_mfma_f32_16x16x32_bf16 v[160:163], v[208:211], v[80:83], v[160:163]
    v_mfma_f32_16x16x32_bf16 v[168:171], v[208:211], v[84:87], v[168:171]
    ds_read_b128 v[200:203], v234 offset:8192
    buffer_store_dwordx4 v[248:251], v232, s[16:19], s33 offen sc1
    s_waitcnt lgkmcnt(5)
    v_mfma_f32_16x16x32_bf16 v[164:167], v[212:215], v[80:83], v[164:167]
    v_mfma_f32_16x16x32_bf16 v[172:175], v[212:215], v[84:87], v[172:175]
    ds_read_b128 v[204:207], v234 offset:12288
    s_waitcnt lgkmcnt(5)
    v_mfma_f32_16x16x32_bf16 v[160:163], v[216:219], v[112:115], v[160:163]
    v_mfma_f32_16x16x32_bf16 v[168:171], v[216:219], v[116:119], v[168:171]
    ds_read_b128 v[208:211], v234 offset:16384
    s_waitcnt lgkmcnt(5)
    v_mfma_f32_16x16x32_bf16 v[164:167], v[220:223], v[112:115], v[164:167]
    v_mfma_f32_16x16x32_bf16 v[172:175], v[220:223], v[116:119], v[172:175]
    ds_read_b128 v[212:215], v234 offset:20480
    s_waitcnt lgkmcnt(5)
    v_mfma_f32_16x16x32_bf16 v[160:163], v[192:195], v[24:27], v[160:163]
    v_mfma_f32_16x16x32_bf16 v[168:171], v[192:195], v[28:31], v[168:171]
    ds_read_b128 v[216:219], v234 offset:24576
    s_waitcnt lgkmcnt(5)
    v_mfma_f32_16x16x32_bf16 v[164:167], v[196:199], v[24:27], v[164:167]
    v_mfma_f32_16x16x32_bf16 v[172:175], v[196:199], v[28:31], v[172:175]
    ds_read_b128 v[220:223], v234 offset:28672
    s_waitcnt vmcnt(3)
    s_barrier
    s_waitcnt lgkmcnt(5)
    v_mfma_f32_16x16x32_bf16 v[160:163], v[200:203], v[56:59], v[160:163]
    v_mfma_f32_16x16x32_bf16 v[168:171], v[200:203], v[60:63], v[168:171]
    v_xor_b32 v235, 0, v233
    ds_read_b128 v[192:195], v235 offset:0
    s_add_u32 s25, s54, 229376
    s_waitcnt lgkmcnt(5)
    v_mfma_f32_16x16x32_bf16 v[164:167], v[204:207], v[56:59], v[164:167]
    v_mfma_f32_16x16x32_bf16 v[172:175], v[204:207], v[60:63], v[172:175]
    ds_read_b128 v[196:199], v235 offset:4096
    s_add_u32 m0, s28, 32768
    s_nop 0
    buffer_load_dwordx4 v243, s[8:11], s25 offen offset:0 lds
    s_waitcnt lgkmcnt(5)
    v_mfma_f32_16x16x32_bf16 v[160:163], v[208:211], v[88:91], v[160:163]
    v_mfma_f32_16x16x32_bf16 v[168:171], v[208:211], v[92:95], v[168:171]
    ds_read_b128 v[200:203], v235 offset:8192
    s_add_u32 m0, s28, 32768
    s_nop 0
    buffer_load_dwordx4 v244, s[8:11], s25 offen offset:1024 lds
    s_waitcnt lgkmcnt(5)
    v_mfma_f32_16x16x32_bf16 v[164:167], v[212:215], v[88:91], v[164:167]
    v_mfma_f32_16x16x32_bf16 v[172:175], v[212:215], v[92:95], v[172:175]
    ds_read_b128 v[204:207], v235 offset:12288
    s_add_u32 m0, s28, 32768
    s_nop 0
    buffer_load_dwordx4 v245, s[8:11], s25 offen offset:2048 lds
    s_waitcnt lgkmcnt(5)
    v_mfma_f32_16x16x32_bf16 v[160:163], v[216:219], v[120:123], v[160:163]
    v_mfma_f32_16x16x32_bf16 v[168:171], v[216:219], v[124:127], v[168:171]
    ds_read_b128 v[208:211], v235 offset:16384
    s_add_u32 m0, s28, 32768
    s_nop 0
    buffer_load_dwordx4 v246, s[8:11], s25 offen offset:3072 lds
    s_waitcnt lgkmcnt(5)
    v_mfma_f32_16x16x32_bf16 v[164:167], v[220:223], v[120:123], v[164:167]
    v_mfma_f32_16x16x32_bf16 v[172:175], v[220:223], v[124:127], v[172:175]
    ds_read_b128 v[212:215], v235 offset:20480
    s_waitcnt lgkmcnt(5)
    v_mfma_f32_16x16x32_bf16 v[128:131], v[192:195], v[0:3], 0
    v_mfma_f32_16x16x32_bf16 v[136:139], v[192:195], v[4:7], 0
    ds_read_b128 v[216:219], v235 offset:24576
    s_waitcnt lgkmcnt(5)
    v_mfma_f32_16x16x32_bf16 v[132:135], v[196:199], v[0:3], 0
    v_mfma_f32_16x16x32_bf16 v[140:143], v[196:199], v[4:7], 0
    ds_read_b128 v[220:223], v235 offset:28672
    s_waitcnt lgkmcnt(5)
    v_mfma_f32_16x16x32_bf16 v[128:131], v[200:203], v[32:35], v[128:131]
    v_mfma_f32_16x16x32_bf16 v[136:139], v[200:203], v[36:39], v[136:139]
    v_xor_b32 v234, 64, v233
    ds_read_b128 v[192:195], v234 offset:0
    v_cvt_pk_bf16_f32 v224, v160, v161
    v_cvt_pk_bf16_f32 v225, v162, v163
    s_waitcnt lgkmcnt(5)
    v_mfma_f32_16x16x32_bf16 v[132:135], v[204:207], v[32:35], v[132:135]
    v_mfma_f32_16x16x32_bf16 v[140:143], v[204:207], v[36:39], v[140:143]
    ds_read_b128 v[196:199], v234 offset:4096
    v_cvt_pk_bf16_f32 v226, v164, v165
    s_waitcnt lgkmcnt(5)
    v_mfma_f32_16x16x32_bf16 v[128:131], v[208:211], v[64:67], v[128:131]
    v_mfma_f32_16x16x32_bf16 v[136:139], v[208:211], v[68:71], v[136:139]
    ds_read_b128 v[200:203], v234 offset:8192
    v_cvt_pk_bf16_f32 v227, v166, v167
    s_waitcnt lgkmcnt(5)
    v_mfma_f32_16x16x32_bf16 v[132:135], v[212:215], v[64:67], v[132:135]
    v_mfma_f32_16x16x32_bf16 v[140:143], v[212:215], v[68:71], v[140:143]
    ds_read_b128 v[204:207], v234 offset:12288
    v_cvt_pk_bf16_f32 v228, v168, v169
    v_cvt_pk_bf16_f32 v229, v170, v171
    s_waitcnt lgkmcnt(5)
    v_mfma_f32_16x16x32_bf16 v[128:131], v[216:219], v[96:99], v[128:131]
    v_mfma_f32_16x16x32_bf16 v[136:139], v[216:219], v[100:103], v[136:139]
    ds_read_b128 v[208:211], v234 offset:16384
    v_cvt_pk_bf16_f32 v230, v172, v173
    s_waitcnt lgkmcnt(5)
    v_mfma_f32_16x16x32_bf16 v[132:135], v[220:223], v[96:99], v[132:135]
    v_mfma_f32_16x16x32_bf16 v[140:143], v[220:223], v[100:103], v[140:143]
    ds_read_b128 v[212:215], v234 offset:20480
    v_cvt_pk_bf16_f32 v231, v174, v175
    s_waitcnt lgkmcnt(5)
    v_mfma_f32_16x16x32_bf16 v[128:131], v[192:195], v[8:11], v[128:131]
    v_mfma_f32_16x16x32_bf16 v[136:139], v[192:195], v[12:15], v[136:139]
    ds_read_b128 v[216:219], v234 offset:24576
    s_add_u32 s51, s27, 40960
    buffer_store_dwordx4 v[224:227], v232, s[16:19], s51 offen sc1
    s_waitcnt lgkmcnt(5)
    v_mfma_f32_16x16x32_bf16 v[132:135], v[196:199], v[8:11], v[132:135]
    v_mfma_f32_16x16x32_bf16 v[140:143], v[196:199], v[12:15], v[140:143]
    ds_read_b128 v[220:223], v234 offset:28672
    s_waitcnt lgkmcnt(5)
    v_mfma_f32_16x16x32_bf16 v[128:131], v[200:203], v[40:43], v[128:131]
    v_mfma_f32_16x16x32_bf16 v[136:139], v[200:203], v[44:47], v[136:139]
    v_xor_b32 v235, 128, v233
    ds_read_b128 v[192:195], v235 offset:0
    s_waitcnt lgkmcnt(5)
    v_mfma_f32_16x16x32_bf16 v[132:135], v[204:207], v[40:43], v[132:135]
    v_mfma_f32_16x16x32_bf16 v[140:143], v[204:207], v[44:47], v[140:143]
    ds_read_b128 v[196:199], v235 offset:4096
    s_waitcnt lgkmcnt(5)
    v_mfma_f32_16x16x32_bf16 v[128:131], v[208:211], v[72:75], v[128:131]
    v_mfma_f32_16x16x32_bf16 v[136:139], v[208:211], v[76:79], v[136:139]
    ds_read_b128 v[200:203], v235 offset:8192
    s_waitcnt lgkmcnt(5)
    v_mfma_f32_16x16x32_bf16 v[132:135], v[212:215], v[72:75], v[132:135]
    v_mfma_f32_16x16x32_bf16 v[140:143], v[212:215], v[76:79], v[140:143]
    ds_read_b128 v[204:207], v235 offset:12288
    s_waitcnt lgkmcnt(5)
    v_mfma_f32_16x16x32_bf16 v[128:131], v[216:219], v[104:107], v[128:131]
    v_mfma_f32_16x16x32_bf16 v[136:139], v[216:219], v[108:111], v[136:139]
    ds_read_b128 v[208:211], v235 offset:16384
    s_add_u32 s51, s27, 40960
    buffer_store_dwordx4 v[228:231], v232, s[16:19], s51 offen offset:1024 sc1
    s_waitcnt lgkmcnt(5)
    v_mfma_f32_16x16x32_bf16 v[132:135], v[220:223], v[104:107], v[132:135]
    v_mfma_f32_16x16x32_bf16 v[140:143], v[220:223], v[108:111], v[140:143]
    ds_read_b128 v[212:215], v235 offset:20480
    s_waitcnt lgkmcnt(5)
    v_mfma_f32_16x16x32_bf16 v[128:131], v[192:195], v[16:19], v[128:131]
    v_mfma_f32_16x16x32_bf16 v[136:139], v[192:195], v[20:23], v[136:139]
    ds_read_b128 v[216:219], v235 offset:24576
    s_waitcnt lgkmcnt(5)
    v_mfma_f32_16x16x32_bf16 v[132:135], v[196:199], v[16:19], v[132:135]
    v_mfma_f32_16x16x32_bf16 v[140:143], v[196:199], v[20:23], v[140:143]
    ds_read_b128 v[220:223], v235 offset:28672
    s_waitcnt lgkmcnt(5)
    v_mfma_f32_16x16x32_bf16 v[128:131], v[200:203], v[48:51], v[128:131]
    v_mfma_f32_16x16x32_bf16 v[136:139], v[200:203], v[52:55], v[136:139]
    v_xor_b32 v234, 192, v233
    ds_read_b128 v[192:195], v234 offset:0
    s_waitcnt lgkmcnt(5)
    v_mfma_f32_16x16x32_bf16 v[132:135], v[204:207], v[48:51], v[132:135]
    v_mfma_f32_16x16x32_bf16 v[140:143], v[204:207], v[52:55], v[140:143]
    ds_read_b128 v[196:199], v234 offset:4096
    s_waitcnt lgkmcnt(5)
    v_mfma_f32_16x16x32_bf16 v[128:131], v[208:211], v[80:83], v[128:131]
    v_mfma_f32_16x16x32_bf16 v[136:139], v[208:211], v[84:87], v[136:139]
    ds_read_b128 v[200:203], v234 offset:8192
    buffer_store_dwordx4 v[184:187], v253, s[16:19], s58 offen sc1
    s_waitcnt lgkmcnt(5)
    v_mfma_f32_16x16x32_bf16 v[132:135], v[212:215], v[80:83], v[132:135]
    v_mfma_f32_16x16x32_bf16 v[140:143], v[212:215], v[84:87], v[140:143]
    ds_read_b128 v[204:207], v234 offset:12288
    s_waitcnt lgkmcnt(5)
    v_mfma_f32_16x16x32_bf16 v[128:131], v[216:219], v[112:115], v[128:131]
    v_mfma_f32_16x16x32_bf16 v[136:139], v[216:219], v[116:119], v[136:139]
    ds_read_b128 v[208:211], v234 offset:16384
    s_waitcnt lgkmcnt(5)
    v_mfma_f32_16x16x32_bf16 v[132:135], v[220:223], v[112:115], v[132:135]
    v_mfma_f32_16x16x32_bf16 v[140:143], v[220:223], v[116:119], v[140:143]
    ds_read_b128 v[212:215], v234 offset:20480
    s_waitcnt lgkmcnt(5)
    v_mfma_f32_16x16x32_bf16 v[128:131], v[192:195], v[24:27], v[128:131]
    v_mfma_f32_16x16x32_bf16 v[136:139], v[192:195], v[28:31], v[136:139]
    ds_read_b128 v[216:219], v234 offset:24576
    s_waitcnt lgkmcnt(5)
    v_mfma_f32_16x16x32_bf16 v[132:135], v[196:199], v[24:27], v[132:135]
    v_mfma_f32_16x16x32_bf16 v[140:143], v[196:199], v[28:31], v[140:143]
    ds_read_b128 v[220:223], v234 offset:28672
    s_waitcnt vmcnt(3)
    s_barrier
    s_waitcnt lgkmcnt(5)
    v_mfma_f32_16x16x32_bf16 v[128:131], v[200:203], v[56:59], v[128:131]
    v_mfma_f32_16x16x32_bf16 v[136:139], v[200:203], v[60:63], v[136:139]
    v_xor_b32 v235, 0, v233
    ds_read_b128 v[192:195], v235 offset:32768
    s_lshr_b32 s48, s2, 3
    s_lshl_b32 s48, s48, 3
    s_add_u32 s48, s48, s24
    v_bfe_u32 v240, v232, 7, 1
    v_lshlrev_b32 v240, 13, v240
    v_bfe_u32 v239, v232, 4, 3
    v_lshl_add_u32 v240, v239, 7, v240
    s_lshl_b32 s49, s48, 14
    s_and_b32 s48, s2, 7
    s_lshl_b32 s48, s48, 10
    s_add_u32 s49, s49, s48
    buffer_load_dword v242, v240, s[60:63], s49 offen
    s_waitcnt lgkmcnt(5)
    v_mfma_f32_16x16x32_bf16 v[132:135], v[204:207], v[56:59], v[132:135]
    v_mfma_f32_16x16x32_bf16 v[140:143], v[204:207], v[60:63], v[140:143]
    ds_read_b128 v[196:199], v235 offset:36864
    s_waitcnt lgkmcnt(5)
    v_mfma_f32_16x16x32_bf16 v[128:131], v[208:211], v[88:91], v[128:131]
    v_mfma_f32_16x16x32_bf16 v[136:139], v[208:211], v[92:95], v[136:139]
    ds_read_b128 v[200:203], v235 offset:40960
    s_waitcnt lgkmcnt(5)
    v_mfma_f32_16x16x32_bf16 v[132:135], v[212:215], v[88:91], v[132:135]
    v_mfma_f32_16x16x32_bf16 v[140:143], v[212:215], v[92:95], v[140:143]
    ds_read_b128 v[204:207], v235 offset:45056
    s_waitcnt lgkmcnt(5)
    v_mfma_f32_16x16x32_bf16 v[128:131], v[216:219], v[120:123], v[128:131]
    v_mfma_f32_16x16x32_bf16 v[136:139], v[216:219], v[124:127], v[136:139]
    ds_read_b128 v[208:211], v235 offset:49152
    s_waitcnt lgkmcnt(5)
    v_mfma_f32_16x16x32_bf16 v[132:135], v[220:223], v[120:123], v[132:135]
    v_mfma_f32_16x16x32_bf16 v[140:143], v[220:223], v[124:127], v[140:143]
    ds_read_b128 v[212:215], v235 offset:53248
    s_waitcnt lgkmcnt(5)
    v_mfma_f32_16x16x32_bf16 v[144:147], v[192:195], v[0:3], 0
    v_mfma_f32_16x16x32_bf16 v[152:155], v[192:195], v[4:7], 0
    ds_read_b128 v[216:219], v235 offset:57344
    s_waitcnt lgkmcnt(5)
    v_mfma_f32_16x16x32_bf16 v[148:151], v[196:199], v[0:3], 0
    v_mfma_f32_16x16x32_bf16 v[156:159], v[196:199], v[4:7], 0
    ds_read_b128 v[220:223], v235 offset:61440
    s_waitcnt lgkmcnt(5)
    v_mfma_f32_16x16x32_bf16 v[144:147], v[200:203], v[32:35], v[144:147]
    v_mfma_f32_16x16x32_bf16 v[152:155], v[200:203], v[36:39], v[152:155]
    v_xor_b32 v234, 64, v233
    ds_read_b128 v[192:195], v234 offset:32768
    v_cvt_pk_bf16_f32 v176, v128, v129
    v_cvt_pk_bf16_f32 v177, v130, v131
    s_waitcnt lgkmcnt(5)
    v_mfma_f32_16x16x32_bf16 v[148:151], v[204:207], v[32:35], v[148:151]
    v_mfma_f32_16x16x32_bf16 v[156:159], v[204:207], v[36:39], v[156:159]
    ds_read_b128 v[196:199], v234 offset:36864
    v_cvt_pk_bf16_f32 v178, v132, v133
    s_waitcnt lgkmcnt(5)
    v_mfma_f32_16x16x32_bf16 v[144:147], v[208:211], v[64:67], v[144:147]
    v_mfma_f32_16x16x32_bf16 v[152:155], v[208:211], v[68:71], v[152:155]
    ds_read_b128 v[200:203], v234 offset:40960
    v_cvt_pk_bf16_f32 v179, v134, v135
    s_waitcnt lgkmcnt(5)
    v_mfma_f32_16x16x32_bf16 v[148:151], v[212:215], v[64:67], v[148:151]
    v_mfma_f32_16x16x32_bf16 v[156:159], v[212:215], v[68:71], v[156:159]
    ds_read_b128 v[204:207], v234 offset:45056
    v_cvt_pk_bf16_f32 v180, v136, v137
    v_cvt_pk_bf16_f32 v181, v138, v139
    s_waitcnt lgkmcnt(5)
    v_mfma_f32_16x16x32_bf16 v[144:147], v[216:219], v[96:99], v[144:147]
    v_mfma_f32_16x16x32_bf16 v[152:155], v[216:219], v[100:103], v[152:155]
    ds_read_b128 v[208:211], v234 offset:49152
    v_cvt_pk_bf16_f32 v182, v140, v141
    s_waitcnt lgkmcnt(5)
    v_mfma_f32_16x16x32_bf16 v[148:151], v[220:223], v[96:99], v[148:151]
    v_mfma_f32_16x16x32_bf16 v[156:159], v[220:223], v[100:103], v[156:159]
    ds_read_b128 v[212:215], v234 offset:53248
    v_cvt_pk_bf16_f32 v183, v142, v143
    s_waitcnt lgkmcnt(5)
    v_mfma_f32_16x16x32_bf16 v[144:147], v[192:195], v[8:11], v[144:147]
    v_mfma_f32_16x16x32_bf16 v[152:155], v[192:195], v[12:15], v[152:155]
    ds_read_b128 v[216:219], v234 offset:57344
    s_add_u32 s51, s27, 49152
    buffer_store_dwordx4 v[176:179], v232, s[16:19], s51 offen sc1
    s_waitcnt lgkmcnt(5)
    v_mfma_f32_16x16x32_bf16 v[148:151], v[196:199], v[8:11], v[148:151]
    v_mfma_f32_16x16x32_bf16 v[156:159], v[196:199], v[12:15], v[156:159]
    ds_read_b128 v[220:223], v234 offset:61440
    s_waitcnt lgkmcnt(5)
    v_mfma_f32_16x16x32_bf16 v[144:147], v[200:203], v[40:43], v[144:147]
    v_mfma_f32_16x16x32_bf16 v[152:155], v[200:203], v[44:47], v[152:155]
    v_xor_b32 v235, 128, v233
    ds_read_b128 v[192:195], v235 offset:32768
    s_waitcnt lgkmcnt(5)
    v_mfma_f32_16x16x32_bf16 v[148:151], v[204:207], v[40:43], v[148:151]
    v_mfma_f32_16x16x32_bf16 v[156:159], v[204:207], v[44:47], v[156:159]
    ds_read_b128 v[196:199], v235 offset:36864
    s_waitcnt lgkmcnt(5)
    v_mfma_f32_16x16x32_bf16 v[144:147], v[208:211], v[72:75], v[144:147]
    v_mfma_f32_16x16x32_bf16 v[152:155], v[208:211], v[76:79], v[152:155]
    ds_read_b128 v[200:203], v235 offset:40960
    s_waitcnt lgkmcnt(5)
    v_mfma_f32_16x16x32_bf16 v[148:151], v[212:215], v[72:75], v[148:151]
    v_mfma_f32_16x16x32_bf16 v[156:159], v[212:215], v[76:79], v[156:159]
    ds_read_b128 v[204:207], v235 offset:45056
    s_waitcnt lgkmcnt(5)
    v_mfma_f32_16x16x32_bf16 v[144:147], v[216:219], v[104:107], v[144:147]
    v_mfma_f32_16x16x32_bf16 v[152:155], v[216:219], v[108:111], v[152:155]
    ds_read_b128 v[208:211], v235 offset:49152
    s_waitcnt lgkmcnt(5)
    v_mfma_f32_16x16x32_bf16 v[148:151], v[220:223], v[104:107], v[148:151]
    v_mfma_f32_16x16x32_bf16 v[156:159], v[220:223], v[108:111], v[156:159]
    ds_read_b128 v[212:215], v235 offset:53248
    s_waitcnt lgkmcnt(5)
    v_mfma_f32_16x16x32_bf16 v[144:147], v[192:195], v[16:19], v[144:147]
    v_mfma_f32_16x16x32_bf16 v[152:155], v[192:195], v[20:23], v[152:155]
    ds_read_b128 v[216:219], v235 offset:57344
    s_waitcnt lgkmcnt(5)
    v_mfma_f32_16x16x32_bf16 v[148:151], v[196:199], v[16:19], v[148:151]
    v_mfma_f32_16x16x32_bf16 v[156:159], v[196:199], v[20:23], v[156:159]
    ds_read_b128 v[220:223], v235 offset:61440
    s_add_u32 s51, s27, 49152
    buffer_store_dwordx4 v[180:183], v232, s[16:19], s51 offen offset:1024 sc1
    s_waitcnt lgkmcnt(5)
    v_mfma_f32_16x16x32_bf16 v[144:147], v[200:203], v[48:51], v[144:147]
    v_mfma_f32_16x16x32_bf16 v[152:155], v[200:203], v[52:55], v[152:155]
    v_xor_b32 v234, 192, v233
    ds_read_b128 v[192:195], v234 offset:32768
    s_waitcnt lgkmcnt(5)
    v_mfma_f32_16x16x32_bf16 v[148:151], v[204:207], v[48:51], v[148:151]
    v_mfma_f32_16x16x32_bf16 v[156:159], v[204:207], v[52:55], v[156:159]
    ds_read_b128 v[196:199], v234 offset:36864
    s_waitcnt lgkmcnt(5)
    v_mfma_f32_16x16x32_bf16 v[144:147], v[208:211], v[80:83], v[144:147]
    v_mfma_f32_16x16x32_bf16 v[152:155], v[208:211], v[84:87], v[152:155]
    ds_read_b128 v[200:203], v234 offset:40960
    s_waitcnt lgkmcnt(5)
    v_mfma_f32_16x16x32_bf16 v[148:151], v[212:215], v[80:83], v[148:151]
    v_mfma_f32_16x16x32_bf16 v[156:159], v[212:215], v[84:87], v[156:159]
    ds_read_b128 v[204:207], v234 offset:45056
    s_waitcnt lgkmcnt(5)
    v_mfma_f32_16x16x32_bf16 v[144:147], v[216:219], v[112:115], v[144:147]
    v_mfma_f32_16x16x32_bf16 v[152:155], v[216:219], v[116:119], v[152:155]
    ds_read_b128 v[208:211], v234 offset:49152
    s_waitcnt lgkmcnt(5)
    v_mfma_f32_16x16x32_bf16 v[148:151], v[220:223], v[112:115], v[148:151]
    v_mfma_f32_16x16x32_bf16 v[156:159], v[220:223], v[116:119], v[156:159]
    ds_read_b128 v[212:215], v234 offset:53248
    s_waitcnt lgkmcnt(5)
    v_mfma_f32_16x16x32_bf16 v[144:147], v[192:195], v[24:27], v[144:147]
    v_mfma_f32_16x16x32_bf16 v[152:155], v[192:195], v[28:31], v[152:155]
    ds_read_b128 v[216:219], v234 offset:57344
    s_waitcnt lgkmcnt(5)
    v_mfma_f32_16x16x32_bf16 v[148:151], v[196:199], v[24:27], v[148:151]
    v_mfma_f32_16x16x32_bf16 v[156:159], v[196:199], v[28:31], v[156:159]
    ds_read_b128 v[220:223], v234 offset:61440
    s_waitcnt lgkmcnt(5)
    v_mfma_f32_16x16x32_bf16 v[144:147], v[200:203], v[56:59], v[144:147]
    v_mfma_f32_16x16x32_bf16 v[152:155], v[200:203], v[60:63], v[152:155]
    s_waitcnt lgkmcnt(4)
    v_mfma_f32_16x16x32_bf16 v[148:151], v[204:207], v[56:59], v[148:151]
    v_mfma_f32_16x16x32_bf16 v[156:159], v[204:207], v[60:63], v[156:159]
    s_waitcnt lgkmcnt(3)
    v_mfma_f32_16x16x32_bf16 v[144:147], v[208:211], v[88:91], v[144:147]
    v_mfma_f32_16x16x32_bf16 v[152:155], v[208:211], v[92:95], v[152:155]
    s_waitcnt lgkmcnt(2)
    v_mfma_f32_16x16x32_bf16 v[148:151], v[212:215], v[88:91], v[148:151]
    v_mfma_f32_16x16x32_bf16 v[156:159], v[212:215], v[92:95], v[156:159]
    s_waitcnt lgkmcnt(1)
    v_mfma_f32_16x16x32_bf16 v[144:147], v[216:219], v[120:123], v[144:147]
    v_mfma_f32_16x16x32_bf16 v[152:155], v[216:219], v[124:127], v[152:155]
    s_waitcnt lgkmcnt(0)
    v_mfma_f32_16x16x32_bf16 v[148:151], v[220:223], v[120:123], v[148:151]
    v_mfma_f32_16x16x32_bf16 v[156:159], v[220:223], v[124:127], v[156:159]
    s_nop 3
    v_cvt_pk_bf16_f32 v168, v144, v145
    v_cvt_pk_bf16_f32 v169, v146, v147
    s_nop 0
    v_cvt_pk_bf16_f32 v170, v148, v149
    v_cvt_pk_bf16_f32 v171, v150, v151
    v_cvt_pk_bf16_f32 v172, v152, v153
    v_cvt_pk_bf16_f32 v173, v154, v155
    v_cvt_pk_bf16_f32 v174, v156, v157
    v_cvt_pk_bf16_f32 v175, v158, v159
    s_add_u32 s51, s27, 57344
    buffer_store_dwordx4 v[168:171], v232, s[16:19], s51 offen sc1
    s_add_u32 s51, s27, 57344
    buffer_store_dwordx4 v[172:175], v232, s[16:19], s51 offen offset:1024 sc1
    s_endpgm
k1_kernel_done:
    s_endpgm
.globl k2_kernel
.p2align 8
.type k2_kernel,@function
k2_kernel:
    s_cmp_ge_u32 s2, 256
    s_cbranch_scc1 k2_kernel_done
    s_load_dwordx2 s[4:5], s[0:1], 72
    s_load_dwordx2 s[6:7], s[0:1], 120
    s_load_dwordx2 s[12:13], s[0:1], 96
    s_load_dwordx2 s[20:21], s[0:1], 48
    v_lshrrev_b32 v233, 6, v0
    v_and_b32 v235, 63, v0
    v_readfirstlane_b32 s24, v233
    v_lshlrev_b32 v224, 4, v235
    s_and_b32 s40, s2, 7
    s_lshr_b32 s41, s2, 3
    s_and_b32 s42, s41, 3
    s_lshl_b32 s40, s40, 2
    s_add_u32 s25, s40, s42
    s_lshr_b32 s41, s41, 2
    s_and_b32 s42, s24, 3
    s_sub_u32 s43, 15, s41
    s_sub_u32 s47, 3, s42
    s_cmp_lt_u32 s24, 4
    s_cselect_b32 s43, s43, s41
    s_cselect_b32 s42, s42, s47
    s_lshl_b32 s43, s43, 2
    s_add_u32 s38, s43, s42
    s_add_u32 s26, s38, 1
    s_lshl_b32 s43, s41, 1
    s_sub_u32 s32, 32, s43
    s_add_u32 s29, s32, 4
    s_add_u32 s22, s43, 8
    s_cmp_le_i32 s41, -1
    s_cselect_b32 s60, 1, 0
    s_lshl_b32 s42, s41, 2
    s_sub_u32 s61, 61, s42
    s_and_b32 s42, s24, 3
    s_add_u32 s61, s61, s42
    s_lshl_b32 s62, s2, 2
    s_add_u32 s62, s62, s42
    s_mul_i32 s62, s62, 9216
    s_add_u32 s62, s62, 75497472
    s_mov_b32 s23, 0
    s_lshl_b32 s45, s25, 19
    s_and_b32 s42, s24, 3
    s_lshl_b32 s42, s42, 12
    s_add_u32 s30, s45, s42
    s_lshr_b32 s31, s24, 2
    s_mul_i32 s42, s31, 16760832
    s_add_u32 s30, s30, s42
    s_lshl_b32 s33, s24, 12
    s_lshl_b32 s36, s38, 13
    s_add_u32 s36, s36, 33554432
    s_lshl_b32 s37, s38, 11
    s_add_u32 s37, s37, s45
    s_add_u32 s37, s37, 37748736
    s_mov_b32 s39, 0x3e0293ee
    s_mov_b32 s57, s30
    s_sub_u32 s58, 0, s31
    s_mov_b32 s59, 0
    v_lshrrev_b32 v233, 4, v235
    v_and_b32 v238, 15, v235
    v_lshlrev_b32 v234, 1, v233
    v_xor_b32 v238, v238, v234
    v_lshlrev_b32 v238, 4, v238
    v_lshl_add_u32 v229, v233, 13, v238
    v_xor_b32 v230, 128, v229
    s_lshl_b32 s44, s25, 8
    s_lshl_b32 s42, s24, 17
    s_add_u32 s44, s44, s42
    v_lshrrev_b32 v233, 4, v235
    v_lshlrev_b32 v228, 11, v233
    v_bfe_u32 v233, v235, 2, 2
    v_lshl_add_u32 v228, v233, 8, v228
    v_lshl_add_u32 v228, v233, 5, v228
    v_bfe_u32 v233, v235, 4, 1
    v_lshl_add_u32 v228, v233, 7, v228
    v_and_b32 v233, 3, v235
    v_lshl_add_u32 v228, v233, 3, v228
    v_and_b32 v233, 15, v235
    v_lshrrev_b32 v238, 4, v235
    v_lshlrev_b32 v238, 2, v238
    v_sub_u32 v231, v233, v238
    v_mov_b32 v232, 0xf149f2ca
    s_lshl_b32 s42, s24, 8
    s_add_u32 s42, s42, 131072
    v_lshl_add_u32 v237, v235, 2, s42
    v_and_b32 v233, 7, v235
    v_mul_u32_u24 v239, 260, v233
    v_add_u32 v239, 131072, v239
    v_mov_b32 v241, -1
    ds_write_b32 v237, v241
    s_mov_b32 s28, 0
    s_mov_b32 s46, 0
    s_waitcnt lgkmcnt(0)
    s_mov_b32 s8, s4
    s_mov_b32 s9, s5
    s_mov_b32 s10, 0x400000
    s_mov_b32 s11, 0x00020000
    s_mov_b32 s16, s6
    s_mov_b32 s17, s7
    s_mov_b32 s18, 0x10000000
    s_mov_b32 s19, 0x00020000
    s_mov_b32 s14, 0x400000
    s_mov_b32 s15, 0x00020000
    s_add_u32 m0, s33, 0
    s_add_u32 s35, s44, 0
    buffer_load_dwordx4 v229, s[8:11], s35 offen offset:0 lds
    s_add_u32 m0, s33, 0
    s_add_u32 s35, s44, 31744
    buffer_load_dwordx4 v229, s[8:11], s35 offen offset:1024 lds
    s_add_u32 m0, s33, 0
    s_add_u32 s35, s44, 63488
    buffer_load_dwordx4 v230, s[8:11], s35 offen offset:2048 lds
    s_add_u32 m0, s33, 0
    s_add_u32 s35, s44, 95232
    buffer_load_dwordx4 v230, s[8:11], s35 offen offset:3072 lds
    s_add_u32 s48, s36, 0
    buffer_load_dwordx4 v[0:3], v224, s[16:19], s48 offen offset:0
    s_add_u32 s48, s36, 0
    buffer_load_dwordx4 v[4:7], v224, s[16:19], s48 offen offset:1024
    s_add_u32 s48, s36, 0
    buffer_load_dwordx4 v[8:11], v224, s[16:19], s48 offen offset:2048
    s_add_u32 s48, s36, 0
    buffer_load_dwordx4 v[12:15], v224, s[16:19], s48 offen offset:3072
    s_add_u32 s48, s36, 4096
    buffer_load_dwordx4 v[64:67], v224, s[16:19], s48 offen offset:0
    s_add_u32 s48, s36, 4096
    buffer_load_dwordx4 v[68:71], v224, s[16:19], s48 offen offset:1024
    s_add_u32 s48, s36, 4096
    buffer_load_dwordx4 v[72:75], v224, s[16:19], s48 offen offset:2048
    s_add_u32 s48, s36, 4096
    buffer_load_dwordx4 v[76:79], v224, s[16:19], s48 offen offset:3072
    s_add_u32 m0, s33, 32768
    s_add_u32 s35, s44, 1048576
    buffer_load_dwordx4 v229, s[8:11], s35 offen offset:0 lds
    s_add_u32 m0, s33, 32768
    s_add_u32 s35, s44, 1080320
    buffer_load_dwordx4 v229, s[8:11], s35 offen offset:1024 lds
    s_add_u32 m0, s33, 32768
    s_add_u32 s35, s44, 1112064
    buffer_load_dwordx4 v230, s[8:11], s35 offen offset:2048 lds
    s_add_u32 m0, s33, 32768
    s_add_u32 s35, s44, 1143808
    buffer_load_dwordx4 v230, s[8:11], s35 offen offset:3072 lds
    s_waitcnt vmcnt(12)
    s_barrier
    v_xor_b32 v227, 0, v228
    ds_read_b64_tr_b16 v[192:193], v227 offset:0
    ds_read_b64_tr_b16 v[194:195], v227 offset:1024
    s_waitcnt vmcnt(11) lgkmcnt(0)
    v_mfma_f32_16x16x32_bf16 v[128:131], v[192:195], v[0:3], 0
    s_waitcnt vmcnt(7)
    v_mfma_f32_16x16x32_bf16 v[160:163], v[192:195], v[64:67], 0
    ds_read_b64_tr_b16 v[196:197], v227 offset:8192
    ds_read_b64_tr_b16 v[198:199], v227 offset:9216
    ds_read_b64_tr_b16 v[200:201], v227 offset:16384
    ds_read_b64_tr_b16 v[202:203], v227 offset:17408
    ds_read_b64_tr_b16 v[204:205], v227 offset:24576
    ds_read_b64_tr_b16 v[206:207], v227 offset:25600
    v_xor_b32 v226, 32, v228
    ds_read_b64_tr_b16 v[208:209], v226 offset:0
    ds_read_b64_tr_b16 v[210:211], v226 offset:1024
    ds_read_b64_tr_b16 v[212:213], v226 offset:8192
    ds_read_b64_tr_b16 v[214:215], v226 offset:9216
    s_add_u32 s48, s36, 524288
    buffer_load_dwordx4 v[16:19], v224, s[16:19], s48 offen offset:0
    s_waitcnt lgkmcnt(8)
    v_mfma_f32_16x16x32_bf16 v[128:131], v[196:199], v[4:7], v[128:131]
    s_waitcnt vmcnt(7)
    v_mfma_f32_16x16x32_bf16 v[160:163], v[196:199], v[68:71], v[160:163]
    ds_read_b64_tr_b16 v[216:217], v226 offset:16384
    ds_read_b64_tr_b16 v[218:219], v226 offset:17408
    s_add_u32 s48, s36, 524288
    buffer_load_dwordx4 v[20:23], v224, s[16:19], s48 offen offset:1024
    s_waitcnt lgkmcnt(8)
    v_mfma_f32_16x16x32_bf16 v[128:131], v[200:203], v[8:11], v[128:131]
    s_waitcnt vmcnt(7)
    v_mfma_f32_16x16x32_bf16 v[160:163], v[200:203], v[72:75], v[160:163]
    ds_read_b64_tr_b16 v[220:221], v226 offset:24576
    ds_read_b64_tr_b16 v[222:223], v226 offset:25600
    s_add_u32 s48, s36, 524288
    buffer_load_dwordx4 v[24:27], v224, s[16:19], s48 offen offset:2048
    s_waitcnt lgkmcnt(8)
    v_mfma_f32_16x16x32_bf16 v[128:131], v[204:207], v[12:15], v[128:131]
    s_waitcnt vmcnt(7)
    v_mfma_f32_16x16x32_bf16 v[160:163], v[204:207], v[76:79], v[160:163]
    v_xor_b32 v227, 64, v228
    ds_read_b64_tr_b16 v[192:193], v227 offset:0
    ds_read_b64_tr_b16 v[194:195], v227 offset:1024
    s_add_u32 s48, s36, 524288
    buffer_load_dwordx4 v[28:31], v224, s[16:19], s48 offen offset:3072
    s_waitcnt lgkmcnt(8)
    v_mfma_f32_16x16x32_bf16 v[132:135], v[208:211], v[0:3], 0
    v_mfma_f32_16x16x32_bf16 v[164:167], v[208:211], v[64:67], 0
    ds_read_b64_tr_b16 v[196:197], v227 offset:8192
    ds_read_b64_tr_b16 v[198:199], v227 offset:9216
    s_add_u32 s48, s36, 528384
    buffer_load_dwordx4 v[80:83], v224, s[16:19], s48 offen offset:0
    s_waitcnt lgkmcnt(8)
    v_mfma_f32_16x16x32_bf16 v[132:135], v[212:215], v[4:7], v[132:135]
    v_mfma_f32_16x16x32_bf16 v[164:167], v[212:215], v[68:71], v[164:167]
    ds_read_b64_tr_b16 v[200:201], v227 offset:16384
    ds_read_b64_tr_b16 v[202:203], v227 offset:17408
    s_add_u32 s48, s36, 528384
    buffer_load_dwordx4 v[84:87], v224, s[16:19], s48 offen offset:1024
    s_waitcnt lgkmcnt(8)
    v_mfma_f32_16x16x32_bf16 v[132:135], v[216:219], v[8:11], v[132:135]
    v_mfma_f32_16x16x32_bf16 v[164:167], v[216:219], v[72:75], v[164:167]
    ds_read_b64_tr_b16 v[204:205], v227 offset:24576
    ds_read_b64_tr_b16 v[206:207], v227 offset:25600
    s_waitcnt lgkmcnt(8)
    v_mfma_f32_16x16x32_bf16 v[132:135], v[220:223], v[12:15], v[132:135]
    v_mfma_f32_16x16x32_bf16 v[164:167], v[220:223], v[76:79], v[164:167]
    v_xor_b32 v226, 96, v228
    ds_read_b64_tr_b16 v[208:209], v226 offset:0
    ds_read_b64_tr_b16 v[210:211], v226 offset:1024
    s_add_u32 s48, s36, 528384
    buffer_load_dwordx4 v[88:91], v224, s[16:19], s48 offen offset:2048
    s_waitcnt lgkmcnt(8)
    v_mfma_f32_16x16x32_bf16 v[136:139], v[192:195], v[0:3], 0
    v_mfma_f32_16x16x32_bf16 v[168:171], v[192:195], v[64:67], 0
    ds_read_b64_tr_b16 v[212:213], v226 offset:8192
    ds_read_b64_tr_b16 v[214:215], v226 offset:9216
    s_add_u32 s48, s36, 528384
    buffer_load_dwordx4 v[92:95], v224, s[16:19], s48 offen offset:3072
    s_waitcnt lgkmcnt(8)
    v_mfma_f32_16x16x32_bf16 v[136:139], v[196:199], v[4:7], v[136:139]
    v_mfma_f32_16x16x32_bf16 v[168:171], v[196:199], v[68:71], v[168:171]
    ds_read_b64_tr_b16 v[216:217], v226 offset:16384
    ds_read_b64_tr_b16 v[218:219], v226 offset:17408
    s_add_u32 m0, s33, 65536
    s_add_u32 s35, s44, 2097152
    buffer_load_dwordx4 v229, s[8:11], s35 offen offset:0 lds
    s_waitcnt lgkmcnt(8)
    v_mfma_f32_16x16x32_bf16 v[136:139], v[200:203], v[8:11], v[136:139]
    v_mfma_f32_16x16x32_bf16 v[168:171], v[200:203], v[72:75], v[168:171]
    ds_read_b64_tr_b16 v[220:221], v226 offset:24576
    ds_read_b64_tr_b16 v[222:223], v226 offset:25600
    s_add_u32 m0, s33, 65536
    s_add_u32 s35, s44, 2128896
    buffer_load_dwordx4 v229, s[8:11], s35 offen offset:1024 lds
    s_waitcnt lgkmcnt(8)
    v_mfma_f32_16x16x32_bf16 v[136:139], v[204:207], v[12:15], v[136:139]
    v_mfma_f32_16x16x32_bf16 v[168:171], v[204:207], v[76:79], v[168:171]
    v_xor_b32 v227, 128, v228
    ds_read_b64_tr_b16 v[192:193], v227 offset:0
    ds_read_b64_tr_b16 v[194:195], v227 offset:1024
    s_add_u32 m0, s33, 65536
    s_add_u32 s35, s44, 2160640
    buffer_load_dwordx4 v230, s[8:11], s35 offen offset:2048 lds
    s_waitcnt lgkmcnt(8)
    v_mfma_f32_16x16x32_bf16 v[140:143], v[208:211], v[0:3], 0
    v_mfma_f32_16x16x32_bf16 v[172:175], v[208:211], v[64:67], 0
    ds_read_b64_tr_b16 v[196:197], v227 offset:8192
    ds_read_b64_tr_b16 v[198:199], v227 offset:9216
    s_add_u32 m0, s33, 65536
    s_add_u32 s35, s44, 2192384
    buffer_load_dwordx4 v230, s[8:11], s35 offen offset:3072 lds
    s_waitcnt lgkmcnt(8)
    v_mfma_f32_16x16x32_bf16 v[140:143], v[212:215], v[4:7], v[140:143]
    v_mfma_f32_16x16x32_bf16 v[172:175], v[212:215], v[68:71], v[172:175]
    ds_read_b64_tr_b16 v[200:201], v227 offset:16384
    ds_read_b64_tr_b16 v[202:203], v227 offset:17408
    s_waitcnt vmcnt(12)
    v_mov_b32 v241, s28
    ds_write_b32 v237, v241
    s_waitcnt lgkmcnt(9)
    v_mfma_f32_16x16x32_bf16 v[140:143], v[216:219], v[8:11], v[140:143]
    v_mfma_f32_16x16x32_bf16 v[172:175], v[216:219], v[72:75], v[172:175]
    ds_read_b64_tr_b16 v[204:205], v227 offset:24576
    ds_read_b64_tr_b16 v[206:207], v227 offset:25600
    s_add_u32 s48, s36, 1048576
    buffer_load_dwordx4 v[32:35], v224, s[16:19], s48 offen offset:0
    s_waitcnt lgkmcnt(9)
    v_mfma_f32_16x16x32_bf16 v[140:143], v[220:223], v[12:15], v[140:143]
    v_mfma_f32_16x16x32_bf16 v[172:175], v[220:223], v[76:79], v[172:175]
    v_xor_b32 v226, 160, v228
    ds_read_b64_tr_b16 v[208:209], v226 offset:0
    ds_read_b64_tr_b16 v[210:211], v226 offset:1024
    s_waitcnt lgkmcnt(9)
    v_mfma_f32_16x16x32_bf16 v[144:147], v[192:195], v[0:3], 0
    v_mfma_f32_16x16x32_bf16 v[176:179], v[192:195], v[64:67], 0
    ds_read_b64_tr_b16 v[212:213], v226 offset:8192
    ds_read_b64_tr_b16 v[214:215], v226 offset:9216
    s_add_u32 s48, s36, 1048576
    buffer_load_dwordx4 v[36:39], v224, s[16:19], s48 offen offset:1024
    s_waitcnt lgkmcnt(9)
    v_mfma_f32_16x16x32_bf16 v[144:147], v[196:199], v[4:7], v[144:147]
    v_mfma_f32_16x16x32_bf16 v[176:179], v[196:199], v[68:71], v[176:179]
    ds_read_b64_tr_b16 v[216:217], v226 offset:16384
    ds_read_b64_tr_b16 v[218:219], v226 offset:17408
    s_waitcnt lgkmcnt(9)
    v_mfma_f32_16x16x32_bf16 v[144:147], v[200:203], v[8:11], v[144:147]
    v_mfma_f32_16x16x32_bf16 v[176:179], v[200:203], v[72:75], v[176:179]
    ds_read_b64_tr_b16 v[220:221], v226 offset:24576
    ds_read_b64_tr_b16 v[222:223], v226 offset:25600
    s_add_u32 s48, s36, 1048576
    buffer_load_dwordx4 v[40:43], v224, s[16:19], s48 offen offset:2048
    s_waitcnt lgkmcnt(8)
    v_mfma_f32_16x16x32_bf16 v[144:147], v[204:207], v[12:15], v[144:147]
    v_mfma_f32_16x16x32_bf16 v[176:179], v[204:207], v[76:79], v[176:179]
    v_xor_b32 v227, 192, v228
    ds_read_b64_tr_b16 v[192:193], v227 offset:0
    ds_read_b64_tr_b16 v[194:195], v227 offset:1024
    s_waitcnt lgkmcnt(8)
    v_mfma_f32_16x16x32_bf16 v[148:151], v[208:211], v[0:3], 0
    v_mfma_f32_16x16x32_bf16 v[180:183], v[208:211], v[64:67], 0
    ds_read_b64_tr_b16 v[196:197], v227 offset:8192
    ds_read_b64_tr_b16 v[198:199], v227 offset:9216
    s_add_u32 s48, s36, 1048576
    buffer_load_dwordx4 v[44:47], v224, s[16:19], s48 offen offset:3072
    s_waitcnt lgkmcnt(8)
    v_mfma_f32_16x16x32_bf16 v[148:151], v[212:215], v[4:7], v[148:151]
    v_mfma_f32_16x16x32_bf16 v[180:183], v[212:215], v[68:71], v[180:183]
    ds_read_b64_tr_b16 v[200:201], v227 offset:16384
    ds_read_b64_tr_b16 v[202:203], v227 offset:17408
    ds_read_b32 v240, v239
    s_waitcnt lgkmcnt(9)
    v_mfma_f32_16x16x32_bf16 v[148:151], v[216:219], v[8:11], v[148:151]
    v_mfma_f32_16x16x32_bf16 v[180:183], v[216:219], v[72:75], v[180:183]
    ds_read_b64_tr_b16 v[204:205], v227 offset:24576
    ds_read_b64_tr_b16 v[206:207], v227 offset:25600
    s_waitcnt lgkmcnt(9)
    v_mfma_f32_16x16x32_bf16 v[148:151], v[220:223], v[12:15], v[148:151]
    v_mfma_f32_16x16x32_bf16 v[180:183], v[220:223], v[76:79], v[180:183]
    v_xor_b32 v226, 224, v228
    ds_read_b64_tr_b16 v[208:209], v226 offset:0
    ds_read_b64_tr_b16 v[210:211], v226 offset:1024
    s_waitcnt lgkmcnt(9)
    v_mfma_f32_16x16x32_bf16 v[152:155], v[192:195], v[0:3], 0
    v_mfma_f32_16x16x32_bf16 v[184:187], v[192:195], v[64:67], 0
    ds_read_b64_tr_b16 v[212:213], v226 offset:8192
    ds_read_b64_tr_b16 v[214:215], v226 offset:9216
    s_waitcnt lgkmcnt(9)
    v_mfma_f32_16x16x32_bf16 v[152:155], v[196:199], v[4:7], v[152:155]
    v_mfma_f32_16x16x32_bf16 v[184:187], v[196:199], v[68:71], v[184:187]
    ds_read_b64_tr_b16 v[216:217], v226 offset:16384
    ds_read_b64_tr_b16 v[218:219], v226 offset:17408
    s_waitcnt lgkmcnt(8)
    v_cmp_gt_i32 vcc, s28, v240
    s_cbranch_vccnz k2_kernel_spin_1
k2_kernel_back_2:
    s_add_u32 s28, s28, 1
    v_mfma_f32_16x16x32_bf16 v[152:155], v[200:203], v[8:11], v[152:155]
    v_mfma_f32_16x16x32_bf16 v[184:187], v[200:203], v[72:75], v[184:187]
    ds_read_b64_tr_b16 v[220:221], v226 offset:24576
    ds_read_b64_tr_b16 v[222:223], v226 offset:25600
    s_add_u32 m0, s33, 98304
    s_add_u32 s35, s44, 3145728
    buffer_load_dwordx4 v229, s[8:11], s35 offen offset:0 lds
    s_waitcnt lgkmcnt(8)
    v_mfma_f32_16x16x32_bf16 v[152:155], v[204:207], v[12:15], v[152:155]
    v_mfma_f32_16x16x32_bf16 v[184:187], v[204:207], v[76:79], v[184:187]
    v_xor_b32 v227, 0, v228
    ds_read_b64_tr_b16 v[192:193], v227 offset:32768
    ds_read_b64_tr_b16 v[194:195], v227 offset:33792
    s_add_u32 m0, s33, 98304
    s_add_u32 s35, s44, 3177472
    buffer_load_dwordx4 v229, s[8:11], s35 offen offset:1024 lds
    s_waitcnt lgkmcnt(8)
    v_mfma_f32_16x16x32_bf16 v[156:159], v[208:211], v[0:3], 0
    v_mfma_f32_16x16x32_bf16 v[188:191], v[208:211], v[64:67], 0
    ds_read_b64_tr_b16 v[196:197], v227 offset:40960
    ds_read_b64_tr_b16 v[198:199], v227 offset:41984
    s_waitcnt lgkmcnt(8)
    v_mfma_f32_16x16x32_bf16 v[156:159], v[212:215], v[4:7], v[156:159]
    v_mfma_f32_16x16x32_bf16 v[188:191], v[212:215], v[68:71], v[188:191]
    ds_read_b64_tr_b16 v[200:201], v227 offset:49152
    ds_read_b64_tr_b16 v[202:203], v227 offset:50176
    s_add_u32 m0, s33, 98304
    s_add_u32 s35, s44, 3209216
    buffer_load_dwordx4 v230, s[8:11], s35 offen offset:2048 lds
    s_waitcnt lgkmcnt(8)
    v_mfma_f32_16x16x32_bf16 v[156:159], v[216:219], v[8:11], v[156:159]
    v_mfma_f32_16x16x32_bf16 v[188:191], v[216:219], v[72:75], v[188:191]
    ds_read_b64_tr_b16 v[204:205], v227 offset:57344
    ds_read_b64_tr_b16 v[206:207], v227 offset:58368
    s_add_u32 m0, s33, 98304
    s_add_u32 s35, s44, 3240960
    buffer_load_dwordx4 v230, s[8:11], s35 offen offset:3072 lds
    s_waitcnt lgkmcnt(8)
    v_mfma_f32_16x16x32_bf16 v[156:159], v[220:223], v[12:15], v[156:159]
    v_mfma_f32_16x16x32_bf16 v[188:191], v[220:223], v[76:79], v[188:191]
    v_xor_b32 v226, 32, v228
    ds_read_b64_tr_b16 v[208:209], v226 offset:32768
    ds_read_b64_tr_b16 v[210:211], v226 offset:33792
    s_waitcnt vmcnt(19) lgkmcnt(8)
    v_mfma_f32_16x16x32_bf16 v[128:131], v[192:195], v[16:19], v[128:131]
    s_waitcnt vmcnt(15)
    v_mfma_f32_16x16x32_bf16 v[160:163], v[192:195], v[80:83], v[160:163]
    ds_read_b64_tr_b16 v[212:213], v226 offset:40960
    ds_read_b64_tr_b16 v[214:215], v226 offset:41984
    s_add_u32 s48, s36, 1052672
    buffer_load_dwordx4 v[96:99], v224, s[16:19], s48 offen offset:0
    s_waitcnt lgkmcnt(8)
    v_mfma_f32_16x16x32_bf16 v[128:131], v[196:199], v[20:23], v[128:131]
    s_waitcnt vmcnt(15)
    v_mfma_f32_16x16x32_bf16 v[160:163], v[196:199], v[84:87], v[160:163]
    ds_read_b64_tr_b16 v[216:217], v226 offset:49152
    ds_read_b64_tr_b16 v[218:219], v226 offset:50176
    s_add_u32 s48, s36, 1052672
    buffer_load_dwordx4 v[100:103], v224, s[16:19], s48 offen offset:1024
    s_waitcnt lgkmcnt(8)
    v_mfma_f32_16x16x32_bf16 v[128:131], v[200:203], v[24:27], v[128:131]
    s_waitcnt vmcnt(15)
    v_mfma_f32_16x16x32_bf16 v[160:163], v[200:203], v[88:91], v[160:163]
    ds_read_b64_tr_b16 v[220:221], v226 offset:57344
    ds_read_b64_tr_b16 v[222:223], v226 offset:58368
    s_add_u32 s48, s36, 1052672
    buffer_load_dwordx4 v[104:107], v224, s[16:19], s48 offen offset:2048
    s_waitcnt lgkmcnt(8)
    v_mfma_f32_16x16x32_bf16 v[128:131], v[204:207], v[28:31], v[128:131]
    s_waitcnt vmcnt(15)
    v_mfma_f32_16x16x32_bf16 v[160:163], v[204:207], v[92:95], v[160:163]
    v_xor_b32 v227, 64, v228
    ds_read_b64_tr_b16 v[192:193], v227 offset:32768
    ds_read_b64_tr_b16 v[194:195], v227 offset:33792
    s_add_u32 s48, s36, 1052672
    buffer_load_dwordx4 v[108:111], v224, s[16:19], s48 offen offset:3072
    s_waitcnt lgkmcnt(8)
    v_mfma_f32_16x16x32_bf16 v[132:135], v[208:211], v[16:19], v[132:135]
    v_mfma_f32_16x16x32_bf16 v[164:167], v[208:211], v[80:83], v[164:167]
    ds_read_b64_tr_b16 v[196:197], v227 offset:40960
    ds_read_b64_tr_b16 v[198:199], v227 offset:41984
    s_add_u32 s48, s36, 1572864
    buffer_load_dwordx4 v[48:51], v224, s[16:19], s48 offen offset:0
    s_waitcnt lgkmcnt(8)
    v_mfma_f32_16x16x32_bf16 v[132:135], v[212:215], v[20:23], v[132:135]
    v_mfma_f32_16x16x32_bf16 v[164:167], v[212:215], v[84:87], v[164:167]
    ds_read_b64_tr_b16 v[200:201], v227 offset:49152
    ds_read_b64_tr_b16 v[202:203], v227 offset:50176
    s_add_u32 s48, s36, 1572864
    buffer_load_dwordx4 v[52:55], v224, s[16:19], s48 offen offset:1024
    s_waitcnt lgkmcnt(8)
    v_mfma_f32_16x16x32_bf16 v[132:135], v[216:219], v[24:27], v[132:135]
    v_mfma_f32_16x16x32_bf16 v[164:167], v[216:219], v[88:91], v[164:167]
    ds_read_b64_tr_b16 v[204:205], v227 offset:57344
    ds_read_b64_tr_b16 v[206:207], v227 offset:58368
    s_waitcnt lgkmcnt(8)
    v_mfma_f32_16x16x32_bf16 v[132:135], v[220:223], v[28:31], v[132:135]
    v_mfma_f32_16x16x32_bf16 v[164:167], v[220:223], v[92:95], v[164:167]
    v_xor_b32 v226, 96, v228
    ds_read_b64_tr_b16 v[208:209], v226 offset:32768
    ds_read_b64_tr_b16 v[210:211], v226 offset:33792
    s_add_u32 s48, s36, 1572864
    buffer_load_dwordx4 v[56:59], v224, s[16:19], s48 offen offset:2048
    s_waitcnt lgkmcnt(8)
    v_mfma_f32_16x16x32_bf16 v[136:139], v[192:195], v[16:19], v[136:139]
    v_mfma_f32_16x16x32_bf16 v[168:171], v[192:195], v[80:83], v[168:171]
    ds_read_b64_tr_b16 v[212:213], v226 offset:40960
    ds_read_b64_tr_b16 v[214:215], v226 offset:41984
    s_add_u32 s48, s36, 1572864
    buffer_load_dwordx4 v[60:63], v224, s[16:19], s48 offen offset:3072
    s_waitcnt lgkmcnt(8)
    v_mfma_f32_16x16x32_bf16 v[136:139], v[196:199], v[20:23], v[136:139]
    v_mfma_f32_16x16x32_bf16 v[168:171], v[196:199], v[84:87], v[168:171]
    ds_read_b64_tr_b16 v[216:217], v226 offset:49152
    ds_read_b64_tr_b16 v[218:219], v226 offset:50176
    s_add_u32 s48, s36, 1576960
    buffer_load_dwordx4 v[112:115], v224, s[16:19], s48 offen offset:0
    s_waitcnt lgkmcnt(8)
    v_mfma_f32_16x16x32_bf16 v[136:139], v[200:203], v[24:27], v[136:139]
    v_mfma_f32_16x16x32_bf16 v[168:171], v[200:203], v[88:91], v[168:171]
    ds_read_b64_tr_b16 v[220:221], v226 offset:57344
    ds_read_b64_tr_b16 v[222:223], v226 offset:58368
    s_add_u32 s48, s36, 1576960
    buffer_load_dwordx4 v[116:119], v224, s[16:19], s48 offen offset:1024
    s_waitcnt lgkmcnt(8)
    v_mfma_f32_16x16x32_bf16 v[136:139], v[204:207], v[28:31], v[136:139]
    v_mfma_f32_16x16x32_bf16 v[168:171], v[204:207], v[92:95], v[168:171]
    v_xor_b32 v227, 128, v228
    ds_read_b64_tr_b16 v[192:193], v227 offset:32768
    ds_read_b64_tr_b16 v[194:195], v227 offset:33792
    s_add_u32 s48, s36, 1576960
    buffer_load_dwordx4 v[120:123], v224, s[16:19], s48 offen offset:2048
    s_waitcnt lgkmcnt(8)
    v_mfma_f32_16x16x32_bf16 v[140:143], v[208:211], v[16:19], v[140:143]
    v_mfma_f32_16x16x32_bf16 v[172:175], v[208:211], v[80:83], v[172:175]
    ds_read_b64_tr_b16 v[196:197], v227 offset:40960
    ds_read_b64_tr_b16 v[198:199], v227 offset:41984
    s_add_u32 s48, s36, 1576960
    buffer_load_dwordx4 v[124:127], v224, s[16:19], s48 offen offset:3072
    s_waitcnt lgkmcnt(8)
    v_mfma_f32_16x16x32_bf16 v[140:143], v[212:215], v[20:23], v[140:143]
    v_mfma_f32_16x16x32_bf16 v[172:175], v[212:215], v[84:87], v[172:175]
    ds_read_b64_tr_b16 v[200:201], v227 offset:49152
    ds_read_b64_tr_b16 v[202:203], v227 offset:50176
    s_waitcnt vmcnt(20)
    v_mov_b32 v241, s28
    ds_write_b32 v237, v241
    s_waitcnt lgkmcnt(9)
    v_mfma_f32_16x16x32_bf16 v[140:143], v[216:219], v[24:27], v[140:143]
    v_mfma_f32_16x16x32_bf16 v[172:175], v[216:219], v[88:91], v[172:175]
    ds_read_b64_tr_b16 v[204:205], v227 offset:57344
    ds_read_b64_tr_b16 v[206:207], v227 offset:58368
    s_waitcnt lgkmcnt(9)
    v_mfma_f32_16x16x32_bf16 v[140:143], v[220:223], v[28:31], v[140:143]
    v_mfma_f32_16x16x32_bf16 v[172:175], v[220:223], v[92:95], v[172:175]
    v_xor_b32 v226, 160, v228
    ds_read_b64_tr_b16 v[208:209], v226 offset:32768
    ds_read_b64_tr_b16 v[210:211], v226 offset:33792
    s_waitcnt lgkmcnt(9)
    v_mfma_f32_16x16x32_bf16 v[144:147], v[192:195], v[16:19], v[144:147]
    v_mfma_f32_16x16x32_bf16 v[176:179], v[192:195], v[80:83], v[176:179]
    ds_read_b64_tr_b16 v[212:213], v226 offset:40960
    ds_read_b64_tr_b16 v[214:215], v226 offset:41984
    s_waitcnt lgkmcnt(9)
    v_mfma_f32_16x16x32_bf16 v[144:147], v[196:199], v[20:23], v[144:147]
    v_mfma_f32_16x16x32_bf16 v[176:179], v[196:199], v[84:87], v[176:179]
    ds_read_b64_tr_b16 v[216:217], v226 offset:49152
    ds_read_b64_tr_b16 v[218:219], v226 offset:50176
    s_waitcnt lgkmcnt(9)
    v_mfma_f32_16x16x32_bf16 v[144:147], v[200:203], v[24:27], v[144:147]
    v_mfma_f32_16x16x32_bf16 v[176:179], v[200:203], v[88:91], v[176:179]
    ds_read_b64_tr_b16 v[220:221], v226 offset:57344
    ds_read_b64_tr_b16 v[222:223], v226 offset:58368
    s_waitcnt lgkmcnt(8)
    v_mfma_f32_16x16x32_bf16 v[144:147], v[204:207], v[28:31], v[144:147]
    v_mfma_f32_16x16x32_bf16 v[176:179], v[204:207], v[92:95], v[176:179]
    v_xor_b32 v227, 192, v228
    ds_read_b64_tr_b16 v[192:193], v227 offset:32768
    ds_read_b64_tr_b16 v[194:195], v227 offset:33792
    s_waitcnt lgkmcnt(8)
    v_mfma_f32_16x16x32_bf16 v[148:151], v[208:211], v[16:19], v[148:151]
    v_mfma_f32_16x16x32_bf16 v[180:183], v[208:211], v[80:83], v[180:183]
    ds_read_b64_tr_b16 v[196:197], v227 offset:40960
    ds_read_b64_tr_b16 v[198:199], v227 offset:41984
    s_waitcnt lgkmcnt(8)
    v_mfma_f32_16x16x32_bf16 v[148:151], v[212:215], v[20:23], v[148:151]
    v_mfma_f32_16x16x32_bf16 v[180:183], v[212:215], v[84:87], v[180:183]
    ds_read_b64_tr_b16 v[200:201], v227 offset:49152
    ds_read_b64_tr_b16 v[202:203], v227 offset:50176
    ds_read_b32 v240, v239
    s_waitcnt lgkmcnt(9)
    v_mfma_f32_16x16x32_bf16 v[148:151], v[216:219], v[24:27], v[148:151]
    v_mfma_f32_16x16x32_bf16 v[180:183], v[216:219], v[88:91], v[180:183]
    ds_read_b64_tr_b16 v[204:205], v227 offset:57344
    ds_read_b64_tr_b16 v[206:207], v227 offset:58368
    s_waitcnt lgkmcnt(9)
    v_mfma_f32_16x16x32_bf16 v[148:151], v[220:223], v[28:31], v[148:151]
    v_mfma_f32_16x16x32_bf16 v[180:183], v[220:223], v[92:95], v[180:183]
    v_xor_b32 v226, 224, v228
    ds_read_b64_tr_b16 v[208:209], v226 offset:32768
    ds_read_b64_tr_b16 v[210:211], v226 offset:33792
    s_waitcnt lgkmcnt(9)
    v_mfma_f32_16x16x32_bf16 v[152:155], v[192:195], v[16:19], v[152:155]
    v_mfma_f32_16x16x32_bf16 v[184:187], v[192:195], v[80:83], v[184:187]
    ds_read_b64_tr_b16 v[212:213], v226 offset:40960
    ds_read_b64_tr_b16 v[214:215], v226 offset:41984
    s_waitcnt lgkmcnt(9)
    v_mfma_f32_16x16x32_bf16 v[152:155], v[196:199], v[20:23], v[152:155]
    v_mfma_f32_16x16x32_bf16 v[184:187], v[196:199], v[84:87], v[184:187]
    ds_read_b64_tr_b16 v[216:217], v226 offset:49152
    ds_read_b64_tr_b16 v[218:219], v226 offset:50176
    s_waitcnt lgkmcnt(8)
    v_cmp_gt_i32 vcc, s28, v240
    s_cbranch_vccnz k2_kernel_spin_3
k2_kernel_back_4:
    s_add_u32 s28, s28, 1
    v_mfma_f32_16x16x32_bf16 v[152:155], v[200:203], v[24:27], v[152:155]
    v_mfma_f32_16x16x32_bf16 v[184:187], v[200:203], v[88:91], v[184:187]
    ds_read_b64_tr_b16 v[220:221], v226 offset:57344
    ds_read_b64_tr_b16 v[222:223], v226 offset:58368
    s_cmp_lt_u32 s58, s32
    s_cselect_b32 s47, s57, 0x7ff00000
    s_add_u32 m0, s59, s33
    s_waitcnt lgkmcnt(8)
    v_mfma_f32_16x16x32_bf16 v[152:155], v[204:207], v[28:31], v[152:155]
    v_mfma_f32_16x16x32_bf16 v[184:187], v[204:207], v[92:95], v[184:187]
    v_xor_b32 v227, 65536, v228
    ds_read_b64_tr_b16 v[192:193], v227 offset:0
    ds_read_b64_tr_b16 v[194:195], v227 offset:1024
    buffer_load_dwordx4 v224, s[16:19], s47 offen offset:0 lds
    s_add_u32 s57, s57, 16384
    s_waitcnt lgkmcnt(8)
    v_mfma_f32_16x16x32_bf16 v[156:159], v[208:211], v[16:19], v[156:159]
    v_mfma_f32_16x16x32_bf16 v[188:191], v[208:211], v[80:83], v[188:191]
    ds_read_b64_tr_b16 v[196:197], v227 offset:8192
    ds_read_b64_tr_b16 v[198:199], v227 offset:9216
    buffer_load_dwordx4 v224, s[16:19], s47 offen offset:1024 lds
    s_add_u32 s58, s58, 1
    s_waitcnt lgkmcnt(8)
    v_mfma_f32_16x16x32_bf16 v[156:159], v[212:215], v[20:23], v[156:159]
    v_mfma_f32_16x16x32_bf16 v[188:191], v[212:215], v[84:87], v[188:191]
    ds_read_b64_tr_b16 v[200:201], v227 offset:16384
    ds_read_b64_tr_b16 v[202:203], v227 offset:17408
    buffer_load_dwordx4 v224, s[16:19], s47 offen offset:2048 lds
    s_add_u32 s59, s59, 32768
    s_waitcnt lgkmcnt(8)
    v_mfma_f32_16x16x32_bf16 v[156:159], v[216:219], v[24:27], v[156:159]
    v_mfma_f32_16x16x32_bf16 v[188:191], v[216:219], v[88:91], v[188:191]
    ds_read_b64_tr_b16 v[204:205], v227 offset:24576
    ds_read_b64_tr_b16 v[206:207], v227 offset:25600
    buffer_load_dwordx4 v224, s[16:19], s47 offen offset:3072 lds
    s_and_b32 s59, s59, 98304
    s_waitcnt lgkmcnt(8)
    v_mfma_f32_16x16x32_bf16 v[156:159], v[220:223], v[28:31], v[156:159]
    v_mfma_f32_16x16x32_bf16 v[188:191], v[220:223], v[92:95], v[188:191]
    v_xor_b32 v226, 65568, v228
    ds_read_b64_tr_b16 v[208:209], v226 offset:0
    ds_read_b64_tr_b16 v[210:211], v226 offset:1024
    s_waitcnt vmcnt(23) lgkmcnt(8)
    v_mfma_f32_16x16x32_bf16 v[128:131], v[192:195], v[32:35], v[128:131]
    s_waitcnt vmcnt(15)
    v_mfma_f32_16x16x32_bf16 v[160:163], v[192:195], v[96:99], v[160:163]
    ds_read_b64_tr_b16 v[212:213], v226 offset:8192
    ds_read_b64_tr_b16 v[214:215], v226 offset:9216
    s_waitcnt lgkmcnt(8)
    v_mfma_f32_16x16x32_bf16 v[128:131], v[196:199], v[36:39], v[128:131]
    s_waitcnt vmcnt(14)
    v_mfma_f32_16x16x32_bf16 v[160:163], v[196:199], v[100:103], v[160:163]
    ds_read_b64_tr_b16 v[216:217], v226 offset:16384
    ds_read_b64_tr_b16 v[218:219], v226 offset:17408
    s_waitcnt lgkmcnt(8)
    v_mfma_f32_16x16x32_bf16 v[128:131], v[200:203], v[40:43], v[128:131]
    s_waitcnt vmcnt(13)
    v_mfma_f32_16x16x32_bf16 v[160:163], v[200:203], v[104:107], v[160:163]
    ds_read_b64_tr_b16 v[220:221], v226 offset:24576
    ds_read_b64_tr_b16 v[222:223], v226 offset:25600
    s_waitcnt lgkmcnt(8)
    v_mfma_f32_16x16x32_bf16 v[128:131], v[204:207], v[44:47], v[128:131]
    s_waitcnt vmcnt(12)
    v_mfma_f32_16x16x32_bf16 v[160:163], v[204:207], v[108:111], v[160:163]
    v_xor_b32 v227, 65600, v228
    ds_read_b64_tr_b16 v[192:193], v227 offset:0
    ds_read_b64_tr_b16 v[194:195], v227 offset:1024
    s_waitcnt lgkmcnt(8)
    v_mfma_f32_16x16x32_bf16 v[132:135], v[208:211], v[32:35], v[132:135]
    v_mfma_f32_16x16x32_bf16 v[164:167], v[208:211], v[96:99], v[164:167]
    ds_read_b64_tr_b16 v[196:197], v227 offset:8192
    ds_read_b64_tr_b16 v[198:199], v227 offset:9216
    s_waitcnt lgkmcnt(8)
    v_mfma_f32_16x16x32_bf16 v[132:135], v[212:215], v[36:39], v[132:135]
    v_mfma_f32_16x16x32_bf16 v[164:167], v[212:215], v[100:103], v[164:167]
    ds_read_b64_tr_b16 v[200:201], v227 offset:16384
    ds_read_b64_tr_b16 v[202:203], v227 offset:17408
    s_waitcnt lgkmcnt(8)
    v_mfma_f32_16x16x32_bf16 v[132:135], v[216:219], v[40:43], v[132:135]
    v_mfma_f32_16x16x32_bf16 v[164:167], v[216:219], v[104:107], v[164:167]
    ds_read_b64_tr_b16 v[204:205], v227 offset:24576
    ds_read_b64_tr_b16 v[206:207], v227 offset:25600
    s_waitcnt lgkmcnt(8)
    v_mfma_f32_16x16x32_bf16 v[132:135], v[220:223], v[44:47], v[132:135]
    v_mfma_f32_16x16x32_bf16 v[164:167], v[220:223], v[108:111], v[164:167]
    v_xor_b32 v226, 65632, v228
    ds_read_b64_tr_b16 v[208:209], v226 offset:0
    ds_read_b64_tr_b16 v[210:211], v226 offset:1024
    s_waitcnt lgkmcnt(8)
    v_mfma_f32_16x16x32_bf16 v[136:139], v[192:195], v[32:35], v[136:139]
    v_mfma_f32_16x16x32_bf16 v[168:171], v[192:195], v[96:99], v[168:171]
    ds_read_b64_tr_b16 v[212:213], v226 offset:8192
    ds_read_b64_tr_b16 v[214:215], v226 offset:9216
    s_waitcnt lgkmcnt(8)
    v_mfma_f32_16x16x32_bf16 v[136:139], v[196:199], v[36:39], v[136:139]
    v_mfma_f32_16x16x32_bf16 v[168:171], v[196:199], v[100:103], v[168:171]
    ds_read_b64_tr_b16 v[216:217], v226 offset:16384
    ds_read_b64_tr_b16 v[218:219], v226 offset:17408
    s_waitcnt lgkmcnt(8)
    v_mfma_f32_16x16x32_bf16 v[136:139], v[200:203], v[40:43], v[136:139]
    v_mfma_f32_16x16x32_bf16 v[168:171], v[200:203], v[104:107], v[168:171]
    ds_read_b64_tr_b16 v[220:221], v226 offset:24576
    ds_read_b64_tr_b16 v[222:223], v226 offset:25600
    s_waitcnt lgkmcnt(8)
    v_mfma_f32_16x16x32_bf16 v[136:139], v[204:207], v[44:47], v[136:139]
    v_mfma_f32_16x16x32_bf16 v[168:171], v[204:207], v[108:111], v[168:171]
    v_xor_b32 v227, 65664, v228
    ds_read_b64_tr_b16 v[192:193], v227 offset:0
    ds_read_b64_tr_b16 v[194:195], v227 offset:1024
    s_waitcnt lgkmcnt(8)
    v_mfma_f32_16x16x32_bf16 v[140:143], v[208:211], v[32:35], v[140:143]
    v_mfma_f32_16x16x32_bf16 v[172:175], v[208:211], v[96:99], v[172:175]
    ds_read_b64_tr_b16 v[196:197], v227 offset:8192
    ds_read_b64_tr_b16 v[198:199], v227 offset:9216
    s_waitcnt lgkmcnt(8)
    v_mfma_f32_16x16x32_bf16 v[140:143], v[212:215], v[36:39], v[140:143]
    v_mfma_f32_16x16x32_bf16 v[172:175], v[212:215], v[100:103], v[172:175]
    ds_read_b64_tr_b16 v[200:201], v227 offset:16384
    ds_read_b64_tr_b16 v[202:203], v227 offset:17408
    v_mov_b32 v241, s28
    ds_write_b32 v237, v241
    s_waitcnt lgkmcnt(9)
    v_mfma_f32_16x16x32_bf16 v[140:143], v[216:219], v[40:43], v[140:143]
    v_mfma_f32_16x16x32_bf16 v[172:175], v[216:219], v[104:107], v[172:175]
    ds_read_b64_tr_b16 v[204:205], v227 offset:24576
    ds_read_b64_tr_b16 v[206:207], v227 offset:25600
    s_waitcnt lgkmcnt(9)
    v_mfma_f32_16x16x32_bf16 v[140:143], v[220:223], v[44:47], v[140:143]
    v_mfma_f32_16x16x32_bf16 v[172:175], v[220:223], v[108:111], v[172:175]
    v_xor_b32 v226, 65696, v228
    ds_read_b64_tr_b16 v[208:209], v226 offset:0
    ds_read_b64_tr_b16 v[210:211], v226 offset:1024
    s_waitcnt lgkmcnt(9)
    v_mfma_f32_16x16x32_bf16 v[144:147], v[192:195], v[32:35], v[144:147]
    v_mfma_f32_16x16x32_bf16 v[176:179], v[192:195], v[96:99], v[176:179]
    ds_read_b64_tr_b16 v[212:213], v226 offset:8192
    ds_read_b64_tr_b16 v[214:215], v226 offset:9216
    s_waitcnt lgkmcnt(9)
    v_mfma_f32_16x16x32_bf16 v[144:147], v[196:199], v[36:39], v[144:147]
    v_mfma_f32_16x16x32_bf16 v[176:179], v[196:199], v[100:103], v[176:179]
    ds_read_b64_tr_b16 v[216:217], v226 offset:16384
    ds_read_b64_tr_b16 v[218:219], v226 offset:17408
    s_waitcnt lgkmcnt(9)
    v_mfma_f32_16x16x32_bf16 v[144:147], v[200:203], v[40:43], v[144:147]
    v_mfma_f32_16x16x32_bf16 v[176:179], v[200:203], v[104:107], v[176:179]
    ds_read_b64_tr_b16 v[220:221], v226 offset:24576
    ds_read_b64_tr_b16 v[222:223], v226 offset:25600
    s_waitcnt lgkmcnt(8)
    v_mfma_f32_16x16x32_bf16 v[144:147], v[204:207], v[44:47], v[144:147]
    v_mfma_f32_16x16x32_bf16 v[176:179], v[204:207], v[108:111], v[176:179]
    v_xor_b32 v227, 65728, v228
    ds_read_b64_tr_b16 v[192:193], v227 offset:0
    ds_read_b64_tr_b16 v[194:195], v227 offset:1024
    s_waitcnt lgkmcnt(8)
    v_mfma_f32_16x16x32_bf16 v[148:151], v[208:211], v[32:35], v[148:151]
    v_mfma_f32_16x16x32_bf16 v[180:183], v[208:211], v[96:99], v[180:183]
    ds_read_b64_tr_b16 v[196:197], v227 offset:8192
    ds_read_b64_tr_b16 v[198:199], v227 offset:9216
    s_waitcnt lgkmcnt(8)
    v_mfma_f32_16x16x32_bf16 v[148:151], v[212:215], v[36:39], v[148:151]
    v_mfma_f32_16x16x32_bf16 v[180:183], v[212:215], v[100:103], v[180:183]
    ds_read_b64_tr_b16 v[200:201], v227 offset:16384
    ds_read_b64_tr_b16 v[202:203], v227 offset:17408
    ds_read_b32 v240, v239
    s_waitcnt lgkmcnt(9)
    v_mfma_f32_16x16x32_bf16 v[148:151], v[216:219], v[40:43], v[148:151]
    v_mfma_f32_16x16x32_bf16 v[180:183], v[216:219], v[104:107], v[180:183]
    ds_read_b64_tr_b16 v[204:205], v227 offset:24576
    ds_read_b64_tr_b16 v[206:207], v227 offset:25600
    s_waitcnt lgkmcnt(9)
    v_mfma_f32_16x16x32_bf16 v[148:151], v[220:223], v[44:47], v[148:151]
    v_mfma_f32_16x16x32_bf16 v[180:183], v[220:223], v[108:111], v[180:183]
    v_xor_b32 v226, 65760, v228
    ds_read_b64_tr_b16 v[208:209], v226 offset:0
    ds_read_b64_tr_b16 v[210:211], v226 offset:1024
    s_waitcnt lgkmcnt(9)
    v_mfma_f32_16x16x32_bf16 v[152:155], v[192:195], v[32:35], v[152:155]
    v_mfma_f32_16x16x32_bf16 v[184:187], v[192:195], v[96:99], v[184:187]
    ds_read_b64_tr_b16 v[212:213], v226 offset:8192
    ds_read_b64_tr_b16 v[214:215], v226 offset:9216
    s_waitcnt lgkmcnt(9)
    v_mfma_f32_16x16x32_bf16 v[152:155], v[196:199], v[36:39], v[152:155]
    v_mfma_f32_16x16x32_bf16 v[184:187], v[196:199], v[100:103], v[184:187]
    ds_read_b64_tr_b16 v[216:217], v226 offset:16384
    ds_read_b64_tr_b16 v[218:219], v226 offset:17408
    s_waitcnt lgkmcnt(8)
    v_cmp_gt_i32 vcc, s28, v240
    s_cbranch_vccnz k2_kernel_spin_5
k2_kernel_back_6:
    s_add_u32 s28, s28, 1
    v_mfma_f32_16x16x32_bf16 v[152:155], v[200:203], v[40:43], v[152:155]
    v_mfma_f32_16x16x32_bf16 v[184:187], v[200:203], v[104:107], v[184:187]
    ds_read_b64_tr_b16 v[220:221], v226 offset:24576
    ds_read_b64_tr_b16 v[222:223], v226 offset:25600
    s_cmp_lt_u32 s58, s32
    s_cselect_b32 s47, s57, 0x7ff00000
    s_add_u32 m0, s59, s33
    s_waitcnt lgkmcnt(8)
    v_mfma_f32_16x16x32_bf16 v[152:155], v[204:207], v[44:47], v[152:155]
    v_mfma_f32_16x16x32_bf16 v[184:187], v[204:207], v[108:111], v[184:187]
    v_xor_b32 v227, 65536, v228
    ds_read_b64_tr_b16 v[192:193], v227 offset:32768
    ds_read_b64_tr_b16 v[194:195], v227 offset:33792
    buffer_load_dwordx4 v224, s[16:19], s47 offen offset:0 lds
    s_add_u32 s57, s57, 16384
    s_waitcnt lgkmcnt(8)
    v_mfma_f32_16x16x32_bf16 v[156:159], v[208:211], v[32:35], v[156:159]
    v_mfma_f32_16x16x32_bf16 v[188:191], v[208:211], v[96:99], v[188:191]
    ds_read_b64_tr_b16 v[196:197], v227 offset:40960
    ds_read_b64_tr_b16 v[198:199], v227 offset:41984
    buffer_load_dwordx4 v224, s[16:19], s47 offen offset:1024 lds
    s_add_u32 s58, s58, 1
    s_waitcnt lgkmcnt(8)
    v_mfma_f32_16x16x32_bf16 v[156:159], v[212:215], v[36:39], v[156:159]
    v_mfma_f32_16x16x32_bf16 v[188:191], v[212:215], v[100:103], v[188:191]
    ds_read_b64_tr_b16 v[200:201], v227 offset:49152
    ds_read_b64_tr_b16 v[202:203], v227 offset:50176
    buffer_load_dwordx4 v224, s[16:19], s47 offen offset:2048 lds
    s_add_u32 s59, s59, 32768
    s_waitcnt lgkmcnt(8)
    v_mfma_f32_16x16x32_bf16 v[156:159], v[216:219], v[40:43], v[156:159]
    v_mfma_f32_16x16x32_bf16 v[188:191], v[216:219], v[104:107], v[188:191]
    ds_read_b64_tr_b16 v[204:205], v227 offset:57344
    ds_read_b64_tr_b16 v[206:207], v227 offset:58368
    buffer_load_dwordx4 v224, s[16:19], s47 offen offset:3072 lds
    s_and_b32 s59, s59, 98304
    s_waitcnt lgkmcnt(8)
    v_mfma_f32_16x16x32_bf16 v[156:159], v[220:223], v[44:47], v[156:159]
    v_mfma_f32_16x16x32_bf16 v[188:191], v[220:223], v[108:111], v[188:191]
    v_xor_b32 v226, 65568, v228
    ds_read_b64_tr_b16 v[208:209], v226 offset:32768
    ds_read_b64_tr_b16 v[210:211], v226 offset:33792
    s_waitcnt vmcnt(15) lgkmcnt(8)
    v_mfma_f32_16x16x32_bf16 v[128:131], v[192:195], v[48:51], v[128:131]
    s_waitcnt vmcnt(11)
    v_mfma_f32_16x16x32_bf16 v[160:163], v[192:195], v[112:115], v[160:163]
    ds_read_b64_tr_b16 v[212:213], v226 offset:40960
    ds_read_b64_tr_b16 v[214:215], v226 offset:41984
    s_waitcnt lgkmcnt(8)
    v_mfma_f32_16x16x32_bf16 v[128:131], v[196:199], v[52:55], v[128:131]
    s_waitcnt vmcnt(10)
    v_mfma_f32_16x16x32_bf16 v[160:163], v[196:199], v[116:119], v[160:163]
    ds_read_b64_tr_b16 v[216:217], v226 offset:49152
    ds_read_b64_tr_b16 v[218:219], v226 offset:50176
    s_waitcnt lgkmcnt(8)
    v_mfma_f32_16x16x32_bf16 v[128:131], v[200:203], v[56:59], v[128:131]
    s_waitcnt vmcnt(9)
    v_mfma_f32_16x16x32_bf16 v[160:163], v[200:203], v[120:123], v[160:163]
    ds_read_b64_tr_b16 v[220:221], v226 offset:57344
    ds_read_b64_tr_b16 v[222:223], v226 offset:58368
    s_waitcnt lgkmcnt(8)
    v_mfma_f32_16x16x32_bf16 v[128:131], v[204:207], v[60:63], v[128:131]
    s_waitcnt vmcnt(8)
    v_mfma_f32_16x16x32_bf16 v[160:163], v[204:207], v[124:127], v[160:163]
    v_xor_b32 v227, 65600, v228
    ds_read_b64_tr_b16 v[192:193], v227 offset:32768
    ds_read_b64_tr_b16 v[194:195], v227 offset:33792
    s_waitcnt lgkmcnt(8)
    v_mfma_f32_16x16x32_bf16 v[132:135], v[208:211], v[48:51], v[132:135]
    v_mfma_f32_16x16x32_bf16 v[164:167], v[208:211], v[112:115], v[164:167]
    ds_read_b64_tr_b16 v[196:197], v227 offset:40960
    ds_read_b64_tr_b16 v[198:199], v227 offset:41984
    s_waitcnt lgkmcnt(8)
    v_mfma_f32_16x16x32_bf16 v[132:135], v[212:215], v[52:55], v[132:135]
    v_mfma_f32_16x16x32_bf16 v[164:167], v[212:215], v[116:119], v[164:167]
    ds_read_b64_tr_b16 v[200:201], v227 offset:49152
    ds_read_b64_tr_b16 v[202:203], v227 offset:50176
    s_waitcnt lgkmcnt(8)
    v_mfma_f32_16x16x32_bf16 v[132:135], v[216:219], v[56:59], v[132:135]
    v_mfma_f32_16x16x32_bf16 v[164:167], v[216:219], v[120:123], v[164:167]
    ds_read_b64_tr_b16 v[204:205], v227 offset:57344
    ds_read_b64_tr_b16 v[206:207], v227 offset:58368
    s_waitcnt lgkmcnt(8)
    v_mfma_f32_16x16x32_bf16 v[132:135], v[220:223], v[60:63], v[132:135]
    v_mfma_f32_16x16x32_bf16 v[164:167], v[220:223], v[124:127], v[164:167]
    v_xor_b32 v226, 65632, v228
    ds_read_b64_tr_b16 v[208:209], v226 offset:32768
    ds_read_b64_tr_b16 v[210:211], v226 offset:33792
    s_waitcnt lgkmcnt(8)
    v_mfma_f32_16x16x32_bf16 v[136:139], v[192:195], v[48:51], v[136:139]
    v_mfma_f32_16x16x32_bf16 v[168:171], v[192:195], v[112:115], v[168:171]
    ds_read_b64_tr_b16 v[212:213], v226 offset:40960
    ds_read_b64_tr_b16 v[214:215], v226 offset:41984
    s_waitcnt lgkmcnt(8)
    v_mfma_f32_16x16x32_bf16 v[136:139], v[196:199], v[52:55], v[136:139]
    v_mfma_f32_16x16x32_bf16 v[168:171], v[196:199], v[116:119], v[168:171]
    ds_read_b64_tr_b16 v[216:217], v226 offset:49152
    ds_read_b64_tr_b16 v[218:219], v226 offset:50176
    s_waitcnt lgkmcnt(8)
    v_mfma_f32_16x16x32_bf16 v[136:139], v[200:203], v[56:59], v[136:139]
    v_mfma_f32_16x16x32_bf16 v[168:171], v[200:203], v[120:123], v[168:171]
    ds_read_b64_tr_b16 v[220:221], v226 offset:57344
    ds_read_b64_tr_b16 v[222:223], v226 offset:58368
    v_mul_f32 v128, s39, v128
    v_mul_f32 v129, s39, v129
    v_mul_f32 v130, s39, v130
    s_waitcnt lgkmcnt(8)
    v_mfma_f32_16x16x32_bf16 v[136:139], v[204:207], v[60:63], v[136:139]
    v_mfma_f32_16x16x32_bf16 v[168:171], v[204:207], v[124:127], v[168:171]
    v_xor_b32 v227, 65664, v228
    ds_read_b64_tr_b16 v[192:193], v227 offset:32768
    ds_read_b64_tr_b16 v[194:195], v227 offset:33792
    v_mul_f32 v131, s39, v131
    v_mul_f32 v132, s39, v132
    v_mul_f32 v133, s39, v133
    s_waitcnt lgkmcnt(8)
    v_mfma_f32_16x16x32_bf16 v[140:143], v[208:211], v[48:51], v[140:143]
    v_mfma_f32_16x16x32_bf16 v[172:175], v[208:211], v[112:115], v[172:175]
    ds_read_b64_tr_b16 v[196:197], v227 offset:40960
    ds_read_b64_tr_b16 v[198:199], v227 offset:41984
    v_mul_f32 v134, s39, v134
    v_mul_f32 v135, s39, v135
    v_cvt_pk_bf16_f32 v0, v128, v129
    s_waitcnt lgkmcnt(8)
    v_mfma_f32_16x16x32_bf16 v[140:143], v[212:215], v[52:55], v[140:143]
    v_mfma_f32_16x16x32_bf16 v[172:175], v[212:215], v[116:119], v[172:175]
    ds_read_b64_tr_b16 v[200:201], v227 offset:49152
    ds_read_b64_tr_b16 v[202:203], v227 offset:50176
    v_cvt_pk_bf16_f32 v1, v130, v131
    v_cvt_pk_bf16_f32 v2, v132, v133
    v_cvt_pk_bf16_f32 v3, v134, v135
    s_waitcnt vmcnt(4)
    v_mov_b32 v241, s28
    ds_write_b32 v237, v241
    s_waitcnt lgkmcnt(9)
    v_mfma_f32_16x16x32_bf16 v[140:143], v[216:219], v[56:59], v[140:143]
    v_mfma_f32_16x16x32_bf16 v[172:175], v[216:219], v[120:123], v[172:175]
    ds_read_b64_tr_b16 v[204:205], v227 offset:57344
    ds_read_b64_tr_b16 v[206:207], v227 offset:58368
    v_mul_f32 v160, s39, v160
    v_mul_f32 v161, s39, v161
    v_mul_f32 v162, s39, v162
    s_waitcnt lgkmcnt(9)
    v_mfma_f32_16x16x32_bf16 v[140:143], v[220:223], v[60:63], v[140:143]
    v_mfma_f32_16x16x32_bf16 v[172:175], v[220:223], v[124:127], v[172:175]
    v_xor_b32 v226, 65696, v228
    ds_read_b64_tr_b16 v[208:209], v226 offset:32768
    ds_read_b64_tr_b16 v[210:211], v226 offset:33792
    v_mul_f32 v163, s39, v163
    v_mul_f32 v164, s39, v164
    v_mul_f32 v165, s39, v165
    s_waitcnt lgkmcnt(9)
    v_mfma_f32_16x16x32_bf16 v[144:147], v[192:195], v[48:51], v[144:147]
    v_mfma_f32_16x16x32_bf16 v[176:179], v[192:195], v[112:115], v[176:179]
    ds_read_b64_tr_b16 v[212:213], v226 offset:40960
    ds_read_b64_tr_b16 v[214:215], v226 offset:41984
    v_mul_f32 v166, s39, v166
    v_mul_f32 v167, s39, v167
    v_cvt_pk_bf16_f32 v16, v160, v161
    s_waitcnt lgkmcnt(9)
    v_mfma_f32_16x16x32_bf16 v[144:147], v[196:199], v[52:55], v[144:147]
    v_mfma_f32_16x16x32_bf16 v[176:179], v[196:199], v[116:119], v[176:179]
    ds_read_b64_tr_b16 v[216:217], v226 offset:49152
    ds_read_b64_tr_b16 v[218:219], v226 offset:50176
    v_cvt_pk_bf16_f32 v17, v162, v163
    v_cvt_pk_bf16_f32 v18, v164, v165
    v_cvt_pk_bf16_f32 v19, v166, v167
    s_waitcnt lgkmcnt(9)
    v_mfma_f32_16x16x32_bf16 v[144:147], v[200:203], v[56:59], v[144:147]
    v_mfma_f32_16x16x32_bf16 v[176:179], v[200:203], v[120:123], v[176:179]
    ds_read_b64_tr_b16 v[220:221], v226 offset:57344
    ds_read_b64_tr_b16 v[222:223], v226 offset:58368
    v_mul_f32 v136, s39, v136
    v_mul_f32 v137, s39, v137
    v_mul_f32 v138, s39, v138
    s_waitcnt lgkmcnt(8)
    v_mfma_f32_16x16x32_bf16 v[144:147], v[204:207], v[60:63], v[144:147]
    v_mfma_f32_16x16x32_bf16 v[176:179], v[204:207], v[124:127], v[176:179]
    v_xor_b32 v227, 65728, v228
    ds_read_b64_tr_b16 v[192:193], v227 offset:32768
    ds_read_b64_tr_b16 v[194:195], v227 offset:33792
    v_mul_f32 v139, s39, v139
    v_mul_f32 v140, s39, v140
    v_mul_f32 v141, s39, v141
    s_waitcnt lgkmcnt(8)
    v_mfma_f32_16x16x32_bf16 v[148:151], v[208:211], v[48:51], v[148:151]
    v_mfma_f32_16x16x32_bf16 v[180:183], v[208:211], v[112:115], v[180:183]
    ds_read_b64_tr_b16 v[196:197], v227 offset:40960
    ds_read_b64_tr_b16 v[198:199], v227 offset:41984
    v_mul_f32 v142, s39, v142
    v_mul_f32 v143, s39, v143
    v_cvt_pk_bf16_f32 v4, v136, v137
    s_waitcnt lgkmcnt(8)
    v_mfma_f32_16x16x32_bf16 v[148:151], v[212:215], v[52:55], v[148:151]
    v_mfma_f32_16x16x32_bf16 v[180:183], v[212:215], v[116:119], v[180:183]
    ds_read_b64_tr_b16 v[200:201], v227 offset:49152
    ds_read_b64_tr_b16 v[202:203], v227 offset:50176
    v_cvt_pk_bf16_f32 v5, v138, v139
    v_cvt_pk_bf16_f32 v6, v140, v141
    v_cvt_pk_bf16_f32 v7, v142, v143
    ds_read_b32 v240, v239
    s_waitcnt lgkmcnt(9)
    v_mfma_f32_16x16x32_bf16 v[148:151], v[216:219], v[56:59], v[148:151]
    v_mfma_f32_16x16x32_bf16 v[180:183], v[216:219], v[120:123], v[180:183]
    ds_read_b64_tr_b16 v[204:205], v227 offset:57344
    ds_read_b64_tr_b16 v[206:207], v227 offset:58368
    v_mul_f32 v168, s39, v168
    v_mul_f32 v169, s39, v169
    v_mul_f32 v170, s39, v170
    s_waitcnt lgkmcnt(9)
    v_mfma_f32_16x16x32_bf16 v[148:151], v[220:223], v[60:63], v[148:151]
    v_mfma_f32_16x16x32_bf16 v[180:183], v[220:223], v[124:127], v[180:183]
    v_xor_b32 v226, 65760, v228
    ds_read_b64_tr_b16 v[208:209], v226 offset:32768
    ds_read_b64_tr_b16 v[210:211], v226 offset:33792
    v_mul_f32 v171, s39, v171
    v_mul_f32 v172, s39, v172
    v_mul_f32 v173, s39, v173
    s_waitcnt lgkmcnt(9)
    v_mfma_f32_16x16x32_bf16 v[152:155], v[192:195], v[48:51], v[152:155]
    v_mfma_f32_16x16x32_bf16 v[184:187], v[192:195], v[112:115], v[184:187]
    ds_read_b64_tr_b16 v[212:213], v226 offset:40960
    ds_read_b64_tr_b16 v[214:215], v226 offset:41984
    v_mul_f32 v174, s39, v174
    v_mul_f32 v175, s39, v175
    v_cvt_pk_bf16_f32 v20, v168, v169
    s_waitcnt lgkmcnt(9)
    v_mfma_f32_16x16x32_bf16 v[152:155], v[196:199], v[52:55], v[152:155]
    v_mfma_f32_16x16x32_bf16 v[184:187], v[196:199], v[116:119], v[184:187]
    ds_read_b64_tr_b16 v[216:217], v226 offset:49152
    ds_read_b64_tr_b16 v[218:219], v226 offset:50176
    v_cvt_pk_bf16_f32 v21, v170, v171
    v_cvt_pk_bf16_f32 v22, v172, v173
    v_cvt_pk_bf16_f32 v23, v174, v175
    s_waitcnt lgkmcnt(8)
    v_cmp_gt_i32 vcc, s28, v240
    s_cbranch_vccnz k2_kernel_spin_7
k2_kernel_back_8:
    s_add_u32 s28, s28, 1
    v_mfma_f32_16x16x32_bf16 v[152:155], v[200:203], v[56:59], v[152:155]
    v_mfma_f32_16x16x32_bf16 v[184:187], v[200:203], v[120:123], v[184:187]
    ds_read_b64_tr_b16 v[220:221], v226 offset:57344
    ds_read_b64_tr_b16 v[222:223], v226 offset:58368
    s_cmp_lt_u32 s58, s32
    s_cselect_b32 s47, s57, 0x7ff00000
    s_add_u32 m0, s59, s33
    s_nop 0
    buffer_load_dwordx4 v224, s[16:19], s47 offen offset:0 lds
    s_add_u32 s57, s57, 16384
    buffer_load_dwordx4 v224, s[16:19], s47 offen offset:1024 lds
    s_add_u32 s58, s58, 1
    buffer_load_dwordx4 v224, s[16:19], s47 offen offset:2048 lds
    s_add_u32 s59, s59, 32768
    buffer_load_dwordx4 v224, s[16:19], s47 offen offset:3072 lds
    s_and_b32 s59, s59, 98304
    s_waitcnt lgkmcnt(8)
    v_mfma_f32_16x16x32_bf16 v[152:155], v[204:207], v[60:63], v[152:155]
    v_mfma_f32_16x16x32_bf16 v[184:187], v[204:207], v[124:127], v[184:187]
    v_mul_f32 v144, s39, v144
    v_mul_f32 v145, s39, v145
    v_mul_f32 v146, s39, v146
    v_mul_f32 v147, s39, v147
    v_mul_f32 v148, s39, v148
    s_waitcnt lgkmcnt(6)
    v_mfma_f32_16x16x32_bf16 v[156:159], v[208:211], v[48:51], v[156:159]
    v_mfma_f32_16x16x32_bf16 v[188:191], v[208:211], v[112:115], v[188:191]
    v_mul_f32 v149, s39, v149
    v_mul_f32 v150, s39, v150
    v_mul_f32 v151, s39, v151
    v_cvt_pk_bf16_f32 v8, v144, v145
    v_cvt_pk_bf16_f32 v9, v146, v147
    s_waitcnt lgkmcnt(4)
    v_mfma_f32_16x16x32_bf16 v[156:159], v[212:215], v[52:55], v[156:159]
    v_mfma_f32_16x16x32_bf16 v[188:191], v[212:215], v[116:119], v[188:191]
    v_cvt_pk_bf16_f32 v10, v148, v149
    v_cvt_pk_bf16_f32 v11, v150, v151
    v_mul_f32 v176, s39, v176
    v_mul_f32 v177, s39, v177
    v_mul_f32 v178, s39, v178
    s_waitcnt lgkmcnt(2)
    v_mfma_f32_16x16x32_bf16 v[156:159], v[216:219], v[56:59], v[156:159]
    v_mfma_f32_16x16x32_bf16 v[188:191], v[216:219], v[120:123], v[188:191]
    v_mul_f32 v179, s39, v179
    v_mul_f32 v180, s39, v180
    v_mul_f32 v181, s39, v181
    v_mul_f32 v182, s39, v182
    v_mul_f32 v183, s39, v183
    s_waitcnt lgkmcnt(0)
    v_mfma_f32_16x16x32_bf16 v[156:159], v[220:223], v[60:63], v[156:159]
    v_mfma_f32_16x16x32_bf16 v[188:191], v[220:223], v[124:127], v[188:191]
    v_cvt_pk_bf16_f32 v24, v176, v177
    v_cvt_pk_bf16_f32 v25, v178, v179
    v_cvt_pk_bf16_f32 v26, v180, v181
    v_cvt_pk_bf16_f32 v27, v182, v183
    v_mov_b32 v225, v224
    v_mov_b32 v236, v224
    s_mov_b32 s34, 0
    ds_read_b128 v[192:195], v225 offset:0
    ds_read_b128 v[196:199], v225 offset:1024
    ds_read_b128 v[200:203], v225 offset:2048
    ds_read_b128 v[204:207], v225 offset:3072
    ds_read_b128 v[208:211], v225 offset:4096
    ds_read_b128 v[212:215], v225 offset:5120
    ds_read_b128 v[216:219], v225 offset:6144
    ds_read_b128 v[220:223], v225 offset:7168
    v_mov_b32 v80, 0
    v_mov_b32 v81, 0
    v_mov_b32 v82, 0
    v_mov_b32 v83, 0
    v_mov_b32 v84, 0
    v_mov_b32 v85, 0
    v_mov_b32 v86, 0
    v_mov_b32 v87, 0
    v_mov_b32 v88, 0
    v_mov_b32 v89, 0
    v_mov_b32 v90, 0
    v_mov_b32 v91, 0
    v_mov_b32 v92, 0
    v_mov_b32 v93, 0
    v_mov_b32 v94, 0
    v_mov_b32 v95, 0
    v_mul_f32 v152, s39, v152
    v_mul_f32 v153, s39, v153
    v_mul_f32 v154, s39, v154
    v_mul_f32 v155, s39, v155
    v_mul_f32 v156, s39, v156
    v_mul_f32 v157, s39, v157
    v_mul_f32 v158, s39, v158
    v_mul_f32 v159, s39, v159
    v_cvt_pk_bf16_f32 v12, v152, v153
    v_cvt_pk_bf16_f32 v13, v154, v155
    v_cvt_pk_bf16_f32 v14, v156, v157
    v_cvt_pk_bf16_f32 v15, v158, v159
    v_mul_f32 v184, s39, v184
    v_mul_f32 v185, s39, v185
    v_mul_f32 v186, s39, v186
    v_mul_f32 v187, s39, v187
    v_mul_f32 v188, s39, v188
    v_mul_f32 v189, s39, v189
    v_mul_f32 v190, s39, v190
    v_mul_f32 v191, s39, v191
    v_cvt_pk_bf16_f32 v28, v184, v185
    v_cvt_pk_bf16_f32 v29, v186, v187
    v_cvt_pk_bf16_f32 v30, v188, v189
    v_cvt_pk_bf16_f32 v31, v190, v191
    s_cmp_lg_u32 s26, 1
    s_cbranch_scc1 k2_kernel_nomask_9
    v_cmp_gt_i32 s[48:49], 0, v231
    s_nop 1
    v_cndmask_b32 v80, v80, v232, s[48:49]
    v_cmp_gt_i32 s[50:51], 1, v231
    s_nop 1
    v_cndmask_b32 v81, v81, v232, s[50:51]
    v_cmp_gt_i32 s[52:53], 2, v231
    s_nop 1
    v_cndmask_b32 v82, v82, v232, s[52:53]
    v_cmp_gt_i32 s[54:55], 3, v231
    s_nop 1
    v_cndmask_b32 v83, v83, v232, s[54:55]
    v_mov_b32 v84, v232
    v_mov_b32 v85, v232
    v_mov_b32 v86, v232
    v_mov_b32 v87, v232
    v_cmp_gt_i32 s[48:49], 0, v231
    s_nop 1
    v_cndmask_b32 v92, v92, v232, s[48:49]
    v_cmp_gt_i32 s[50:51], 1, v231
    s_nop 1
    v_cndmask_b32 v93, v93, v232, s[50:51]
    v_cmp_gt_i32 s[52:53], 2, v231
    s_nop 1
    v_cndmask_b32 v94, v94, v232, s[52:53]
    v_cmp_gt_i32 s[54:55], 3, v231
    s_nop 1
    v_cndmask_b32 v95, v95, v232, s[54:55]
k2_kernel_nomask_9:
    s_waitcnt vmcnt(4)
    v_mov_b32 v241, s28
    ds_write_b32 v237, v241
    s_waitcnt lgkmcnt(7)
    v_mfma_f32_16x16x32_bf16 v[32:35], v[192:195], v[0:3], v[80:83]
    v_mfma_f32_16x16x32_bf16 v[40:43], v[192:195], v[16:19], v[88:91]
    v_mov_b32 v128, 0
    v_mov_b32 v129, 0
    v_mov_b32 v130, 0
    v_mov_b32 v131, 0
    v_mov_b32 v132, 0
    v_mfma_f32_16x16x32_bf16 v[36:39], v[196:199], v[0:3], v[84:87]
    v_mfma_f32_16x16x32_bf16 v[44:47], v[196:199], v[16:19], v[92:95]
    v_mov_b32 v133, 0
    v_mov_b32 v134, 0
    v_mov_b32 v135, 0
    v_mov_b32 v136, 0
    v_mov_b32 v137, 0
    s_waitcnt lgkmcnt(5)
    v_mfma_f32_16x16x32_bf16 v[32:35], v[200:203], v[4:7], v[32:35]
    v_mfma_f32_16x16x32_bf16 v[40:43], v[200:203], v[20:23], v[40:43]
    v_mov_b32 v138, 0
    v_mov_b32 v139, 0
    v_mov_b32 v140, 0
    v_mov_b32 v141, 0
    v_mov_b32 v142, 0
    v_mfma_f32_16x16x32_bf16 v[36:39], v[204:207], v[4:7], v[36:39]
    v_mfma_f32_16x16x32_bf16 v[44:47], v[204:207], v[20:23], v[44:47]
    v_mov_b32 v143, 0
    v_mov_b32 v144, 0
    v_mov_b32 v145, 0
    v_mov_b32 v146, 0
    v_mov_b32 v147, 0
    s_waitcnt lgkmcnt(3)
    v_mfma_f32_16x16x32_bf16 v[32:35], v[208:211], v[8:11], v[32:35]
    v_mfma_f32_16x16x32_bf16 v[40:43], v[208:211], v[24:27], v[40:43]
    v_mov_b32 v148, 0
    v_mov_b32 v149, 0
    v_mov_b32 v150, 0
    v_mov_b32 v151, 0
    v_mov_b32 v152, 0
    v_mfma_f32_16x16x32_bf16 v[36:39], v[212:215], v[8:11], v[36:39]
    v_mfma_f32_16x16x32_bf16 v[44:47], v[212:215], v[24:27], v[44:47]
    v_mov_b32 v153, 0
    v_mov_b32 v154, 0
    v_mov_b32 v155, 0
    v_mov_b32 v156, 0
    v_mov_b32 v157, 0
    s_waitcnt lgkmcnt(1)
    v_mfma_f32_16x16x32_bf16 v[32:35], v[216:219], v[12:15], v[32:35]
    v_mfma_f32_16x16x32_bf16 v[40:43], v[216:219], v[28:31], v[40:43]
    v_mov_b32 v158, 0
    v_mov_b32 v159, 0
    v_mov_b32 v160, 0
    v_mov_b32 v161, 0
    v_mov_b32 v162, 0
    v_mfma_f32_16x16x32_bf16 v[36:39], v[220:223], v[12:15], v[36:39]
    v_mfma_f32_16x16x32_bf16 v[44:47], v[220:223], v[28:31], v[44:47]
    v_mov_b32 v163, 0
    v_mov_b32 v164, 0
    v_mov_b32 v165, 0
    v_mov_b32 v166, 0
    v_mov_b32 v167, 0
    ds_read_b128 v[192:195], v225 offset:8192
    ds_read_b128 v[196:199], v225 offset:9216
    ds_read_b128 v[200:203], v225 offset:10240
    ds_read_b128 v[204:207], v225 offset:11264
    ds_read_b128 v[208:211], v225 offset:12288
    ds_read_b128 v[212:215], v225 offset:13312
    ds_read_b128 v[216:219], v225 offset:14336
    ds_read_b128 v[220:223], v225 offset:15360
    v_max3_f32 v242, v32, v33, v34
    v_max3_f32 v242, v242, v35, v36
    v_max3_f32 v242, v242, v37, v38
    v_max_f32 v242, v242, v39
    v_mov_b32 v233, v242
    s_nop 1
    v_permlane32_swap_b32 v242, v233
    v_max_f32 v242, v242, v233
    v_mov_b32 v233, v242
    s_nop 1
    v_permlane16_swap_b32 v242, v233
    v_max_f32 v242, v242, v233
    v_sub_f32 v80, 0, v242
    v_sub_f32 v81, 0, v242
    v_sub_f32 v82, 0, v242
    v_sub_f32 v83, 0, v242
    v_sub_f32 v84, 0, v242
    v_sub_f32 v85, 0, v242
    v_sub_f32 v86, 0, v242
    v_sub_f32 v87, 0, v242
    v_max3_f32 v243, v40, v41, v42
    v_max3_f32 v243, v243, v43, v44
    v_max3_f32 v243, v243, v45, v46
    v_max_f32 v243, v243, v47
    v_mov_b32 v233, v243
    s_nop 1
    v_permlane32_swap_b32 v243, v233
    v_max_f32 v243, v243, v233
    v_mov_b32 v233, v243
    s_nop 1
    v_permlane16_swap_b32 v243, v233
    v_max_f32 v243, v243, v233
    v_sub_f32 v88, 0, v243
    v_sub_f32 v89, 0, v243
    v_sub_f32 v90, 0, v243
    v_sub_f32 v91, 0, v243
    v_sub_f32 v92, 0, v243
    v_sub_f32 v93, 0, v243
    v_sub_f32 v94, 0, v243
    v_sub_f32 v95, 0, v243
    v_sub_f32 v32, v32, v242
    v_sub_f32 v33, v33, v242
    v_sub_f32 v34, v34, v242
    v_sub_f32 v35, v35, v242
    v_sub_f32 v36, v36, v242
    v_sub_f32 v37, v37, v242
    v_sub_f32 v38, v38, v242
    v_sub_f32 v39, v39, v242
    v_sub_f32 v40, v40, v243
    v_sub_f32 v41, v41, v243
    v_sub_f32 v42, v42, v243
    v_sub_f32 v43, v43, v243
    v_sub_f32 v44, v44, v243
    v_sub_f32 v45, v45, v243
    v_sub_f32 v46, v46, v243
    v_sub_f32 v47, v47, v243
    s_cmp_lg_u32 s26, 2
    s_cbranch_scc1 k2_kernel_nomask_10
    v_cmp_gt_i32 s[48:49], 0, v231
    s_nop 1
    v_cndmask_b32 v80, v80, v232, s[48:49]
    v_cmp_gt_i32 s[50:51], 1, v231
    s_nop 1
    v_cndmask_b32 v81, v81, v232, s[50:51]
    v_cmp_gt_i32 s[52:53], 2, v231
    s_nop 1
    v_cndmask_b32 v82, v82, v232, s[52:53]
    v_cmp_gt_i32 s[54:55], 3, v231
    s_nop 1
    v_cndmask_b32 v83, v83, v232, s[54:55]
    v_mov_b32 v84, v232
    v_mov_b32 v85, v232
    v_mov_b32 v86, v232
    v_mov_b32 v87, v232
    v_cmp_gt_i32 s[48:49], 0, v231
    s_nop 1
    v_cndmask_b32 v92, v92, v232, s[48:49]
    v_cmp_gt_i32 s[50:51], 1, v231
    s_nop 1
    v_cndmask_b32 v93, v93, v232, s[50:51]
    v_cmp_gt_i32 s[52:53], 2, v231
    s_nop 1
    v_cndmask_b32 v94, v94, v232, s[52:53]
    v_cmp_gt_i32 s[54:55], 3, v231
    s_nop 1
    v_cndmask_b32 v95, v95, v232, s[54:55]
k2_kernel_nomask_10:
    ds_read_b32 v240, v239
    s_waitcnt lgkmcnt(7)
    v_mfma_f32_16x16x32_bf16 v[48:51], v[192:195], v[0:3], v[80:83]
    v_exp_f32 v32, v32
    v_exp_f32 v33, v33
    v_mfma_f32_16x16x32_bf16 v[56:59], v[192:195], v[16:19], v[88:91]
    v_mov_b32 v168, 0
    v_mov_b32 v169, 0
    v_mov_b32 v170, 0
    v_mov_b32 v171, 0
    v_mov_b32 v172, 0
    v_mfma_f32_16x16x32_bf16 v[52:55], v[196:199], v[0:3], v[84:87]
    v_exp_f32 v34, v34
    v_exp_f32 v35, v35
    v_mfma_f32_16x16x32_bf16 v[60:63], v[196:199], v[16:19], v[92:95]
    v_cvt_pk_bf16_f32 v64, v32, v33
    v_mov_b32 v173, 0
    v_mov_b32 v174, 0
    v_mov_b32 v175, 0
    v_mov_b32 v176, 0
    v_mov_b32 v177, 0
    s_waitcnt lgkmcnt(5)
    v_mfma_f32_16x16x32_bf16 v[48:51], v[200:203], v[4:7], v[48:51]
    v_exp_f32 v36, v36
    v_exp_f32 v37, v37
    v_mfma_f32_16x16x32_bf16 v[56:59], v[200:203], v[20:23], v[56:59]
    v_cvt_pk_bf16_f32 v65, v34, v35
    v_mov_b32 v178, 0
    v_mov_b32 v179, 0
    v_mov_b32 v180, 0
    v_mov_b32 v181, 0
    v_mov_b32 v182, 0
    v_mfma_f32_16x16x32_bf16 v[52:55], v[204:207], v[4:7], v[52:55]
    v_exp_f32 v38, v38
    v_exp_f32 v39, v39
    v_mfma_f32_16x16x32_bf16 v[60:63], v[204:207], v[20:23], v[60:63]
    v_cvt_pk_bf16_f32 v66, v36, v37
    v_mov_b32 v183, 0
    v_mov_b32 v184, 0
    v_mov_b32 v185, 0
    v_mov_b32 v186, 0
    v_mov_b32 v187, 0
    s_waitcnt lgkmcnt(3)
    v_mfma_f32_16x16x32_bf16 v[48:51], v[208:211], v[8:11], v[48:51]
    v_exp_f32 v40, v40
    v_exp_f32 v41, v41
    v_mfma_f32_16x16x32_bf16 v[56:59], v[208:211], v[24:27], v[56:59]
    v_cvt_pk_bf16_f32 v67, v38, v39
    v_mov_b32 v188, 0
    v_mov_b32 v189, 0
    v_mov_b32 v190, 0
    v_mov_b32 v191, 0
    v_mov_b32 v248, 0
    v_mfma_f32_16x16x32_bf16 v[52:55], v[212:215], v[8:11], v[52:55]
    v_exp_f32 v42, v42
    v_exp_f32 v43, v43
    v_mfma_f32_16x16x32_bf16 v[60:63], v[212:215], v[24:27], v[60:63]
    v_cvt_pk_bf16_f32 v68, v40, v41
    v_mov_b32 v249, 0
    v_mov_b32 v250, 0
    v_mov_b32 v251, 0
    v_mov_b32 v252, 0
    v_mov_b32 v253, 0
    s_waitcnt lgkmcnt(1)
    v_mfma_f32_16x16x32_bf16 v[48:51], v[216:219], v[12:15], v[48:51]
    v_exp_f32 v44, v44
    v_exp_f32 v45, v45
    v_mfma_f32_16x16x32_bf16 v[56:59], v[216:219], v[28:31], v[56:59]
    v_cvt_pk_bf16_f32 v69, v42, v43
    v_mov_b32 v254, 0
    v_mov_b32 v255, 0
    v_mov_b32 v244, 0x3f803f80
    v_mov_b32 v245, 0x3f803f80
    v_mov_b32 v246, 0x3f803f80
    v_mfma_f32_16x16x32_bf16 v[52:55], v[220:223], v[12:15], v[52:55]
    v_exp_f32 v46, v46
    v_exp_f32 v47, v47
    v_mfma_f32_16x16x32_bf16 v[60:63], v[220:223], v[28:31], v[60:63]
    v_cvt_pk_bf16_f32 v70, v44, v45
    v_mov_b32 v247, 0x3f803f80
    v_cvt_pk_bf16_f32 v71, v46, v47
    s_waitcnt lgkmcnt(0)
    v_cmp_gt_i32 vcc, s28, v240
    s_cbranch_vccnz k2_kernel_spin_11
k2_kernel_back_12:
    s_add_u32 s28, s28, 1
    s_add_u32 s34, s34, 32768
    s_and_b32 s34, s34, 98304
    v_add_u32 v225, s34, v236
    ds_read_b128 v[192:195], v225 offset:0
    ds_read_b128 v[196:199], v225 offset:1024
    ds_read_b128 v[200:203], v225 offset:2048
    ds_read_b128 v[204:207], v225 offset:3072
    ds_read_b128 v[208:211], v225 offset:4096
    ds_read_b128 v[212:215], v225 offset:5120
    ds_read_b128 v[216:219], v225 offset:6144
    ds_read_b128 v[220:223], v225 offset:7168
    s_cmp_lt_u32 s58, s32
    s_cselect_b32 s47, s57, 0x7ff00000
    s_add_u32 m0, s59, s33
    s_nop 0
    buffer_load_dwordx4 v224, s[16:19], s47 offen offset:0 lds
    s_add_u32 s57, s57, 16384
    buffer_load_dwordx4 v224, s[16:19], s47 offen offset:1024 lds
    s_add_u32 s58, s58, 1
    buffer_load_dwordx4 v224, s[16:19], s47 offen offset:2048 lds
    s_add_u32 s59, s59, 32768
    buffer_load_dwordx4 v224, s[16:19], s47 offen offset:3072 lds
    s_and_b32 s59, s59, 98304
    s_cmp_eq_u32 s26, 1
    s_cbranch_scc1 k2_kernel_Hodd
    s_max_u32 s56, s26, 3
    s_sub_u32 s56, s56, 3
    s_lshr_b32 s56, s56, 1
    s_lshl_b32 s27, s56, 1
    s_add_u32 s27, s27, 2
    s_cmp_ge_u32 s24, 4
    s_cbranch_scc1 k2_kernel_nosplit_13
    s_cmp_eq_u32 s60, 0
    s_cbranch_scc1 k2_kernel_nosplit_13
    s_add_u32 s48, s62, 0
    buffer_store_dwordx4 v[0:3], v224, s[16:19], s48 offen offset:0 sc1
    buffer_store_dwordx4 v[4:7], v224, s[16:19], s48 offen offset:1024 sc1
    buffer_store_dwordx4 v[8:11], v224, s[16:19], s48 offen offset:2048 sc1
    buffer_store_dwordx4 v[12:15], v224, s[16:19], s48 offen offset:3072 sc1
    s_add_u32 s48, s62, 4096
    buffer_store_dwordx4 v[16:19], v224, s[16:19], s48 offen offset:0 sc1
    buffer_store_dwordx4 v[20:23], v224, s[16:19], s48 offen offset:1024 sc1
    buffer_store_dwordx4 v[24:27], v224, s[16:19], s48 offen offset:2048 sc1
    buffer_store_dwordx4 v[28:31], v224, s[16:19], s48 offen offset:3072 sc1
    s_add_u32 s48, s62, 8192
    buffer_store_dwordx2 v[242:243], v224, s[16:19], s48 offen sc1
    s_sub_u32 s56, s22, 5
    s_mov_b32 s23, 1
k2_kernel_nosplit_13:
    s_cmp_eq_u32 s56, 0
    s_cbranch_scc1 k2_kernel_gen
.p2align 6
k2_kernel_main:
    s_waitcnt lgkmcnt(6)
    v_mfma_f32_16x16x32_bf16 v[32:35], v[192:195], v[0:3], v[80:83]
    v_exp_f32 v48, v48
    v_mfma_f32_16x16x32_bf16 v[40:43], v[192:195], v[16:19], v[88:91]
    ds_read_b128 v[96:99], v225 offset:16384
    v_mfma_f32_16x16x32_bf16 v[36:39], v[196:199], v[0:3], v[84:87]
    v_exp_f32 v49, v49
    v_mfma_f32_16x16x32_bf16 v[44:47], v[196:199], v[16:19], v[92:95]
    ds_read_b128 v[100:103], v225 offset:17408
    s_waitcnt lgkmcnt(6)
    v_mfma_f32_16x16x32_bf16 v[32:35], v[200:203], v[4:7], v[32:35]
    v_exp_f32 v50, v50
    v_mfma_f32_16x16x32_bf16 v[40:43], v[200:203], v[20:23], v[40:43]
    ds_read_b128 v[104:107], v225 offset:18432
    s_waitcnt vmcnt(4)
    v_mov_b32 v241, s28
    ds_write_b32 v237, v241
    v_cvt_pk_bf16_f32 v72, v48, v49
    v_mfma_f32_16x16x32_bf16 v[36:39], v[204:207], v[4:7], v[36:39]
    v_exp_f32 v51, v51
    v_mfma_f32_16x16x32_bf16 v[44:47], v[204:207], v[20:23], v[44:47]
    ds_read_b128 v[108:111], v225 offset:19456
    s_waitcnt lgkmcnt(7)
    v_mfma_f32_16x16x32_bf16 v[32:35], v[208:211], v[8:11], v[32:35]
    v_exp_f32 v52, v52
    v_mfma_f32_16x16x32_bf16 v[40:43], v[208:211], v[24:27], v[40:43]
    ds_read_b128 v[112:115], v225 offset:20480
    v_cvt_pk_bf16_f32 v73, v50, v51
    v_mfma_f32_16x16x32_bf16 v[36:39], v[212:215], v[8:11], v[36:39]
    v_exp_f32 v53, v53
    v_mfma_f32_16x16x32_bf16 v[44:47], v[212:215], v[24:27], v[44:47]
    ds_read_b128 v[116:119], v225 offset:21504
    s_waitcnt lgkmcnt(7)
    v_mfma_f32_16x16x32_bf16 v[32:35], v[216:219], v[12:15], v[32:35]
    v_exp_f32 v54, v54
    v_mfma_f32_16x16x32_bf16 v[40:43], v[216:219], v[28:31], v[40:43]
    ds_read_b128 v[120:123], v225 offset:22528
    v_cvt_pk_bf16_f32 v74, v52, v53
    v_mfma_f32_16x16x32_bf16 v[36:39], v[220:223], v[12:15], v[36:39]
    v_exp_f32 v55, v55
    v_mfma_f32_16x16x32_bf16 v[44:47], v[220:223], v[28:31], v[44:47]
    ds_read_b128 v[124:127], v225 offset:23552
    s_waitcnt lgkmcnt(7)
    v_mfma_f32_16x16x32_bf16 v[128:131], v[96:99], v[64:67], v[128:131]
    v_exp_f32 v56, v56
    v_mfma_f32_16x16x32_bf16 v[160:163], v[96:99], v[68:71], v[160:163]
    ds_read_b128 v[192:195], v225 offset:8192
    v_cvt_pk_bf16_f32 v75, v54, v55
    v_mfma_f32_16x16x32_bf16 v[132:135], v[100:103], v[64:67], v[132:135]
    v_exp_f32 v57, v57
    v_mfma_f32_16x16x32_bf16 v[164:167], v[100:103], v[68:71], v[164:167]
    ds_read_b128 v[196:199], v225 offset:9216
    v_mfma_f32_16x16x32_bf16 v[248:251], v[244:247], v[64:67], v[248:251]
    s_waitcnt lgkmcnt(6)
    v_mfma_f32_16x16x32_bf16 v[136:139], v[104:107], v[64:67], v[136:139]
    v_exp_f32 v58, v58
    v_mfma_f32_16x16x32_bf16 v[168:171], v[104:107], v[68:71], v[168:171]
    ds_read_b128 v[200:203], v225 offset:10240
    v_cvt_pk_bf16_f32 v76, v56, v57
    v_mfma_f32_16x16x32_bf16 v[140:143], v[108:111], v[64:67], v[140:143]
    v_exp_f32 v59, v59
    v_mfma_f32_16x16x32_bf16 v[172:175], v[108:111], v[68:71], v[172:175]
    ds_read_b128 v[204:207], v225 offset:11264
    s_waitcnt lgkmcnt(6)
    v_mfma_f32_16x16x32_bf16 v[144:147], v[112:115], v[64:67], v[144:147]
    v_exp_f32 v60, v60
    v_mfma_f32_16x16x32_bf16 v[176:179], v[112:115], v[68:71], v[176:179]
    ds_read_b128 v[208:211], v225 offset:12288
    v_cvt_pk_bf16_f32 v77, v58, v59
    v_mfma_f32_16x16x32_bf16 v[148:151], v[116:119], v[64:67], v[148:151]
    v_exp_f32 v61, v61
    v_mfma_f32_16x16x32_bf16 v[180:183], v[116:119], v[68:71], v[180:183]
    ds_read_b128 v[212:215], v225 offset:13312
    v_mfma_f32_16x16x32_bf16 v[252:255], v[244:247], v[68:71], v[252:255]
    s_waitcnt lgkmcnt(6)
    v_mfma_f32_16x16x32_bf16 v[152:155], v[120:123], v[64:67], v[152:155]
    v_exp_f32 v62, v62
    v_mfma_f32_16x16x32_bf16 v[184:187], v[120:123], v[68:71], v[184:187]
    ds_read_b128 v[216:219], v225 offset:14336
    v_cvt_pk_bf16_f32 v78, v60, v61
    v_mfma_f32_16x16x32_bf16 v[156:159], v[124:127], v[64:67], v[156:159]
    v_exp_f32 v63, v63
    v_mfma_f32_16x16x32_bf16 v[188:191], v[124:127], v[68:71], v[188:191]
    ds_read_b128 v[220:223], v225 offset:15360
    v_cvt_pk_bf16_f32 v79, v62, v63
    s_waitcnt lgkmcnt(6)
    v_mfma_f32_16x16x32_bf16 v[48:51], v[192:195], v[0:3], v[80:83]
    v_exp_f32 v32, v32
    v_mfma_f32_16x16x32_bf16 v[56:59], v[192:195], v[16:19], v[88:91]
    ds_read_b128 v[96:99], v225 offset:24576
    v_mfma_f32_16x16x32_bf16 v[52:55], v[196:199], v[0:3], v[84:87]
    v_exp_f32 v33, v33
    v_mfma_f32_16x16x32_bf16 v[60:63], v[196:199], v[16:19], v[92:95]
    ds_read_b128 v[100:103], v225 offset:25600
    s_waitcnt lgkmcnt(6)
    v_mfma_f32_16x16x32_bf16 v[48:51], v[200:203], v[4:7], v[48:51]
    v_exp_f32 v34, v34
    v_mfma_f32_16x16x32_bf16 v[56:59], v[200:203], v[20:23], v[56:59]
    ds_read_b128 v[104:107], v225 offset:26624
    v_cvt_pk_bf16_f32 v64, v32, v33
    v_mfma_f32_16x16x32_bf16 v[52:55], v[204:207], v[4:7], v[52:55]
    v_exp_f32 v35, v35
    v_mfma_f32_16x16x32_bf16 v[60:63], v[204:207], v[20:23], v[60:63]
    ds_read_b128 v[108:111], v225 offset:27648
    s_waitcnt lgkmcnt(6)
    v_mfma_f32_16x16x32_bf16 v[48:51], v[208:211], v[8:11], v[48:51]
    v_exp_f32 v36, v36
    v_mfma_f32_16x16x32_bf16 v[56:59], v[208:211], v[24:27], v[56:59]
    ds_read_b128 v[112:115], v225 offset:28672
    ds_read_b32 v240, v239
    v_cvt_pk_bf16_f32 v65, v34, v35
    v_mfma_f32_16x16x32_bf16 v[52:55], v[212:215], v[8:11], v[52:55]
    v_exp_f32 v37, v37
    v_mfma_f32_16x16x32_bf16 v[60:63], v[212:215], v[24:27], v[60:63]
    ds_read_b128 v[116:119], v225 offset:29696
    s_waitcnt lgkmcnt(7)
    v_mfma_f32_16x16x32_bf16 v[48:51], v[216:219], v[12:15], v[48:51]
    v_exp_f32 v38, v38
    v_mfma_f32_16x16x32_bf16 v[56:59], v[216:219], v[28:31], v[56:59]
    ds_read_b128 v[120:123], v225 offset:30720
    v_cvt_pk_bf16_f32 v66, v36, v37
    v_mfma_f32_16x16x32_bf16 v[52:55], v[220:223], v[12:15], v[52:55]
    v_exp_f32 v39, v39
    v_mfma_f32_16x16x32_bf16 v[60:63], v[220:223], v[28:31], v[60:63]
    ds_read_b128 v[124:127], v225 offset:31744
    s_waitcnt lgkmcnt(7)
    v_mfma_f32_16x16x32_bf16 v[128:131], v[96:99], v[72:75], v[128:131]
    v_exp_f32 v40, v40
    v_mfma_f32_16x16x32_bf16 v[160:163], v[96:99], v[76:79], v[160:163]
    s_waitcnt lgkmcnt(3)
    v_cmp_gt_i32 vcc, s28, v240
    s_cbranch_vccnz k2_kernel_spin_14
k2_kernel_back_15:
    s_add_u32 s28, s28, 1
    s_add_u32 s34, s34, 32768
    s_and_b32 s34, s34, 98304
    v_add_u32 v225, s34, v236
    ds_read_b128 v[192:195], v225 offset:0
    v_cvt_pk_bf16_f32 v67, v38, v39
    v_mfma_f32_16x16x32_bf16 v[132:135], v[100:103], v[72:75], v[132:135]
    v_exp_f32 v41, v41
    v_mfma_f32_16x16x32_bf16 v[164:167], v[100:103], v[76:79], v[164:167]
    ds_read_b128 v[196:199], v225 offset:1024
    s_cmp_lt_u32 s58, s32
    s_cselect_b32 s47, s57, 0x7ff00000
    s_add_u32 m0, s59, s33
    v_mfma_f32_16x16x32_bf16 v[248:251], v[244:247], v[72:75], v[248:251]
    v_mfma_f32_16x16x32_bf16 v[136:139], v[104:107], v[72:75], v[136:139]
    v_exp_f32 v42, v42
    v_mfma_f32_16x16x32_bf16 v[168:171], v[104:107], v[76:79], v[168:171]
    ds_read_b128 v[200:203], v225 offset:2048
    v_cvt_pk_bf16_f32 v68, v40, v41
    v_mfma_f32_16x16x32_bf16 v[140:143], v[108:111], v[72:75], v[140:143]
    v_exp_f32 v43, v43
    v_mfma_f32_16x16x32_bf16 v[172:175], v[108:111], v[76:79], v[172:175]
    ds_read_b128 v[204:207], v225 offset:3072
    buffer_load_dwordx4 v224, s[16:19], s47 offen offset:0 lds
    s_add_u32 s57, s57, 16384
    s_waitcnt lgkmcnt(6)
    v_mfma_f32_16x16x32_bf16 v[144:147], v[112:115], v[72:75], v[144:147]
    v_exp_f32 v44, v44
    v_mfma_f32_16x16x32_bf16 v[176:179], v[112:115], v[76:79], v[176:179]
    ds_read_b128 v[208:211], v225 offset:4096
    v_cvt_pk_bf16_f32 v69, v42, v43
    v_mfma_f32_16x16x32_bf16 v[148:151], v[116:119], v[72:75], v[148:151]
    v_exp_f32 v45, v45
    v_mfma_f32_16x16x32_bf16 v[180:183], v[116:119], v[76:79], v[180:183]
    ds_read_b128 v[212:215], v225 offset:5120
    buffer_load_dwordx4 v224, s[16:19], s47 offen offset:1024 lds
    s_add_u32 s58, s58, 1
    v_mfma_f32_16x16x32_bf16 v[252:255], v[244:247], v[76:79], v[252:255]
    s_waitcnt lgkmcnt(6)
    v_mfma_f32_16x16x32_bf16 v[152:155], v[120:123], v[72:75], v[152:155]
    v_exp_f32 v46, v46
    v_mfma_f32_16x16x32_bf16 v[184:187], v[120:123], v[76:79], v[184:187]
    ds_read_b128 v[216:219], v225 offset:6144
    v_cvt_pk_bf16_f32 v70, v44, v45
    v_mfma_f32_16x16x32_bf16 v[156:159], v[124:127], v[72:75], v[156:159]
    v_exp_f32 v47, v47
    v_mfma_f32_16x16x32_bf16 v[188:191], v[124:127], v[76:79], v[188:191]
    ds_read_b128 v[220:223], v225 offset:7168
    buffer_load_dwordx4 v224, s[16:19], s47 offen offset:2048 lds
    s_add_u32 s59, s59, 32768
    v_cvt_pk_bf16_f32 v71, v46, v47
    buffer_load_dwordx4 v224, s[16:19], s47 offen offset:3072 lds
    s_and_b32 s59, s59, 98304
    s_sub_u32 s56, s56, 1
    s_cmp_lg_u32 s56, 0
    s_cbranch_scc1 k2_kernel_main
    s_cmp_eq_u32 s23, 1
    s_cbranch_scc1 k2_kernel_trans
k2_kernel_gen:
    s_cmp_eq_u32 s27, s26
    s_cbranch_scc1 k2_kernel_Godd
    s_add_u32 s27, s27, 1
    s_cmp_lg_u32 s26, s27
    s_cbranch_scc1 k2_kernel_nomask_16
    v_cmp_gt_i32 s[48:49], 0, v231
    s_nop 1
    v_cndmask_b32 v80, v80, v232, s[48:49]
    v_cmp_gt_i32 s[50:51], 1, v231
    s_nop 1
    v_cndmask_b32 v81, v81, v232, s[50:51]
    v_cmp_gt_i32 s[52:53], 2, v231
    s_nop 1
    v_cndmask_b32 v82, v82, v232, s[52:53]
    v_cmp_gt_i32 s[54:55], 3, v231
    s_nop 1
    v_cndmask_b32 v83, v83, v232, s[54:55]
    v_mov_b32 v84, v232
    v_mov_b32 v85, v232
    v_mov_b32 v86, v232
    v_mov_b32 v87, v232
    v_cmp_gt_i32 s[48:49], 0, v231
    s_nop 1
    v_cndmask_b32 v92, v92, v232, s[48:49]
    v_cmp_gt_i32 s[50:51], 1, v231
    s_nop 1
    v_cndmask_b32 v93, v93, v232, s[50:51]
    v_cmp_gt_i32 s[52:53], 2, v231
    s_nop 1
    v_cndmask_b32 v94, v94, v232, s[52:53]
    v_cmp_gt_i32 s[54:55], 3, v231
    s_nop 1
    v_cndmask_b32 v95, v95, v232, s[54:55]
k2_kernel_nomask_16:
    s_waitcnt lgkmcnt(6)
    v_mfma_f32_16x16x32_bf16 v[32:35], v[192:195], v[0:3], v[80:83]
    v_exp_f32 v48, v48
    v_mfma_f32_16x16x32_bf16 v[40:43], v[192:195], v[16:19], v[88:91]
    ds_read_b128 v[96:99], v225 offset:16384
    v_mfma_f32_16x16x32_bf16 v[36:39], v[196:199], v[0:3], v[84:87]
    v_exp_f32 v49, v49
    v_mfma_f32_16x16x32_bf16 v[44:47], v[196:199], v[16:19], v[92:95]
    ds_read_b128 v[100:103], v225 offset:17408
    s_waitcnt lgkmcnt(6)
    v_mfma_f32_16x16x32_bf16 v[32:35], v[200:203], v[4:7], v[32:35]
    v_exp_f32 v50, v50
    v_mfma_f32_16x16x32_bf16 v[40:43], v[200:203], v[20:23], v[40:43]
    ds_read_b128 v[104:107], v225 offset:18432
    s_waitcnt vmcnt(4)
    v_mov_b32 v241, s28
    ds_write_b32 v237, v241
    v_cvt_pk_bf16_f32 v72, v48, v49
    v_mfma_f32_16x16x32_bf16 v[36:39], v[204:207], v[4:7], v[36:39]
    v_exp_f32 v51, v51
    v_mfma_f32_16x16x32_bf16 v[44:47], v[204:207], v[20:23], v[44:47]
    ds_read_b128 v[108:111], v225 offset:19456
    s_waitcnt lgkmcnt(7)
    v_mfma_f32_16x16x32_bf16 v[32:35], v[208:211], v[8:11], v[32:35]
    v_exp_f32 v52, v52
    v_mfma_f32_16x16x32_bf16 v[40:43], v[208:211], v[24:27], v[40:43]
    ds_read_b128 v[112:115], v225 offset:20480
    v_cvt_pk_bf16_f32 v73, v50, v51
    v_mfma_f32_16x16x32_bf16 v[36:39], v[212:215], v[8:11], v[36:39]
    v_exp_f32 v53, v53
    v_mfma_f32_16x16x32_bf16 v[44:47], v[212:215], v[24:27], v[44:47]
    ds_read_b128 v[116:119], v225 offset:21504
    s_waitcnt lgkmcnt(7)
    v_mfma_f32_16x16x32_bf16 v[32:35], v[216:219], v[12:15], v[32:35]
    v_exp_f32 v54, v54
    v_mfma_f32_16x16x32_bf16 v[40:43], v[216:219], v[28:31], v[40:43]
    ds_read_b128 v[120:123], v225 offset:22528
    v_cvt_pk_bf16_f32 v74, v52, v53
    v_mfma_f32_16x16x32_bf16 v[36:39], v[220:223], v[12:15], v[36:39]
    v_exp_f32 v55, v55
    v_mfma_f32_16x16x32_bf16 v[44:47], v[220:223], v[28:31], v[44:47]
    ds_read_b128 v[124:127], v225 offset:23552
    s_waitcnt lgkmcnt(7)
    v_mfma_f32_16x16x32_bf16 v[128:131], v[96:99], v[64:67], v[128:131]
    v_exp_f32 v56, v56
    v_mfma_f32_16x16x32_bf16 v[160:163], v[96:99], v[68:71], v[160:163]
    ds_read_b128 v[192:195], v225 offset:8192
    v_cvt_pk_bf16_f32 v75, v54, v55
    v_mfma_f32_16x16x32_bf16 v[132:135], v[100:103], v[64:67], v[132:135]
    v_exp_f32 v57, v57
    v_mfma_f32_16x16x32_bf16 v[164:167], v[100:103], v[68:71], v[164:167]
    ds_read_b128 v[196:199], v225 offset:9216
    v_mfma_f32_16x16x32_bf16 v[248:251], v[244:247], v[64:67], v[248:251]
    s_waitcnt lgkmcnt(6)
    v_mfma_f32_16x16x32_bf16 v[136:139], v[104:107], v[64:67], v[136:139]
    v_exp_f32 v58, v58
    v_mfma_f32_16x16x32_bf16 v[168:171], v[104:107], v[68:71], v[168:171]
    ds_read_b128 v[200:203], v225 offset:10240
    v_cvt_pk_bf16_f32 v76, v56, v57
    v_mfma_f32_16x16x32_bf16 v[140:143], v[108:111], v[64:67], v[140:143]
    v_exp_f32 v59, v59
    v_mfma_f32_16x16x32_bf16 v[172:175], v[108:111], v[68:71], v[172:175]
    ds_read_b128 v[204:207], v225 offset:11264
    s_waitcnt lgkmcnt(6)
    v_mfma_f32_16x16x32_bf16 v[144:147], v[112:115], v[64:67], v[144:147]
    v_exp_f32 v60, v60
    v_mfma_f32_16x16x32_bf16 v[176:179], v[112:115], v[68:71], v[176:179]
    ds_read_b128 v[208:211], v225 offset:12288
    v_cvt_pk_bf16_f32 v77, v58, v59
    v_mfma_f32_16x16x32_bf16 v[148:151], v[116:119], v[64:67], v[148:151]
    v_exp_f32 v61, v61
    v_mfma_f32_16x16x32_bf16 v[180:183], v[116:119], v[68:71], v[180:183]
    ds_read_b128 v[212:215], v225 offset:13312
    v_mfma_f32_16x16x32_bf16 v[252:255], v[244:247], v[68:71], v[252:255]
    s_waitcnt lgkmcnt(6)
    v_mfma_f32_16x16x32_bf16 v[152:155], v[120:123], v[64:67], v[152:155]
    v_exp_f32 v62, v62
    v_mfma_f32_16x16x32_bf16 v[184:187], v[120:123], v[68:71], v[184:187]
    ds_read_b128 v[216:219], v225 offset:14336
    v_cvt_pk_bf16_f32 v78, v60, v61
    v_mfma_f32_16x16x32_bf16 v[156:159], v[124:127], v[64:67], v[156:159]
    v_exp_f32 v63, v63
    v_mfma_f32_16x16x32_bf16 v[188:191], v[124:127], v[68:71], v[188:191]
    ds_read_b128 v[220:223], v225 offset:15360
    v_cvt_pk_bf16_f32 v79, v62, v63
    s_cmp_eq_u32 s27, s26
    s_cbranch_scc1 k2_kernel_Geven
    s_add_u32 s27, s27, 1
    s_cmp_lg_u32 s26, s27
    s_cbranch_scc1 k2_kernel_nomask_17
    v_cmp_gt_i32 s[48:49], 0, v231
    s_nop 1
    v_cndmask_b32 v80, v80, v232, s[48:49]
    v_cmp_gt_i32 s[50:51], 1, v231
    s_nop 1
    v_cndmask_b32 v81, v81, v232, s[50:51]
    v_cmp_gt_i32 s[52:53], 2, v231
    s_nop 1
    v_cndmask_b32 v82, v82, v232, s[52:53]
    v_cmp_gt_i32 s[54:55], 3, v231
    s_nop 1
    v_cndmask_b32 v83, v83, v232, s[54:55]
    v_mov_b32 v84, v232
    v_mov_b32 v85, v232
    v_mov_b32 v86, v232
    v_mov_b32 v87, v232
    v_cmp_gt_i32 s[48:49], 0, v231
    s_nop 1
    v_cndmask_b32 v92, v92, v232, s[48:49]
    v_cmp_gt_i32 s[50:51], 1, v231
    s_nop 1
    v_cndmask_b32 v93, v93, v232, s[50:51]
    v_cmp_gt_i32 s[52:53], 2, v231
    s_nop 1
    v_cndmask_b32 v94, v94, v232, s[52:53]
    v_cmp_gt_i32 s[54:55], 3, v231
    s_nop 1
    v_cndmask_b32 v95, v95, v232, s[54:55]
k2_kernel_nomask_17:
    s_waitcnt lgkmcnt(6)
    v_mfma_f32_16x16x32_bf16 v[48:51], v[192:195], v[0:3], v[80:83]
    v_exp_f32 v32, v32
    v_mfma_f32_16x16x32_bf16 v[56:59], v[192:195], v[16:19], v[88:91]
    ds_read_b128 v[96:99], v225 offset:24576
    v_mfma_f32_16x16x32_bf16 v[52:55], v[196:199], v[0:3], v[84:87]
    v_exp_f32 v33, v33
    v_mfma_f32_16x16x32_bf16 v[60:63], v[196:199], v[16:19], v[92:95]
    ds_read_b128 v[100:103], v225 offset:25600
    s_waitcnt lgkmcnt(6)
    v_mfma_f32_16x16x32_bf16 v[48:51], v[200:203], v[4:7], v[48:51]
    v_exp_f32 v34, v34
    v_mfma_f32_16x16x32_bf16 v[56:59], v[200:203], v[20:23], v[56:59]
    ds_read_b128 v[104:107], v225 offset:26624
    v_cvt_pk_bf16_f32 v64, v32, v33
    v_mfma_f32_16x16x32_bf16 v[52:55], v[204:207], v[4:7], v[52:55]
    v_exp_f32 v35, v35
    v_mfma_f32_16x16x32_bf16 v[60:63], v[204:207], v[20:23], v[60:63]
    ds_read_b128 v[108:111], v225 offset:27648
    s_waitcnt lgkmcnt(6)
    v_mfma_f32_16x16x32_bf16 v[48:51], v[208:211], v[8:11], v[48:51]
    v_exp_f32 v36, v36
    v_mfma_f32_16x16x32_bf16 v[56:59], v[208:211], v[24:27], v[56:59]
    ds_read_b128 v[112:115], v225 offset:28672
    ds_read_b32 v240, v239
    v_cvt_pk_bf16_f32 v65, v34, v35
    v_mfma_f32_16x16x32_bf16 v[52:55], v[212:215], v[8:11], v[52:55]
    v_exp_f32 v37, v37
    v_mfma_f32_16x16x32_bf16 v[60:63], v[212:215], v[24:27], v[60:63]
    ds_read_b128 v[116:119], v225 offset:29696
    s_waitcnt lgkmcnt(7)
    v_mfma_f32_16x16x32_bf16 v[48:51], v[216:219], v[12:15], v[48:51]
    v_exp_f32 v38, v38
    v_mfma_f32_16x16x32_bf16 v[56:59], v[216:219], v[28:31], v[56:59]
    ds_read_b128 v[120:123], v225 offset:30720
    v_cvt_pk_bf16_f32 v66, v36, v37
    v_mfma_f32_16x16x32_bf16 v[52:55], v[220:223], v[12:15], v[52:55]
    v_exp_f32 v39, v39
    v_mfma_f32_16x16x32_bf16 v[60:63], v[220:223], v[28:31], v[60:63]
    ds_read_b128 v[124:127], v225 offset:31744
    s_waitcnt lgkmcnt(7)
    v_mfma_f32_16x16x32_bf16 v[128:131], v[96:99], v[72:75], v[128:131]
    v_exp_f32 v40, v40
    v_mfma_f32_16x16x32_bf16 v[160:163], v[96:99], v[76:79], v[160:163]
    s_waitcnt lgkmcnt(3)
    v_cmp_gt_i32 vcc, s28, v240
    s_cbranch_vccnz k2_kernel_spin_18
k2_kernel_back_19:
    s_add_u32 s28, s28, 1
    s_add_u32 s34, s34, 32768
    s_and_b32 s34, s34, 98304
    v_add_u32 v225, s34, v236
    ds_read_b128 v[192:195], v225 offset:0
    v_cvt_pk_bf16_f32 v67, v38, v39
    v_mfma_f32_16x16x32_bf16 v[132:135], v[100:103], v[72:75], v[132:135]
    v_exp_f32 v41, v41
    v_mfma_f32_16x16x32_bf16 v[164:167], v[100:103], v[76:79], v[164:167]
    ds_read_b128 v[196:199], v225 offset:1024
    s_cmp_lt_u32 s58, s32
    s_cselect_b32 s47, s57, 0x7ff00000
    s_add_u32 m0, s59, s33
    v_mfma_f32_16x16x32_bf16 v[248:251], v[244:247], v[72:75], v[248:251]
    v_mfma_f32_16x16x32_bf16 v[136:139], v[104:107], v[72:75], v[136:139]
    v_exp_f32 v42, v42
    v_mfma_f32_16x16x32_bf16 v[168:171], v[104:107], v[76:79], v[168:171]
    ds_read_b128 v[200:203], v225 offset:2048
    v_cvt_pk_bf16_f32 v68, v40, v41
    v_mfma_f32_16x16x32_bf16 v[140:143], v[108:111], v[72:75], v[140:143]
    v_exp_f32 v43, v43
    v_mfma_f32_16x16x32_bf16 v[172:175], v[108:111], v[76:79], v[172:175]
    ds_read_b128 v[204:207], v225 offset:3072
    buffer_load_dwordx4 v224, s[16:19], s47 offen offset:0 lds
    s_add_u32 s57, s57, 16384
    s_waitcnt lgkmcnt(6)
    v_mfma_f32_16x16x32_bf16 v[144:147], v[112:115], v[72:75], v[144:147]
    v_exp_f32 v44, v44
    v_mfma_f32_16x16x32_bf16 v[176:179], v[112:115], v[76:79], v[176:179]
    ds_read_b128 v[208:211], v225 offset:4096
    v_cvt_pk_bf16_f32 v69, v42, v43
    v_mfma_f32_16x16x32_bf16 v[148:151], v[116:119], v[72:75], v[148:151]
    v_exp_f32 v45, v45
    v_mfma_f32_16x16x32_bf16 v[180:183], v[116:119], v[76:79], v[180:183]
    ds_read_b128 v[212:215], v225 offset:5120
    buffer_load_dwordx4 v224, s[16:19], s47 offen offset:1024 lds
    s_add_u32 s58, s58, 1
    v_mfma_f32_16x16x32_bf16 v[252:255], v[244:247], v[76:79], v[252:255]
    s_waitcnt lgkmcnt(6)
    v_mfma_f32_16x16x32_bf16 v[152:155], v[120:123], v[72:75], v[152:155]
    v_exp_f32 v46, v46
    v_mfma_f32_16x16x32_bf16 v[184:187], v[120:123], v[76:79], v[184:187]
    ds_read_b128 v[216:219], v225 offset:6144
    v_cvt_pk_bf16_f32 v70, v44, v45
    v_mfma_f32_16x16x32_bf16 v[156:159], v[124:127], v[72:75], v[156:159]
    v_exp_f32 v47, v47
    v_mfma_f32_16x16x32_bf16 v[188:191], v[124:127], v[76:79], v[188:191]
    ds_read_b128 v[220:223], v225 offset:7168
    buffer_load_dwordx4 v224, s[16:19], s47 offen offset:2048 lds
    s_add_u32 s59, s59, 32768
    v_cvt_pk_bf16_f32 v71, v46, v47
    buffer_load_dwordx4 v224, s[16:19], s47 offen offset:3072 lds
    s_and_b32 s59, s59, 98304
    s_branch k2_kernel_gen
k2_kernel_Godd:
    ds_read_b128 v[96:99], v225 offset:16384
    ds_read_b128 v[100:103], v225 offset:17408
    ds_read_b128 v[104:107], v225 offset:18432
    ds_read_b128 v[108:111], v225 offset:19456
    ds_read_b128 v[112:115], v225 offset:20480
    ds_read_b128 v[116:119], v225 offset:21504
    ds_read_b128 v[120:123], v225 offset:22528
    ds_read_b128 v[124:127], v225 offset:23552
    s_waitcnt vmcnt(4)
    v_mov_b32 v241, s28
    ds_write_b32 v237, v241
    s_waitcnt lgkmcnt(7)
    v_mfma_f32_16x16x32_bf16 v[128:131], v[96:99], v[64:67], v[128:131]
    v_exp_f32 v48, v48
    v_exp_f32 v49, v49
    v_mfma_f32_16x16x32_bf16 v[160:163], v[96:99], v[68:71], v[160:163]
    v_mfma_f32_16x16x32_bf16 v[132:135], v[100:103], v[64:67], v[132:135]
    v_exp_f32 v50, v50
    v_exp_f32 v51, v51
    v_mfma_f32_16x16x32_bf16 v[164:167], v[100:103], v[68:71], v[164:167]
    v_cvt_pk_bf16_f32 v72, v48, v49
    v_mfma_f32_16x16x32_bf16 v[248:251], v[244:247], v[64:67], v[248:251]
    s_waitcnt lgkmcnt(5)
    v_mfma_f32_16x16x32_bf16 v[136:139], v[104:107], v[64:67], v[136:139]
    v_exp_f32 v52, v52
    v_exp_f32 v53, v53
    v_mfma_f32_16x16x32_bf16 v[168:171], v[104:107], v[68:71], v[168:171]
    v_cvt_pk_bf16_f32 v73, v50, v51
    v_mfma_f32_16x16x32_bf16 v[140:143], v[108:111], v[64:67], v[140:143]
    v_exp_f32 v54, v54
    v_exp_f32 v55, v55
    v_mfma_f32_16x16x32_bf16 v[172:175], v[108:111], v[68:71], v[172:175]
    v_cvt_pk_bf16_f32 v74, v52, v53
    s_waitcnt lgkmcnt(3)
    v_mfma_f32_16x16x32_bf16 v[144:147], v[112:115], v[64:67], v[144:147]
    v_exp_f32 v56, v56
    v_exp_f32 v57, v57
    v_mfma_f32_16x16x32_bf16 v[176:179], v[112:115], v[68:71], v[176:179]
    v_cvt_pk_bf16_f32 v75, v54, v55
    v_mfma_f32_16x16x32_bf16 v[148:151], v[116:119], v[64:67], v[148:151]
    v_exp_f32 v58, v58
    v_exp_f32 v59, v59
    v_mfma_f32_16x16x32_bf16 v[180:183], v[116:119], v[68:71], v[180:183]
    v_cvt_pk_bf16_f32 v76, v56, v57
    v_mfma_f32_16x16x32_bf16 v[252:255], v[244:247], v[68:71], v[252:255]
    s_waitcnt lgkmcnt(1)
    v_mfma_f32_16x16x32_bf16 v[152:155], v[120:123], v[64:67], v[152:155]
    v_exp_f32 v60, v60
    v_exp_f32 v61, v61
    v_mfma_f32_16x16x32_bf16 v[184:187], v[120:123], v[68:71], v[184:187]
    v_cvt_pk_bf16_f32 v77, v58, v59
    v_mfma_f32_16x16x32_bf16 v[156:159], v[124:127], v[64:67], v[156:159]
    v_exp_f32 v62, v62
    v_exp_f32 v63, v63
    v_mfma_f32_16x16x32_bf16 v[188:191], v[124:127], v[68:71], v[188:191]
    v_cvt_pk_bf16_f32 v78, v60, v61
    v_cvt_pk_bf16_f32 v79, v62, v63
    ds_read_b128 v[192:195], v225 offset:8192
    ds_read_b128 v[196:199], v225 offset:9216
    ds_read_b128 v[200:203], v225 offset:10240
    ds_read_b128 v[204:207], v225 offset:11264
    ds_read_b128 v[208:211], v225 offset:12288
    ds_read_b128 v[212:215], v225 offset:13312
    ds_read_b128 v[216:219], v225 offset:14336
    ds_read_b128 v[220:223], v225 offset:15360
    ds_read_b128 v[96:99], v225 offset:24576
    ds_read_b128 v[100:103], v225 offset:25600
    ds_read_b128 v[104:107], v225 offset:26624
    ds_read_b128 v[108:111], v225 offset:27648
    ds_read_b128 v[112:115], v225 offset:28672
    ds_read_b128 v[116:119], v225 offset:29696
    ds_read_b128 v[120:123], v225 offset:30720
    ds_read_b128 v[124:127], v225 offset:31744
    ds_read_b32 v240, v239
    s_waitcnt lgkmcnt(7)
    v_mfma_f32_16x16x32_bf16 v[128:131], v[96:99], v[72:75], v[128:131]
    v_mfma_f32_16x16x32_bf16 v[160:163], v[96:99], v[76:79], v[160:163]
    v_mfma_f32_16x16x32_bf16 v[132:135], v[100:103], v[72:75], v[132:135]
    v_mfma_f32_16x16x32_bf16 v[164:167], v[100:103], v[76:79], v[164:167]
    v_mfma_f32_16x16x32_bf16 v[248:251], v[244:247], v[72:75], v[248:251]
    s_waitcnt lgkmcnt(5)
    v_mfma_f32_16x16x32_bf16 v[136:139], v[104:107], v[72:75], v[136:139]
    v_mfma_f32_16x16x32_bf16 v[168:171], v[104:107], v[76:79], v[168:171]
    v_mfma_f32_16x16x32_bf16 v[140:143], v[108:111], v[72:75], v[140:143]
    v_mfma_f32_16x16x32_bf16 v[172:175], v[108:111], v[76:79], v[172:175]
    s_waitcnt lgkmcnt(3)
    v_mfma_f32_16x16x32_bf16 v[144:147], v[112:115], v[72:75], v[144:147]
    v_mfma_f32_16x16x32_bf16 v[176:179], v[112:115], v[76:79], v[176:179]
    v_mfma_f32_16x16x32_bf16 v[148:151], v[116:119], v[72:75], v[148:151]
    v_mfma_f32_16x16x32_bf16 v[180:183], v[116:119], v[76:79], v[180:183]
    v_mfma_f32_16x16x32_bf16 v[252:255], v[244:247], v[76:79], v[252:255]
    s_waitcnt lgkmcnt(1)
    v_mfma_f32_16x16x32_bf16 v[152:155], v[120:123], v[72:75], v[152:155]
    v_mfma_f32_16x16x32_bf16 v[184:187], v[120:123], v[76:79], v[184:187]
    v_mfma_f32_16x16x32_bf16 v[156:159], v[124:127], v[72:75], v[156:159]
    v_mfma_f32_16x16x32_bf16 v[188:191], v[124:127], v[76:79], v[188:191]
    s_waitcnt lgkmcnt(0)
    v_cmp_gt_i32 vcc, s28, v240
    s_cbranch_vccnz k2_kernel_spin_20
k2_kernel_back_21:
    s_add_u32 s28, s28, 1
    s_add_u32 s34, s34, 32768
    s_and_b32 s34, s34, 98304
    v_add_u32 v225, s34, v236
    ds_read_b128 v[192:195], v225 offset:0
    ds_read_b128 v[196:199], v225 offset:1024
    ds_read_b128 v[200:203], v225 offset:2048
    ds_read_b128 v[204:207], v225 offset:3072
    ds_read_b128 v[208:211], v225 offset:4096
    ds_read_b128 v[212:215], v225 offset:5120
    ds_read_b128 v[216:219], v225 offset:6144
    ds_read_b128 v[220:223], v225 offset:7168
    s_cmp_lt_u32 s58, s32
    s_cselect_b32 s47, s57, 0x7ff00000
    s_add_u32 m0, s59, s33
    s_nop 0
    buffer_load_dwordx4 v224, s[16:19], s47 offen offset:0 lds
    s_add_u32 s57, s57, 16384
    buffer_load_dwordx4 v224, s[16:19], s47 offen offset:1024 lds
    s_add_u32 s58, s58, 1
    buffer_load_dwordx4 v224, s[16:19], s47 offen offset:2048 lds
    s_add_u32 s59, s59, 32768
    buffer_load_dwordx4 v224, s[16:19], s47 offen offset:3072 lds
    s_and_b32 s59, s59, 98304
    s_branch k2_kernel_epi
k2_kernel_Geven:
    ds_read_b128 v[96:99], v225 offset:24576
    ds_read_b128 v[100:103], v225 offset:25600
    ds_read_b128 v[104:107], v225 offset:26624
    ds_read_b128 v[108:111], v225 offset:27648
    ds_read_b128 v[112:115], v225 offset:28672
    ds_read_b128 v[116:119], v225 offset:29696
    ds_read_b128 v[120:123], v225 offset:30720
    ds_read_b128 v[124:127], v225 offset:31744
    ds_read_b32 v240, v239
    s_waitcnt lgkmcnt(7)
    v_mfma_f32_16x16x32_bf16 v[128:131], v[96:99], v[72:75], v[128:131]
    v_exp_f32 v32, v32
    v_exp_f32 v33, v33
    v_mfma_f32_16x16x32_bf16 v[160:163], v[96:99], v[76:79], v[160:163]
    v_mfma_f32_16x16x32_bf16 v[132:135], v[100:103], v[72:75], v[132:135]
    v_exp_f32 v34, v34
    v_exp_f32 v35, v35
    v_mfma_f32_16x16x32_bf16 v[164:167], v[100:103], v[76:79], v[164:167]
    v_cvt_pk_bf16_f32 v64, v32, v33
    v_mfma_f32_16x16x32_bf16 v[248:251], v[244:247], v[72:75], v[248:251]
    s_waitcnt lgkmcnt(5)
    v_mfma_f32_16x16x32_bf16 v[136:139], v[104:107], v[72:75], v[136:139]
    v_exp_f32 v36, v36
    v_exp_f32 v37, v37
    v_mfma_f32_16x16x32_bf16 v[168:171], v[104:107], v[76:79], v[168:171]
    v_cvt_pk_bf16_f32 v65, v34, v35
    v_mfma_f32_16x16x32_bf16 v[140:143], v[108:111], v[72:75], v[140:143]
    v_exp_f32 v38, v38
    v_exp_f32 v39, v39
    v_mfma_f32_16x16x32_bf16 v[172:175], v[108:111], v[76:79], v[172:175]
    v_cvt_pk_bf16_f32 v66, v36, v37
    s_waitcnt lgkmcnt(3)
    v_mfma_f32_16x16x32_bf16 v[144:147], v[112:115], v[72:75], v[144:147]
    v_exp_f32 v40, v40
    v_exp_f32 v41, v41
    v_mfma_f32_16x16x32_bf16 v[176:179], v[112:115], v[76:79], v[176:179]
    v_cvt_pk_bf16_f32 v67, v38, v39
    v_mfma_f32_16x16x32_bf16 v[148:151], v[116:119], v[72:75], v[148:151]
    v_exp_f32 v42, v42
    v_exp_f32 v43, v43
    v_mfma_f32_16x16x32_bf16 v[180:183], v[116:119], v[76:79], v[180:183]
    v_cvt_pk_bf16_f32 v68, v40, v41
    v_mfma_f32_16x16x32_bf16 v[252:255], v[244:247], v[76:79], v[252:255]
    s_waitcnt lgkmcnt(1)
    v_mfma_f32_16x16x32_bf16 v[152:155], v[120:123], v[72:75], v[152:155]
    v_exp_f32 v44, v44
    v_exp_f32 v45, v45
    v_mfma_f32_16x16x32_bf16 v[184:187], v[120:123], v[76:79], v[184:187]
    v_cvt_pk_bf16_f32 v69, v42, v43
    v_mfma_f32_16x16x32_bf16 v[156:159], v[124:127], v[72:75], v[156:159]
    v_exp_f32 v46, v46
    v_exp_f32 v47, v47
    v_mfma_f32_16x16x32_bf16 v[188:191], v[124:127], v[76:79], v[188:191]
    v_cvt_pk_bf16_f32 v70, v44, v45
    v_cvt_pk_bf16_f32 v71, v46, v47
    s_waitcnt lgkmcnt(0)
    v_cmp_gt_i32 vcc, s28, v240
    s_cbranch_vccnz k2_kernel_spin_22
k2_kernel_back_23:
    s_add_u32 s28, s28, 1
    s_add_u32 s34, s34, 32768
    s_and_b32 s34, s34, 98304
    v_add_u32 v225, s34, v236
    ds_read_b128 v[192:195], v225 offset:0
    ds_read_b128 v[196:199], v225 offset:1024
    ds_read_b128 v[200:203], v225 offset:2048
    ds_read_b128 v[204:207], v225 offset:3072
    ds_read_b128 v[208:211], v225 offset:4096
    ds_read_b128 v[212:215], v225 offset:5120
    ds_read_b128 v[216:219], v225 offset:6144
    ds_read_b128 v[220:223], v225 offset:7168
    s_cmp_lt_u32 s58, s32
    s_cselect_b32 s47, s57, 0x7ff00000
    s_add_u32 m0, s59, s33
    s_nop 0
    buffer_load_dwordx4 v224, s[16:19], s47 offen offset:0 lds
    s_add_u32 s57, s57, 16384
    buffer_load_dwordx4 v224, s[16:19], s47 offen offset:1024 lds
    s_add_u32 s58, s58, 1
    buffer_load_dwordx4 v224, s[16:19], s47 offen offset:2048 lds
    s_add_u32 s59, s59, 32768
    buffer_load_dwordx4 v224, s[16:19], s47 offen offset:3072 lds
    s_and_b32 s59, s59, 98304
k2_kernel_Hodd:
    ds_read_b128 v[96:99], v225 offset:16384
    ds_read_b128 v[100:103], v225 offset:17408
    ds_read_b128 v[104:107], v225 offset:18432
    ds_read_b128 v[108:111], v225 offset:19456
    ds_read_b128 v[112:115], v225 offset:20480
    ds_read_b128 v[116:119], v225 offset:21504
    ds_read_b128 v[120:123], v225 offset:22528
    ds_read_b128 v[124:127], v225 offset:23552
    s_waitcnt vmcnt(4)
    v_mov_b32 v241, s28
    ds_write_b32 v237, v241
    s_waitcnt lgkmcnt(7)
    v_mfma_f32_16x16x32_bf16 v[128:131], v[96:99], v[64:67], v[128:131]
    v_mfma_f32_16x16x32_bf16 v[160:163], v[96:99], v[68:71], v[160:163]
    v_mfma_f32_16x16x32_bf16 v[132:135], v[100:103], v[64:67], v[132:135]
    v_mfma_f32_16x16x32_bf16 v[164:167], v[100:103], v[68:71], v[164:167]
    v_mfma_f32_16x16x32_bf16 v[248:251], v[244:247], v[64:67], v[248:251]
    s_waitcnt lgkmcnt(5)
    v_mfma_f32_16x16x32_bf16 v[136:139], v[104:107], v[64:67], v[136:139]
    v_mfma_f32_16x16x32_bf16 v[168:171], v[104:107], v[68:71], v[168:171]
    v_mfma_f32_16x16x32_bf16 v[140:143], v[108:111], v[64:67], v[140:143]
    v_mfma_f32_16x16x32_bf16 v[172:175], v[108:111], v[68:71], v[172:175]
    s_waitcnt lgkmcnt(3)
    v_mfma_f32_16x16x32_bf16 v[144:147], v[112:115], v[64:67], v[144:147]
    v_mfma_f32_16x16x32_bf16 v[176:179], v[112:115], v[68:71], v[176:179]
    v_mfma_f32_16x16x32_bf16 v[148:151], v[116:119], v[64:67], v[148:151]
    v_mfma_f32_16x16x32_bf16 v[180:183], v[116:119], v[68:71], v[180:183]
    v_mfma_f32_16x16x32_bf16 v[252:255], v[244:247], v[68:71], v[252:255]
    s_waitcnt lgkmcnt(1)
    v_mfma_f32_16x16x32_bf16 v[152:155], v[120:123], v[64:67], v[152:155]
    v_mfma_f32_16x16x32_bf16 v[184:187], v[120:123], v[68:71], v[184:187]
    v_mfma_f32_16x16x32_bf16 v[156:159], v[124:127], v[64:67], v[156:159]
    v_mfma_f32_16x16x32_bf16 v[188:191], v[124:127], v[68:71], v[188:191]
    ds_read_b128 v[192:195], v225 offset:8192
    ds_read_b128 v[196:199], v225 offset:9216
    ds_read_b128 v[200:203], v225 offset:10240
    ds_read_b128 v[204:207], v225 offset:11264
    ds_read_b128 v[208:211], v225 offset:12288
    ds_read_b128 v[212:215], v225 offset:13312
    ds_read_b128 v[216:219], v225 offset:14336
    ds_read_b128 v[220:223], v225 offset:15360
    ds_read_b32 v240, v239
    s_waitcnt lgkmcnt(0)
    v_cmp_gt_i32 vcc, s28, v240
    s_cbranch_vccnz k2_kernel_spin_24
k2_kernel_back_25:
    s_add_u32 s28, s28, 1
    s_cmp_lt_u32 s58, s32
    s_cselect_b32 s47, s57, 0x7ff00000
    s_add_u32 m0, s59, s33
    s_nop 0
    buffer_load_dwordx4 v224, s[16:19], s47 offen offset:0 lds
    s_add_u32 s57, s57, 16384
    buffer_load_dwordx4 v224, s[16:19], s47 offen offset:1024 lds
    s_add_u32 s58, s58, 1
    buffer_load_dwordx4 v224, s[16:19], s47 offen offset:2048 lds
    s_add_u32 s59, s59, 32768
    buffer_load_dwordx4 v224, s[16:19], s47 offen offset:3072 lds
    s_and_b32 s59, s59, 98304
k2_kernel_epi:
    s_cmp_eq_u32 s23, 2
    s_cbranch_scc1 k2_kernel_nopub_26
    s_waitcnt vmcnt(4)
    v_mov_b32 v241, s28
    ds_write_b32 v237, v241
k2_kernel_nopub_26:
    v_mov_b32 v233, 0x5d800000
    v_cmp_nlt_f32 s[48:49], v248, v233
    v_cmp_nlt_f32 s[50:51], v252, v233
    s_or_b64 s[48:49], s[48:49], s[50:51]
    s_cmp_lg_u64 s[48:49], 0
    s_cbranch_scc1 k2_kernel_slowinit
k2_kernel_store:
    s_waitcnt lgkmcnt(0)
    v_rcp_f32 v229, v248
    v_rcp_f32 v230, v252
    v_mul_f32 v128, v229, v128
    v_mul_f32 v129, v229, v129
    v_mul_f32 v130, v229, v130
    v_mul_f32 v131, v229, v131
    v_mul_f32 v132, v229, v132
    v_mul_f32 v133, v229, v133
    v_mul_f32 v134, v229, v134
    v_mul_f32 v135, v229, v135
    v_mul_f32 v136, v229, v136
    v_mul_f32 v137, v229, v137
    v_mul_f32 v138, v229, v138
    v_mul_f32 v139, v229, v139
    v_mul_f32 v140, v229, v140
    v_mul_f32 v141, v229, v141
    v_mul_f32 v142, v229, v142
    v_mul_f32 v143, v229, v143
    v_mul_f32 v144, v229, v144
    v_mul_f32 v145, v229, v145
    v_mul_f32 v146, v229, v146
    v_mul_f32 v147, v229, v147
    v_mul_f32 v148, v229, v148
    v_mul_f32 v149, v229, v149
    v_mul_f32 v150, v229, v150
    v_mul_f32 v151, v229, v151
    v_mul_f32 v152, v229, v152
    v_mul_f32 v153, v229, v153
    v_mul_f32 v154, v229, v154
    v_mul_f32 v155, v229, v155
    v_mul_f32 v156, v229, v156
    v_mul_f32 v157, v229, v157
    v_mul_f32 v158, v229, v158
    v_mul_f32 v159, v229, v159
    v_cvt_pk_bf16_f32 v32, v128, v129
    v_cvt_pk_bf16_f32 v33, v130, v131
    v_cvt_pk_bf16_f32 v34, v132, v133
    v_cvt_pk_bf16_f32 v35, v134, v135
    v_cvt_pk_bf16_f32 v36, v136, v137
    v_cvt_pk_bf16_f32 v37, v138, v139
    v_cvt_pk_bf16_f32 v38, v140, v141
    v_cvt_pk_bf16_f32 v39, v142, v143
    v_cvt_pk_bf16_f32 v40, v144, v145
    v_cvt_pk_bf16_f32 v41, v146, v147
    v_cvt_pk_bf16_f32 v42, v148, v149
    v_cvt_pk_bf16_f32 v43, v150, v151
    v_cvt_pk_bf16_f32 v44, v152, v153
    v_cvt_pk_bf16_f32 v45, v154, v155
    v_cvt_pk_bf16_f32 v46, v156, v157
    v_cvt_pk_bf16_f32 v47, v158, v159
    s_add_u32 s48, s37, 0
    buffer_store_dwordx4 v[32:35], v224, s[16:19], s48 offen offset:0 sc1
    s_add_u32 s48, s37, 131072
    buffer_store_dwordx4 v[36:39], v224, s[16:19], s48 offen offset:0 sc1
    s_add_u32 s48, s37, 262144
    buffer_store_dwordx4 v[40:43], v224, s[16:19], s48 offen offset:0 sc1
    s_add_u32 s48, s37, 393216
    buffer_store_dwordx4 v[44:47], v224, s[16:19], s48 offen offset:0 sc1
    v_mul_f32 v160, v230, v160
    v_mul_f32 v161, v230, v161
    v_mul_f32 v162, v230, v162
    v_mul_f32 v163, v230, v163
    v_mul_f32 v164, v230, v164
    v_mul_f32 v165, v230, v165
    v_mul_f32 v166, v230, v166
    v_mul_f32 v167, v230, v167
    v_mul_f32 v168, v230, v168
    v_mul_f32 v169, v230, v169
    v_mul_f32 v170, v230, v170
    v_mul_f32 v171, v230, v171
    v_mul_f32 v172, v230, v172
    v_mul_f32 v173, v230, v173
    v_mul_f32 v174, v230, v174
    v_mul_f32 v175, v230, v175
    v_mul_f32 v176, v230, v176
    v_mul_f32 v177, v230, v177
    v_mul_f32 v178, v230, v178
    v_mul_f32 v179, v230, v179
    v_mul_f32 v180, v230, v180
    v_mul_f32 v181, v230, v181
    v_mul_f32 v182, v230, v182
    v_mul_f32 v183, v230, v183
    v_mul_f32 v184, v230, v184
    v_mul_f32 v185, v230, v185
    v_mul_f32 v186, v230, v186
    v_mul_f32 v187, v230, v187
    v_mul_f32 v188, v230, v188
    v_mul_f32 v189, v230, v189
    v_mul_f32 v190, v230, v190
    v_mul_f32 v191, v230, v191
    v_cvt_pk_bf16_f32 v48, v160, v161
    v_cvt_pk_bf16_f32 v49, v162, v163
    v_cvt_pk_bf16_f32 v50, v164, v165
    v_cvt_pk_bf16_f32 v51, v166, v167
    v_cvt_pk_bf16_f32 v52, v168, v169
    v_cvt_pk_bf16_f32 v53, v170, v171
    v_cvt_pk_bf16_f32 v54, v172, v173
    v_cvt_pk_bf16_f32 v55, v174, v175
    v_cvt_pk_bf16_f32 v56, v176, v177
    v_cvt_pk_bf16_f32 v57, v178, v179
    v_cvt_pk_bf16_f32 v58, v180, v181
    v_cvt_pk_bf16_f32 v59, v182, v183
    v_cvt_pk_bf16_f32 v60, v184, v185
    v_cvt_pk_bf16_f32 v61, v186, v187
    v_cvt_pk_bf16_f32 v62, v188, v189
    v_cvt_pk_bf16_f32 v63, v190, v191
    s_add_u32 s48, s37, 0
    buffer_store_dwordx4 v[48:51], v224, s[16:19], s48 offen offset:1024 sc1
    s_add_u32 s48, s37, 131072
    buffer_store_dwordx4 v[52:55], v224, s[16:19], s48 offen offset:1024 sc1
    s_add_u32 s48, s37, 262144
    buffer_store_dwordx4 v[56:59], v224, s[16:19], s48 offen offset:1024 sc1
    s_add_u32 s48, s37, 393216
    buffer_store_dwordx4 v[60:63], v224, s[16:19], s48 offen offset:1024 sc1
    s_cmp_eq_u32 s23, 2
    s_cbranch_scc1 k2_kernel_out
k2_kernel_idle:
    s_cmp_eq_u32 s60, 0
    s_cbranch_scc1 k2_kernel_nohelp_27
    s_cmp_eq_u32 s28, s22
    s_cbranch_scc1 k2_kernel_helper
k2_kernel_nohelp_27:
    s_add_u32 s42, s28, 3
    s_cmp_gt_u32 s42, s29
    s_cbranch_scc1 k2_kernel_fin
    s_waitcnt vmcnt(4)
    v_mov_b32 v241, s28
    ds_write_b32 v237, v241
    ds_read_b32 v240, v239
    s_waitcnt lgkmcnt(0)
    v_cmp_gt_i32 vcc, s28, v240
    s_cbranch_vccnz k2_kernel_spin_28
k2_kernel_back_29:
    s_add_u32 s28, s28, 1
    s_cmp_eq_u32 s22, 8
    s_cbranch_scc1 k2_kernel_fast_30
    s_cmp_lt_u32 s58, s32
    s_cselect_b32 s47, s57, 0x7ff00000
    s_add_u32 m0, s59, s33
    s_nop 0
    buffer_load_dwordx4 v224, s[16:19], s47 offen offset:0 lds
    s_add_u32 s57, s57, 16384
    s_waitcnt vmcnt(1)
    buffer_load_dwordx4 v224, s[16:19], s47 offen offset:1024 lds
    s_add_u32 s58, s58, 1
    s_waitcnt vmcnt(1)
    buffer_load_dwordx4 v224, s[16:19], s47 offen offset:2048 lds
    s_add_u32 s59, s59, 32768
    s_waitcnt vmcnt(1)
    buffer_load_dwordx4 v224, s[16:19], s47 offen offset:3072 lds
    s_and_b32 s59, s59, 98304
    s_branch k2_kernel_idle
k2_kernel_fast_30:
    s_cmp_lt_u32 s58, s32
    s_cselect_b32 s47, s57, 0x7ff00000
    s_add_u32 m0, s59, s33
    s_nop 0
    buffer_load_dwordx4 v224, s[16:19], s47 offen offset:0 lds
    s_add_u32 s57, s57, 16384
    buffer_load_dwordx4 v224, s[16:19], s47 offen offset:1024 lds
    s_add_u32 s58, s58, 1
    buffer_load_dwordx4 v224, s[16:19], s47 offen offset:2048 lds
    s_add_u32 s59, s59, 32768
    buffer_load_dwordx4 v224, s[16:19], s47 offen offset:3072 lds
    s_and_b32 s59, s59, 98304
    s_branch k2_kernel_idle
k2_kernel_helper:
    s_waitcnt vmcnt(4)
    v_mov_b32 v241, s28
    ds_write_b32 v237, v241
    s_add_u32 s48, s62, 0
    buffer_load_dwordx4 v[0:3], v224, s[16:19], s48 offen offset:0 sc1
    buffer_load_dwordx4 v[4:7], v224, s[16:19], s48 offen offset:1024 sc1
    buffer_load_dwordx4 v[8:11], v224, s[16:19], s48 offen offset:2048 sc1
    buffer_load_dwordx4 v[12:15], v224, s[16:19], s48 offen offset:3072 sc1
    s_add_u32 s48, s62, 4096
    buffer_load_dwordx4 v[16:19], v224, s[16:19], s48 offen offset:0 sc1
    buffer_load_dwordx4 v[20:23], v224, s[16:19], s48 offen offset:1024 sc1
    buffer_load_dwordx4 v[24:27], v224, s[16:19], s48 offen offset:2048 sc1
    buffer_load_dwordx4 v[28:31], v224, s[16:19], s48 offen offset:3072 sc1
    s_add_u32 s48, s62, 8192
    buffer_load_dwordx2 v[242:243], v224, s[16:19], s48 offen sc1
    v_mov_b32 v128, 0
    v_mov_b32 v129, 0
    v_mov_b32 v130, 0
    v_mov_b32 v131, 0
    v_mov_b32 v132, 0
    v_mov_b32 v133, 0
    v_mov_b32 v134, 0
    v_mov_b32 v135, 0
    v_mov_b32 v136, 0
    v_mov_b32 v137, 0
    v_mov_b32 v138, 0
    v_mov_b32 v139, 0
    v_mov_b32 v140, 0
    v_mov_b32 v141, 0
    v_mov_b32 v142, 0
    v_mov_b32 v143, 0
    v_mov_b32 v144, 0
    v_mov_b32 v145, 0
    v_mov_b32 v146, 0
    v_mov_b32 v147, 0
    v_mov_b32 v148, 0
    v_mov_b32 v149, 0
    v_mov_b32 v150, 0
    v_mov_b32 v151, 0
    v_mov_b32 v152, 0
    v_mov_b32 v153, 0
    v_mov_b32 v154, 0
    v_mov_b32 v155, 0
    v_mov_b32 v156, 0
    v_mov_b32 v157, 0
    v_mov_b32 v158, 0
    v_mov_b32 v159, 0
    v_mov_b32 v160, 0
    v_mov_b32 v161, 0
    v_mov_b32 v162, 0
    v_mov_b32 v163, 0
    v_mov_b32 v164, 0
    v_mov_b32 v165, 0
    v_mov_b32 v166, 0
    v_mov_b32 v167, 0
    v_mov_b32 v168, 0
    v_mov_b32 v169, 0
    v_mov_b32 v170, 0
    v_mov_b32 v171, 0
    v_mov_b32 v172, 0
    v_mov_b32 v173, 0
    v_mov_b32 v174, 0
    v_mov_b32 v175, 0
    v_mov_b32 v176, 0
    v_mov_b32 v177, 0
    v_mov_b32 v178, 0
    v_mov_b32 v179, 0
    v_mov_b32 v180, 0
    v_mov_b32 v181, 0
    v_mov_b32 v182, 0
    v_mov_b32 v183, 0
    v_mov_b32 v184, 0
    v_mov_b32 v185, 0
    v_mov_b32 v186, 0
    v_mov_b32 v187, 0
    v_mov_b32 v188, 0
    v_mov_b32 v189, 0
    v_mov_b32 v190, 0
    v_mov_b32 v191, 0
    v_mov_b32 v248, 0
    v_mov_b32 v249, 0
    v_mov_b32 v250, 0
    v_mov_b32 v251, 0
    v_mov_b32 v252, 0
    v_mov_b32 v253, 0
    v_mov_b32 v254, 0
    v_mov_b32 v255, 0
    v_add_u32 v236, 8192, v224
    s_and_b32 s34, s28, 3
    s_lshl_b32 s34, s34, 15
    v_add_u32 v225, s34, v236
    ds_read_b128 v[192:195], v225 offset:0
    ds_read_b128 v[196:199], v225 offset:1024
    ds_read_b128 v[200:203], v225 offset:2048
    ds_read_b128 v[204:207], v225 offset:3072
    ds_read_b128 v[208:211], v225 offset:4096
    ds_read_b128 v[212:215], v225 offset:5120
    ds_read_b128 v[216:219], v225 offset:6144
    ds_read_b128 v[220:223], v225 offset:7168
    s_waitcnt vmcnt(0)
    v_sub_f32 v80, 0, v242
    v_sub_f32 v81, 0, v242
    v_sub_f32 v82, 0, v242
    v_sub_f32 v83, 0, v242
    v_sub_f32 v84, 0, v242
    v_sub_f32 v85, 0, v242
    v_sub_f32 v86, 0, v242
    v_sub_f32 v87, 0, v242
    v_sub_f32 v88, 0, v243
    v_sub_f32 v89, 0, v243
    v_sub_f32 v90, 0, v243
    v_sub_f32 v91, 0, v243
    v_sub_f32 v92, 0, v243
    v_sub_f32 v93, 0, v243
    v_sub_f32 v94, 0, v243
    v_sub_f32 v95, 0, v243
    s_waitcnt vmcnt(0)
    s_waitcnt vmcnt(4)
    v_mov_b32 v241, s28
    ds_write_b32 v237, v241
    ds_read_b32 v240, v239
    s_waitcnt lgkmcnt(8)
    v_mfma_f32_16x16x32_bf16 v[32:35], v[192:195], v[0:3], v[80:83]
    v_mfma_f32_16x16x32_bf16 v[40:43], v[192:195], v[16:19], v[88:91]
    v_mfma_f32_16x16x32_bf16 v[36:39], v[196:199], v[0:3], v[84:87]
    v_mfma_f32_16x16x32_bf16 v[44:47], v[196:199], v[16:19], v[92:95]
    s_waitcnt lgkmcnt(6)
    v_mfma_f32_16x16x32_bf16 v[32:35], v[200:203], v[4:7], v[32:35]
    v_mfma_f32_16x16x32_bf16 v[40:43], v[200:203], v[20:23], v[40:43]
    v_mfma_f32_16x16x32_bf16 v[36:39], v[204:207], v[4:7], v[36:39]
    v_mfma_f32_16x16x32_bf16 v[44:47], v[204:207], v[20:23], v[44:47]
    s_waitcnt lgkmcnt(4)
    v_mfma_f32_16x16x32_bf16 v[32:35], v[208:211], v[8:11], v[32:35]
    v_mfma_f32_16x16x32_bf16 v[40:43], v[208:211], v[24:27], v[40:43]
    v_mfma_f32_16x16x32_bf16 v[36:39], v[212:215], v[8:11], v[36:39]
    v_mfma_f32_16x16x32_bf16 v[44:47], v[212:215], v[24:27], v[44:47]
    s_waitcnt lgkmcnt(2)
    v_mfma_f32_16x16x32_bf16 v[32:35], v[216:219], v[12:15], v[32:35]
    v_mfma_f32_16x16x32_bf16 v[40:43], v[216:219], v[28:31], v[40:43]
    v_mfma_f32_16x16x32_bf16 v[36:39], v[220:223], v[12:15], v[36:39]
    v_mfma_f32_16x16x32_bf16 v[44:47], v[220:223], v[28:31], v[44:47]
    s_waitcnt lgkmcnt(0)
    v_cmp_gt_i32 vcc, s28, v240
    s_cbranch_vccnz k2_kernel_spin_31
k2_kernel_back_32:
    s_add_u32 s28, s28, 1
    s_add_u32 s34, s34, 32768
    s_and_b32 s34, s34, 98304
    v_add_u32 v225, s34, v236
    ds_read_b128 v[192:195], v225 offset:0
    ds_read_b128 v[196:199], v225 offset:1024
    ds_read_b128 v[200:203], v225 offset:2048
    ds_read_b128 v[204:207], v225 offset:3072
    ds_read_b128 v[208:211], v225 offset:4096
    ds_read_b128 v[212:215], v225 offset:5120
    ds_read_b128 v[216:219], v225 offset:6144
    ds_read_b128 v[220:223], v225 offset:7168
    s_cmp_lt_u32 s58, s32
    s_cselect_b32 s47, s57, 0x7ff00000
    s_add_u32 m0, s59, s33
    s_nop 0
    buffer_load_dwordx4 v224, s[16:19], s47 offen offset:0 lds
    s_add_u32 s57, s57, 16384
    buffer_load_dwordx4 v224, s[16:19], s47 offen offset:1024 lds
    s_add_u32 s58, s58, 1
    buffer_load_dwordx4 v224, s[16:19], s47 offen offset:2048 lds
    s_add_u32 s59, s59, 32768
    buffer_load_dwordx4 v224, s[16:19], s47 offen offset:3072 lds
    s_and_b32 s59, s59, 98304
    s_sub_u32 s42, s61, 2
    s_lshr_b32 s42, s42, 1
    s_and_b32 s63, s61, 1
    s_xor_b32 s63, s63, 1
    s_branch k2_kernel_sstart
k2_kernel_trans:
    s_waitcnt lgkmcnt(6)
    v_mfma_f32_16x16x32_bf16 v[32:35], v[192:195], v[0:3], v[80:83]
    v_exp_f32 v48, v48
    v_mfma_f32_16x16x32_bf16 v[40:43], v[192:195], v[16:19], v[88:91]
    ds_read_b128 v[96:99], v225 offset:16384
    v_mfma_f32_16x16x32_bf16 v[36:39], v[196:199], v[0:3], v[84:87]
    v_exp_f32 v49, v49
    v_mfma_f32_16x16x32_bf16 v[44:47], v[196:199], v[16:19], v[92:95]
    ds_read_b128 v[100:103], v225 offset:17408
    s_waitcnt lgkmcnt(6)
    v_mfma_f32_16x16x32_bf16 v[32:35], v[200:203], v[4:7], v[32:35]
    v_exp_f32 v50, v50
    v_mfma_f32_16x16x32_bf16 v[40:43], v[200:203], v[20:23], v[40:43]
    ds_read_b128 v[104:107], v225 offset:18432
    s_waitcnt vmcnt(4)
    v_mov_b32 v241, s28
    ds_write_b32 v237, v241
    v_cvt_pk_bf16_f32 v72, v48, v49
    v_mfma_f32_16x16x32_bf16 v[36:39], v[204:207], v[4:7], v[36:39]
    v_exp_f32 v51, v51
    v_mfma_f32_16x16x32_bf16 v[44:47], v[204:207], v[20:23], v[44:47]
    ds_read_b128 v[108:111], v225 offset:19456
    s_waitcnt lgkmcnt(7)
    v_mfma_f32_16x16x32_bf16 v[32:35], v[208:211], v[8:11], v[32:35]
    v_exp_f32 v52, v52
    v_mfma_f32_16x16x32_bf16 v[40:43], v[208:211], v[24:27], v[40:43]
    ds_read_b128 v[112:115], v225 offset:20480
    v_cvt_pk_bf16_f32 v73, v50, v51
    v_mfma_f32_16x16x32_bf16 v[36:39], v[212:215], v[8:11], v[36:39]
    v_exp_f32 v53, v53
    v_mfma_f32_16x16x32_bf16 v[44:47], v[212:215], v[24:27], v[44:47]
    ds_read_b128 v[116:119], v225 offset:21504
    s_waitcnt lgkmcnt(7)
    v_mfma_f32_16x16x32_bf16 v[32:35], v[216:219], v[12:15], v[32:35]
    v_exp_f32 v54, v54
    v_mfma_f32_16x16x32_bf16 v[40:43], v[216:219], v[28:31], v[40:43]
    ds_read_b128 v[120:123], v225 offset:22528
    v_cvt_pk_bf16_f32 v74, v52, v53
    v_mfma_f32_16x16x32_bf16 v[36:39], v[220:223], v[12:15], v[36:39]
    v_exp_f32 v55, v55
    v_mfma_f32_16x16x32_bf16 v[44:47], v[220:223], v[28:31], v[44:47]
    ds_read_b128 v[124:127], v225 offset:23552
    s_waitcnt lgkmcnt(7)
    v_mfma_f32_16x16x32_bf16 v[128:131], v[96:99], v[64:67], v[128:131]
    v_exp_f32 v56, v56
    v_mfma_f32_16x16x32_bf16 v[160:163], v[96:99], v[68:71], v[160:163]
    ds_read_b128 v[192:195], v225 offset:8192
    v_cvt_pk_bf16_f32 v75, v54, v55
    v_mfma_f32_16x16x32_bf16 v[132:135], v[100:103], v[64:67], v[132:135]
    v_exp_f32 v57, v57
    v_mfma_f32_16x16x32_bf16 v[164:167], v[100:103], v[68:71], v[164:167]
    ds_read_b128 v[196:199], v225 offset:9216
    v_mfma_f32_16x16x32_bf16 v[248:251], v[244:247], v[64:67], v[248:251]
    s_waitcnt lgkmcnt(6)
    v_mfma_f32_16x16x32_bf16 v[136:139], v[104:107], v[64:67], v[136:139]
    v_exp_f32 v58, v58
    v_mfma_f32_16x16x32_bf16 v[168:171], v[104:107], v[68:71], v[168:171]
    ds_read_b128 v[200:203], v225 offset:10240
    v_cvt_pk_bf16_f32 v76, v56, v57
    v_mfma_f32_16x16x32_bf16 v[140:143], v[108:111], v[64:67], v[140:143]
    v_exp_f32 v59, v59
    v_mfma_f32_16x16x32_bf16 v[172:175], v[108:111], v[68:71], v[172:175]
    ds_read_b128 v[204:207], v225 offset:11264
    s_waitcnt lgkmcnt(6)
    v_mfma_f32_16x16x32_bf16 v[144:147], v[112:115], v[64:67], v[144:147]
    v_exp_f32 v60, v60
    v_mfma_f32_16x16x32_bf16 v[176:179], v[112:115], v[68:71], v[176:179]
    ds_read_b128 v[208:211], v225 offset:12288
    v_cvt_pk_bf16_f32 v77, v58, v59
    v_mfma_f32_16x16x32_bf16 v[148:151], v[116:119], v[64:67], v[148:151]
    v_exp_f32 v61, v61
    v_mfma_f32_16x16x32_bf16 v[180:183], v[116:119], v[68:71], v[180:183]
    ds_read_b128 v[212:215], v225 offset:13312
    v_mfma_f32_16x16x32_bf16 v[252:255], v[244:247], v[68:71], v[252:255]
    s_waitcnt lgkmcnt(6)
    v_mfma_f32_16x16x32_bf16 v[152:155], v[120:123], v[64:67], v[152:155]
    v_exp_f32 v62, v62
    v_mfma_f32_16x16x32_bf16 v[184:187], v[120:123], v[68:71], v[184:187]
    ds_read_b128 v[216:219], v225 offset:14336
    v_cvt_pk_bf16_f32 v78, v60, v61
    v_mfma_f32_16x16x32_bf16 v[156:159], v[124:127], v[64:67], v[156:159]
    v_exp_f32 v63, v63
    v_mfma_f32_16x16x32_bf16 v[188:191], v[124:127], v[68:71], v[188:191]
    ds_read_b128 v[220:223], v225 offset:15360
    v_cvt_pk_bf16_f32 v79, v62, v63
    ds_read_b128 v[96:99], v225 offset:24576
    ds_read_b128 v[100:103], v225 offset:25600
    ds_read_b128 v[104:107], v225 offset:26624
    ds_read_b128 v[108:111], v225 offset:27648
    ds_read_b128 v[112:115], v225 offset:28672
    ds_read_b128 v[116:119], v225 offset:29696
    ds_read_b128 v[120:123], v225 offset:30720
    ds_read_b128 v[124:127], v225 offset:31744
    ds_read_b32 v240, v239
    s_waitcnt lgkmcnt(7)
    v_mfma_f32_16x16x32_bf16 v[128:131], v[96:99], v[72:75], v[128:131]
    v_mfma_f32_16x16x32_bf16 v[160:163], v[96:99], v[76:79], v[160:163]
    v_mfma_f32_16x16x32_bf16 v[132:135], v[100:103], v[72:75], v[132:135]
    v_mfma_f32_16x16x32_bf16 v[164:167], v[100:103], v[76:79], v[164:167]
    v_mfma_f32_16x16x32_bf16 v[248:251], v[244:247], v[72:75], v[248:251]
    s_waitcnt lgkmcnt(5)
    v_mfma_f32_16x16x32_bf16 v[136:139], v[104:107], v[72:75], v[136:139]
    v_mfma_f32_16x16x32_bf16 v[168:171], v[104:107], v[76:79], v[168:171]
    v_mfma_f32_16x16x32_bf16 v[140:143], v[108:111], v[72:75], v[140:143]
    v_mfma_f32_16x16x32_bf16 v[172:175], v[108:111], v[76:79], v[172:175]
    s_waitcnt lgkmcnt(3)
    v_mfma_f32_16x16x32_bf16 v[144:147], v[112:115], v[72:75], v[144:147]
    v_mfma_f32_16x16x32_bf16 v[176:179], v[112:115], v[76:79], v[176:179]
    v_mfma_f32_16x16x32_bf16 v[148:151], v[116:119], v[72:75], v[148:151]
    v_mfma_f32_16x16x32_bf16 v[180:183], v[116:119], v[76:79], v[180:183]
    v_mfma_f32_16x16x32_bf16 v[252:255], v[244:247], v[76:79], v[252:255]
    s_waitcnt lgkmcnt(1)
    v_mfma_f32_16x16x32_bf16 v[152:155], v[120:123], v[72:75], v[152:155]
    v_mfma_f32_16x16x32_bf16 v[184:187], v[120:123], v[76:79], v[184:187]
    v_mfma_f32_16x16x32_bf16 v[156:159], v[124:127], v[72:75], v[156:159]
    v_mfma_f32_16x16x32_bf16 v[188:191], v[124:127], v[76:79], v[188:191]
    s_waitcnt lgkmcnt(0)
    v_cmp_gt_i32 vcc, s28, v240
    s_cbranch_vccnz k2_kernel_spin_33
k2_kernel_back_34:
    s_add_u32 s28, s28, 1
    s_add_u32 s34, s34, 32768
    s_and_b32 s34, s34, 98304
    v_add_u32 v225, s34, v236
    ds_read_b128 v[192:195], v225 offset:0
    ds_read_b128 v[196:199], v225 offset:1024
    ds_read_b128 v[200:203], v225 offset:2048
    ds_read_b128 v[204:207], v225 offset:3072
    ds_read_b128 v[208:211], v225 offset:4096
    ds_read_b128 v[212:215], v225 offset:5120
    ds_read_b128 v[216:219], v225 offset:6144
    ds_read_b128 v[220:223], v225 offset:7168
    s_cmp_lt_u32 s58, s32
    s_cselect_b32 s47, s57, 0x7ff00000
    s_add_u32 m0, s59, s33
    s_nop 0
    buffer_load_dwordx4 v224, s[16:19], s47 offen offset:0 lds
    s_add_u32 s57, s57, 16384
    buffer_load_dwordx4 v224, s[16:19], s47 offen offset:1024 lds
    s_add_u32 s58, s58, 1
    buffer_load_dwordx4 v224, s[16:19], s47 offen offset:2048 lds
    s_add_u32 s59, s59, 32768
    buffer_load_dwordx4 v224, s[16:19], s47 offen offset:3072 lds
    s_and_b32 s59, s59, 98304
    s_sub_u32 s42, s61, 1
    s_lshr_b32 s42, s42, 1
    s_and_b32 s63, s61, 1
k2_kernel_sstart:
    s_add_u32 s42, s42, 4
    s_sub_u32 s56, s42, s22
.p2align 6
k2_kernel_sloop:
    s_cmp_eq_u32 s56, 0
    s_cbranch_scc1 k2_kernel_sfin0
    s_cmp_eq_u32 s56, s63
    s_cbranch_scc1 k2_kernel_smask_35
k2_kernel_sback_36:
    s_sub_u32 s56, s56, 1
    s_waitcnt lgkmcnt(6)
    v_mfma_f32_16x16x32_bf16 v[48:51], v[192:195], v[0:3], v[80:83]
    v_exp_f32 v32, v32
    v_mfma_f32_16x16x32_bf16 v[56:59], v[192:195], v[16:19], v[88:91]
    ds_read_b128 v[96:99], v225 offset:16384
    s_waitcnt vmcnt(4)
    v_mov_b32 v241, s28
    ds_write_b32 v237, v241
    v_exp_f32 v33, v33
    v_mfma_f32_16x16x32_bf16 v[52:55], v[196:199], v[0:3], v[84:87]
    v_exp_f32 v34, v34
    v_mfma_f32_16x16x32_bf16 v[60:63], v[196:199], v[16:19], v[92:95]
    ds_read_b128 v[100:103], v225 offset:17408
    v_exp_f32 v35, v35
    v_cvt_pk_bf16_f32 v64, v32, v33
    s_waitcnt lgkmcnt(7)
    v_mfma_f32_16x16x32_bf16 v[48:51], v[200:203], v[4:7], v[48:51]
    v_exp_f32 v36, v36
    v_mfma_f32_16x16x32_bf16 v[56:59], v[200:203], v[20:23], v[56:59]
    ds_read_b128 v[104:107], v225 offset:18432
    v_exp_f32 v37, v37
    v_cvt_pk_bf16_f32 v65, v34, v35
    v_mfma_f32_16x16x32_bf16 v[52:55], v[204:207], v[4:7], v[52:55]
    v_exp_f32 v38, v38
    v_mfma_f32_16x16x32_bf16 v[60:63], v[204:207], v[20:23], v[60:63]
    ds_read_b128 v[108:111], v225 offset:19456
    v_exp_f32 v39, v39
    v_cvt_pk_bf16_f32 v66, v36, v37
    s_waitcnt lgkmcnt(7)
    v_mfma_f32_16x16x32_bf16 v[48:51], v[208:211], v[8:11], v[48:51]
    v_exp_f32 v40, v40
    v_mfma_f32_16x16x32_bf16 v[56:59], v[208:211], v[24:27], v[56:59]
    ds_read_b128 v[112:115], v225 offset:20480
    v_exp_f32 v41, v41
    v_cvt_pk_bf16_f32 v67, v38, v39
    v_mfma_f32_16x16x32_bf16 v[52:55], v[212:215], v[8:11], v[52:55]
    v_exp_f32 v42, v42
    v_mfma_f32_16x16x32_bf16 v[60:63], v[212:215], v[24:27], v[60:63]
    ds_read_b128 v[116:119], v225 offset:21504
    ds_read_b32 v240, v239
    v_exp_f32 v43, v43
    v_cvt_pk_bf16_f32 v68, v40, v41
    s_waitcnt lgkmcnt(8)
    v_mfma_f32_16x16x32_bf16 v[48:51], v[216:219], v[12:15], v[48:51]
    v_exp_f32 v44, v44
    v_mfma_f32_16x16x32_bf16 v[56:59], v[216:219], v[28:31], v[56:59]
    ds_read_b128 v[120:123], v225 offset:22528
    v_exp_f32 v45, v45
    v_cvt_pk_bf16_f32 v69, v42, v43
    v_mfma_f32_16x16x32_bf16 v[52:55], v[220:223], v[12:15], v[52:55]
    v_exp_f32 v46, v46
    v_mfma_f32_16x16x32_bf16 v[60:63], v[220:223], v[28:31], v[60:63]
    ds_read_b128 v[124:127], v225 offset:23552
    v_exp_f32 v47, v47
    v_cvt_pk_bf16_f32 v70, v44, v45
    v_cvt_pk_bf16_f32 v71, v46, v47
    s_waitcnt lgkmcnt(7)
    v_mfma_f32_16x16x32_bf16 v[128:131], v[96:99], v[64:67], v[128:131]
    v_mfma_f32_16x16x32_bf16 v[160:163], v[96:99], v[68:71], v[160:163]
    s_waitcnt lgkmcnt(2)
    v_cmp_gt_i32 vcc, s28, v240
    s_cbranch_vccnz k2_kernel_spin_37
k2_kernel_back_38:
    s_add_u32 s28, s28, 1
    s_add_u32 s34, s34, 32768
    s_and_b32 s34, s34, 98304
    v_add_u32 v225, s34, v236
    ds_read_b128 v[192:195], v225 offset:0
    v_mfma_f32_16x16x32_bf16 v[132:135], v[100:103], v[64:67], v[132:135]
    v_mfma_f32_16x16x32_bf16 v[164:167], v[100:103], v[68:71], v[164:167]
    ds_read_b128 v[196:199], v225 offset:1024
    s_cmp_lt_u32 s58, s32
    s_cselect_b32 s47, s57, 0x7ff00000
    s_add_u32 m0, s59, s33
    v_mfma_f32_16x16x32_bf16 v[136:139], v[104:107], v[64:67], v[136:139]
    v_mfma_f32_16x16x32_bf16 v[168:171], v[104:107], v[68:71], v[168:171]
    ds_read_b128 v[200:203], v225 offset:2048
    buffer_load_dwordx4 v224, s[16:19], s47 offen offset:0 lds
    s_add_u32 s57, s57, 16384
    v_mfma_f32_16x16x32_bf16 v[248:251], v[244:247], v[64:67], v[248:251]
    v_mfma_f32_16x16x32_bf16 v[140:143], v[108:111], v[64:67], v[140:143]
    v_mfma_f32_16x16x32_bf16 v[172:175], v[108:111], v[68:71], v[172:175]
    ds_read_b128 v[204:207], v225 offset:3072
    buffer_load_dwordx4 v224, s[16:19], s47 offen offset:1024 lds
    s_add_u32 s58, s58, 1
    v_mfma_f32_16x16x32_bf16 v[144:147], v[112:115], v[64:67], v[144:147]
    v_mfma_f32_16x16x32_bf16 v[176:179], v[112:115], v[68:71], v[176:179]
    ds_read_b128 v[208:211], v225 offset:4096
    buffer_load_dwordx4 v224, s[16:19], s47 offen offset:2048 lds
    s_add_u32 s59, s59, 32768
    v_mfma_f32_16x16x32_bf16 v[148:151], v[116:119], v[64:67], v[148:151]
    v_mfma_f32_16x16x32_bf16 v[180:183], v[116:119], v[68:71], v[180:183]
    ds_read_b128 v[212:215], v225 offset:5120
    buffer_load_dwordx4 v224, s[16:19], s47 offen offset:3072 lds
    s_and_b32 s59, s59, 98304
    v_mfma_f32_16x16x32_bf16 v[252:255], v[244:247], v[68:71], v[252:255]
    s_waitcnt lgkmcnt(6)
    v_mfma_f32_16x16x32_bf16 v[152:155], v[120:123], v[64:67], v[152:155]
    v_mfma_f32_16x16x32_bf16 v[184:187], v[120:123], v[68:71], v[184:187]
    ds_read_b128 v[216:219], v225 offset:6144
    v_mfma_f32_16x16x32_bf16 v[156:159], v[124:127], v[64:67], v[156:159]
    v_mfma_f32_16x16x32_bf16 v[188:191], v[124:127], v[68:71], v[188:191]
    ds_read_b128 v[220:223], v225 offset:7168
    s_cmp_eq_u32 s56, 0
    s_cbranch_scc1 k2_kernel_sfin1
    s_cmp_eq_u32 s56, s63
    s_cbranch_scc1 k2_kernel_smask_39
k2_kernel_sback_40:
    s_sub_u32 s56, s56, 1
    s_waitcnt lgkmcnt(6)
    v_mfma_f32_16x16x32_bf16 v[32:35], v[192:195], v[0:3], v[80:83]
    v_exp_f32 v48, v48
    v_mfma_f32_16x16x32_bf16 v[40:43], v[192:195], v[16:19], v[88:91]
    ds_read_b128 v[96:99], v225 offset:16384
    s_waitcnt vmcnt(4)
    v_mov_b32 v241, s28
    ds_write_b32 v237, v241
    v_exp_f32 v49, v49
    v_mfma_f32_16x16x32_bf16 v[36:39], v[196:199], v[0:3], v[84:87]
    v_exp_f32 v50, v50
    v_mfma_f32_16x16x32_bf16 v[44:47], v[196:199], v[16:19], v[92:95]
    ds_read_b128 v[100:103], v225 offset:17408
    v_exp_f32 v51, v51
    v_cvt_pk_bf16_f32 v64, v48, v49
    s_waitcnt lgkmcnt(7)
    v_mfma_f32_16x16x32_bf16 v[32:35], v[200:203], v[4:7], v[32:35]
    v_exp_f32 v52, v52
    v_mfma_f32_16x16x32_bf16 v[40:43], v[200:203], v[20:23], v[40:43]
    ds_read_b128 v[104:107], v225 offset:18432
    v_exp_f32 v53, v53
    v_cvt_pk_bf16_f32 v65, v50, v51
    v_mfma_f32_16x16x32_bf16 v[36:39], v[204:207], v[4:7], v[36:39]
    v_exp_f32 v54, v54
    v_mfma_f32_16x16x32_bf16 v[44:47], v[204:207], v[20:23], v[44:47]
    ds_read_b128 v[108:111], v225 offset:19456
    v_exp_f32 v55, v55
    v_cvt_pk_bf16_f32 v66, v52, v53
    s_waitcnt lgkmcnt(7)
    v_mfma_f32_16x16x32_bf16 v[32:35], v[208:211], v[8:11], v[32:35]
    v_exp_f32 v56, v56
    v_mfma_f32_16x16x32_bf16 v[40:43], v[208:211], v[24:27], v[40:43]
    ds_read_b128 v[112:115], v225 offset:20480
    v_exp_f32 v57, v57
    v_cvt_pk_bf16_f32 v67, v54, v55
    v_mfma_f32_16x16x32_bf16 v[36:39], v[212:215], v[8:11], v[36:39]
    v_exp_f32 v58, v58
    v_mfma_f32_16x16x32_bf16 v[44:47], v[212:215], v[24:27], v[44:47]
    ds_read_b128 v[116:119], v225 offset:21504
    ds_read_b32 v240, v239
    v_exp_f32 v59, v59
    v_cvt_pk_bf16_f32 v68, v56, v57
    s_waitcnt lgkmcnt(8)
    v_mfma_f32_16x16x32_bf16 v[32:35], v[216:219], v[12:15], v[32:35]
    v_exp_f32 v60, v60
    v_mfma_f32_16x16x32_bf16 v[40:43], v[216:219], v[28:31], v[40:43]
    ds_read_b128 v[120:123], v225 offset:22528
    v_exp_f32 v61, v61
    v_cvt_pk_bf16_f32 v69, v58, v59
    v_mfma_f32_16x16x32_bf16 v[36:39], v[220:223], v[12:15], v[36:39]
    v_exp_f32 v62, v62
    v_mfma_f32_16x16x32_bf16 v[44:47], v[220:223], v[28:31], v[44:47]
    ds_read_b128 v[124:127], v225 offset:23552
    v_exp_f32 v63, v63
    v_cvt_pk_bf16_f32 v70, v60, v61
    v_cvt_pk_bf16_f32 v71, v62, v63
    s_waitcnt lgkmcnt(7)
    v_mfma_f32_16x16x32_bf16 v[128:131], v[96:99], v[64:67], v[128:131]
    v_mfma_f32_16x16x32_bf16 v[160:163], v[96:99], v[68:71], v[160:163]
    s_waitcnt lgkmcnt(2)
    v_cmp_gt_i32 vcc, s28, v240
    s_cbranch_vccnz k2_kernel_spin_41
k2_kernel_back_42:
    s_add_u32 s28, s28, 1
    s_add_u32 s34, s34, 32768
    s_and_b32 s34, s34, 98304
    v_add_u32 v225, s34, v236
    ds_read_b128 v[192:195], v225 offset:0
    v_mfma_f32_16x16x32_bf16 v[132:135], v[100:103], v[64:67], v[132:135]
    v_mfma_f32_16x16x32_bf16 v[164:167], v[100:103], v[68:71], v[164:167]
    ds_read_b128 v[196:199], v225 offset:1024
    s_cmp_lt_u32 s58, s32
    s_cselect_b32 s47, s57, 0x7ff00000
    s_add_u32 m0, s59, s33
    v_mfma_f32_16x16x32_bf16 v[136:139], v[104:107], v[64:67], v[136:139]
    v_mfma_f32_16x16x32_bf16 v[168:171], v[104:107], v[68:71], v[168:171]
    ds_read_b128 v[200:203], v225 offset:2048
    buffer_load_dwordx4 v224, s[16:19], s47 offen offset:0 lds
    s_add_u32 s57, s57, 16384
    v_mfma_f32_16x16x32_bf16 v[248:251], v[244:247], v[64:67], v[248:251]
    v_mfma_f32_16x16x32_bf16 v[140:143], v[108:111], v[64:67], v[140:143]
    v_mfma_f32_16x16x32_bf16 v[172:175], v[108:111], v[68:71], v[172:175]
    ds_read_b128 v[204:207], v225 offset:3072
    buffer_load_dwordx4 v224, s[16:19], s47 offen offset:1024 lds
    s_add_u32 s58, s58, 1
    v_mfma_f32_16x16x32_bf16 v[144:147], v[112:115], v[64:67], v[144:147]
    v_mfma_f32_16x16x32_bf16 v[176:179], v[112:115], v[68:71], v[176:179]
    ds_read_b128 v[208:211], v225 offset:4096
    buffer_load_dwordx4 v224, s[16:19], s47 offen offset:2048 lds
    s_add_u32 s59, s59, 32768
    v_mfma_f32_16x16x32_bf16 v[148:151], v[116:119], v[64:67], v[148:151]
    v_mfma_f32_16x16x32_bf16 v[180:183], v[116:119], v[68:71], v[180:183]
    ds_read_b128 v[212:215], v225 offset:5120
    buffer_load_dwordx4 v224, s[16:19], s47 offen offset:3072 lds
    s_and_b32 s59, s59, 98304
    v_mfma_f32_16x16x32_bf16 v[252:255], v[244:247], v[68:71], v[252:255]
    s_waitcnt lgkmcnt(6)
    v_mfma_f32_16x16x32_bf16 v[152:155], v[120:123], v[64:67], v[152:155]
    v_mfma_f32_16x16x32_bf16 v[184:187], v[120:123], v[68:71], v[184:187]
    ds_read_b128 v[216:219], v225 offset:6144
    v_mfma_f32_16x16x32_bf16 v[156:159], v[124:127], v[64:67], v[156:159]
    v_mfma_f32_16x16x32_bf16 v[188:191], v[124:127], v[68:71], v[188:191]
    ds_read_b128 v[220:223], v225 offset:7168
    s_branch k2_kernel_sloop
k2_kernel_sfin0:
    ds_read_b128 v[96:99], v225 offset:16384
    ds_read_b128 v[100:103], v225 offset:17408
    ds_read_b128 v[104:107], v225 offset:18432
    ds_read_b128 v[108:111], v225 offset:19456
    ds_read_b128 v[112:115], v225 offset:20480
    ds_read_b128 v[116:119], v225 offset:21504
    ds_read_b128 v[120:123], v225 offset:22528
    ds_read_b128 v[124:127], v225 offset:23552
    s_waitcnt vmcnt(4)
    v_mov_b32 v241, s28
    ds_write_b32 v237, v241
    ds_read_b32 v240, v239
    v_exp_f32 v32, v32
    v_exp_f32 v33, v33
    v_exp_f32 v34, v34
    v_exp_f32 v35, v35
    v_exp_f32 v36, v36
    v_exp_f32 v37, v37
    v_exp_f32 v38, v38
    v_exp_f32 v39, v39
    v_exp_f32 v40, v40
    v_exp_f32 v41, v41
    v_exp_f32 v42, v42
    v_exp_f32 v43, v43
    v_exp_f32 v44, v44
    v_exp_f32 v45, v45
    v_exp_f32 v46, v46
    v_exp_f32 v47, v47
    v_cvt_pk_bf16_f32 v64, v32, v33
    v_cvt_pk_bf16_f32 v65, v34, v35
    v_cvt_pk_bf16_f32 v66, v36, v37
    v_cvt_pk_bf16_f32 v67, v38, v39
    v_cvt_pk_bf16_f32 v68, v40, v41
    v_cvt_pk_bf16_f32 v69, v42, v43
    v_cvt_pk_bf16_f32 v70, v44, v45
    v_cvt_pk_bf16_f32 v71, v46, v47
    s_waitcnt lgkmcnt(8)
    v_mfma_f32_16x16x32_bf16 v[128:131], v[96:99], v[64:67], v[128:131]
    v_mfma_f32_16x16x32_bf16 v[160:163], v[96:99], v[68:71], v[160:163]
    v_mfma_f32_16x16x32_bf16 v[132:135], v[100:103], v[64:67], v[132:135]
    v_mfma_f32_16x16x32_bf16 v[164:167], v[100:103], v[68:71], v[164:167]
    s_waitcnt lgkmcnt(6)
    v_mfma_f32_16x16x32_bf16 v[136:139], v[104:107], v[64:67], v[136:139]
    v_mfma_f32_16x16x32_bf16 v[168:171], v[104:107], v[68:71], v[168:171]
    v_mfma_f32_16x16x32_bf16 v[248:251], v[244:247], v[64:67], v[248:251]
    v_mfma_f32_16x16x32_bf16 v[140:143], v[108:111], v[64:67], v[140:143]
    v_mfma_f32_16x16x32_bf16 v[172:175], v[108:111], v[68:71], v[172:175]
    s_waitcnt lgkmcnt(4)
    v_mfma_f32_16x16x32_bf16 v[144:147], v[112:115], v[64:67], v[144:147]
    v_mfma_f32_16x16x32_bf16 v[176:179], v[112:115], v[68:71], v[176:179]
    v_mfma_f32_16x16x32_bf16 v[148:151], v[116:119], v[64:67], v[148:151]
    v_mfma_f32_16x16x32_bf16 v[180:183], v[116:119], v[68:71], v[180:183]
    v_mfma_f32_16x16x32_bf16 v[252:255], v[244:247], v[68:71], v[252:255]
    s_waitcnt lgkmcnt(2)
    v_mfma_f32_16x16x32_bf16 v[152:155], v[120:123], v[64:67], v[152:155]
    v_mfma_f32_16x16x32_bf16 v[184:187], v[120:123], v[68:71], v[184:187]
    v_mfma_f32_16x16x32_bf16 v[156:159], v[124:127], v[64:67], v[156:159]
    v_mfma_f32_16x16x32_bf16 v[188:191], v[124:127], v[68:71], v[188:191]
    s_waitcnt lgkmcnt(0)
    v_cmp_gt_i32 vcc, s28, v240
    s_cbranch_vccnz k2_kernel_spin_43
k2_kernel_back_44:
    s_add_u32 s28, s28, 1
    s_add_u32 s34, s34, 32768
    s_and_b32 s34, s34, 98304
    v_add_u32 v225, s34, v236
    ds_read_b128 v[192:195], v225 offset:0
    ds_read_b128 v[196:199], v225 offset:1024
    ds_read_b128 v[200:203], v225 offset:2048
    ds_read_b128 v[204:207], v225 offset:3072
    ds_read_b128 v[208:211], v225 offset:4096
    ds_read_b128 v[212:215], v225 offset:5120
    ds_read_b128 v[216:219], v225 offset:6144
    ds_read_b128 v[220:223], v225 offset:7168
    s_cmp_lt_u32 s58, s32
    s_cselect_b32 s47, s57, 0x7ff00000
    s_add_u32 m0, s59, s33
    s_nop 0
    buffer_load_dwordx4 v224, s[16:19], s47 offen offset:0 lds
    s_add_u32 s57, s57, 16384
    buffer_load_dwordx4 v224, s[16:19], s47 offen offset:1024 lds
    s_add_u32 s58, s58, 1
    buffer_load_dwordx4 v224, s[16:19], s47 offen offset:2048 lds
    s_add_u32 s59, s59, 32768
    buffer_load_dwordx4 v224, s[16:19], s47 offen offset:3072 lds
    s_and_b32 s59, s59, 98304
    s_branch k2_kernel_merge
k2_kernel_sfin1:
    ds_read_b128 v[96:99], v225 offset:16384
    ds_read_b128 v[100:103], v225 offset:17408
    ds_read_b128 v[104:107], v225 offset:18432
    ds_read_b128 v[108:111], v225 offset:19456
    ds_read_b128 v[112:115], v225 offset:20480
    ds_read_b128 v[116:119], v225 offset:21504
    ds_read_b128 v[120:123], v225 offset:22528
    ds_read_b128 v[124:127], v225 offset:23552
    s_waitcnt vmcnt(4)
    v_mov_b32 v241, s28
    ds_write_b32 v237, v241
    ds_read_b32 v240, v239
    v_exp_f32 v48, v48
    v_exp_f32 v49, v49
    v_exp_f32 v50, v50
    v_exp_f32 v51, v51
    v_exp_f32 v52, v52
    v_exp_f32 v53, v53
    v_exp_f32 v54, v54
    v_exp_f32 v55, v55
    v_exp_f32 v56, v56
    v_exp_f32 v57, v57
    v_exp_f32 v58, v58
    v_exp_f32 v59, v59
    v_exp_f32 v60, v60
    v_exp_f32 v61, v61
    v_exp_f32 v62, v62
    v_exp_f32 v63, v63
    v_cvt_pk_bf16_f32 v64, v48, v49
    v_cvt_pk_bf16_f32 v65, v50, v51
    v_cvt_pk_bf16_f32 v66, v52, v53
    v_cvt_pk_bf16_f32 v67, v54, v55
    v_cvt_pk_bf16_f32 v68, v56, v57
    v_cvt_pk_bf16_f32 v69, v58, v59
    v_cvt_pk_bf16_f32 v70, v60, v61
    v_cvt_pk_bf16_f32 v71, v62, v63
    s_waitcnt lgkmcnt(8)
    v_mfma_f32_16x16x32_bf16 v[128:131], v[96:99], v[64:67], v[128:131]
    v_mfma_f32_16x16x32_bf16 v[160:163], v[96:99], v[68:71], v[160:163]
    v_mfma_f32_16x16x32_bf16 v[132:135], v[100:103], v[64:67], v[132:135]
    v_mfma_f32_16x16x32_bf16 v[164:167], v[100:103], v[68:71], v[164:167]
    s_waitcnt lgkmcnt(6)
    v_mfma_f32_16x16x32_bf16 v[136:139], v[104:107], v[64:67], v[136:139]
    v_mfma_f32_16x16x32_bf16 v[168:171], v[104:107], v[68:71], v[168:171]
    v_mfma_f32_16x16x32_bf16 v[248:251], v[244:247], v[64:67], v[248:251]
    v_mfma_f32_16x16x32_bf16 v[140:143], v[108:111], v[64:67], v[140:143]
    v_mfma_f32_16x16x32_bf16 v[172:175], v[108:111], v[68:71], v[172:175]
    s_waitcnt lgkmcnt(4)
    v_mfma_f32_16x16x32_bf16 v[144:147], v[112:115], v[64:67], v[144:147]
    v_mfma_f32_16x16x32_bf16 v[176:179], v[112:115], v[68:71], v[176:179]
    v_mfma_f32_16x16x32_bf16 v[148:151], v[116:119], v[64:67], v[148:151]
    v_mfma_f32_16x16x32_bf16 v[180:183], v[116:119], v[68:71], v[180:183]
    v_mfma_f32_16x16x32_bf16 v[252:255], v[244:247], v[68:71], v[252:255]
    s_waitcnt lgkmcnt(2)
    v_mfma_f32_16x16x32_bf16 v[152:155], v[120:123], v[64:67], v[152:155]
    v_mfma_f32_16x16x32_bf16 v[184:187], v[120:123], v[68:71], v[184:187]
    v_mfma_f32_16x16x32_bf16 v[156:159], v[124:127], v[64:67], v[156:159]
    v_mfma_f32_16x16x32_bf16 v[188:191], v[124:127], v[68:71], v[188:191]
    s_waitcnt lgkmcnt(0)
    v_cmp_gt_i32 vcc, s28, v240
    s_cbranch_vccnz k2_kernel_spin_45
k2_kernel_back_46:
    s_add_u32 s28, s28, 1
    s_add_u32 s34, s34, 32768
    s_and_b32 s34, s34, 98304
    v_add_u32 v225, s34, v236
    ds_read_b128 v[192:195], v225 offset:0
    ds_read_b128 v[196:199], v225 offset:1024
    ds_read_b128 v[200:203], v225 offset:2048
    ds_read_b128 v[204:207], v225 offset:3072
    ds_read_b128 v[208:211], v225 offset:4096
    ds_read_b128 v[212:215], v225 offset:5120
    ds_read_b128 v[216:219], v225 offset:6144
    ds_read_b128 v[220:223], v225 offset:7168
    s_cmp_lt_u32 s58, s32
    s_cselect_b32 s47, s57, 0x7ff00000
    s_add_u32 m0, s59, s33
    s_nop 0
    buffer_load_dwordx4 v224, s[16:19], s47 offen offset:0 lds
    s_add_u32 s57, s57, 16384
    buffer_load_dwordx4 v224, s[16:19], s47 offen offset:1024 lds
    s_add_u32 s58, s58, 1
    buffer_load_dwordx4 v224, s[16:19], s47 offen offset:2048 lds
    s_add_u32 s59, s59, 32768
    buffer_load_dwordx4 v224, s[16:19], s47 offen offset:3072 lds
    s_and_b32 s59, s59, 98304
k2_kernel_merge:
    s_waitcnt vmcnt(0)
    v_mov_b32 v241, 0x7fffffff
    ds_write_b32 v237, v241
    s_waitcnt lgkmcnt(0)
    s_barrier
    s_and_b32 s42, s24, 3
    s_mul_i32 s42, s42, 17408
    v_add_u32 v233, s42, v224
    s_cmp_lt_u32 s24, 4
    s_cbranch_scc1 k2_kernel_mrecv
    ds_write_b128 v233, v[128:131] offset:0
    ds_write_b128 v233, v[132:135] offset:1024
    ds_write_b128 v233, v[136:139] offset:2048
    ds_write_b128 v233, v[140:143] offset:3072
    ds_write_b128 v233, v[144:147] offset:4096
    ds_write_b128 v233, v[148:151] offset:5120
    ds_write_b128 v233, v[152:155] offset:6144
    ds_write_b128 v233, v[156:159] offset:7168
    ds_write_b128 v233, v[160:163] offset:8192
    ds_write_b128 v233, v[164:167] offset:9216
    ds_write_b128 v233, v[168:171] offset:10240
    ds_write_b128 v233, v[172:175] offset:11264
    ds_write_b128 v233, v[176:179] offset:12288
    ds_write_b128 v233, v[180:183] offset:13312
    ds_write_b128 v233, v[184:187] offset:14336
    ds_write_b128 v233, v[188:191] offset:15360
    v_mov_b32 v249, v252
    ds_write_b64 v233, v[248:249] offset:16384
    s_waitcnt lgkmcnt(0)
    s_barrier
    s_branch k2_kernel_out
k2_kernel_mrecv:
    s_barrier
    ds_read_b128 v[32:35], v233 offset:0
    ds_read_b128 v[36:39], v233 offset:1024
    ds_read_b128 v[40:43], v233 offset:2048
    ds_read_b128 v[44:47], v233 offset:3072
    ds_read_b128 v[48:51], v233 offset:4096
    ds_read_b128 v[52:55], v233 offset:5120
    ds_read_b128 v[56:59], v233 offset:6144
    ds_read_b128 v[60:63], v233 offset:7168
    ds_read_b128 v[64:67], v233 offset:8192
    ds_read_b128 v[68:71], v233 offset:9216
    ds_read_b128 v[72:75], v233 offset:10240
    ds_read_b128 v[76:79], v233 offset:11264
    ds_read_b128 v[80:83], v233 offset:12288
    ds_read_b128 v[84:87], v233 offset:13312
    ds_read_b128 v[88:91], v233 offset:14336
    ds_read_b128 v[92:95], v233 offset:15360
    ds_read_b64 v[96:97], v233 offset:16384
    s_waitcnt lgkmcnt(15)
    v_add_f32 v128, v128, v32
    v_add_f32 v129, v129, v33
    v_add_f32 v130, v130, v34
    v_add_f32 v131, v131, v35
    v_add_f32 v132, v132, v36
    v_add_f32 v133, v133, v37
    v_add_f32 v134, v134, v38
    v_add_f32 v135, v135, v39
    s_waitcnt lgkmcnt(14)
    v_add_f32 v136, v136, v40
    v_add_f32 v137, v137, v41
    v_add_f32 v138, v138, v42
    v_add_f32 v139, v139, v43
    s_waitcnt lgkmcnt(13)
    v_add_f32 v140, v140, v44
    v_add_f32 v141, v141, v45
    v_add_f32 v142, v142, v46
    v_add_f32 v143, v143, v47
    s_waitcnt lgkmcnt(12)
    v_add_f32 v144, v144, v48
    v_add_f32 v145, v145, v49
    v_add_f32 v146, v146, v50
    v_add_f32 v147, v147, v51
    s_waitcnt lgkmcnt(11)
    v_add_f32 v148, v148, v52
    v_add_f32 v149, v149, v53
    v_add_f32 v150, v150, v54
    v_add_f32 v151, v151, v55
    s_waitcnt lgkmcnt(10)
    v_add_f32 v152, v152, v56
    v_add_f32 v153, v153, v57
    v_add_f32 v154, v154, v58
    v_add_f32 v155, v155, v59
    s_waitcnt lgkmcnt(9)
    v_add_f32 v156, v156, v60
    v_add_f32 v157, v157, v61
    v_add_f32 v158, v158, v62
    v_add_f32 v159, v159, v63
    s_waitcnt lgkmcnt(8)
    v_add_f32 v160, v160, v64
    v_add_f32 v161, v161, v65
    v_add_f32 v162, v162, v66
    v_add_f32 v163, v163, v67
    s_waitcnt lgkmcnt(7)
    v_add_f32 v164, v164, v68
    v_add_f32 v165, v165, v69
    v_add_f32 v166, v166, v70
    v_add_f32 v167, v167, v71
    s_waitcnt lgkmcnt(6)
    v_add_f32 v168, v168, v72
    v_add_f32 v169, v169, v73
    v_add_f32 v170, v170, v74
    v_add_f32 v171, v171, v75
    s_waitcnt lgkmcnt(5)
    v_add_f32 v172, v172, v76
    v_add_f32 v173, v173, v77
    v_add_f32 v174, v174, v78
    v_add_f32 v175, v175, v79
    s_waitcnt lgkmcnt(4)
    v_add_f32 v176, v176, v80
    v_add_f32 v177, v177, v81
    v_add_f32 v178, v178, v82
    v_add_f32 v179, v179, v83
    s_waitcnt lgkmcnt(3)
    v_add_f32 v180, v180, v84
    v_add_f32 v181, v181, v85
    v_add_f32 v182, v182, v86
    v_add_f32 v183, v183, v87
    s_waitcnt lgkmcnt(2)
    v_add_f32 v184, v184, v88
    v_add_f32 v185, v185, v89
    v_add_f32 v186, v186, v90
    v_add_f32 v187, v187, v91
    s_waitcnt lgkmcnt(1)
    v_add_f32 v188, v188, v92
    v_add_f32 v189, v189, v93
    v_add_f32 v190, v190, v94
    v_add_f32 v191, v191, v95
    s_waitcnt lgkmcnt(0)
    v_add_f32 v248, v248, v96
    v_add_f32 v252, v252, v97
    s_mov_b32 s23, 2
    s_branch k2_kernel_epi
k2_kernel_fin:
    s_waitcnt vmcnt(0)
    v_mov_b32 v241, 0x7fffffff
    ds_write_b32 v237, v241
    s_waitcnt lgkmcnt(0)
k2_kernel_out:
    s_cmp_lt_u32 s24, 4
    s_cbranch_scc1 k2_kernel_nopf_47
    s_cmp_eq_u32 s46, 1
    s_cbranch_scc1 k2_kernel_nopf_47
    s_lshr_b32 s48, s2, 3
    s_lshl_b32 s48, s48, 2
    s_and_b32 s49, s24, 3
    s_add_u32 s48, s48, s49
    s_lshl_b32 s48, s48, 15
    v_lshrrev_b32 v233, 6, v224
    v_lshlrev_b32 v233, 10, v233
    v_bfe_u32 v234, v224, 4, 2
    v_lshl_add_u32 v233, v234, 7, v233
    s_and_b32 s49, s2, 1
    s_lshl_b32 s49, s49, 9
    s_add_u32 s48, s48, s49
    buffer_load_dword v192, v233, s[12:15], s48 offen
    s_add_u32 s48, s48, 16384
    buffer_load_dword v193, v233, s[12:15], s48 offen
    s_add_u32 s48, s48, 16384
    s_waitcnt vmcnt(0)
k2_kernel_nopf_47:
    s_endpgm
k2_kernel_slowinit:
    s_waitcnt lgkmcnt(0)
    v_mov_b32 v128, 0
    v_mov_b32 v129, 0
    v_mov_b32 v130, 0
    v_mov_b32 v131, 0
    v_mov_b32 v132, 0
    v_mov_b32 v133, 0
    v_mov_b32 v134, 0
    v_mov_b32 v135, 0
    v_mov_b32 v136, 0
    v_mov_b32 v137, 0
    v_mov_b32 v138, 0
    v_mov_b32 v139, 0
    v_mov_b32 v140, 0
    v_mov_b32 v141, 0
    v_mov_b32 v142, 0
    v_mov_b32 v143, 0
    v_mov_b32 v144, 0
    v_mov_b32 v145, 0
    v_mov_b32 v146, 0
    v_mov_b32 v147, 0
    v_mov_b32 v148, 0
    v_mov_b32 v149, 0
    v_mov_b32 v150, 0
    v_mov_b32 v151, 0
    v_mov_b32 v152, 0
    v_mov_b32 v153, 0
    v_mov_b32 v154, 0
    v_mov_b32 v155, 0
    v_mov_b32 v156, 0
    v_mov_b32 v157, 0
    v_mov_b32 v158, 0
    v_mov_b32 v159, 0
    v_mov_b32 v160, 0
    v_mov_b32 v161, 0
    v_mov_b32 v162, 0
    v_mov_b32 v163, 0
    v_mov_b32 v164, 0
    v_mov_b32 v165, 0
    v_mov_b32 v166, 0
    v_mov_b32 v167, 0
    v_mov_b32 v168, 0
    v_mov_b32 v169, 0
    v_mov_b32 v170, 0
    v_mov_b32 v171, 0
    v_mov_b32 v172, 0
    v_mov_b32 v173, 0
    v_mov_b32 v174, 0
    v_mov_b32 v175, 0
    v_mov_b32 v176, 0
    v_mov_b32 v177, 0
    v_mov_b32 v178, 0
    v_mov_b32 v179, 0
    v_mov_b32 v180, 0
    v_mov_b32 v181, 0
    v_mov_b32 v182, 0
    v_mov_b32 v183, 0
    v_mov_b32 v184, 0
    v_mov_b32 v185, 0
    v_mov_b32 v186, 0
    v_mov_b32 v187, 0
    v_mov_b32 v188, 0
    v_mov_b32 v189, 0
    v_mov_b32 v190, 0
    v_mov_b32 v191, 0
    v_mov_b32 v80, 0
    v_mov_b32 v81, 0
    v_mov_b32 v82, 0
    v_mov_b32 v83, 0
    v_mov_b32 v84, 0
    v_mov_b32 v85, 0
    v_mov_b32 v86, 0
    v_mov_b32 v87, 0
    v_mov_b32 v88, 0
    v_mov_b32 v89, 0
    v_mov_b32 v90, 0
    v_mov_b32 v91, 0
    v_mov_b32 v92, 0
    v_mov_b32 v93, 0
    v_mov_b32 v94, 0
    v_mov_b32 v95, 0
    v_mov_b32 v235, 0
    v_mov_b32 v226, 0
    v_mov_b32 v242, v232
    v_mov_b32 v243, v232
    s_mov_b32 s27, 1
    s_mov_b32 s47, s45
k2_kernel_slow:
    s_add_u32 s43, s47, 4096
    s_add_u32 s42, s47, 16777216
    s_add_u32 s41, s42, 4096
    buffer_load_dwordx4 v[192:195], v224, s[16:19], s47 offen offset:0
    buffer_load_dwordx4 v[196:199], v224, s[16:19], s47 offen offset:1024
    buffer_load_dwordx4 v[200:203], v224, s[16:19], s47 offen offset:2048
    buffer_load_dwordx4 v[204:207], v224, s[16:19], s47 offen offset:3072
    buffer_load_dwordx4 v[208:211], v224, s[16:19], s43 offen offset:0
    buffer_load_dwordx4 v[212:215], v224, s[16:19], s43 offen offset:1024
    buffer_load_dwordx4 v[216:219], v224, s[16:19], s43 offen offset:2048
    buffer_load_dwordx4 v[220:223], v224, s[16:19], s43 offen offset:3072
    buffer_load_dwordx4 v[96:99], v224, s[16:19], s42 offen offset:0
    buffer_load_dwordx4 v[100:103], v224, s[16:19], s42 offen offset:1024
    buffer_load_dwordx4 v[104:107], v224, s[16:19], s42 offen offset:2048
    buffer_load_dwordx4 v[108:111], v224, s[16:19], s42 offen offset:3072
    buffer_load_dwordx4 v[112:115], v224, s[16:19], s41 offen offset:0
    buffer_load_dwordx4 v[116:119], v224, s[16:19], s41 offen offset:1024
    buffer_load_dwordx4 v[120:123], v224, s[16:19], s41 offen offset:2048
    buffer_load_dwordx4 v[124:127], v224, s[16:19], s41 offen offset:3072
    s_cmp_lg_u32 s26, s27
    s_cbranch_scc1 k2_kernel_nomask_48
    v_cmp_gt_i32 s[48:49], 0, v231
    s_nop 1
    v_cndmask_b32 v80, v80, v232, s[48:49]
    v_cmp_gt_i32 s[50:51], 1, v231
    s_nop 1
    v_cndmask_b32 v81, v81, v232, s[50:51]
    v_cmp_gt_i32 s[52:53], 2, v231
    s_nop 1
    v_cndmask_b32 v82, v82, v232, s[52:53]
    v_cmp_gt_i32 s[54:55], 3, v231
    s_nop 1
    v_cndmask_b32 v83, v83, v232, s[54:55]
    v_mov_b32 v84, v232
    v_mov_b32 v85, v232
    v_mov_b32 v86, v232
    v_mov_b32 v87, v232
    v_cmp_gt_i32 s[48:49], 0, v231
    s_nop 1
    v_cndmask_b32 v92, v92, v232, s[48:49]
    v_cmp_gt_i32 s[50:51], 1, v231
    s_nop 1
    v_cndmask_b32 v93, v93, v232, s[50:51]
    v_cmp_gt_i32 s[52:53], 2, v231
    s_nop 1
    v_cndmask_b32 v94, v94, v232, s[52:53]
    v_cmp_gt_i32 s[54:55], 3, v231
    s_nop 1
    v_cndmask_b32 v95, v95, v232, s[54:55]
k2_kernel_nomask_48:
    s_waitcnt vmcnt(15)
    v_mfma_f32_16x16x32_bf16 v[32:35], v[192:195], v[0:3], v[80:83]
    v_mfma_f32_16x16x32_bf16 v[40:43], v[192:195], v[16:19], v[88:91]
    s_waitcnt vmcnt(14)
    v_mfma_f32_16x16x32_bf16 v[36:39], v[196:199], v[0:3], v[84:87]
    v_mfma_f32_16x16x32_bf16 v[44:47], v[196:199], v[16:19], v[92:95]
    s_waitcnt vmcnt(13)
    v_mfma_f32_16x16x32_bf16 v[32:35], v[200:203], v[4:7], v[32:35]
    v_mfma_f32_16x16x32_bf16 v[40:43], v[200:203], v[20:23], v[40:43]
    s_waitcnt vmcnt(12)
    v_mfma_f32_16x16x32_bf16 v[36:39], v[204:207], v[4:7], v[36:39]
    v_mfma_f32_16x16x32_bf16 v[44:47], v[204:207], v[20:23], v[44:47]
    s_waitcnt vmcnt(11)
    v_mfma_f32_16x16x32_bf16 v[32:35], v[208:211], v[8:11], v[32:35]
    v_mfma_f32_16x16x32_bf16 v[40:43], v[208:211], v[24:27], v[40:43]
    s_waitcnt vmcnt(10)
    v_mfma_f32_16x16x32_bf16 v[36:39], v[212:215], v[8:11], v[36:39]
    v_mfma_f32_16x16x32_bf16 v[44:47], v[212:215], v[24:27], v[44:47]
    s_waitcnt vmcnt(9)
    v_mfma_f32_16x16x32_bf16 v[32:35], v[216:219], v[12:15], v[32:35]
    v_mfma_f32_16x16x32_bf16 v[40:43], v[216:219], v[28:31], v[40:43]
    s_waitcnt vmcnt(8)
    v_mfma_f32_16x16x32_bf16 v[36:39], v[220:223], v[12:15], v[36:39]
    v_mfma_f32_16x16x32_bf16 v[44:47], v[220:223], v[28:31], v[44:47]
    s_nop 3
    v_max3_f32 v238, v32, v33, v34
    s_nop 1
    v_max3_f32 v238, v238, v35, v36
    v_max3_f32 v238, v238, v37, v38
    v_max_f32 v238, v238, v39
    v_mov_b32 v233, v238
    s_nop 1
    v_permlane32_swap_b32 v238, v233
    v_max_f32 v238, v238, v233
    v_mov_b32 v233, v238
    s_nop 1
    v_permlane16_swap_b32 v238, v233
    v_max_f32 v238, v238, v233
    v_max_f32 v238, v238, v242
    v_sub_f32 v229, v242, v238
    v_exp_f32 v229, v229
    v_mov_b32 v242, v238
    v_mul_f32 v235, v229, v235
    v_sub_f32 v32, v32, v238
    v_exp_f32 v32, v32
    v_sub_f32 v33, v33, v238
    v_exp_f32 v33, v33
    v_sub_f32 v34, v34, v238
    v_exp_f32 v34, v34
    v_sub_f32 v35, v35, v238
    v_exp_f32 v35, v35
    v_sub_f32 v36, v36, v238
    v_exp_f32 v36, v36
    v_sub_f32 v37, v37, v238
    v_exp_f32 v37, v37
    v_sub_f32 v38, v38, v238
    v_exp_f32 v38, v38
    v_sub_f32 v39, v39, v238
    v_exp_f32 v39, v39
    v_add_f32 v235, v32, v235
    v_add_f32 v235, v33, v235
    v_add_f32 v235, v34, v235
    v_add_f32 v235, v35, v235
    v_add_f32 v235, v36, v235
    v_add_f32 v235, v37, v235
    v_add_f32 v235, v38, v235
    v_add_f32 v235, v39, v235
    v_cvt_pk_bf16_f32 v64, v32, v33
    v_cvt_pk_bf16_f32 v65, v34, v35
    v_cvt_pk_bf16_f32 v66, v36, v37
    v_cvt_pk_bf16_f32 v67, v38, v39
    v_mul_f32 v128, v229, v128
    v_mul_f32 v129, v229, v129
    v_mul_f32 v130, v229, v130
    v_mul_f32 v131, v229, v131
    v_mul_f32 v132, v229, v132
    v_mul_f32 v133, v229, v133
    v_mul_f32 v134, v229, v134
    v_mul_f32 v135, v229, v135
    v_mul_f32 v136, v229, v136
    v_mul_f32 v137, v229, v137
    v_mul_f32 v138, v229, v138
    v_mul_f32 v139, v229, v139
    v_mul_f32 v140, v229, v140
    v_mul_f32 v141, v229, v141
    v_mul_f32 v142, v229, v142
    v_mul_f32 v143, v229, v143
    v_mul_f32 v144, v229, v144
    v_mul_f32 v145, v229, v145
    v_mul_f32 v146, v229, v146
    v_mul_f32 v147, v229, v147
    v_mul_f32 v148, v229, v148
    v_mul_f32 v149, v229, v149
    v_mul_f32 v150, v229, v150
    v_mul_f32 v151, v229, v151
    v_mul_f32 v152, v229, v152
    v_mul_f32 v153, v229, v153
    v_mul_f32 v154, v229, v154
    v_mul_f32 v155, v229, v155
    v_mul_f32 v156, v229, v156
    v_mul_f32 v157, v229, v157
    v_mul_f32 v158, v229, v158
    v_mul_f32 v159, v229, v159
    v_max3_f32 v238, v40, v41, v42
    v_max3_f32 v238, v238, v43, v44
    v_max3_f32 v238, v238, v45, v46
    v_max_f32 v238, v238, v47
    v_mov_b32 v233, v238
    s_nop 1
    v_permlane32_swap_b32 v238, v233
    v_max_f32 v238, v238, v233
    v_mov_b32 v233, v238
    s_nop 1
    v_permlane16_swap_b32 v238, v233
    v_max_f32 v238, v238, v233
    v_max_f32 v238, v238, v243
    v_sub_f32 v230, v243, v238
    v_exp_f32 v230, v230
    v_mov_b32 v243, v238
    v_mul_f32 v226, v230, v226
    v_sub_f32 v40, v40, v238
    v_exp_f32 v40, v40
    v_sub_f32 v41, v41, v238
    v_exp_f32 v41, v41
    v_sub_f32 v42, v42, v238
    v_exp_f32 v42, v42
    v_sub_f32 v43, v43, v238
    v_exp_f32 v43, v43
    v_sub_f32 v44, v44, v238
    v_exp_f32 v44, v44
    v_sub_f32 v45, v45, v238
    v_exp_f32 v45, v45
    v_sub_f32 v46, v46, v238
    v_exp_f32 v46, v46
    v_sub_f32 v47, v47, v238
    v_exp_f32 v47, v47
    v_add_f32 v226, v40, v226
    v_add_f32 v226, v41, v226
    v_add_f32 v226, v42, v226
    v_add_f32 v226, v43, v226
    v_add_f32 v226, v44, v226
    v_add_f32 v226, v45, v226
    v_add_f32 v226, v46, v226
    v_add_f32 v226, v47, v226
    v_cvt_pk_bf16_f32 v68, v40, v41
    v_cvt_pk_bf16_f32 v69, v42, v43
    v_cvt_pk_bf16_f32 v70, v44, v45
    v_cvt_pk_bf16_f32 v71, v46, v47
    v_mul_f32 v160, v230, v160
    v_mul_f32 v161, v230, v161
    v_mul_f32 v162, v230, v162
    v_mul_f32 v163, v230, v163
    v_mul_f32 v164, v230, v164
    v_mul_f32 v165, v230, v165
    v_mul_f32 v166, v230, v166
    v_mul_f32 v167, v230, v167
    v_mul_f32 v168, v230, v168
    v_mul_f32 v169, v230, v169
    v_mul_f32 v170, v230, v170
    v_mul_f32 v171, v230, v171
    v_mul_f32 v172, v230, v172
    v_mul_f32 v173, v230, v173
    v_mul_f32 v174, v230, v174
    v_mul_f32 v175, v230, v175
    v_mul_f32 v176, v230, v176
    v_mul_f32 v177, v230, v177
    v_mul_f32 v178, v230, v178
    v_mul_f32 v179, v230, v179
    v_mul_f32 v180, v230, v180
    v_mul_f32 v181, v230, v181
    v_mul_f32 v182, v230, v182
    v_mul_f32 v183, v230, v183
    v_mul_f32 v184, v230, v184
    v_mul_f32 v185, v230, v185
    v_mul_f32 v186, v230, v186
    v_mul_f32 v187, v230, v187
    v_mul_f32 v188, v230, v188
    v_mul_f32 v189, v230, v189
    v_mul_f32 v190, v230, v190
    v_mul_f32 v191, v230, v191
    s_waitcnt vmcnt(7)
    v_mfma_f32_16x16x32_bf16 v[128:131], v[96:99], v[64:67], v[128:131]
    v_mfma_f32_16x16x32_bf16 v[160:163], v[96:99], v[68:71], v[160:163]
    s_waitcnt vmcnt(6)
    v_mfma_f32_16x16x32_bf16 v[132:135], v[100:103], v[64:67], v[132:135]
    v_mfma_f32_16x16x32_bf16 v[164:167], v[100:103], v[68:71], v[164:167]
    s_waitcnt vmcnt(5)
    v_mfma_f32_16x16x32_bf16 v[136:139], v[104:107], v[64:67], v[136:139]
    v_mfma_f32_16x16x32_bf16 v[168:171], v[104:107], v[68:71], v[168:171]
    s_waitcnt vmcnt(4)
    v_mfma_f32_16x16x32_bf16 v[140:143], v[108:111], v[64:67], v[140:143]
    v_mfma_f32_16x16x32_bf16 v[172:175], v[108:111], v[68:71], v[172:175]
    s_waitcnt vmcnt(3)
    v_mfma_f32_16x16x32_bf16 v[144:147], v[112:115], v[64:67], v[144:147]
    v_mfma_f32_16x16x32_bf16 v[176:179], v[112:115], v[68:71], v[176:179]
    s_waitcnt vmcnt(2)
    v_mfma_f32_16x16x32_bf16 v[148:151], v[116:119], v[64:67], v[148:151]
    v_mfma_f32_16x16x32_bf16 v[180:183], v[116:119], v[68:71], v[180:183]
    s_waitcnt vmcnt(1)
    v_mfma_f32_16x16x32_bf16 v[152:155], v[120:123], v[64:67], v[152:155]
    v_mfma_f32_16x16x32_bf16 v[184:187], v[120:123], v[68:71], v[184:187]
    s_waitcnt vmcnt(0)
    v_mfma_f32_16x16x32_bf16 v[156:159], v[124:127], v[64:67], v[156:159]
    v_mfma_f32_16x16x32_bf16 v[188:191], v[124:127], v[68:71], v[188:191]
    s_add_u32 s47, s47, 8192
    s_add_u32 s27, s27, 1
    s_cmp_le_u32 s27, s26
    s_cbranch_scc1 k2_kernel_slow
    v_mov_b32 v233, v235
    s_nop 1
    v_permlane32_swap_b32 v235, v233
    v_add_f32 v235, v235, v233
    v_mov_b32 v233, v235
    s_nop 1
    v_permlane16_swap_b32 v235, v233
    v_add_f32 v235, v235, v233
    v_mov_b32 v248, v235
    v_mov_b32 v233, v226
    s_nop 1
    v_permlane32_swap_b32 v226, v233
    v_add_f32 v226, v226, v233
    v_mov_b32 v233, v226
    s_nop 1
    v_permlane16_swap_b32 v226, v233
    v_add_f32 v226, v226, v233
    v_mov_b32 v252, v226
    s_branch k2_kernel_store
k2_kernel_done:
    s_endpgm
k2_kernel_smask_35:
    v_cmp_gt_i32 s[48:49], 0, v231
    s_nop 1
    v_cndmask_b32 v80, v80, v232, s[48:49]
    v_cmp_gt_i32 s[50:51], 1, v231
    s_nop 1
    v_cndmask_b32 v81, v81, v232, s[50:51]
    v_cmp_gt_i32 s[52:53], 2, v231
    s_nop 1
    v_cndmask_b32 v82, v82, v232, s[52:53]
    v_cmp_gt_i32 s[54:55], 3, v231
    s_nop 1
    v_cndmask_b32 v83, v83, v232, s[54:55]
    v_mov_b32 v84, v232
    v_mov_b32 v85, v232
    v_mov_b32 v86, v232
    v_mov_b32 v87, v232
    v_cmp_gt_i32 s[48:49], 0, v231
    s_nop 1
    v_cndmask_b32 v92, v92, v232, s[48:49]
    v_cmp_gt_i32 s[50:51], 1, v231
    s_nop 1
    v_cndmask_b32 v93, v93, v232, s[50:51]
    v_cmp_gt_i32 s[52:53], 2, v231
    s_nop 1
    v_cndmask_b32 v94, v94, v232, s[52:53]
    v_cmp_gt_i32 s[54:55], 3, v231
    s_nop 1
    v_cndmask_b32 v95, v95, v232, s[54:55]
    s_branch k2_kernel_sback_36
k2_kernel_smask_39:
    v_cmp_gt_i32 s[48:49], 0, v231
    s_nop 1
    v_cndmask_b32 v80, v80, v232, s[48:49]
    v_cmp_gt_i32 s[50:51], 1, v231
    s_nop 1
    v_cndmask_b32 v81, v81, v232, s[50:51]
    v_cmp_gt_i32 s[52:53], 2, v231
    s_nop 1
    v_cndmask_b32 v82, v82, v232, s[52:53]
    v_cmp_gt_i32 s[54:55], 3, v231
    s_nop 1
    v_cndmask_b32 v83, v83, v232, s[54:55]
    v_mov_b32 v84, v232
    v_mov_b32 v85, v232
    v_mov_b32 v86, v232
    v_mov_b32 v87, v232
    v_cmp_gt_i32 s[48:49], 0, v231
    s_nop 1
    v_cndmask_b32 v92, v92, v232, s[48:49]
    v_cmp_gt_i32 s[50:51], 1, v231
    s_nop 1
    v_cndmask_b32 v93, v93, v232, s[50:51]
    v_cmp_gt_i32 s[52:53], 2, v231
    s_nop 1
    v_cndmask_b32 v94, v94, v232, s[52:53]
    v_cmp_gt_i32 s[54:55], 3, v231
    s_nop 1
    v_cndmask_b32 v95, v95, v232, s[54:55]
    s_branch k2_kernel_sback_40
k2_kernel_spin_1:
    s_sleep 1
    ds_read_b32 v240, v239
    s_waitcnt lgkmcnt(0)
    v_cmp_gt_i32 vcc, s28, v240
    s_cbranch_vccnz k2_kernel_spin_1
    s_branch k2_kernel_back_2
k2_kernel_spin_3:
    s_sleep 1
    ds_read_b32 v240, v239
    s_waitcnt lgkmcnt(0)
    v_cmp_gt_i32 vcc, s28, v240
    s_cbranch_vccnz k2_kernel_spin_3
    s_branch k2_kernel_back_4
k2_kernel_spin_5:
    s_sleep 1
    ds_read_b32 v240, v239
    s_waitcnt lgkmcnt(0)
    v_cmp_gt_i32 vcc, s28, v240
    s_cbranch_vccnz k2_kernel_spin_5
    s_branch k2_kernel_back_6
k2_kernel_spin_7:
    s_sleep 1
    ds_read_b32 v240, v239
    s_waitcnt lgkmcnt(0)
    v_cmp_gt_i32 vcc, s28, v240
    s_cbranch_vccnz k2_kernel_spin_7
    s_branch k2_kernel_back_8
k2_kernel_spin_11:
    s_sleep 1
    ds_read_b32 v240, v239
    s_waitcnt lgkmcnt(0)
    v_cmp_gt_i32 vcc, s28, v240
    s_cbranch_vccnz k2_kernel_spin_11
    s_branch k2_kernel_back_12
k2_kernel_spin_14:
    s_sleep 1
    ds_read_b32 v240, v239
    s_waitcnt lgkmcnt(0)
    v_cmp_gt_i32 vcc, s28, v240
    s_cbranch_vccnz k2_kernel_spin_14
    s_branch k2_kernel_back_15
k2_kernel_spin_18:
    s_sleep 1
    ds_read_b32 v240, v239
    s_waitcnt lgkmcnt(0)
    v_cmp_gt_i32 vcc, s28, v240
    s_cbranch_vccnz k2_kernel_spin_18
    s_branch k2_kernel_back_19
k2_kernel_spin_20:
    s_sleep 1
    ds_read_b32 v240, v239
    s_waitcnt lgkmcnt(0)
    v_cmp_gt_i32 vcc, s28, v240
    s_cbranch_vccnz k2_kernel_spin_20
    s_branch k2_kernel_back_21
k2_kernel_spin_22:
    s_sleep 1
    ds_read_b32 v240, v239
    s_waitcnt lgkmcnt(0)
    v_cmp_gt_i32 vcc, s28, v240
    s_cbranch_vccnz k2_kernel_spin_22
    s_branch k2_kernel_back_23
k2_kernel_spin_24:
    s_sleep 1
    ds_read_b32 v240, v239
    s_waitcnt lgkmcnt(0)
    v_cmp_gt_i32 vcc, s28, v240
    s_cbranch_vccnz k2_kernel_spin_24
    s_branch k2_kernel_back_25
k2_kernel_spin_28:
    s_sleep 1
    ds_read_b32 v240, v239
    s_waitcnt lgkmcnt(0)
    v_cmp_gt_i32 vcc, s28, v240
    s_cbranch_vccnz k2_kernel_spin_28
    s_branch k2_kernel_back_29
k2_kernel_spin_31:
    s_sleep 1
    ds_read_b32 v240, v239
    s_waitcnt lgkmcnt(0)
    v_cmp_gt_i32 vcc, s28, v240
    s_cbranch_vccnz k2_kernel_spin_31
    s_branch k2_kernel_back_32
k2_kernel_spin_33:
    s_sleep 1
    ds_read_b32 v240, v239
    s_waitcnt lgkmcnt(0)
    v_cmp_gt_i32 vcc, s28, v240
    s_cbranch_vccnz k2_kernel_spin_33
    s_branch k2_kernel_back_34
k2_kernel_spin_37:
    s_sleep 1
    ds_read_b32 v240, v239
    s_waitcnt lgkmcnt(0)
    v_cmp_gt_i32 vcc, s28, v240
    s_cbranch_vccnz k2_kernel_spin_37
    s_branch k2_kernel_back_38
k2_kernel_spin_41:
    s_sleep 1
    ds_read_b32 v240, v239
    s_waitcnt lgkmcnt(0)
    v_cmp_gt_i32 vcc, s28, v240
    s_cbranch_vccnz k2_kernel_spin_41
    s_branch k2_kernel_back_42
k2_kernel_spin_43:
    s_sleep 1
    ds_read_b32 v240, v239
    s_waitcnt lgkmcnt(0)
    v_cmp_gt_i32 vcc, s28, v240
    s_cbranch_vccnz k2_kernel_spin_43
    s_branch k2_kernel_back_44
k2_kernel_spin_45:
    s_sleep 1
    ds_read_b32 v240, v239
    s_waitcnt lgkmcnt(0)
    v_cmp_gt_i32 vcc, s28, v240
    s_cbranch_vccnz k2_kernel_spin_45
    s_branch k2_kernel_back_46
.globl k3_kernel
.p2align 8
.type k3_kernel,@function
k3_kernel:
    s_cmp_ge_u32 s2, 512
    s_cbranch_scc1 k3_kernel_done
    s_lshr_b32 s4, s2, 3
    s_and_b32 s5, s4, 1
    s_lshr_b32 s6, s4, 5
    s_xor_b32 s5, s5, s6
    s_lshr_b32 s4, s4, 1
    s_lshl_b32 s4, s4, 3
    s_and_b32 s3, s2, 7
    s_add_u32 s3, s3, s4
    s_cmp_eq_u32 s5, 1
    s_cbranch_scc1 k3_kernel_ssm
    s_load_dwordx2 s[4:5], s[0:1], 96
    s_load_dwordx2 s[6:7], s[0:1], 120
    s_load_dwordx2 s[40:41], s[0:1], 104
    v_lshrrev_b32 v166, 6, v0
    v_and_b32 v167, 63, v0
    v_readfirstlane_b32 s24, v166
    v_lshlrev_b32 v160, 4, v167
    s_and_b32 s42, s3, 7
    s_lshr_b32 s43, s3, 3
    s_and_b32 s44, s43, 7
    s_lshr_b32 s45, s42, 1
    s_lshl_b32 s45, s45, 3
    s_add_u32 s30, s45, s44
    s_and_b32 s42, s42, 1
    s_lshl_b32 s42, s42, 2
    s_lshr_b32 s43, s43, 3
    s_add_u32 s31, s42, s43
    s_lshl_b32 s25, s30, 12
    s_lshl_b32 s42, s24, 22
    s_add_u32 s25, s25, s42
    s_add_u32 s25, s25, 37748736
    s_lshl_b32 s26, s24, 20
    s_lshl_b32 s42, s31, 7
    s_add_u32 s26, s26, s42
    s_lshl_b32 s27, s24, 14
    v_lshrrev_b32 v166, 3, v167
    v_lshlrev_b32 v161, 10, v166
    v_lshrrev_b32 v166, 4, v167
    v_lshlrev_b32 v166, 1, v166
    v_and_b32 v168, 7, v167
    v_xor_b32 v166, v166, v168
    v_lshl_add_u32 v161, v166, 4, v161
    v_lshrrev_b32 v166, 2, v167
    v_lshlrev_b32 v162, 7, v166
    v_bfe_u32 v166, v167, 3, 2
    v_lshl_add_u32 v162, v166, 5, v162
    v_and_b32 v166, 3, v167
    v_lshl_add_u32 v162, v166, 3, v162
    v_add_u32 v162, s27, v162
    v_xor_b32 v163, 32, v162
    v_xor_b32 v164, 64, v162
    v_xor_b32 v165, 96, v162
    v_add_u32 v169, s27, v160
    v_bfe_u32 v166, v167, 1, 2
    v_lshlrev_b32 v170, 10, v166
    v_and_b32 v166, 1, v167
    v_lshl_add_u32 v170, v166, 9, v170
    v_lshrrev_b32 v166, 3, v167
    v_lshl_add_u32 v170, v166, 4, v170
    s_lshl_b32 s42, s24, 12
    v_add_u32 v170, s42, v170
    v_lshlrev_b32 v171, 11, v166
    v_and_b32 v166, 7, v167
    v_lshl_add_u32 v171, v166, 4, v171
    s_waitcnt lgkmcnt(0)
    s_mov_b32 s8, s4
    s_mov_b32 s9, s5
    s_mov_b32 s10, 0x400000
    s_mov_b32 s11, 0x00020000
    s_mov_b32 s16, s6
    s_mov_b32 s17, s7
    s_mov_b32 s18, 0x10000000
    s_mov_b32 s19, 0x00020000
    s_mov_b32 s20, s40
    s_mov_b32 s21, s41
    s_mov_b32 s22, 0x400000
    s_mov_b32 s23, 0x00020000
    s_add_u32 m0, s27, 0
    s_add_u32 s29, s26, 0
    buffer_load_dwordx4 v161, s[8:11], s29 offen offset:0 lds
    s_add_u32 m0, s27, 0
    s_add_u32 s29, s26, 7168
    buffer_load_dwordx4 v161, s[8:11], s29 offen offset:1024 lds
    s_add_u32 m0, s27, 0
    s_add_u32 s29, s26, 14336
    buffer_load_dwordx4 v161, s[8:11], s29 offen offset:2048 lds
    s_add_u32 m0, s27, 0
    s_add_u32 s29, s26, 21504
    buffer_load_dwordx4 v161, s[8:11], s29 offen offset:3072 lds
    s_add_u32 s29, s25, 0
    buffer_load_dwordx4 v[64:67], v160, s[16:19], s29 offen offset:0
    s_add_u32 s29, s25, 0
    buffer_load_dwordx4 v[68:71], v160, s[16:19], s29 offen offset:1024
    s_add_u32 s29, s25, 0
    buffer_load_dwordx4 v[72:75], v160, s[16:19], s29 offen offset:2048
    s_add_u32 s29, s25, 0
    buffer_load_dwordx4 v[76:79], v160, s[16:19], s29 offen offset:3072
    s_add_u32 m0, s27, 4096
    s_add_u32 s29, s26, 32768
    buffer_load_dwordx4 v161, s[8:11], s29 offen offset:0 lds
    s_add_u32 m0, s27, 4096
    s_add_u32 s29, s26, 39936
    buffer_load_dwordx4 v161, s[8:11], s29 offen offset:1024 lds
    s_add_u32 m0, s27, 4096
    s_add_u32 s29, s26, 47104
    buffer_load_dwordx4 v161, s[8:11], s29 offen offset:2048 lds
    s_add_u32 m0, s27, 4096
    s_add_u32 s29, s26, 54272
    buffer_load_dwordx4 v161, s[8:11], s29 offen offset:3072 lds
    s_add_u32 s29, s25, 131072
    buffer_load_dwordx4 v[80:83], v160, s[16:19], s29 offen offset:0
    s_add_u32 s29, s25, 131072
    buffer_load_dwordx4 v[84:87], v160, s[16:19], s29 offen offset:1024
    s_add_u32 s29, s25, 131072
    buffer_load_dwordx4 v[88:91], v160, s[16:19], s29 offen offset:2048
    s_add_u32 s29, s25, 131072
    buffer_load_dwordx4 v[92:95], v160, s[16:19], s29 offen offset:3072
    s_add_u32 m0, s27, 8192
    s_add_u32 s29, s26, 65536
    buffer_load_dwordx4 v161, s[8:11], s29 offen offset:0 lds
    s_add_u32 m0, s27, 8192
    s_add_u32 s29, s26, 72704
    buffer_load_dwordx4 v161, s[8:11], s29 offen offset:1024 lds
    s_add_u32 m0, s27, 8192
    s_add_u32 s29, s26, 79872
    buffer_load_dwordx4 v161, s[8:11], s29 offen offset:2048 lds
    s_add_u32 m0, s27, 8192
    s_add_u32 s29, s26, 87040
    buffer_load_dwordx4 v161, s[8:11], s29 offen offset:3072 lds
    s_add_u32 s29, s25, 262144
    buffer_load_dwordx4 v[96:99], v160, s[16:19], s29 offen offset:0
    s_add_u32 s29, s25, 262144
    buffer_load_dwordx4 v[100:103], v160, s[16:19], s29 offen offset:1024
    s_add_u32 s29, s25, 262144
    buffer_load_dwordx4 v[104:107], v160, s[16:19], s29 offen offset:2048
    s_add_u32 s29, s25, 262144
    buffer_load_dwordx4 v[108:111], v160, s[16:19], s29 offen offset:3072
    s_add_u32 m0, s27, 12288
    s_add_u32 s29, s26, 98304
    buffer_load_dwordx4 v161, s[8:11], s29 offen offset:0 lds
    s_add_u32 m0, s27, 12288
    s_add_u32 s29, s26, 105472
    buffer_load_dwordx4 v161, s[8:11], s29 offen offset:1024 lds
    s_add_u32 m0, s27, 12288
    s_add_u32 s29, s26, 112640
    buffer_load_dwordx4 v161, s[8:11], s29 offen offset:2048 lds
    s_add_u32 m0, s27, 12288
    s_add_u32 s29, s26, 119808
    buffer_load_dwordx4 v161, s[8:11], s29 offen offset:3072 lds
    s_add_u32 s29, s25, 393216
    buffer_load_dwordx4 v[112:115], v160, s[16:19], s29 offen offset:0
    s_add_u32 s29, s25, 393216
    buffer_load_dwordx4 v[116:119], v160, s[16:19], s29 offen offset:1024
    s_add_u32 s29, s25, 393216
    buffer_load_dwordx4 v[120:123], v160, s[16:19], s29 offen offset:2048
    s_add_u32 s29, s25, 393216
    buffer_load_dwordx4 v[124:127], v160, s[16:19], s29 offen offset:3072
    s_setprio 2
    s_waitcnt vmcnt(28)
    ds_read_b64_tr_b16 v[128:129], v162 offset:0
    ds_read_b64_tr_b16 v[130:131], v162 offset:2048
    ds_read_b64_tr_b16 v[132:133], v163 offset:0
    ds_read_b64_tr_b16 v[134:135], v163 offset:2048
    ds_read_b64_tr_b16 v[136:137], v164 offset:0
    ds_read_b64_tr_b16 v[138:139], v164 offset:2048
    ds_read_b64_tr_b16 v[140:141], v165 offset:0
    ds_read_b64_tr_b16 v[142:143], v165 offset:2048
    s_waitcnt vmcnt(27) lgkmcnt(6)
    v_mfma_f32_16x16x32_bf16 v[0:3], v[128:131], v[64:67], 0
    s_waitcnt lgkmcnt(4)
    v_mfma_f32_16x16x32_bf16 v[4:7], v[132:135], v[64:67], 0
    s_waitcnt lgkmcnt(2)
    v_mfma_f32_16x16x32_bf16 v[8:11], v[136:139], v[64:67], 0
    s_waitcnt lgkmcnt(0)
    v_mfma_f32_16x16x32_bf16 v[12:15], v[140:143], v[64:67], 0
    s_waitcnt vmcnt(20)
    ds_read_b64_tr_b16 v[144:145], v162 offset:4096
    ds_read_b64_tr_b16 v[146:147], v162 offset:6144
    ds_read_b64_tr_b16 v[148:149], v163 offset:4096
    ds_read_b64_tr_b16 v[150:151], v163 offset:6144
    ds_read_b64_tr_b16 v[152:153], v164 offset:4096
    ds_read_b64_tr_b16 v[154:155], v164 offset:6144
    ds_read_b64_tr_b16 v[156:157], v165 offset:4096
    ds_read_b64_tr_b16 v[158:159], v165 offset:6144
    v_mfma_f32_16x16x32_bf16 v[16:19], v[128:131], v[68:71], 0
    v_mfma_f32_16x16x32_bf16 v[20:23], v[132:135], v[68:71], 0
    s_add_u32 m0, s27, 0
    s_add_u32 s29, s26, 131072
    buffer_load_dwordx4 v161, s[8:11], s29 offen offset:0 lds
    v_mfma_f32_16x16x32_bf16 v[24:27], v[136:139], v[68:71], 0
    v_mfma_f32_16x16x32_bf16 v[28:31], v[140:143], v[68:71], 0
    s_add_u32 m0, s27, 0
    s_add_u32 s29, s26, 138240
    buffer_load_dwordx4 v161, s[8:11], s29 offen offset:1024 lds
    s_add_u32 s29, s25, 524288
    buffer_load_dwordx4 v[64:67], v160, s[16:19], s29 offen offset:0
    v_mfma_f32_16x16x32_bf16 v[32:35], v[128:131], v[72:75], 0
    v_mfma_f32_16x16x32_bf16 v[36:39], v[132:135], v[72:75], 0
    s_add_u32 m0, s27, 0
    s_add_u32 s29, s26, 145408
    buffer_load_dwordx4 v161, s[8:11], s29 offen offset:2048 lds
    v_mfma_f32_16x16x32_bf16 v[40:43], v[136:139], v[72:75], 0
    v_mfma_f32_16x16x32_bf16 v[44:47], v[140:143], v[72:75], 0
    s_add_u32 m0, s27, 0
    s_add_u32 s29, s26, 152576
    buffer_load_dwordx4 v161, s[8:11], s29 offen offset:3072 lds
    s_add_u32 s29, s25, 524288
    buffer_load_dwordx4 v[68:71], v160, s[16:19], s29 offen offset:1024
    v_mfma_f32_16x16x32_bf16 v[48:51], v[128:131], v[76:79], 0
    v_mfma_f32_16x16x32_bf16 v[52:55], v[132:135], v[76:79], 0
    v_mfma_f32_16x16x32_bf16 v[56:59], v[136:139], v[76:79], 0
    v_mfma_f32_16x16x32_bf16 v[60:63], v[140:143], v[76:79], 0
    s_add_u32 s29, s25, 524288
    buffer_load_dwordx4 v[72:75], v160, s[16:19], s29 offen offset:2048
    s_add_u32 s29, s25, 524288
    buffer_load_dwordx4 v[76:79], v160, s[16:19], s29 offen offset:3072
    s_waitcnt vmcnt(27) lgkmcnt(6)
    v_mfma_f32_16x16x32_bf16 v[0:3], v[144:147], v[80:83], v[0:3]
    s_waitcnt lgkmcnt(4)
    v_mfma_f32_16x16x32_bf16 v[4:7], v[148:151], v[80:83], v[4:7]
    s_waitcnt lgkmcnt(2)
    v_mfma_f32_16x16x32_bf16 v[8:11], v[152:155], v[80:83], v[8:11]
    s_waitcnt lgkmcnt(0)
    v_mfma_f32_16x16x32_bf16 v[12:15], v[156:159], v[80:83], v[12:15]
    s_waitcnt vmcnt(20)
    ds_read_b64_tr_b16 v[128:129], v162 offset:8192
    ds_read_b64_tr_b16 v[130:131], v162 offset:10240
    ds_read_b64_tr_b16 v[132:133], v163 offset:8192
    ds_read_b64_tr_b16 v[134:135], v163 offset:10240
    ds_read_b64_tr_b16 v[136:137], v164 offset:8192
    ds_read_b64_tr_b16 v[138:139], v164 offset:10240
    ds_read_b64_tr_b16 v[140:141], v165 offset:8192
    ds_read_b64_tr_b16 v[142:143], v165 offset:10240
    v_mfma_f32_16x16x32_bf16 v[16:19], v[144:147], v[84:87], v[16:19]
    v_mfma_f32_16x16x32_bf16 v[20:23], v[148:151], v[84:87], v[20:23]
    s_add_u32 m0, s27, 4096
    s_add_u32 s29, s26, 163840
    buffer_load_dwordx4 v161, s[8:11], s29 offen offset:0 lds
    v_mfma_f32_16x16x32_bf16 v[24:27], v[152:155], v[84:87], v[24:27]
    v_mfma_f32_16x16x32_bf16 v[28:31], v[156:159], v[84:87], v[28:31]
    s_add_u32 m0, s27, 4096
    s_add_u32 s29, s26, 171008
    buffer_load_dwordx4 v161, s[8:11], s29 offen offset:1024 lds
    s_add_u32 s29, s25, 655360
    buffer_load_dwordx4 v[80:83], v160, s[16:19], s29 offen offset:0
    v_mfma_f32_16x16x32_bf16 v[32:35], v[144:147], v[88:91], v[32:35]
    v_mfma_f32_16x16x32_bf16 v[36:39], v[148:151], v[88:91], v[36:39]
    s_add_u32 m0, s27, 4096
    s_add_u32 s29, s26, 178176
    buffer_load_dwordx4 v161, s[8:11], s29 offen offset:2048 lds
    v_mfma_f32_16x16x32_bf16 v[40:43], v[152:155], v[88:91], v[40:43]
    v_mfma_f32_16x16x32_bf16 v[44:47], v[156:159], v[88:91], v[44:47]
    s_add_u32 m0, s27, 4096
    s_add_u32 s29, s26, 185344
    buffer_load_dwordx4 v161, s[8:11], s29 offen offset:3072 lds
    s_add_u32 s29, s25, 655360
    buffer_load_dwordx4 v[84:87], v160, s[16:19], s29 offen offset:1024
    v_mfma_f32_16x16x32_bf16 v[48:51], v[144:147], v[92:95], v[48:51]
    v_mfma_f32_16x16x32_bf16 v[52:55], v[148:151], v[92:95], v[52:55]
    v_mfma_f32_16x16x32_bf16 v[56:59], v[152:155], v[92:95], v[56:59]
    v_mfma_f32_16x16x32_bf16 v[60:63], v[156:159], v[92:95], v[60:63]
    s_add_u32 s29, s25, 655360
    buffer_load_dwordx4 v[88:91], v160, s[16:19], s29 offen offset:2048
    s_add_u32 s29, s25, 655360
    buffer_load_dwordx4 v[92:95], v160, s[16:19], s29 offen offset:3072
    s_waitcnt vmcnt(27) lgkmcnt(6)
    v_mfma_f32_16x16x32_bf16 v[0:3], v[128:131], v[96:99], v[0:3]
    s_waitcnt lgkmcnt(4)
    v_mfma_f32_16x16x32_bf16 v[4:7], v[132:135], v[96:99], v[4:7]
    s_waitcnt lgkmcnt(2)
    v_mfma_f32_16x16x32_bf16 v[8:11], v[136:139], v[96:99], v[8:11]
    s_waitcnt lgkmcnt(0)
    v_mfma_f32_16x16x32_bf16 v[12:15], v[140:143], v[96:99], v[12:15]
    s_waitcnt vmcnt(20)
    ds_read_b64_tr_b16 v[144:145], v162 offset:12288
    ds_read_b64_tr_b16 v[146:147], v162 offset:14336
    ds_read_b64_tr_b16 v[148:149], v163 offset:12288
    ds_read_b64_tr_b16 v[150:151], v163 offset:14336
    ds_read_b64_tr_b16 v[152:153], v164 offset:12288
    ds_read_b64_tr_b16 v[154:155], v164 offset:14336
    ds_read_b64_tr_b16 v[156:157], v165 offset:12288
    ds_read_b64_tr_b16 v[158:159], v165 offset:14336
    v_mfma_f32_16x16x32_bf16 v[16:19], v[128:131], v[100:103], v[16:19]
    v_mfma_f32_16x16x32_bf16 v[20:23], v[132:135], v[100:103], v[20:23]
    s_add_u32 m0, s27, 8192
    s_add_u32 s29, s26, 196608
    buffer_load_dwordx4 v161, s[8:11], s29 offen offset:0 lds
    v_mfma_f32_16x16x32_bf16 v[24:27], v[136:139], v[100:103], v[24:27]
    v_mfma_f32_16x16x32_bf16 v[28:31], v[140:143], v[100:103], v[28:31]
    s_add_u32 m0, s27, 8192
    s_add_u32 s29, s26, 203776
    buffer_load_dwordx4 v161, s[8:11], s29 offen offset:1024 lds
    s_add_u32 s29, s25, 786432
    buffer_load_dwordx4 v[96:99], v160, s[16:19], s29 offen offset:0
    v_mfma_f32_16x16x32_bf16 v[32:35], v[128:131], v[104:107], v[32:35]
    v_mfma_f32_16x16x32_bf16 v[36:39], v[132:135], v[104:107], v[36:39]
    s_add_u32 m0, s27, 8192
    s_add_u32 s29, s26, 210944
    buffer_load_dwordx4 v161, s[8:11], s29 offen offset:2048 lds
    v_mfma_f32_16x16x32_bf16 v[40:43], v[136:139], v[104:107], v[40:43]
    v_mfma_f32_16x16x32_bf16 v[44:47], v[140:143], v[104:107], v[44:47]
    s_add_u32 m0, s27, 8192
    s_add_u32 s29, s26, 218112
    buffer_load_dwordx4 v161, s[8:11], s29 offen offset:3072 lds
    s_add_u32 s29, s25, 786432
    buffer_load_dwordx4 v[100:103], v160, s[16:19], s29 offen offset:1024
    v_mfma_f32_16x16x32_bf16 v[48:51], v[128:131], v[108:111], v[48:51]
    v_mfma_f32_16x16x32_bf16 v[52:55], v[132:135], v[108:111], v[52:55]
    v_mfma_f32_16x16x32_bf16 v[56:59], v[136:139], v[108:111], v[56:59]
    v_mfma_f32_16x16x32_bf16 v[60:63], v[140:143], v[108:111], v[60:63]
    s_add_u32 s29, s25, 786432
    buffer_load_dwordx4 v[104:107], v160, s[16:19], s29 offen offset:2048
    s_add_u32 s29, s25, 786432
    buffer_load_dwordx4 v[108:111], v160, s[16:19], s29 offen offset:3072
    s_waitcnt vmcnt(27) lgkmcnt(6)
    v_mfma_f32_16x16x32_bf16 v[0:3], v[144:147], v[112:115], v[0:3]
    s_waitcnt lgkmcnt(4)
    v_mfma_f32_16x16x32_bf16 v[4:7], v[148:151], v[112:115], v[4:7]
    s_waitcnt lgkmcnt(2)
    v_mfma_f32_16x16x32_bf16 v[8:11], v[152:155], v[112:115], v[8:11]
    s_waitcnt lgkmcnt(0)
    v_mfma_f32_16x16x32_bf16 v[12:15], v[156:159], v[112:115], v[12:15]
    s_waitcnt vmcnt(19)
    ds_read_b64_tr_b16 v[128:129], v162 offset:0
    ds_read_b64_tr_b16 v[130:131], v162 offset:2048
    ds_read_b64_tr_b16 v[132:133], v163 offset:0
    ds_read_b64_tr_b16 v[134:135], v163 offset:2048
    ds_read_b64_tr_b16 v[136:137], v164 offset:0
    ds_read_b64_tr_b16 v[138:139], v164 offset:2048
    ds_read_b64_tr_b16 v[140:141], v165 offset:0
    ds_read_b64_tr_b16 v[142:143], v165 offset:2048
    v_mfma_f32_16x16x32_bf16 v[16:19], v[144:147], v[116:119], v[16:19]
    v_mfma_f32_16x16x32_bf16 v[20:23], v[148:151], v[116:119], v[20:23]
    s_add_u32 m0, s27, 12288
    s_add_u32 s29, s26, 229376
    buffer_load_dwordx4 v161, s[8:11], s29 offen offset:0 lds
    v_mfma_f32_16x16x32_bf16 v[24:27], v[152:155], v[116:119], v[24:27]
    v_mfma_f32_16x16x32_bf16 v[28:31], v[156:159], v[116:119], v[28:31]
    s_add_u32 m0, s27, 12288
    s_add_u32 s29, s26, 236544
    buffer_load_dwordx4 v161, s[8:11], s29 offen offset:1024 lds
    s_add_u32 s29, s25, 917504
    buffer_load_dwordx4 v[112:115], v160, s[16:19], s29 offen offset:0
    v_mfma_f32_16x16x32_bf16 v[32:35], v[144:147], v[120:123], v[32:35]
    v_mfma_f32_16x16x32_bf16 v[36:39], v[148:151], v[120:123], v[36:39]
    s_add_u32 m0, s27, 12288
    s_add_u32 s29, s26, 243712
    buffer_load_dwordx4 v161, s[8:11], s29 offen offset:2048 lds
    v_mfma_f32_16x16x32_bf16 v[40:43], v[152:155], v[120:123], v[40:43]
    v_mfma_f32_16x16x32_bf16 v[44:47], v[156:159], v[120:123], v[44:47]
    s_add_u32 m0, s27, 12288
    s_add_u32 s29, s26, 250880
    buffer_load_dwordx4 v161, s[8:11], s29 offen offset:3072 lds
    s_add_u32 s29, s25, 917504
    buffer_load_dwordx4 v[116:119], v160, s[16:19], s29 offen offset:1024
    v_mfma_f32_16x16x32_bf16 v[48:51], v[144:147], v[124:127], v[48:51]
    v_mfma_f32_16x16x32_bf16 v[52:55], v[148:151], v[124:127], v[52:55]
    v_mfma_f32_16x16x32_bf16 v[56:59], v[152:155], v[124:127], v[56:59]
    v_mfma_f32_16x16x32_bf16 v[60:63], v[156:159], v[124:127], v[60:63]
    s_add_u32 s29, s25, 917504
    buffer_load_dwordx4 v[120:123], v160, s[16:19], s29 offen offset:2048
    s_add_u32 s29, s25, 917504
    buffer_load_dwordx4 v[124:127], v160, s[16:19], s29 offen offset:3072
    s_waitcnt lgkmcnt(6)
    v_mfma_f32_16x16x32_bf16 v[0:3], v[128:131], v[64:67], v[0:3]
    s_waitcnt lgkmcnt(4)
    v_mfma_f32_16x16x32_bf16 v[4:7], v[132:135], v[64:67], v[4:7]
    s_waitcnt lgkmcnt(2)
    v_mfma_f32_16x16x32_bf16 v[8:11], v[136:139], v[64:67], v[8:11]
    s_waitcnt lgkmcnt(0)
    v_mfma_f32_16x16x32_bf16 v[12:15], v[140:143], v[64:67], v[12:15]
    s_waitcnt vmcnt(19)
    ds_read_b64_tr_b16 v[144:145], v162 offset:4096
    ds_read_b64_tr_b16 v[146:147], v162 offset:6144
    ds_read_b64_tr_b16 v[148:149], v163 offset:4096
    ds_read_b64_tr_b16 v[150:151], v163 offset:6144
    ds_read_b64_tr_b16 v[152:153], v164 offset:4096
    ds_read_b64_tr_b16 v[154:155], v164 offset:6144
    ds_read_b64_tr_b16 v[156:157], v165 offset:4096
    ds_read_b64_tr_b16 v[158:159], v165 offset:6144
    v_mfma_f32_16x16x32_bf16 v[16:19], v[128:131], v[68:71], v[16:19]
    v_mfma_f32_16x16x32_bf16 v[20:23], v[132:135], v[68:71], v[20:23]
    s_add_u32 m0, s27, 0
    s_add_u32 s29, s26, 262144
    buffer_load_dwordx4 v161, s[8:11], s29 offen offset:0 lds
    v_mfma_f32_16x16x32_bf16 v[24:27], v[136:139], v[68:71], v[24:27]
    v_mfma_f32_16x16x32_bf16 v[28:31], v[140:143], v[68:71], v[28:31]
    s_add_u32 m0, s27, 0
    s_add_u32 s29, s26, 269312
    buffer_load_dwordx4 v161, s[8:11], s29 offen offset:1024 lds
    s_add_u32 s29, s25, 1048576
    buffer_load_dwordx4 v[64:67], v160, s[16:19], s29 offen offset:0
    v_mfma_f32_16x16x32_bf16 v[32:35], v[128:131], v[72:75], v[32:35]
    v_mfma_f32_16x16x32_bf16 v[36:39], v[132:135], v[72:75], v[36:39]
    s_add_u32 m0, s27, 0
    s_add_u32 s29, s26, 276480
    buffer_load_dwordx4 v161, s[8:11], s29 offen offset:2048 lds
    v_mfma_f32_16x16x32_bf16 v[40:43], v[136:139], v[72:75], v[40:43]
    v_mfma_f32_16x16x32_bf16 v[44:47], v[140:143], v[72:75], v[44:47]
    s_add_u32 m0, s27, 0
    s_add_u32 s29, s26, 283648
    buffer_load_dwordx4 v161, s[8:11], s29 offen offset:3072 lds
    s_add_u32 s29, s25, 1048576
    buffer_load_dwordx4 v[68:71], v160, s[16:19], s29 offen offset:1024
    v_mfma_f32_16x16x32_bf16 v[48:51], v[128:131], v[76:79], v[48:51]
    v_mfma_f32_16x16x32_bf16 v[52:55], v[132:135], v[76:79], v[52:55]
    v_mfma_f32_16x16x32_bf16 v[56:59], v[136:139], v[76:79], v[56:59]
    v_mfma_f32_16x16x32_bf16 v[60:63], v[140:143], v[76:79], v[60:63]
    s_add_u32 s29, s25, 1048576
    buffer_load_dwordx4 v[72:75], v160, s[16:19], s29 offen offset:2048
    s_add_u32 s29, s25, 1048576
    buffer_load_dwordx4 v[76:79], v160, s[16:19], s29 offen offset:3072
    s_waitcnt lgkmcnt(6)
    v_mfma_f32_16x16x32_bf16 v[0:3], v[144:147], v[80:83], v[0:3]
    s_waitcnt lgkmcnt(4)
    v_mfma_f32_16x16x32_bf16 v[4:7], v[148:151], v[80:83], v[4:7]
    s_waitcnt lgkmcnt(2)
    v_mfma_f32_16x16x32_bf16 v[8:11], v[152:155], v[80:83], v[8:11]
    s_waitcnt lgkmcnt(0)
    v_mfma_f32_16x16x32_bf16 v[12:15], v[156:159], v[80:83], v[12:15]
    s_waitcnt vmcnt(19)
    ds_read_b64_tr_b16 v[128:129], v162 offset:8192
    ds_read_b64_tr_b16 v[130:131], v162 offset:10240
    ds_read_b64_tr_b16 v[132:133], v163 offset:8192
    ds_read_b64_tr_b16 v[134:135], v163 offset:10240
    ds_read_b64_tr_b16 v[136:137], v164 offset:8192
    ds_read_b64_tr_b16 v[138:139], v164 offset:10240
    ds_read_b64_tr_b16 v[140:141], v165 offset:8192
    ds_read_b64_tr_b16 v[142:143], v165 offset:10240
    v_mfma_f32_16x16x32_bf16 v[16:19], v[144:147], v[84:87], v[16:19]
    v_mfma_f32_16x16x32_bf16 v[20:23], v[148:151], v[84:87], v[20:23]
    s_add_u32 m0, s27, 4096
    s_add_u32 s29, s26, 294912
    buffer_load_dwordx4 v161, s[8:11], s29 offen offset:0 lds
    v_mfma_f32_16x16x32_bf16 v[24:27], v[152:155], v[84:87], v[24:27]
    v_mfma_f32_16x16x32_bf16 v[28:31], v[156:159], v[84:87], v[28:31]
    s_add_u32 m0, s27, 4096
    s_add_u32 s29, s26, 302080
    buffer_load_dwordx4 v161, s[8:11], s29 offen offset:1024 lds
    s_add_u32 s29, s25, 1179648
    buffer_load_dwordx4 v[80:83], v160, s[16:19], s29 offen offset:0
    v_mfma_f32_16x16x32_bf16 v[32:35], v[144:147], v[88:91], v[32:35]
    v_mfma_f32_16x16x32_bf16 v[36:39], v[148:151], v[88:91], v[36:39]
    s_add_u32 m0, s27, 4096
    s_add_u32 s29, s26, 309248
    buffer_load_dwordx4 v161, s[8:11], s29 offen offset:2048 lds
    v_mfma_f32_16x16x32_bf16 v[40:43], v[152:155], v[88:91], v[40:43]
    v_mfma_f32_16x16x32_bf16 v[44:47], v[156:159], v[88:91], v[44:47]
    s_add_u32 m0, s27, 4096
    s_add_u32 s29, s26, 316416
    buffer_load_dwordx4 v161, s[8:11], s29 offen offset:3072 lds
    s_add_u32 s29, s25, 1179648
    buffer_load_dwordx4 v[84:87], v160, s[16:19], s29 offen offset:1024
    v_mfma_f32_16x16x32_bf16 v[48:51], v[144:147], v[92:95], v[48:51]
    v_mfma_f32_16x16x32_bf16 v[52:55], v[148:151], v[92:95], v[52:55]
    v_mfma_f32_16x16x32_bf16 v[56:59], v[152:155], v[92:95], v[56:59]
    v_mfma_f32_16x16x32_bf16 v[60:63], v[156:159], v[92:95], v[60:63]
    s_add_u32 s29, s25, 1179648
    buffer_load_dwordx4 v[88:91], v160, s[16:19], s29 offen offset:2048
    s_add_u32 s29, s25, 1179648
    buffer_load_dwordx4 v[92:95], v160, s[16:19], s29 offen offset:3072
    s_waitcnt lgkmcnt(6)
    v_mfma_f32_16x16x32_bf16 v[0:3], v[128:131], v[96:99], v[0:3]
    s_waitcnt lgkmcnt(4)
    v_mfma_f32_16x16x32_bf16 v[4:7], v[132:135], v[96:99], v[4:7]
    s_waitcnt lgkmcnt(2)
    v_mfma_f32_16x16x32_bf16 v[8:11], v[136:139], v[96:99], v[8:11]
    s_waitcnt lgkmcnt(0)
    v_mfma_f32_16x16x32_bf16 v[12:15], v[140:143], v[96:99], v[12:15]
    s_waitcnt vmcnt(19)
    ds_read_b64_tr_b16 v[144:145], v162 offset:12288
    ds_read_b64_tr_b16 v[146:147], v162 offset:14336
    ds_read_b64_tr_b16 v[148:149], v163 offset:12288
    ds_read_b64_tr_b16 v[150:151], v163 offset:14336
    ds_read_b64_tr_b16 v[152:153], v164 offset:12288
    ds_read_b64_tr_b16 v[154:155], v164 offset:14336
    ds_read_b64_tr_b16 v[156:157], v165 offset:12288
    ds_read_b64_tr_b16 v[158:159], v165 offset:14336
    v_mfma_f32_16x16x32_bf16 v[16:19], v[128:131], v[100:103], v[16:19]
    v_mfma_f32_16x16x32_bf16 v[20:23], v[132:135], v[100:103], v[20:23]
    s_add_u32 m0, s27, 8192
    s_add_u32 s29, s26, 327680
    buffer_load_dwordx4 v161, s[8:11], s29 offen offset:0 lds
    v_mfma_f32_16x16x32_bf16 v[24:27], v[136:139], v[100:103], v[24:27]
    v_mfma_f32_16x16x32_bf16 v[28:31], v[140:143], v[100:103], v[28:31]
    s_add_u32 m0, s27, 8192
    s_add_u32 s29, s26, 334848
    buffer_load_dwordx4 v161, s[8:11], s29 offen offset:1024 lds
    s_add_u32 s29, s25, 1310720
    buffer_load_dwordx4 v[96:99], v160, s[16:19], s29 offen offset:0
    v_mfma_f32_16x16x32_bf16 v[32:35], v[128:131], v[104:107], v[32:35]
    v_mfma_f32_16x16x32_bf16 v[36:39], v[132:135], v[104:107], v[36:39]
    s_add_u32 m0, s27, 8192
    s_add_u32 s29, s26, 342016
    buffer_load_dwordx4 v161, s[8:11], s29 offen offset:2048 lds
    v_mfma_f32_16x16x32_bf16 v[40:43], v[136:139], v[104:107], v[40:43]
    v_mfma_f32_16x16x32_bf16 v[44:47], v[140:143], v[104:107], v[44:47]
    s_add_u32 m0, s27, 8192
    s_add_u32 s29, s26, 349184
    buffer_load_dwordx4 v161, s[8:11], s29 offen offset:3072 lds
    s_add_u32 s29, s25, 1310720
    buffer_load_dwordx4 v[100:103], v160, s[16:19], s29 offen offset:1024
    v_mfma_f32_16x16x32_bf16 v[48:51], v[128:131], v[108:111], v[48:51]
    v_mfma_f32_16x16x32_bf16 v[52:55], v[132:135], v[108:111], v[52:55]
    v_mfma_f32_16x16x32_bf16 v[56:59], v[136:139], v[108:111], v[56:59]
    v_mfma_f32_16x16x32_bf16 v[60:63], v[140:143], v[108:111], v[60:63]
    s_add_u32 s29, s25, 1310720
    buffer_load_dwordx4 v[104:107], v160, s[16:19], s29 offen offset:2048
    s_add_u32 s29, s25, 1310720
    buffer_load_dwordx4 v[108:111], v160, s[16:19], s29 offen offset:3072
    s_waitcnt lgkmcnt(6)
    v_mfma_f32_16x16x32_bf16 v[0:3], v[144:147], v[112:115], v[0:3]
    s_waitcnt lgkmcnt(4)
    v_mfma_f32_16x16x32_bf16 v[4:7], v[148:151], v[112:115], v[4:7]
    s_waitcnt lgkmcnt(2)
    v_mfma_f32_16x16x32_bf16 v[8:11], v[152:155], v[112:115], v[8:11]
    s_waitcnt lgkmcnt(0)
    v_mfma_f32_16x16x32_bf16 v[12:15], v[156:159], v[112:115], v[12:15]
    s_waitcnt vmcnt(19)
    ds_read_b64_tr_b16 v[128:129], v162 offset:0
    ds_read_b64_tr_b16 v[130:131], v162 offset:2048
    ds_read_b64_tr_b16 v[132:133], v163 offset:0
    ds_read_b64_tr_b16 v[134:135], v163 offset:2048
    ds_read_b64_tr_b16 v[136:137], v164 offset:0
    ds_read_b64_tr_b16 v[138:139], v164 offset:2048
    ds_read_b64_tr_b16 v[140:141], v165 offset:0
    ds_read_b64_tr_b16 v[142:143], v165 offset:2048
    v_mfma_f32_16x16x32_bf16 v[16:19], v[144:147], v[116:119], v[16:19]
    v_mfma_f32_16x16x32_bf16 v[20:23], v[148:151], v[116:119], v[20:23]
    s_add_u32 m0, s27, 12288
    s_add_u32 s29, s26, 360448
    buffer_load_dwordx4 v161, s[8:11], s29 offen offset:0 lds
    v_mfma_f32_16x16x32_bf16 v[24:27], v[152:155], v[116:119], v[24:27]
    v_mfma_f32_16x16x32_bf16 v[28:31], v[156:159], v[116:119], v[28:31]
    s_add_u32 m0, s27, 12288
    s_add_u32 s29, s26, 367616
    buffer_load_dwordx4 v161, s[8:11], s29 offen offset:1024 lds
    s_add_u32 s29, s25, 1441792
    buffer_load_dwordx4 v[112:115], v160, s[16:19], s29 offen offset:0
    v_mfma_f32_16x16x32_bf16 v[32:35], v[144:147], v[120:123], v[32:35]
    v_mfma_f32_16x16x32_bf16 v[36:39], v[148:151], v[120:123], v[36:39]
    s_add_u32 m0, s27, 12288
    s_add_u32 s29, s26, 374784
    buffer_load_dwordx4 v161, s[8:11], s29 offen offset:2048 lds
    v_mfma_f32_16x16x32_bf16 v[40:43], v[152:155], v[120:123], v[40:43]
    v_mfma_f32_16x16x32_bf16 v[44:47], v[156:159], v[120:123], v[44:47]
    s_add_u32 m0, s27, 12288
    s_add_u32 s29, s26, 381952
    buffer_load_dwordx4 v161, s[8:11], s29 offen offset:3072 lds
    s_add_u32 s29, s25, 1441792
    buffer_load_dwordx4 v[116:119], v160, s[16:19], s29 offen offset:1024
    v_mfma_f32_16x16x32_bf16 v[48:51], v[144:147], v[124:127], v[48:51]
    v_mfma_f32_16x16x32_bf16 v[52:55], v[148:151], v[124:127], v[52:55]
    v_mfma_f32_16x16x32_bf16 v[56:59], v[152:155], v[124:127], v[56:59]
    v_mfma_f32_16x16x32_bf16 v[60:63], v[156:159], v[124:127], v[60:63]
    s_add_u32 s29, s25, 1441792
    buffer_load_dwordx4 v[120:123], v160, s[16:19], s29 offen offset:2048
    s_add_u32 s29, s25, 1441792
    buffer_load_dwordx4 v[124:127], v160, s[16:19], s29 offen offset:3072
    s_waitcnt lgkmcnt(6)
    v_mfma_f32_16x16x32_bf16 v[0:3], v[128:131], v[64:67], v[0:3]
    s_waitcnt lgkmcnt(4)
    v_mfma_f32_16x16x32_bf16 v[4:7], v[132:135], v[64:67], v[4:7]
    s_waitcnt lgkmcnt(2)
    v_mfma_f32_16x16x32_bf16 v[8:11], v[136:139], v[64:67], v[8:11]
    s_waitcnt lgkmcnt(0)
    v_mfma_f32_16x16x32_bf16 v[12:15], v[140:143], v[64:67], v[12:15]
    s_waitcnt vmcnt(19)
    ds_read_b64_tr_b16 v[144:145], v162 offset:4096
    ds_read_b64_tr_b16 v[146:147], v162 offset:6144
    ds_read_b64_tr_b16 v[148:149], v163 offset:4096
    ds_read_b64_tr_b16 v[150:151], v163 offset:6144
    ds_read_b64_tr_b16 v[152:153], v164 offset:4096
    ds_read_b64_tr_b16 v[154:155], v164 offset:6144
    ds_read_b64_tr_b16 v[156:157], v165 offset:4096
    ds_read_b64_tr_b16 v[158:159], v165 offset:6144
    v_mfma_f32_16x16x32_bf16 v[16:19], v[128:131], v[68:71], v[16:19]
    v_mfma_f32_16x16x32_bf16 v[20:23], v[132:135], v[68:71], v[20:23]
    s_add_u32 m0, s27, 0
    s_add_u32 s29, s26, 393216
    buffer_load_dwordx4 v161, s[8:11], s29 offen offset:0 lds
    v_mfma_f32_16x16x32_bf16 v[24:27], v[136:139], v[68:71], v[24:27]
    v_mfma_f32_16x16x32_bf16 v[28:31], v[140:143], v[68:71], v[28:31]
    s_add_u32 m0, s27, 0
    s_add_u32 s29, s26, 400384
    buffer_load_dwordx4 v161, s[8:11], s29 offen offset:1024 lds
    s_add_u32 s29, s25, 1572864
    buffer_load_dwordx4 v[64:67], v160, s[16:19], s29 offen offset:0
    v_mfma_f32_16x16x32_bf16 v[32:35], v[128:131], v[72:75], v[32:35]
    v_mfma_f32_16x16x32_bf16 v[36:39], v[132:135], v[72:75], v[36:39]
    s_add_u32 m0, s27, 0
    s_add_u32 s29, s26, 407552
    buffer_load_dwordx4 v161, s[8:11], s29 offen offset:2048 lds
    v_mfma_f32_16x16x32_bf16 v[40:43], v[136:139], v[72:75], v[40:43]
    v_mfma_f32_16x16x32_bf16 v[44:47], v[140:143], v[72:75], v[44:47]
    s_add_u32 m0, s27, 0
    s_add_u32 s29, s26, 414720
    buffer_load_dwordx4 v161, s[8:11], s29 offen offset:3072 lds
    s_add_u32 s29, s25, 1572864
    buffer_load_dwordx4 v[68:71], v160, s[16:19], s29 offen offset:1024
    v_mfma_f32_16x16x32_bf16 v[48:51], v[128:131], v[76:79], v[48:51]
    v_mfma_f32_16x16x32_bf16 v[52:55], v[132:135], v[76:79], v[52:55]
    v_mfma_f32_16x16x32_bf16 v[56:59], v[136:139], v[76:79], v[56:59]
    v_mfma_f32_16x16x32_bf16 v[60:63], v[140:143], v[76:79], v[60:63]
    s_add_u32 s29, s25, 1572864
    buffer_load_dwordx4 v[72:75], v160, s[16:19], s29 offen offset:2048
    s_add_u32 s29, s25, 1572864
    buffer_load_dwordx4 v[76:79], v160, s[16:19], s29 offen offset:3072
    s_waitcnt lgkmcnt(6)
    v_mfma_f32_16x16x32_bf16 v[0:3], v[144:147], v[80:83], v[0:3]
    s_waitcnt lgkmcnt(4)
    v_mfma_f32_16x16x32_bf16 v[4:7], v[148:151], v[80:83], v[4:7]
    s_waitcnt lgkmcnt(2)
    v_mfma_f32_16x16x32_bf16 v[8:11], v[152:155], v[80:83], v[8:11]
    s_waitcnt lgkmcnt(0)
    v_mfma_f32_16x16x32_bf16 v[12:15], v[156:159], v[80:83], v[12:15]
    s_waitcnt vmcnt(19)
    ds_read_b64_tr_b16 v[128:129], v162 offset:8192
    ds_read_b64_tr_b16 v[130:131], v162 offset:10240
    ds_read_b64_tr_b16 v[132:133], v163 offset:8192
    ds_read_b64_tr_b16 v[134:135], v163 offset:10240
    ds_read_b64_tr_b16 v[136:137], v164 offset:8192
    ds_read_b64_tr_b16 v[138:139], v164 offset:10240
    ds_read_b64_tr_b16 v[140:141], v165 offset:8192
    ds_read_b64_tr_b16 v[142:143], v165 offset:10240
    v_mfma_f32_16x16x32_bf16 v[16:19], v[144:147], v[84:87], v[16:19]
    v_mfma_f32_16x16x32_bf16 v[20:23], v[148:151], v[84:87], v[20:23]
    s_add_u32 m0, s27, 4096
    s_add_u32 s29, s26, 425984
    buffer_load_dwordx4 v161, s[8:11], s29 offen offset:0 lds
    v_mfma_f32_16x16x32_bf16 v[24:27], v[152:155], v[84:87], v[24:27]
    v_mfma_f32_16x16x32_bf16 v[28:31], v[156:159], v[84:87], v[28:31]
    s_add_u32 m0, s27, 4096
    s_add_u32 s29, s26, 433152
    buffer_load_dwordx4 v161, s[8:11], s29 offen offset:1024 lds
    s_add_u32 s29, s25, 1703936
    buffer_load_dwordx4 v[80:83], v160, s[16:19], s29 offen offset:0
    v_mfma_f32_16x16x32_bf16 v[32:35], v[144:147], v[88:91], v[32:35]
    v_mfma_f32_16x16x32_bf16 v[36:39], v[148:151], v[88:91], v[36:39]
    s_add_u32 m0, s27, 4096
    s_add_u32 s29, s26, 440320
    buffer_load_dwordx4 v161, s[8:11], s29 offen offset:2048 lds
    v_mfma_f32_16x16x32_bf16 v[40:43], v[152:155], v[88:91], v[40:43]
    v_mfma_f32_16x16x32_bf16 v[44:47], v[156:159], v[88:91], v[44:47]
    s_add_u32 m0, s27, 4096
    s_add_u32 s29, s26, 447488
    buffer_load_dwordx4 v161, s[8:11], s29 offen offset:3072 lds
    s_add_u32 s29, s25, 1703936
    buffer_load_dwordx4 v[84:87], v160, s[16:19], s29 offen offset:1024
    v_mfma_f32_16x16x32_bf16 v[48:51], v[144:147], v[92:95], v[48:51]
    v_mfma_f32_16x16x32_bf16 v[52:55], v[148:151], v[92:95], v[52:55]
    v_mfma_f32_16x16x32_bf16 v[56:59], v[152:155], v[92:95], v[56:59]
    v_mfma_f32_16x16x32_bf16 v[60:63], v[156:159], v[92:95], v[60:63]
    s_add_u32 s29, s25, 1703936
    buffer_load_dwordx4 v[88:91], v160, s[16:19], s29 offen offset:2048
    s_add_u32 s29, s25, 1703936
    buffer_load_dwordx4 v[92:95], v160, s[16:19], s29 offen offset:3072
    s_waitcnt lgkmcnt(6)
    v_mfma_f32_16x16x32_bf16 v[0:3], v[128:131], v[96:99], v[0:3]
    s_waitcnt lgkmcnt(4)
    v_mfma_f32_16x16x32_bf16 v[4:7], v[132:135], v[96:99], v[4:7]
    s_waitcnt lgkmcnt(2)
    v_mfma_f32_16x16x32_bf16 v[8:11], v[136:139], v[96:99], v[8:11]
    s_waitcnt lgkmcnt(0)
    v_mfma_f32_16x16x32_bf16 v[12:15], v[140:143], v[96:99], v[12:15]
    s_waitcnt vmcnt(19)
    ds_read_b64_tr_b16 v[144:145], v162 offset:12288
    ds_read_b64_tr_b16 v[146:147], v162 offset:14336
    ds_read_b64_tr_b16 v[148:149], v163 offset:12288
    ds_read_b64_tr_b16 v[150:151], v163 offset:14336
    ds_read_b64_tr_b16 v[152:153], v164 offset:12288
    ds_read_b64_tr_b16 v[154:155], v164 offset:14336
    ds_read_b64_tr_b16 v[156:157], v165 offset:12288
    ds_read_b64_tr_b16 v[158:159], v165 offset:14336
    v_mfma_f32_16x16x32_bf16 v[16:19], v[128:131], v[100:103], v[16:19]
    v_mfma_f32_16x16x32_bf16 v[20:23], v[132:135], v[100:103], v[20:23]
    s_add_u32 m0, s27, 8192
    s_add_u32 s29, s26, 458752
    buffer_load_dwordx4 v161, s[8:11], s29 offen offset:0 lds
    v_mfma_f32_16x16x32_bf16 v[24:27], v[136:139], v[100:103], v[24:27]
    v_mfma_f32_16x16x32_bf16 v[28:31], v[140:143], v[100:103], v[28:31]
    s_add_u32 m0, s27, 8192
    s_add_u32 s29, s26, 465920
    buffer_load_dwordx4 v161, s[8:11], s29 offen offset:1024 lds
    s_add_u32 s29, s25, 1835008
    buffer_load_dwordx4 v[96:99], v160, s[16:19], s29 offen offset:0
    v_mfma_f32_16x16x32_bf16 v[32:35], v[128:131], v[104:107], v[32:35]
    v_mfma_f32_16x16x32_bf16 v[36:39], v[132:135], v[104:107], v[36:39]
    s_add_u32 m0, s27, 8192
    s_add_u32 s29, s26, 473088
    buffer_load_dwordx4 v161, s[8:11], s29 offen offset:2048 lds
    v_mfma_f32_16x16x32_bf16 v[40:43], v[136:139], v[104:107], v[40:43]
    v_mfma_f32_16x16x32_bf16 v[44:47], v[140:143], v[104:107], v[44:47]
    s_add_u32 m0, s27, 8192
    s_add_u32 s29, s26, 480256
    buffer_load_dwordx4 v161, s[8:11], s29 offen offset:3072 lds
    s_add_u32 s29, s25, 1835008
    buffer_load_dwordx4 v[100:103], v160, s[16:19], s29 offen offset:1024
    v_mfma_f32_16x16x32_bf16 v[48:51], v[128:131], v[108:111], v[48:51]
    v_mfma_f32_16x16x32_bf16 v[52:55], v[132:135], v[108:111], v[52:55]
    v_mfma_f32_16x16x32_bf16 v[56:59], v[136:139], v[108:111], v[56:59]
    v_mfma_f32_16x16x32_bf16 v[60:63], v[140:143], v[108:111], v[60:63]
    s_add_u32 s29, s25, 1835008
    buffer_load_dwordx4 v[104:107], v160, s[16:19], s29 offen offset:2048
    s_add_u32 s29, s25, 1835008
    buffer_load_dwordx4 v[108:111], v160, s[16:19], s29 offen offset:3072
    s_waitcnt lgkmcnt(6)
    v_mfma_f32_16x16x32_bf16 v[0:3], v[144:147], v[112:115], v[0:3]
    s_waitcnt lgkmcnt(4)
    v_mfma_f32_16x16x32_bf16 v[4:7], v[148:151], v[112:115], v[4:7]
    s_waitcnt lgkmcnt(2)
    v_mfma_f32_16x16x32_bf16 v[8:11], v[152:155], v[112:115], v[8:11]
    s_waitcnt lgkmcnt(0)
    v_mfma_f32_16x16x32_bf16 v[12:15], v[156:159], v[112:115], v[12:15]
    s_waitcnt vmcnt(19)
    ds_read_b64_tr_b16 v[128:129], v162 offset:0
    ds_read_b64_tr_b16 v[130:131], v162 offset:2048
    ds_read_b64_tr_b16 v[132:133], v163 offset:0
    ds_read_b64_tr_b16 v[134:135], v163 offset:2048
    ds_read_b64_tr_b16 v[136:137], v164 offset:0
    ds_read_b64_tr_b16 v[138:139], v164 offset:2048
    ds_read_b64_tr_b16 v[140:141], v165 offset:0
    ds_read_b64_tr_b16 v[142:143], v165 offset:2048
    v_mfma_f32_16x16x32_bf16 v[16:19], v[144:147], v[116:119], v[16:19]
    v_mfma_f32_16x16x32_bf16 v[20:23], v[148:151], v[116:119], v[20:23]
    s_add_u32 m0, s27, 12288
    s_add_u32 s29, s26, 491520
    buffer_load_dwordx4 v161, s[8:11], s29 offen offset:0 lds
    v_mfma_f32_16x16x32_bf16 v[24:27], v[152:155], v[116:119], v[24:27]
    v_mfma_f32_16x16x32_bf16 v[28:31], v[156:159], v[116:119], v[28:31]
    s_add_u32 m0, s27, 12288
    s_add_u32 s29, s26, 498688
    buffer_load_dwordx4 v161, s[8:11], s29 offen offset:1024 lds
    s_add_u32 s29, s25, 1966080
    buffer_load_dwordx4 v[112:115], v160, s[16:19], s29 offen offset:0
    v_mfma_f32_16x16x32_bf16 v[32:35], v[144:147], v[120:123], v[32:35]
    v_mfma_f32_16x16x32_bf16 v[36:39], v[148:151], v[120:123], v[36:39]
    s_add_u32 m0, s27, 12288
    s_add_u32 s29, s26, 505856
    buffer_load_dwordx4 v161, s[8:11], s29 offen offset:2048 lds
    v_mfma_f32_16x16x32_bf16 v[40:43], v[152:155], v[120:123], v[40:43]
    v_mfma_f32_16x16x32_bf16 v[44:47], v[156:159], v[120:123], v[44:47]
    s_add_u32 m0, s27, 12288
    s_add_u32 s29, s26, 513024
    buffer_load_dwordx4 v161, s[8:11], s29 offen offset:3072 lds
    s_add_u32 s29, s25, 1966080
    buffer_load_dwordx4 v[116:119], v160, s[16:19], s29 offen offset:1024
    v_mfma_f32_16x16x32_bf16 v[48:51], v[144:147], v[124:127], v[48:51]
    v_mfma_f32_16x16x32_bf16 v[52:55], v[148:151], v[124:127], v[52:55]
    v_mfma_f32_16x16x32_bf16 v[56:59], v[152:155], v[124:127], v[56:59]
    v_mfma_f32_16x16x32_bf16 v[60:63], v[156:159], v[124:127], v[60:63]
    s_add_u32 s29, s25, 1966080
    buffer_load_dwordx4 v[120:123], v160, s[16:19], s29 offen offset:2048
    s_add_u32 s29, s25, 1966080
    buffer_load_dwordx4 v[124:127], v160, s[16:19], s29 offen offset:3072
    s_waitcnt lgkmcnt(6)
    v_mfma_f32_16x16x32_bf16 v[0:3], v[128:131], v[64:67], v[0:3]
    s_waitcnt lgkmcnt(4)
    v_mfma_f32_16x16x32_bf16 v[4:7], v[132:135], v[64:67], v[4:7]
    s_waitcnt lgkmcnt(2)
    v_mfma_f32_16x16x32_bf16 v[8:11], v[136:139], v[64:67], v[8:11]
    s_waitcnt lgkmcnt(0)
    v_mfma_f32_16x16x32_bf16 v[12:15], v[140:143], v[64:67], v[12:15]
    s_waitcnt vmcnt(19)
    ds_read_b64_tr_b16 v[144:145], v162 offset:4096
    ds_read_b64_tr_b16 v[146:147], v162 offset:6144
    ds_read_b64_tr_b16 v[148:149], v163 offset:4096
    ds_read_b64_tr_b16 v[150:151], v163 offset:6144
    ds_read_b64_tr_b16 v[152:153], v164 offset:4096
    ds_read_b64_tr_b16 v[154:155], v164 offset:6144
    ds_read_b64_tr_b16 v[156:157], v165 offset:4096
    ds_read_b64_tr_b16 v[158:159], v165 offset:6144
    v_mfma_f32_16x16x32_bf16 v[16:19], v[128:131], v[68:71], v[16:19]
    v_mfma_f32_16x16x32_bf16 v[20:23], v[132:135], v[68:71], v[20:23]
    s_add_u32 m0, s27, 0
    s_add_u32 s29, s26, 524288
    buffer_load_dwordx4 v161, s[8:11], s29 offen offset:0 lds
    v_mfma_f32_16x16x32_bf16 v[24:27], v[136:139], v[68:71], v[24:27]
    v_mfma_f32_16x16x32_bf16 v[28:31], v[140:143], v[68:71], v[28:31]
    s_add_u32 m0, s27, 0
    s_add_u32 s29, s26, 531456
    buffer_load_dwordx4 v161, s[8:11], s29 offen offset:1024 lds
    s_add_u32 s29, s25, 2097152
    buffer_load_dwordx4 v[64:67], v160, s[16:19], s29 offen offset:0
    v_mfma_f32_16x16x32_bf16 v[32:35], v[128:131], v[72:75], v[32:35]
    v_mfma_f32_16x16x32_bf16 v[36:39], v[132:135], v[72:75], v[36:39]
    s_add_u32 m0, s27, 0
    s_add_u32 s29, s26, 538624
    buffer_load_dwordx4 v161, s[8:11], s29 offen offset:2048 lds
    v_mfma_f32_16x16x32_bf16 v[40:43], v[136:139], v[72:75], v[40:43]
    v_mfma_f32_16x16x32_bf16 v[44:47], v[140:143], v[72:75], v[44:47]
    s_add_u32 m0, s27, 0
    s_add_u32 s29, s26, 545792
    buffer_load_dwordx4 v161, s[8:11], s29 offen offset:3072 lds
    s_add_u32 s29, s25, 2097152
    buffer_load_dwordx4 v[68:71], v160, s[16:19], s29 offen offset:1024
    v_mfma_f32_16x16x32_bf16 v[48:51], v[128:131], v[76:79], v[48:51]
    v_mfma_f32_16x16x32_bf16 v[52:55], v[132:135], v[76:79], v[52:55]
    v_mfma_f32_16x16x32_bf16 v[56:59], v[136:139], v[76:79], v[56:59]
    v_mfma_f32_16x16x32_bf16 v[60:63], v[140:143], v[76:79], v[60:63]
    s_add_u32 s29, s25, 2097152
    buffer_load_dwordx4 v[72:75], v160, s[16:19], s29 offen offset:2048
    s_add_u32 s29, s25, 2097152
    buffer_load_dwordx4 v[76:79], v160, s[16:19], s29 offen offset:3072
    s_waitcnt lgkmcnt(6)
    v_mfma_f32_16x16x32_bf16 v[0:3], v[144:147], v[80:83], v[0:3]
    s_waitcnt lgkmcnt(4)
    v_mfma_f32_16x16x32_bf16 v[4:7], v[148:151], v[80:83], v[4:7]
    s_waitcnt lgkmcnt(2)
    v_mfma_f32_16x16x32_bf16 v[8:11], v[152:155], v[80:83], v[8:11]
    s_waitcnt lgkmcnt(0)
    v_mfma_f32_16x16x32_bf16 v[12:15], v[156:159], v[80:83], v[12:15]
    s_waitcnt vmcnt(19)
    ds_read_b64_tr_b16 v[128:129], v162 offset:8192
    ds_read_b64_tr_b16 v[130:131], v162 offset:10240
    ds_read_b64_tr_b16 v[132:133], v163 offset:8192
    ds_read_b64_tr_b16 v[134:135], v163 offset:10240
    ds_read_b64_tr_b16 v[136:137], v164 offset:8192
    ds_read_b64_tr_b16 v[138:139], v164 offset:10240
    ds_read_b64_tr_b16 v[140:141], v165 offset:8192
    ds_read_b64_tr_b16 v[142:143], v165 offset:10240
    v_mfma_f32_16x16x32_bf16 v[16:19], v[144:147], v[84:87], v[16:19]
    v_mfma_f32_16x16x32_bf16 v[20:23], v[148:151], v[84:87], v[20:23]
    s_add_u32 m0, s27, 4096
    s_add_u32 s29, s26, 557056
    buffer_load_dwordx4 v161, s[8:11], s29 offen offset:0 lds
    v_mfma_f32_16x16x32_bf16 v[24:27], v[152:155], v[84:87], v[24:27]
    v_mfma_f32_16x16x32_bf16 v[28:31], v[156:159], v[84:87], v[28:31]
    s_add_u32 m0, s27, 4096
    s_add_u32 s29, s26, 564224
    buffer_load_dwordx4 v161, s[8:11], s29 offen offset:1024 lds
    s_add_u32 s29, s25, 2228224
    buffer_load_dwordx4 v[80:83], v160, s[16:19], s29 offen offset:0
    v_mfma_f32_16x16x32_bf16 v[32:35], v[144:147], v[88:91], v[32:35]
    v_mfma_f32_16x16x32_bf16 v[36:39], v[148:151], v[88:91], v[36:39]
    s_add_u32 m0, s27, 4096
    s_add_u32 s29, s26, 571392
    buffer_load_dwordx4 v161, s[8:11], s29 offen offset:2048 lds
    v_mfma_f32_16x16x32_bf16 v[40:43], v[152:155], v[88:91], v[40:43]
    v_mfma_f32_16x16x32_bf16 v[44:47], v[156:159], v[88:91], v[44:47]
    s_add_u32 m0, s27, 4096
    s_add_u32 s29, s26, 578560
    buffer_load_dwordx4 v161, s[8:11], s29 offen offset:3072 lds
    s_add_u32 s29, s25, 2228224
    buffer_load_dwordx4 v[84:87], v160, s[16:19], s29 offen offset:1024
    v_mfma_f32_16x16x32_bf16 v[48:51], v[144:147], v[92:95], v[48:51]
    v_mfma_f32_16x16x32_bf16 v[52:55], v[148:151], v[92:95], v[52:55]
    v_mfma_f32_16x16x32_bf16 v[56:59], v[152:155], v[92:95], v[56:59]
    v_mfma_f32_16x16x32_bf16 v[60:63], v[156:159], v[92:95], v[60:63]
    s_add_u32 s29, s25, 2228224
    buffer_load_dwordx4 v[88:91], v160, s[16:19], s29 offen offset:2048
    s_add_u32 s29, s25, 2228224
    buffer_load_dwordx4 v[92:95], v160, s[16:19], s29 offen offset:3072
    s_waitcnt lgkmcnt(6)
    v_mfma_f32_16x16x32_bf16 v[0:3], v[128:131], v[96:99], v[0:3]
    s_waitcnt lgkmcnt(4)
    v_mfma_f32_16x16x32_bf16 v[4:7], v[132:135], v[96:99], v[4:7]
    s_waitcnt lgkmcnt(2)
    v_mfma_f32_16x16x32_bf16 v[8:11], v[136:139], v[96:99], v[8:11]
    s_waitcnt lgkmcnt(0)
    v_mfma_f32_16x16x32_bf16 v[12:15], v[140:143], v[96:99], v[12:15]
    s_waitcnt vmcnt(19)
    ds_read_b64_tr_b16 v[144:145], v162 offset:12288
    ds_read_b64_tr_b16 v[146:147], v162 offset:14336
    ds_read_b64_tr_b16 v[148:149], v163 offset:12288
    ds_read_b64_tr_b16 v[150:151], v163 offset:14336
    ds_read_b64_tr_b16 v[152:153], v164 offset:12288
    ds_read_b64_tr_b16 v[154:155], v164 offset:14336
    ds_read_b64_tr_b16 v[156:157], v165 offset:12288
    ds_read_b64_tr_b16 v[158:159], v165 offset:14336
    v_mfma_f32_16x16x32_bf16 v[16:19], v[128:131], v[100:103], v[16:19]
    v_mfma_f32_16x16x32_bf16 v[20:23], v[132:135], v[100:103], v[20:23]
    s_add_u32 m0, s27, 8192
    s_add_u32 s29, s26, 589824
    buffer_load_dwordx4 v161, s[8:11], s29 offen offset:0 lds
    v_mfma_f32_16x16x32_bf16 v[24:27], v[136:139], v[100:103], v[24:27]
    v_mfma_f32_16x16x32_bf16 v[28:31], v[140:143], v[100:103], v[28:31]
    s_add_u32 m0, s27, 8192
    s_add_u32 s29, s26, 596992
    buffer_load_dwordx4 v161, s[8:11], s29 offen offset:1024 lds
    s_add_u32 s29, s25, 2359296
    buffer_load_dwordx4 v[96:99], v160, s[16:19], s29 offen offset:0
    v_mfma_f32_16x16x32_bf16 v[32:35], v[128:131], v[104:107], v[32:35]
    v_mfma_f32_16x16x32_bf16 v[36:39], v[132:135], v[104:107], v[36:39]
    s_add_u32 m0, s27, 8192
    s_add_u32 s29, s26, 604160
    buffer_load_dwordx4 v161, s[8:11], s29 offen offset:2048 lds
    v_mfma_f32_16x16x32_bf16 v[40:43], v[136:139], v[104:107], v[40:43]
    v_mfma_f32_16x16x32_bf16 v[44:47], v[140:143], v[104:107], v[44:47]
    s_add_u32 m0, s27, 8192
    s_add_u32 s29, s26, 611328
    buffer_load_dwordx4 v161, s[8:11], s29 offen offset:3072 lds
    s_add_u32 s29, s25, 2359296
    buffer_load_dwordx4 v[100:103], v160, s[16:19], s29 offen offset:1024
    v_mfma_f32_16x16x32_bf16 v[48:51], v[128:131], v[108:111], v[48:51]
    v_mfma_f32_16x16x32_bf16 v[52:55], v[132:135], v[108:111], v[52:55]
    v_mfma_f32_16x16x32_bf16 v[56:59], v[136:139], v[108:111], v[56:59]
    v_mfma_f32_16x16x32_bf16 v[60:63], v[140:143], v[108:111], v[60:63]
    s_add_u32 s29, s25, 2359296
    buffer_load_dwordx4 v[104:107], v160, s[16:19], s29 offen offset:2048
    s_add_u32 s29, s25, 2359296
    buffer_load_dwordx4 v[108:111], v160, s[16:19], s29 offen offset:3072
    s_waitcnt lgkmcnt(6)
    v_mfma_f32_16x16x32_bf16 v[0:3], v[144:147], v[112:115], v[0:3]
    s_waitcnt lgkmcnt(4)
    v_mfma_f32_16x16x32_bf16 v[4:7], v[148:151], v[112:115], v[4:7]
    s_waitcnt lgkmcnt(2)
    v_mfma_f32_16x16x32_bf16 v[8:11], v[152:155], v[112:115], v[8:11]
    s_waitcnt lgkmcnt(0)
    v_mfma_f32_16x16x32_bf16 v[12:15], v[156:159], v[112:115], v[12:15]
    s_waitcnt vmcnt(19)
    ds_read_b64_tr_b16 v[128:129], v162 offset:0
    ds_read_b64_tr_b16 v[130:131], v162 offset:2048
    ds_read_b64_tr_b16 v[132:133], v163 offset:0
    ds_read_b64_tr_b16 v[134:135], v163 offset:2048
    ds_read_b64_tr_b16 v[136:137], v164 offset:0
    ds_read_b64_tr_b16 v[138:139], v164 offset:2048
    ds_read_b64_tr_b16 v[140:141], v165 offset:0
    ds_read_b64_tr_b16 v[142:143], v165 offset:2048
    v_mfma_f32_16x16x32_bf16 v[16:19], v[144:147], v[116:119], v[16:19]
    v_mfma_f32_16x16x32_bf16 v[20:23], v[148:151], v[116:119], v[20:23]
    s_add_u32 m0, s27, 12288
    s_add_u32 s29, s26, 622592
    buffer_load_dwordx4 v161, s[8:11], s29 offen offset:0 lds
    v_mfma_f32_16x16x32_bf16 v[24:27], v[152:155], v[116:119], v[24:27]
    v_mfma_f32_16x16x32_bf16 v[28:31], v[156:159], v[116:119], v[28:31]
    s_add_u32 m0, s27, 12288
    s_add_u32 s29, s26, 629760
    buffer_load_dwordx4 v161, s[8:11], s29 offen offset:1024 lds
    s_add_u32 s29, s25, 2490368
    buffer_load_dwordx4 v[112:115], v160, s[16:19], s29 offen offset:0
    v_mfma_f32_16x16x32_bf16 v[32:35], v[144:147], v[120:123], v[32:35]
    v_mfma_f32_16x16x32_bf16 v[36:39], v[148:151], v[120:123], v[36:39]
    s_add_u32 m0, s27, 12288
    s_add_u32 s29, s26, 636928
    buffer_load_dwordx4 v161, s[8:11], s29 offen offset:2048 lds
    v_mfma_f32_16x16x32_bf16 v[40:43], v[152:155], v[120:123], v[40:43]
    v_mfma_f32_16x16x32_bf16 v[44:47], v[156:159], v[120:123], v[44:47]
    s_add_u32 m0, s27, 12288
    s_add_u32 s29, s26, 644096
    buffer_load_dwordx4 v161, s[8:11], s29 offen offset:3072 lds
    s_add_u32 s29, s25, 2490368
    buffer_load_dwordx4 v[116:119], v160, s[16:19], s29 offen offset:1024
    v_mfma_f32_16x16x32_bf16 v[48:51], v[144:147], v[124:127], v[48:51]
    v_mfma_f32_16x16x32_bf16 v[52:55], v[148:151], v[124:127], v[52:55]
    v_mfma_f32_16x16x32_bf16 v[56:59], v[152:155], v[124:127], v[56:59]
    v_mfma_f32_16x16x32_bf16 v[60:63], v[156:159], v[124:127], v[60:63]
    s_add_u32 s29, s25, 2490368
    buffer_load_dwordx4 v[120:123], v160, s[16:19], s29 offen offset:2048
    s_add_u32 s29, s25, 2490368
    buffer_load_dwordx4 v[124:127], v160, s[16:19], s29 offen offset:3072
    s_waitcnt lgkmcnt(6)
    v_mfma_f32_16x16x32_bf16 v[0:3], v[128:131], v[64:67], v[0:3]
    s_waitcnt lgkmcnt(4)
    v_mfma_f32_16x16x32_bf16 v[4:7], v[132:135], v[64:67], v[4:7]
    s_waitcnt lgkmcnt(2)
    v_mfma_f32_16x16x32_bf16 v[8:11], v[136:139], v[64:67], v[8:11]
    s_waitcnt lgkmcnt(0)
    v_mfma_f32_16x16x32_bf16 v[12:15], v[140:143], v[64:67], v[12:15]
    s_waitcnt vmcnt(19)
    ds_read_b64_tr_b16 v[144:145], v162 offset:4096
    ds_read_b64_tr_b16 v[146:147], v162 offset:6144
    ds_read_b64_tr_b16 v[148:149], v163 offset:4096
    ds_read_b64_tr_b16 v[150:151], v163 offset:6144
    ds_read_b64_tr_b16 v[152:153], v164 offset:4096
    ds_read_b64_tr_b16 v[154:155], v164 offset:6144
    ds_read_b64_tr_b16 v[156:157], v165 offset:4096
    ds_read_b64_tr_b16 v[158:159], v165 offset:6144
    v_mfma_f32_16x16x32_bf16 v[16:19], v[128:131], v[68:71], v[16:19]
    v_mfma_f32_16x16x32_bf16 v[20:23], v[132:135], v[68:71], v[20:23]
    s_add_u32 m0, s27, 0
    s_add_u32 s29, s26, 655360
    buffer_load_dwordx4 v161, s[8:11], s29 offen offset:0 lds
    v_mfma_f32_16x16x32_bf16 v[24:27], v[136:139], v[68:71], v[24:27]
    v_mfma_f32_16x16x32_bf16 v[28:31], v[140:143], v[68:71], v[28:31]
    s_add_u32 m0, s27, 0
    s_add_u32 s29, s26, 662528
    buffer_load_dwordx4 v161, s[8:11], s29 offen offset:1024 lds
    s_add_u32 s29, s25, 2621440
    buffer_load_dwordx4 v[64:67], v160, s[16:19], s29 offen offset:0
    v_mfma_f32_16x16x32_bf16 v[32:35], v[128:131], v[72:75], v[32:35]
    v_mfma_f32_16x16x32_bf16 v[36:39], v[132:135], v[72:75], v[36:39]
    s_add_u32 m0, s27, 0
    s_add_u32 s29, s26, 669696
    buffer_load_dwordx4 v161, s[8:11], s29 offen offset:2048 lds
    v_mfma_f32_16x16x32_bf16 v[40:43], v[136:139], v[72:75], v[40:43]
    v_mfma_f32_16x16x32_bf16 v[44:47], v[140:143], v[72:75], v[44:47]
    s_add_u32 m0, s27, 0
    s_add_u32 s29, s26, 676864
    buffer_load_dwordx4 v161, s[8:11], s29 offen offset:3072 lds
    s_add_u32 s29, s25, 2621440
    buffer_load_dwordx4 v[68:71], v160, s[16:19], s29 offen offset:1024
    v_mfma_f32_16x16x32_bf16 v[48:51], v[128:131], v[76:79], v[48:51]
    v_mfma_f32_16x16x32_bf16 v[52:55], v[132:135], v[76:79], v[52:55]
    v_mfma_f32_16x16x32_bf16 v[56:59], v[136:139], v[76:79], v[56:59]
    v_mfma_f32_16x16x32_bf16 v[60:63], v[140:143], v[76:79], v[60:63]
    s_add_u32 s29, s25, 2621440
    buffer_load_dwordx4 v[72:75], v160, s[16:19], s29 offen offset:2048
    s_add_u32 s29, s25, 2621440
    buffer_load_dwordx4 v[76:79], v160, s[16:19], s29 offen offset:3072
    s_waitcnt lgkmcnt(6)
    v_mfma_f32_16x16x32_bf16 v[0:3], v[144:147], v[80:83], v[0:3]
    s_waitcnt lgkmcnt(4)
    v_mfma_f32_16x16x32_bf16 v[4:7], v[148:151], v[80:83], v[4:7]
    s_waitcnt lgkmcnt(2)
    v_mfma_f32_16x16x32_bf16 v[8:11], v[152:155], v[80:83], v[8:11]
    s_waitcnt lgkmcnt(0)
    v_mfma_f32_16x16x32_bf16 v[12:15], v[156:159], v[80:83], v[12:15]
    s_waitcnt vmcnt(19)
    ds_read_b64_tr_b16 v[128:129], v162 offset:8192
    ds_read_b64_tr_b16 v[130:131], v162 offset:10240
    ds_read_b64_tr_b16 v[132:133], v163 offset:8192
    ds_read_b64_tr_b16 v[134:135], v163 offset:10240
    ds_read_b64_tr_b16 v[136:137], v164 offset:8192
    ds_read_b64_tr_b16 v[138:139], v164 offset:10240
    ds_read_b64_tr_b16 v[140:141], v165 offset:8192
    ds_read_b64_tr_b16 v[142:143], v165 offset:10240
    v_mfma_f32_16x16x32_bf16 v[16:19], v[144:147], v[84:87], v[16:19]
    v_mfma_f32_16x16x32_bf16 v[20:23], v[148:151], v[84:87], v[20:23]
    s_add_u32 m0, s27, 4096
    s_add_u32 s29, s26, 688128
    buffer_load_dwordx4 v161, s[8:11], s29 offen offset:0 lds
    v_mfma_f32_16x16x32_bf16 v[24:27], v[152:155], v[84:87], v[24:27]
    v_mfma_f32_16x16x32_bf16 v[28:31], v[156:159], v[84:87], v[28:31]
    s_add_u32 m0, s27, 4096
    s_add_u32 s29, s26, 695296
    buffer_load_dwordx4 v161, s[8:11], s29 offen offset:1024 lds
    s_add_u32 s29, s25, 2752512
    buffer_load_dwordx4 v[80:83], v160, s[16:19], s29 offen offset:0
    v_mfma_f32_16x16x32_bf16 v[32:35], v[144:147], v[88:91], v[32:35]
    v_mfma_f32_16x16x32_bf16 v[36:39], v[148:151], v[88:91], v[36:39]
    s_add_u32 m0, s27, 4096
    s_add_u32 s29, s26, 702464
    buffer_load_dwordx4 v161, s[8:11], s29 offen offset:2048 lds
    v_mfma_f32_16x16x32_bf16 v[40:43], v[152:155], v[88:91], v[40:43]
    v_mfma_f32_16x16x32_bf16 v[44:47], v[156:159], v[88:91], v[44:47]
    s_add_u32 m0, s27, 4096
    s_add_u32 s29, s26, 709632
    buffer_load_dwordx4 v161, s[8:11], s29 offen offset:3072 lds
    s_add_u32 s29, s25, 2752512
    buffer_load_dwordx4 v[84:87], v160, s[16:19], s29 offen offset:1024
    v_mfma_f32_16x16x32_bf16 v[48:51], v[144:147], v[92:95], v[48:51]
    v_mfma_f32_16x16x32_bf16 v[52:55], v[148:151], v[92:95], v[52:55]
    v_mfma_f32_16x16x32_bf16 v[56:59], v[152:155], v[92:95], v[56:59]
    v_mfma_f32_16x16x32_bf16 v[60:63], v[156:159], v[92:95], v[60:63]
    s_add_u32 s29, s25, 2752512
    buffer_load_dwordx4 v[88:91], v160, s[16:19], s29 offen offset:2048
    s_add_u32 s29, s25, 2752512
    buffer_load_dwordx4 v[92:95], v160, s[16:19], s29 offen offset:3072
    s_waitcnt lgkmcnt(6)
    v_mfma_f32_16x16x32_bf16 v[0:3], v[128:131], v[96:99], v[0:3]
    s_waitcnt lgkmcnt(4)
    v_mfma_f32_16x16x32_bf16 v[4:7], v[132:135], v[96:99], v[4:7]
    s_waitcnt lgkmcnt(2)
    v_mfma_f32_16x16x32_bf16 v[8:11], v[136:139], v[96:99], v[8:11]
    s_waitcnt lgkmcnt(0)
    v_mfma_f32_16x16x32_bf16 v[12:15], v[140:143], v[96:99], v[12:15]
    s_waitcnt vmcnt(19)
    ds_read_b64_tr_b16 v[144:145], v162 offset:12288
    ds_read_b64_tr_b16 v[146:147], v162 offset:14336
    ds_read_b64_tr_b16 v[148:149], v163 offset:12288
    ds_read_b64_tr_b16 v[150:151], v163 offset:14336
    ds_read_b64_tr_b16 v[152:153], v164 offset:12288
    ds_read_b64_tr_b16 v[154:155], v164 offset:14336
    ds_read_b64_tr_b16 v[156:157], v165 offset:12288
    ds_read_b64_tr_b16 v[158:159], v165 offset:14336
    v_mfma_f32_16x16x32_bf16 v[16:19], v[128:131], v[100:103], v[16:19]
    v_mfma_f32_16x16x32_bf16 v[20:23], v[132:135], v[100:103], v[20:23]
    s_add_u32 m0, s27, 8192
    s_add_u32 s29, s26, 720896
    buffer_load_dwordx4 v161, s[8:11], s29 offen offset:0 lds
    v_mfma_f32_16x16x32_bf16 v[24:27], v[136:139], v[100:103], v[24:27]
    v_mfma_f32_16x16x32_bf16 v[28:31], v[140:143], v[100:103], v[28:31]
    s_add_u32 m0, s27, 8192
    s_add_u32 s29, s26, 728064
    buffer_load_dwordx4 v161, s[8:11], s29 offen offset:1024 lds
    s_add_u32 s29, s25, 2883584
    buffer_load_dwordx4 v[96:99], v160, s[16:19], s29 offen offset:0
    v_mfma_f32_16x16x32_bf16 v[32:35], v[128:131], v[104:107], v[32:35]
    v_mfma_f32_16x16x32_bf16 v[36:39], v[132:135], v[104:107], v[36:39]
    s_add_u32 m0, s27, 8192
    s_add_u32 s29, s26, 735232
    buffer_load_dwordx4 v161, s[8:11], s29 offen offset:2048 lds
    v_mfma_f32_16x16x32_bf16 v[40:43], v[136:139], v[104:107], v[40:43]
    v_mfma_f32_16x16x32_bf16 v[44:47], v[140:143], v[104:107], v[44:47]
    s_add_u32 m0, s27, 8192
    s_add_u32 s29, s26, 742400
    buffer_load_dwordx4 v161, s[8:11], s29 offen offset:3072 lds
    s_add_u32 s29, s25, 2883584
    buffer_load_dwordx4 v[100:103], v160, s[16:19], s29 offen offset:1024
    v_mfma_f32_16x16x32_bf16 v[48:51], v[128:131], v[108:111], v[48:51]
    v_mfma_f32_16x16x32_bf16 v[52:55], v[132:135], v[108:111], v[52:55]
    v_mfma_f32_16x16x32_bf16 v[56:59], v[136:139], v[108:111], v[56:59]
    v_mfma_f32_16x16x32_bf16 v[60:63], v[140:143], v[108:111], v[60:63]
    s_add_u32 s29, s25, 2883584
    buffer_load_dwordx4 v[104:107], v160, s[16:19], s29 offen offset:2048
    s_add_u32 s29, s25, 2883584
    buffer_load_dwordx4 v[108:111], v160, s[16:19], s29 offen offset:3072
    s_waitcnt lgkmcnt(6)
    v_mfma_f32_16x16x32_bf16 v[0:3], v[144:147], v[112:115], v[0:3]
    s_waitcnt lgkmcnt(4)
    v_mfma_f32_16x16x32_bf16 v[4:7], v[148:151], v[112:115], v[4:7]
    s_waitcnt lgkmcnt(2)
    v_mfma_f32_16x16x32_bf16 v[8:11], v[152:155], v[112:115], v[8:11]
    s_waitcnt lgkmcnt(0)
    v_mfma_f32_16x16x32_bf16 v[12:15], v[156:159], v[112:115], v[12:15]
    s_waitcnt vmcnt(19)
    ds_read_b64_tr_b16 v[128:129], v162 offset:0
    ds_read_b64_tr_b16 v[130:131], v162 offset:2048
    ds_read_b64_tr_b16 v[132:133], v163 offset:0
    ds_read_b64_tr_b16 v[134:135], v163 offset:2048
    ds_read_b64_tr_b16 v[136:137], v164 offset:0
    ds_read_b64_tr_b16 v[138:139], v164 offset:2048
    ds_read_b64_tr_b16 v[140:141], v165 offset:0
    ds_read_b64_tr_b16 v[142:143], v165 offset:2048
    v_mfma_f32_16x16x32_bf16 v[16:19], v[144:147], v[116:119], v[16:19]
    v_mfma_f32_16x16x32_bf16 v[20:23], v[148:151], v[116:119], v[20:23]
    s_add_u32 m0, s27, 12288
    s_add_u32 s29, s26, 753664
    buffer_load_dwordx4 v161, s[8:11], s29 offen offset:0 lds
    v_mfma_f32_16x16x32_bf16 v[24:27], v[152:155], v[116:119], v[24:27]
    v_mfma_f32_16x16x32_bf16 v[28:31], v[156:159], v[116:119], v[28:31]
    s_add_u32 m0, s27, 12288
    s_add_u32 s29, s26, 760832
    buffer_load_dwordx4 v161, s[8:11], s29 offen offset:1024 lds
    s_add_u32 s29, s25, 3014656
    buffer_load_dwordx4 v[112:115], v160, s[16:19], s29 offen offset:0
    v_mfma_f32_16x16x32_bf16 v[32:35], v[144:147], v[120:123], v[32:35]
    v_mfma_f32_16x16x32_bf16 v[36:39], v[148:151], v[120:123], v[36:39]
    s_add_u32 m0, s27, 12288
    s_add_u32 s29, s26, 768000
    buffer_load_dwordx4 v161, s[8:11], s29 offen offset:2048 lds
    v_mfma_f32_16x16x32_bf16 v[40:43], v[152:155], v[120:123], v[40:43]
    v_mfma_f32_16x16x32_bf16 v[44:47], v[156:159], v[120:123], v[44:47]
    s_add_u32 m0, s27, 12288
    s_add_u32 s29, s26, 775168
    buffer_load_dwordx4 v161, s[8:11], s29 offen offset:3072 lds
    s_add_u32 s29, s25, 3014656
    buffer_load_dwordx4 v[116:119], v160, s[16:19], s29 offen offset:1024
    v_mfma_f32_16x16x32_bf16 v[48:51], v[144:147], v[124:127], v[48:51]
    v_mfma_f32_16x16x32_bf16 v[52:55], v[148:151], v[124:127], v[52:55]
    v_mfma_f32_16x16x32_bf16 v[56:59], v[152:155], v[124:127], v[56:59]
    v_mfma_f32_16x16x32_bf16 v[60:63], v[156:159], v[124:127], v[60:63]
    s_add_u32 s29, s25, 3014656
    buffer_load_dwordx4 v[120:123], v160, s[16:19], s29 offen offset:2048
    s_add_u32 s29, s25, 3014656
    buffer_load_dwordx4 v[124:127], v160, s[16:19], s29 offen offset:3072
    s_waitcnt lgkmcnt(6)
    v_mfma_f32_16x16x32_bf16 v[0:3], v[128:131], v[64:67], v[0:3]
    s_waitcnt lgkmcnt(4)
    v_mfma_f32_16x16x32_bf16 v[4:7], v[132:135], v[64:67], v[4:7]
    s_waitcnt lgkmcnt(2)
    v_mfma_f32_16x16x32_bf16 v[8:11], v[136:139], v[64:67], v[8:11]
    s_waitcnt lgkmcnt(0)
    v_mfma_f32_16x16x32_bf16 v[12:15], v[140:143], v[64:67], v[12:15]
    s_waitcnt vmcnt(19)
    ds_read_b64_tr_b16 v[144:145], v162 offset:4096
    ds_read_b64_tr_b16 v[146:147], v162 offset:6144
    ds_read_b64_tr_b16 v[148:149], v163 offset:4096
    ds_read_b64_tr_b16 v[150:151], v163 offset:6144
    ds_read_b64_tr_b16 v[152:153], v164 offset:4096
    ds_read_b64_tr_b16 v[154:155], v164 offset:6144
    ds_read_b64_tr_b16 v[156:157], v165 offset:4096
    ds_read_b64_tr_b16 v[158:159], v165 offset:6144
    v_mfma_f32_16x16x32_bf16 v[16:19], v[128:131], v[68:71], v[16:19]
    v_mfma_f32_16x16x32_bf16 v[20:23], v[132:135], v[68:71], v[20:23]
    s_add_u32 m0, s27, 0
    s_add_u32 s29, s26, 786432
    buffer_load_dwordx4 v161, s[8:11], s29 offen offset:0 lds
    v_mfma_f32_16x16x32_bf16 v[24:27], v[136:139], v[68:71], v[24:27]
    v_mfma_f32_16x16x32_bf16 v[28:31], v[140:143], v[68:71], v[28:31]
    s_add_u32 m0, s27, 0
    s_add_u32 s29, s26, 793600
    buffer_load_dwordx4 v161, s[8:11], s29 offen offset:1024 lds
    s_add_u32 s29, s25, 3145728
    buffer_load_dwordx4 v[64:67], v160, s[16:19], s29 offen offset:0
    v_mfma_f32_16x16x32_bf16 v[32:35], v[128:131], v[72:75], v[32:35]
    v_mfma_f32_16x16x32_bf16 v[36:39], v[132:135], v[72:75], v[36:39]
    s_add_u32 m0, s27, 0
    s_add_u32 s29, s26, 800768
    buffer_load_dwordx4 v161, s[8:11], s29 offen offset:2048 lds
    v_mfma_f32_16x16x32_bf16 v[40:43], v[136:139], v[72:75], v[40:43]
    v_mfma_f32_16x16x32_bf16 v[44:47], v[140:143], v[72:75], v[44:47]
    s_add_u32 m0, s27, 0
    s_add_u32 s29, s26, 807936
    buffer_load_dwordx4 v161, s[8:11], s29 offen offset:3072 lds
    s_add_u32 s29, s25, 3145728
    buffer_load_dwordx4 v[68:71], v160, s[16:19], s29 offen offset:1024
    v_mfma_f32_16x16x32_bf16 v[48:51], v[128:131], v[76:79], v[48:51]
    v_mfma_f32_16x16x32_bf16 v[52:55], v[132:135], v[76:79], v[52:55]
    v_mfma_f32_16x16x32_bf16 v[56:59], v[136:139], v[76:79], v[56:59]
    v_mfma_f32_16x16x32_bf16 v[60:63], v[140:143], v[76:79], v[60:63]
    s_add_u32 s29, s25, 3145728
    buffer_load_dwordx4 v[72:75], v160, s[16:19], s29 offen offset:2048
    s_add_u32 s29, s25, 3145728
    buffer_load_dwordx4 v[76:79], v160, s[16:19], s29 offen offset:3072
    s_waitcnt lgkmcnt(6)
    v_mfma_f32_16x16x32_bf16 v[0:3], v[144:147], v[80:83], v[0:3]
    s_waitcnt lgkmcnt(4)
    v_mfma_f32_16x16x32_bf16 v[4:7], v[148:151], v[80:83], v[4:7]
    s_waitcnt lgkmcnt(2)
    v_mfma_f32_16x16x32_bf16 v[8:11], v[152:155], v[80:83], v[8:11]
    s_waitcnt lgkmcnt(0)
    v_mfma_f32_16x16x32_bf16 v[12:15], v[156:159], v[80:83], v[12:15]
    s_waitcnt vmcnt(19)
    ds_read_b64_tr_b16 v[128:129], v162 offset:8192
    ds_read_b64_tr_b16 v[130:131], v162 offset:10240
    ds_read_b64_tr_b16 v[132:133], v163 offset:8192
    ds_read_b64_tr_b16 v[134:135], v163 offset:10240
    ds_read_b64_tr_b16 v[136:137], v164 offset:8192
    ds_read_b64_tr_b16 v[138:139], v164 offset:10240
    ds_read_b64_tr_b16 v[140:141], v165 offset:8192
    ds_read_b64_tr_b16 v[142:143], v165 offset:10240
    v_mfma_f32_16x16x32_bf16 v[16:19], v[144:147], v[84:87], v[16:19]
    v_mfma_f32_16x16x32_bf16 v[20:23], v[148:151], v[84:87], v[20:23]
    s_add_u32 m0, s27, 4096
    s_add_u32 s29, s26, 819200
    buffer_load_dwordx4 v161, s[8:11], s29 offen offset:0 lds
    v_mfma_f32_16x16x32_bf16 v[24:27], v[152:155], v[84:87], v[24:27]
    v_mfma_f32_16x16x32_bf16 v[28:31], v[156:159], v[84:87], v[28:31]
    s_add_u32 m0, s27, 4096
    s_add_u32 s29, s26, 826368
    buffer_load_dwordx4 v161, s[8:11], s29 offen offset:1024 lds
    s_add_u32 s29, s25, 3276800
    buffer_load_dwordx4 v[80:83], v160, s[16:19], s29 offen offset:0
    v_mfma_f32_16x16x32_bf16 v[32:35], v[144:147], v[88:91], v[32:35]
    v_mfma_f32_16x16x32_bf16 v[36:39], v[148:151], v[88:91], v[36:39]
    s_add_u32 m0, s27, 4096
    s_add_u32 s29, s26, 833536
    buffer_load_dwordx4 v161, s[8:11], s29 offen offset:2048 lds
    v_mfma_f32_16x16x32_bf16 v[40:43], v[152:155], v[88:91], v[40:43]
    v_mfma_f32_16x16x32_bf16 v[44:47], v[156:159], v[88:91], v[44:47]
    s_add_u32 m0, s27, 4096
    s_add_u32 s29, s26, 840704
    buffer_load_dwordx4 v161, s[8:11], s29 offen offset:3072 lds
    s_add_u32 s29, s25, 3276800
    buffer_load_dwordx4 v[84:87], v160, s[16:19], s29 offen offset:1024
    v_mfma_f32_16x16x32_bf16 v[48:51], v[144:147], v[92:95], v[48:51]
    v_mfma_f32_16x16x32_bf16 v[52:55], v[148:151], v[92:95], v[52:55]
    v_mfma_f32_16x16x32_bf16 v[56:59], v[152:155], v[92:95], v[56:59]
    v_mfma_f32_16x16x32_bf16 v[60:63], v[156:159], v[92:95], v[60:63]
    s_add_u32 s29, s25, 3276800
    buffer_load_dwordx4 v[88:91], v160, s[16:19], s29 offen offset:2048
    s_add_u32 s29, s25, 3276800
    buffer_load_dwordx4 v[92:95], v160, s[16:19], s29 offen offset:3072
    s_waitcnt lgkmcnt(6)
    v_mfma_f32_16x16x32_bf16 v[0:3], v[128:131], v[96:99], v[0:3]
    s_waitcnt lgkmcnt(4)
    v_mfma_f32_16x16x32_bf16 v[4:7], v[132:135], v[96:99], v[4:7]
    s_waitcnt lgkmcnt(2)
    v_mfma_f32_16x16x32_bf16 v[8:11], v[136:139], v[96:99], v[8:11]
    s_waitcnt lgkmcnt(0)
    v_mfma_f32_16x16x32_bf16 v[12:15], v[140:143], v[96:99], v[12:15]
    s_waitcnt vmcnt(19)
    ds_read_b64_tr_b16 v[144:145], v162 offset:12288
    ds_read_b64_tr_b16 v[146:147], v162 offset:14336
    ds_read_b64_tr_b16 v[148:149], v163 offset:12288
    ds_read_b64_tr_b16 v[150:151], v163 offset:14336
    ds_read_b64_tr_b16 v[152:153], v164 offset:12288
    ds_read_b64_tr_b16 v[154:155], v164 offset:14336
    ds_read_b64_tr_b16 v[156:157], v165 offset:12288
    ds_read_b64_tr_b16 v[158:159], v165 offset:14336
    v_mfma_f32_16x16x32_bf16 v[16:19], v[128:131], v[100:103], v[16:19]
    v_mfma_f32_16x16x32_bf16 v[20:23], v[132:135], v[100:103], v[20:23]
    s_add_u32 m0, s27, 8192
    s_add_u32 s29, s26, 851968
    buffer_load_dwordx4 v161, s[8:11], s29 offen offset:0 lds
    v_mfma_f32_16x16x32_bf16 v[24:27], v[136:139], v[100:103], v[24:27]
    v_mfma_f32_16x16x32_bf16 v[28:31], v[140:143], v[100:103], v[28:31]
    s_add_u32 m0, s27, 8192
    s_add_u32 s29, s26, 859136
    buffer_load_dwordx4 v161, s[8:11], s29 offen offset:1024 lds
    s_add_u32 s29, s25, 3407872
    buffer_load_dwordx4 v[96:99], v160, s[16:19], s29 offen offset:0
    v_mfma_f32_16x16x32_bf16 v[32:35], v[128:131], v[104:107], v[32:35]
    v_mfma_f32_16x16x32_bf16 v[36:39], v[132:135], v[104:107], v[36:39]
    s_add_u32 m0, s27, 8192
    s_add_u32 s29, s26, 866304
    buffer_load_dwordx4 v161, s[8:11], s29 offen offset:2048 lds
    v_mfma_f32_16x16x32_bf16 v[40:43], v[136:139], v[104:107], v[40:43]
    v_mfma_f32_16x16x32_bf16 v[44:47], v[140:143], v[104:107], v[44:47]
    s_add_u32 m0, s27, 8192
    s_add_u32 s29, s26, 873472
    buffer_load_dwordx4 v161, s[8:11], s29 offen offset:3072 lds
    s_add_u32 s29, s25, 3407872
    buffer_load_dwordx4 v[100:103], v160, s[16:19], s29 offen offset:1024
    v_mfma_f32_16x16x32_bf16 v[48:51], v[128:131], v[108:111], v[48:51]
    v_mfma_f32_16x16x32_bf16 v[52:55], v[132:135], v[108:111], v[52:55]
    v_mfma_f32_16x16x32_bf16 v[56:59], v[136:139], v[108:111], v[56:59]
    v_mfma_f32_16x16x32_bf16 v[60:63], v[140:143], v[108:111], v[60:63]
    s_add_u32 s29, s25, 3407872
    buffer_load_dwordx4 v[104:107], v160, s[16:19], s29 offen offset:2048
    s_add_u32 s29, s25, 3407872
    buffer_load_dwordx4 v[108:111], v160, s[16:19], s29 offen offset:3072
    s_waitcnt lgkmcnt(6)
    v_mfma_f32_16x16x32_bf16 v[0:3], v[144:147], v[112:115], v[0:3]
    s_waitcnt lgkmcnt(4)
    v_mfma_f32_16x16x32_bf16 v[4:7], v[148:151], v[112:115], v[4:7]
    s_waitcnt lgkmcnt(2)
    v_mfma_f32_16x16x32_bf16 v[8:11], v[152:155], v[112:115], v[8:11]
    s_waitcnt lgkmcnt(0)
    v_mfma_f32_16x16x32_bf16 v[12:15], v[156:159], v[112:115], v[12:15]
    s_waitcnt vmcnt(19)
    ds_read_b64_tr_b16 v[128:129], v162 offset:0
    ds_read_b64_tr_b16 v[130:131], v162 offset:2048
    ds_read_b64_tr_b16 v[132:133], v163 offset:0
    ds_read_b64_tr_b16 v[134:135], v163 offset:2048
    ds_read_b64_tr_b16 v[136:137], v164 offset:0
    ds_read_b64_tr_b16 v[138:139], v164 offset:2048
    ds_read_b64_tr_b16 v[140:141], v165 offset:0
    ds_read_b64_tr_b16 v[142:143], v165 offset:2048
    v_mfma_f32_16x16x32_bf16 v[16:19], v[144:147], v[116:119], v[16:19]
    v_mfma_f32_16x16x32_bf16 v[20:23], v[148:151], v[116:119], v[20:23]
    s_add_u32 m0, s27, 12288
    s_add_u32 s29, s26, 884736
    buffer_load_dwordx4 v161, s[8:11], s29 offen offset:0 lds
    v_mfma_f32_16x16x32_bf16 v[24:27], v[152:155], v[116:119], v[24:27]
    v_mfma_f32_16x16x32_bf16 v[28:31], v[156:159], v[116:119], v[28:31]
    s_add_u32 m0, s27, 12288
    s_add_u32 s29, s26, 891904
    buffer_load_dwordx4 v161, s[8:11], s29 offen offset:1024 lds
    s_add_u32 s29, s25, 3538944
    buffer_load_dwordx4 v[112:115], v160, s[16:19], s29 offen offset:0
    v_mfma_f32_16x16x32_bf16 v[32:35], v[144:147], v[120:123], v[32:35]
    v_mfma_f32_16x16x32_bf16 v[36:39], v[148:151], v[120:123], v[36:39]
    s_add_u32 m0, s27, 12288
    s_add_u32 s29, s26, 899072
    buffer_load_dwordx4 v161, s[8:11], s29 offen offset:2048 lds
    v_mfma_f32_16x16x32_bf16 v[40:43], v[152:155], v[120:123], v[40:43]
    v_mfma_f32_16x16x32_bf16 v[44:47], v[156:159], v[120:123], v[44:47]
    s_add_u32 m0, s27, 12288
    s_add_u32 s29, s26, 906240
    buffer_load_dwordx4 v161, s[8:11], s29 offen offset:3072 lds
    s_add_u32 s29, s25, 3538944
    buffer_load_dwordx4 v[116:119], v160, s[16:19], s29 offen offset:1024
    v_mfma_f32_16x16x32_bf16 v[48:51], v[144:147], v[124:127], v[48:51]
    v_mfma_f32_16x16x32_bf16 v[52:55], v[148:151], v[124:127], v[52:55]
    v_mfma_f32_16x16x32_bf16 v[56:59], v[152:155], v[124:127], v[56:59]
    v_mfma_f32_16x16x32_bf16 v[60:63], v[156:159], v[124:127], v[60:63]
    s_add_u32 s29, s25, 3538944
    buffer_load_dwordx4 v[120:123], v160, s[16:19], s29 offen offset:2048
    s_add_u32 s29, s25, 3538944
    buffer_load_dwordx4 v[124:127], v160, s[16:19], s29 offen offset:3072
    s_waitcnt lgkmcnt(6)
    v_mfma_f32_16x16x32_bf16 v[0:3], v[128:131], v[64:67], v[0:3]
    s_waitcnt lgkmcnt(4)
    v_mfma_f32_16x16x32_bf16 v[4:7], v[132:135], v[64:67], v[4:7]
    s_waitcnt lgkmcnt(2)
    v_mfma_f32_16x16x32_bf16 v[8:11], v[136:139], v[64:67], v[8:11]
    s_waitcnt lgkmcnt(0)
    v_mfma_f32_16x16x32_bf16 v[12:15], v[140:143], v[64:67], v[12:15]
    s_waitcnt vmcnt(19)
    ds_read_b64_tr_b16 v[144:145], v162 offset:4096
    ds_read_b64_tr_b16 v[146:147], v162 offset:6144
    ds_read_b64_tr_b16 v[148:149], v163 offset:4096
    ds_read_b64_tr_b16 v[150:151], v163 offset:6144
    ds_read_b64_tr_b16 v[152:153], v164 offset:4096
    ds_read_b64_tr_b16 v[154:155], v164 offset:6144
    ds_read_b64_tr_b16 v[156:157], v165 offset:4096
    ds_read_b64_tr_b16 v[158:159], v165 offset:6144
    v_mfma_f32_16x16x32_bf16 v[16:19], v[128:131], v[68:71], v[16:19]
    v_mfma_f32_16x16x32_bf16 v[20:23], v[132:135], v[68:71], v[20:23]
    s_add_u32 m0, s27, 0
    s_add_u32 s29, s26, 917504
    buffer_load_dwordx4 v161, s[8:11], s29 offen offset:0 lds
    v_mfma_f32_16x16x32_bf16 v[24:27], v[136:139], v[68:71], v[24:27]
    v_mfma_f32_16x16x32_bf16 v[28:31], v[140:143], v[68:71], v[28:31]
    s_add_u32 m0, s27, 0
    s_add_u32 s29, s26, 924672
    buffer_load_dwordx4 v161, s[8:11], s29 offen offset:1024 lds
    s_add_u32 s29, s25, 3670016
    buffer_load_dwordx4 v[64:67], v160, s[16:19], s29 offen offset:0
    v_mfma_f32_16x16x32_bf16 v[32:35], v[128:131], v[72:75], v[32:35]
    v_mfma_f32_16x16x32_bf16 v[36:39], v[132:135], v[72:75], v[36:39]
    s_add_u32 m0, s27, 0
    s_add_u32 s29, s26, 931840
    buffer_load_dwordx4 v161, s[8:11], s29 offen offset:2048 lds
    v_mfma_f32_16x16x32_bf16 v[40:43], v[136:139], v[72:75], v[40:43]
    v_mfma_f32_16x16x32_bf16 v[44:47], v[140:143], v[72:75], v[44:47]
    s_add_u32 m0, s27, 0
    s_add_u32 s29, s26, 939008
    buffer_load_dwordx4 v161, s[8:11], s29 offen offset:3072 lds
    s_add_u32 s29, s25, 3670016
    buffer_load_dwordx4 v[68:71], v160, s[16:19], s29 offen offset:1024
    v_mfma_f32_16x16x32_bf16 v[48:51], v[128:131], v[76:79], v[48:51]
    v_mfma_f32_16x16x32_bf16 v[52:55], v[132:135], v[76:79], v[52:55]
    v_mfma_f32_16x16x32_bf16 v[56:59], v[136:139], v[76:79], v[56:59]
    v_mfma_f32_16x16x32_bf16 v[60:63], v[140:143], v[76:79], v[60:63]
    s_add_u32 s29, s25, 3670016
    buffer_load_dwordx4 v[72:75], v160, s[16:19], s29 offen offset:2048
    s_add_u32 s29, s25, 3670016
    buffer_load_dwordx4 v[76:79], v160, s[16:19], s29 offen offset:3072
    s_waitcnt lgkmcnt(6)
    v_mfma_f32_16x16x32_bf16 v[0:3], v[144:147], v[80:83], v[0:3]
    s_waitcnt lgkmcnt(4)
    v_mfma_f32_16x16x32_bf16 v[4:7], v[148:151], v[80:83], v[4:7]
    s_waitcnt lgkmcnt(2)
    v_mfma_f32_16x16x32_bf16 v[8:11], v[152:155], v[80:83], v[8:11]
    s_waitcnt lgkmcnt(0)
    v_mfma_f32_16x16x32_bf16 v[12:15], v[156:159], v[80:83], v[12:15]
    s_waitcnt vmcnt(19)
    ds_read_b64_tr_b16 v[128:129], v162 offset:8192
    ds_read_b64_tr_b16 v[130:131], v162 offset:10240
    ds_read_b64_tr_b16 v[132:133], v163 offset:8192
    ds_read_b64_tr_b16 v[134:135], v163 offset:10240
    ds_read_b64_tr_b16 v[136:137], v164 offset:8192
    ds_read_b64_tr_b16 v[138:139], v164 offset:10240
    ds_read_b64_tr_b16 v[140:141], v165 offset:8192
    ds_read_b64_tr_b16 v[142:143], v165 offset:10240
    v_mfma_f32_16x16x32_bf16 v[16:19], v[144:147], v[84:87], v[16:19]
    v_mfma_f32_16x16x32_bf16 v[20:23], v[148:151], v[84:87], v[20:23]
    s_add_u32 m0, s27, 4096
    s_add_u32 s29, s26, 950272
    buffer_load_dwordx4 v161, s[8:11], s29 offen offset:0 lds
    v_mfma_f32_16x16x32_bf16 v[24:27], v[152:155], v[84:87], v[24:27]
    v_mfma_f32_16x16x32_bf16 v[28:31], v[156:159], v[84:87], v[28:31]
    s_add_u32 m0, s27, 4096
    s_add_u32 s29, s26, 957440
    buffer_load_dwordx4 v161, s[8:11], s29 offen offset:1024 lds
    s_add_u32 s29, s25, 3801088
    buffer_load_dwordx4 v[80:83], v160, s[16:19], s29 offen offset:0
    v_mfma_f32_16x16x32_bf16 v[32:35], v[144:147], v[88:91], v[32:35]
    v_mfma_f32_16x16x32_bf16 v[36:39], v[148:151], v[88:91], v[36:39]
    s_add_u32 m0, s27, 4096
    s_add_u32 s29, s26, 964608
    buffer_load_dwordx4 v161, s[8:11], s29 offen offset:2048 lds
    v_mfma_f32_16x16x32_bf16 v[40:43], v[152:155], v[88:91], v[40:43]
    v_mfma_f32_16x16x32_bf16 v[44:47], v[156:159], v[88:91], v[44:47]
    s_add_u32 m0, s27, 4096
    s_add_u32 s29, s26, 971776
    buffer_load_dwordx4 v161, s[8:11], s29 offen offset:3072 lds
    s_add_u32 s29, s25, 3801088
    buffer_load_dwordx4 v[84:87], v160, s[16:19], s29 offen offset:1024
    v_mfma_f32_16x16x32_bf16 v[48:51], v[144:147], v[92:95], v[48:51]
    v_mfma_f32_16x16x32_bf16 v[52:55], v[148:151], v[92:95], v[52:55]
    v_mfma_f32_16x16x32_bf16 v[56:59], v[152:155], v[92:95], v[56:59]
    v_mfma_f32_16x16x32_bf16 v[60:63], v[156:159], v[92:95], v[60:63]
    s_add_u32 s29, s25, 3801088
    buffer_load_dwordx4 v[88:91], v160, s[16:19], s29 offen offset:2048
    s_add_u32 s29, s25, 3801088
    buffer_load_dwordx4 v[92:95], v160, s[16:19], s29 offen offset:3072
    s_waitcnt lgkmcnt(6)
    v_mfma_f32_16x16x32_bf16 v[0:3], v[128:131], v[96:99], v[0:3]
    s_waitcnt lgkmcnt(4)
    v_mfma_f32_16x16x32_bf16 v[4:7], v[132:135], v[96:99], v[4:7]
    s_waitcnt lgkmcnt(2)
    v_mfma_f32_16x16x32_bf16 v[8:11], v[136:139], v[96:99], v[8:11]
    s_waitcnt lgkmcnt(0)
    v_mfma_f32_16x16x32_bf16 v[12:15], v[140:143], v[96:99], v[12:15]
    s_waitcnt vmcnt(19)
    ds_read_b64_tr_b16 v[144:145], v162 offset:12288
    ds_read_b64_tr_b16 v[146:147], v162 offset:14336
    ds_read_b64_tr_b16 v[148:149], v163 offset:12288
    ds_read_b64_tr_b16 v[150:151], v163 offset:14336
    ds_read_b64_tr_b16 v[152:153], v164 offset:12288
    ds_read_b64_tr_b16 v[154:155], v164 offset:14336
    ds_read_b64_tr_b16 v[156:157], v165 offset:12288
    ds_read_b64_tr_b16 v[158:159], v165 offset:14336
    v_mfma_f32_16x16x32_bf16 v[16:19], v[128:131], v[100:103], v[16:19]
    v_mfma_f32_16x16x32_bf16 v[20:23], v[132:135], v[100:103], v[20:23]
    s_add_u32 m0, s27, 8192
    s_add_u32 s29, s26, 983040
    buffer_load_dwordx4 v161, s[8:11], s29 offen offset:0 lds
    v_mfma_f32_16x16x32_bf16 v[24:27], v[136:139], v[100:103], v[24:27]
    v_mfma_f32_16x16x32_bf16 v[28:31], v[140:143], v[100:103], v[28:31]
    s_add_u32 m0, s27, 8192
    s_add_u32 s29, s26, 990208
    buffer_load_dwordx4 v161, s[8:11], s29 offen offset:1024 lds
    s_add_u32 s29, s25, 3932160
    buffer_load_dwordx4 v[96:99], v160, s[16:19], s29 offen offset:0
    v_mfma_f32_16x16x32_bf16 v[32:35], v[128:131], v[104:107], v[32:35]
    v_mfma_f32_16x16x32_bf16 v[36:39], v[132:135], v[104:107], v[36:39]
    s_add_u32 m0, s27, 8192
    s_add_u32 s29, s26, 997376
    buffer_load_dwordx4 v161, s[8:11], s29 offen offset:2048 lds
    v_mfma_f32_16x16x32_bf16 v[40:43], v[136:139], v[104:107], v[40:43]
    v_mfma_f32_16x16x32_bf16 v[44:47], v[140:143], v[104:107], v[44:47]
    s_add_u32 m0, s27, 8192
    s_add_u32 s29, s26, 1004544
    buffer_load_dwordx4 v161, s[8:11], s29 offen offset:3072 lds
    s_add_u32 s29, s25, 3932160
    buffer_load_dwordx4 v[100:103], v160, s[16:19], s29 offen offset:1024
    v_mfma_f32_16x16x32_bf16 v[48:51], v[128:131], v[108:111], v[48:51]
    v_mfma_f32_16x16x32_bf16 v[52:55], v[132:135], v[108:111], v[52:55]
    v_mfma_f32_16x16x32_bf16 v[56:59], v[136:139], v[108:111], v[56:59]
    v_mfma_f32_16x16x32_bf16 v[60:63], v[140:143], v[108:111], v[60:63]
    s_add_u32 s29, s25, 3932160
    buffer_load_dwordx4 v[104:107], v160, s[16:19], s29 offen offset:2048
    s_add_u32 s29, s25, 3932160
    buffer_load_dwordx4 v[108:111], v160, s[16:19], s29 offen offset:3072
    s_waitcnt lgkmcnt(6)
    v_mfma_f32_16x16x32_bf16 v[0:3], v[144:147], v[112:115], v[0:3]
    s_waitcnt lgkmcnt(4)
    v_mfma_f32_16x16x32_bf16 v[4:7], v[148:151], v[112:115], v[4:7]
    s_waitcnt lgkmcnt(2)
    v_mfma_f32_16x16x32_bf16 v[8:11], v[152:155], v[112:115], v[8:11]
    s_waitcnt lgkmcnt(0)
    v_mfma_f32_16x16x32_bf16 v[12:15], v[156:159], v[112:115], v[12:15]
    s_waitcnt vmcnt(19)
    ds_read_b64_tr_b16 v[128:129], v162 offset:0
    ds_read_b64_tr_b16 v[130:131], v162 offset:2048
    ds_read_b64_tr_b16 v[132:133], v163 offset:0
    ds_read_b64_tr_b16 v[134:135], v163 offset:2048
    ds_read_b64_tr_b16 v[136:137], v164 offset:0
    ds_read_b64_tr_b16 v[138:139], v164 offset:2048
    ds_read_b64_tr_b16 v[140:141], v165 offset:0
    ds_read_b64_tr_b16 v[142:143], v165 offset:2048
    v_mfma_f32_16x16x32_bf16 v[16:19], v[144:147], v[116:119], v[16:19]
    v_mfma_f32_16x16x32_bf16 v[20:23], v[148:151], v[116:119], v[20:23]
    s_add_u32 m0, s27, 12288
    s_add_u32 s29, s26, 1015808
    buffer_load_dwordx4 v161, s[8:11], s29 offen offset:0 lds
    v_mfma_f32_16x16x32_bf16 v[24:27], v[152:155], v[116:119], v[24:27]
    v_mfma_f32_16x16x32_bf16 v[28:31], v[156:159], v[116:119], v[28:31]
    s_add_u32 m0, s27, 12288
    s_add_u32 s29, s26, 1022976
    buffer_load_dwordx4 v161, s[8:11], s29 offen offset:1024 lds
    s_add_u32 s29, s25, 4063232
    buffer_load_dwordx4 v[112:115], v160, s[16:19], s29 offen offset:0
    v_mfma_f32_16x16x32_bf16 v[32:35], v[144:147], v[120:123], v[32:35]
    v_mfma_f32_16x16x32_bf16 v[36:39], v[148:151], v[120:123], v[36:39]
    s_add_u32 m0, s27, 12288
    s_add_u32 s29, s26, 1030144
    buffer_load_dwordx4 v161, s[8:11], s29 offen offset:2048 lds
    v_mfma_f32_16x16x32_bf16 v[40:43], v[152:155], v[120:123], v[40:43]
    v_mfma_f32_16x16x32_bf16 v[44:47], v[156:159], v[120:123], v[44:47]
    s_add_u32 m0, s27, 12288
    s_add_u32 s29, s26, 1037312
    buffer_load_dwordx4 v161, s[8:11], s29 offen offset:3072 lds
    s_add_u32 s29, s25, 4063232
    buffer_load_dwordx4 v[116:119], v160, s[16:19], s29 offen offset:1024
    v_mfma_f32_16x16x32_bf16 v[48:51], v[144:147], v[124:127], v[48:51]
    v_mfma_f32_16x16x32_bf16 v[52:55], v[148:151], v[124:127], v[52:55]
    v_mfma_f32_16x16x32_bf16 v[56:59], v[152:155], v[124:127], v[56:59]
    v_mfma_f32_16x16x32_bf16 v[60:63], v[156:159], v[124:127], v[60:63]
    s_add_u32 s29, s25, 4063232
    buffer_load_dwordx4 v[120:123], v160, s[16:19], s29 offen offset:2048
    s_add_u32 s29, s25, 4063232
    buffer_load_dwordx4 v[124:127], v160, s[16:19], s29 offen offset:3072
    s_waitcnt lgkmcnt(6)
    v_mfma_f32_16x16x32_bf16 v[0:3], v[128:131], v[64:67], v[0:3]
    s_waitcnt lgkmcnt(4)
    v_mfma_f32_16x16x32_bf16 v[4:7], v[132:135], v[64:67], v[4:7]
    s_waitcnt lgkmcnt(2)
    v_mfma_f32_16x16x32_bf16 v[8:11], v[136:139], v[64:67], v[8:11]
    s_waitcnt lgkmcnt(0)
    v_mfma_f32_16x16x32_bf16 v[12:15], v[140:143], v[64:67], v[12:15]
    s_waitcnt vmcnt(19)
    ds_read_b64_tr_b16 v[144:145], v162 offset:4096
    ds_read_b64_tr_b16 v[146:147], v162 offset:6144
    ds_read_b64_tr_b16 v[148:149], v163 offset:4096
    ds_read_b64_tr_b16 v[150:151], v163 offset:6144
    ds_read_b64_tr_b16 v[152:153], v164 offset:4096
    ds_read_b64_tr_b16 v[154:155], v164 offset:6144
    ds_read_b64_tr_b16 v[156:157], v165 offset:4096
    ds_read_b64_tr_b16 v[158:159], v165 offset:6144
    v_mfma_f32_16x16x32_bf16 v[16:19], v[128:131], v[68:71], v[16:19]
    v_mfma_f32_16x16x32_bf16 v[20:23], v[132:135], v[68:71], v[20:23]
    v_mfma_f32_16x16x32_bf16 v[24:27], v[136:139], v[68:71], v[24:27]
    v_mfma_f32_16x16x32_bf16 v[28:31], v[140:143], v[68:71], v[28:31]
    v_mfma_f32_16x16x32_bf16 v[32:35], v[128:131], v[72:75], v[32:35]
    v_mfma_f32_16x16x32_bf16 v[36:39], v[132:135], v[72:75], v[36:39]
    v_mfma_f32_16x16x32_bf16 v[40:43], v[136:139], v[72:75], v[40:43]
    v_mfma_f32_16x16x32_bf16 v[44:47], v[140:143], v[72:75], v[44:47]
    v_mfma_f32_16x16x32_bf16 v[48:51], v[128:131], v[76:79], v[48:51]
    v_mfma_f32_16x16x32_bf16 v[52:55], v[132:135], v[76:79], v[52:55]
    v_mfma_f32_16x16x32_bf16 v[56:59], v[136:139], v[76:79], v[56:59]
    v_mfma_f32_16x16x32_bf16 v[60:63], v[140:143], v[76:79], v[60:63]
    s_waitcnt lgkmcnt(6)
    v_mfma_f32_16x16x32_bf16 v[0:3], v[144:147], v[80:83], v[0:3]
    s_waitcnt lgkmcnt(4)
    v_mfma_f32_16x16x32_bf16 v[4:7], v[148:151], v[80:83], v[4:7]
    s_waitcnt lgkmcnt(2)
    v_mfma_f32_16x16x32_bf16 v[8:11], v[152:155], v[80:83], v[8:11]
    s_waitcnt lgkmcnt(0)
    v_mfma_f32_16x16x32_bf16 v[12:15], v[156:159], v[80:83], v[12:15]
    s_waitcnt vmcnt(11)
    ds_read_b64_tr_b16 v[128:129], v162 offset:8192
    ds_read_b64_tr_b16 v[130:131], v162 offset:10240
    ds_read_b64_tr_b16 v[132:133], v163 offset:8192
    ds_read_b64_tr_b16 v[134:135], v163 offset:10240
    ds_read_b64_tr_b16 v[136:137], v164 offset:8192
    ds_read_b64_tr_b16 v[138:139], v164 offset:10240
    ds_read_b64_tr_b16 v[140:141], v165 offset:8192
    ds_read_b64_tr_b16 v[142:143], v165 offset:10240
    v_mfma_f32_16x16x32_bf16 v[16:19], v[144:147], v[84:87], v[16:19]
    v_mfma_f32_16x16x32_bf16 v[20:23], v[148:151], v[84:87], v[20:23]
    v_mfma_f32_16x16x32_bf16 v[24:27], v[152:155], v[84:87], v[24:27]
    v_mfma_f32_16x16x32_bf16 v[28:31], v[156:159], v[84:87], v[28:31]
    v_mfma_f32_16x16x32_bf16 v[32:35], v[144:147], v[88:91], v[32:35]
    v_mfma_f32_16x16x32_bf16 v[36:39], v[148:151], v[88:91], v[36:39]
    v_mfma_f32_16x16x32_bf16 v[40:43], v[152:155], v[88:91], v[40:43]
    v_mfma_f32_16x16x32_bf16 v[44:47], v[156:159], v[88:91], v[44:47]
    v_mfma_f32_16x16x32_bf16 v[48:51], v[144:147], v[92:95], v[48:51]
    v_mfma_f32_16x16x32_bf16 v[52:55], v[148:151], v[92:95], v[52:55]
    v_mfma_f32_16x16x32_bf16 v[56:59], v[152:155], v[92:95], v[56:59]
    v_mfma_f32_16x16x32_bf16 v[60:63], v[156:159], v[92:95], v[60:63]
    s_waitcnt lgkmcnt(6)
    v_mfma_f32_16x16x32_bf16 v[0:3], v[128:131], v[96:99], v[0:3]
    s_waitcnt lgkmcnt(4)
    v_mfma_f32_16x16x32_bf16 v[4:7], v[132:135], v[96:99], v[4:7]
    s_waitcnt lgkmcnt(2)
    v_mfma_f32_16x16x32_bf16 v[8:11], v[136:139], v[96:99], v[8:11]
    s_waitcnt lgkmcnt(0)
    v_mfma_f32_16x16x32_bf16 v[12:15], v[140:143], v[96:99], v[12:15]
    s_waitcnt vmcnt(3)
    ds_read_b64_tr_b16 v[144:145], v162 offset:12288
    ds_read_b64_tr_b16 v[146:147], v162 offset:14336
    ds_read_b64_tr_b16 v[148:149], v163 offset:12288
    ds_read_b64_tr_b16 v[150:151], v163 offset:14336
    ds_read_b64_tr_b16 v[152:153], v164 offset:12288
    ds_read_b64_tr_b16 v[154:155], v164 offset:14336
    ds_read_b64_tr_b16 v[156:157], v165 offset:12288
    ds_read_b64_tr_b16 v[158:159], v165 offset:14336
    v_mfma_f32_16x16x32_bf16 v[16:19], v[128:131], v[100:103], v[16:19]
    v_mfma_f32_16x16x32_bf16 v[20:23], v[132:135], v[100:103], v[20:23]
    v_mfma_f32_16x16x32_bf16 v[24:27], v[136:139], v[100:103], v[24:27]
    v_mfma_f32_16x16x32_bf16 v[28:31], v[140:143], v[100:103], v[28:31]
    v_mfma_f32_16x16x32_bf16 v[32:35], v[128:131], v[104:107], v[32:35]
    v_mfma_f32_16x16x32_bf16 v[36:39], v[132:135], v[104:107], v[36:39]
    v_mfma_f32_16x16x32_bf16 v[40:43], v[136:139], v[104:107], v[40:43]
    v_mfma_f32_16x16x32_bf16 v[44:47], v[140:143], v[104:107], v[44:47]
    v_mfma_f32_16x16x32_bf16 v[48:51], v[128:131], v[108:111], v[48:51]
    v_mfma_f32_16x16x32_bf16 v[52:55], v[132:135], v[108:111], v[52:55]
    v_mfma_f32_16x16x32_bf16 v[56:59], v[136:139], v[108:111], v[56:59]
    v_mfma_f32_16x16x32_bf16 v[60:63], v[140:143], v[108:111], v[60:63]
    s_waitcnt lgkmcnt(6)
    v_mfma_f32_16x16x32_bf16 v[0:3], v[144:147], v[112:115], v[0:3]
    s_waitcnt lgkmcnt(4)
    v_mfma_f32_16x16x32_bf16 v[4:7], v[148:151], v[112:115], v[4:7]
    s_waitcnt lgkmcnt(2)
    v_mfma_f32_16x16x32_bf16 v[8:11], v[152:155], v[112:115], v[8:11]
    s_waitcnt lgkmcnt(0)
    v_mfma_f32_16x16x32_bf16 v[12:15], v[156:159], v[112:115], v[12:15]
    s_waitcnt vmcnt(2)
    v_mfma_f32_16x16x32_bf16 v[16:19], v[144:147], v[116:119], v[16:19]
    v_mfma_f32_16x16x32_bf16 v[20:23], v[148:151], v[116:119], v[20:23]
    v_mfma_f32_16x16x32_bf16 v[24:27], v[152:155], v[116:119], v[24:27]
    v_mfma_f32_16x16x32_bf16 v[28:31], v[156:159], v[116:119], v[28:31]
    s_waitcnt vmcnt(1)
    v_mfma_f32_16x16x32_bf16 v[32:35], v[144:147], v[120:123], v[32:35]
    v_mfma_f32_16x16x32_bf16 v[36:39], v[148:151], v[120:123], v[36:39]
    v_mfma_f32_16x16x32_bf16 v[40:43], v[152:155], v[120:123], v[40:43]
    v_mfma_f32_16x16x32_bf16 v[44:47], v[156:159], v[120:123], v[44:47]
    s_waitcnt vmcnt(0)
    v_mfma_f32_16x16x32_bf16 v[48:51], v[144:147], v[124:127], v[48:51]
    v_mfma_f32_16x16x32_bf16 v[52:55], v[148:151], v[124:127], v[52:55]
    v_mfma_f32_16x16x32_bf16 v[56:59], v[152:155], v[124:127], v[56:59]
    v_mfma_f32_16x16x32_bf16 v[60:63], v[156:159], v[124:127], v[60:63]
    ds_write_b128 v169, v[0:3] offset:0
    ds_write_b128 v169, v[4:7] offset:1024
    ds_write_b128 v169, v[8:11] offset:2048
    ds_write_b128 v169, v[12:15] offset:3072
    ds_write_b128 v169, v[16:19] offset:4096
    ds_write_b128 v169, v[20:23] offset:5120
    ds_write_b128 v169, v[24:27] offset:6144
    ds_write_b128 v169, v[28:31] offset:7168
    ds_write_b128 v169, v[32:35] offset:8192
    ds_write_b128 v169, v[36:39] offset:9216
    ds_write_b128 v169, v[40:43] offset:10240
    ds_write_b128 v169, v[44:47] offset:11264
    ds_write_b128 v169, v[48:51] offset:12288
    ds_write_b128 v169, v[52:55] offset:13312
    ds_write_b128 v169, v[56:59] offset:14336
    ds_write_b128 v169, v[60:63] offset:15360
    s_waitcnt lgkmcnt(0)
    s_barrier
    s_lshl_b32 s42, s30, 17
    s_lshl_b32 s43, s24, 15
    s_add_u32 s42, s42, s43
    s_lshl_b32 s43, s31, 7
    s_add_u32 s42, s42, s43
    s_add_u32 s42, s42, 1024
    ds_read_b128 v[64:67], v170 offset:0
    ds_read_b128 v[68:71], v170 offset:256
    ds_read_b128 v[72:75], v170 offset:16384
    ds_read_b128 v[76:79], v170 offset:16640
    ds_read_b128 v[80:83], v170 offset:32768
    ds_read_b128 v[84:87], v170 offset:33024
    ds_read_b128 v[88:91], v170 offset:49152
    ds_read_b128 v[92:95], v170 offset:49408
    ds_read_b128 v[96:99], v170 offset:128
    ds_read_b128 v[100:103], v170 offset:384
    ds_read_b128 v[104:107], v170 offset:16512
    ds_read_b128 v[108:111], v170 offset:16768
    ds_read_b128 v[112:115], v170 offset:32896
    ds_read_b128 v[116:119], v170 offset:33152
    ds_read_b128 v[120:123], v170 offset:49280
    ds_read_b128 v[124:127], v170 offset:49536
    s_waitcnt lgkmcnt(13)
    v_add_f32 v64, v64, v72
    s_waitcnt lgkmcnt(9)
    v_add_f32 v80, v80, v88
    v_add_f32 v65, v65, v73
    v_add_f32 v81, v81, v89
    v_add_f32 v66, v66, v74
    v_add_f32 v82, v82, v90
    v_add_f32 v67, v67, v75
    v_add_f32 v83, v83, v91
    v_add_f32 v68, v68, v76
    s_waitcnt lgkmcnt(8)
    v_add_f32 v84, v84, v92
    v_add_f32 v69, v69, v77
    v_add_f32 v85, v85, v93
    v_add_f32 v70, v70, v78
    v_add_f32 v86, v86, v94
    v_add_f32 v71, v71, v79
    v_add_f32 v87, v87, v95
    v_add_f32 v64, v64, v80
    v_add_f32 v65, v65, v81
    v_add_f32 v66, v66, v82
    v_add_f32 v67, v67, v83
    v_add_f32 v68, v68, v84
    v_add_f32 v69, v69, v85
    v_add_f32 v70, v70, v86
    v_add_f32 v71, v71, v87
    v_cvt_pk_bf16_f32 v72, v64, v65
    v_cvt_pk_bf16_f32 v73, v66, v67
    v_cvt_pk_bf16_f32 v74, v68, v69
    v_cvt_pk_bf16_f32 v75, v70, v71
    buffer_store_dwordx4 v[72:75], v171, s[20:23], s42 offen sc1
    s_waitcnt lgkmcnt(5)
    v_add_f32 v96, v96, v104
    s_waitcnt lgkmcnt(1)
    v_add_f32 v112, v112, v120
    v_add_f32 v97, v97, v105
    v_add_f32 v113, v113, v121
    v_add_f32 v98, v98, v106
    v_add_f32 v114, v114, v122
    v_add_f32 v99, v99, v107
    v_add_f32 v115, v115, v123
    v_add_f32 v100, v100, v108
    s_waitcnt lgkmcnt(0)
    v_add_f32 v116, v116, v124
    v_add_f32 v101, v101, v109
    v_add_f32 v117, v117, v125
    v_add_f32 v102, v102, v110
    v_add_f32 v118, v118, v126
    v_add_f32 v103, v103, v111
    v_add_f32 v119, v119, v127
    v_add_f32 v96, v96, v112
    v_add_f32 v97, v97, v113
    v_add_f32 v98, v98, v114
    v_add_f32 v99, v99, v115
    v_add_f32 v100, v100, v116
    v_add_f32 v101, v101, v117
    v_add_f32 v102, v102, v118
    v_add_f32 v103, v103, v119
    v_cvt_pk_bf16_f32 v104, v96, v97
    v_cvt_pk_bf16_f32 v105, v98, v99
    v_cvt_pk_bf16_f32 v106, v100, v101
    v_cvt_pk_bf16_f32 v107, v102, v103
    s_add_u32 s42, s42, 16384
    buffer_store_dwordx4 v[104:107], v171, s[20:23], s42 offen sc1
    s_endpgm
k3_kernel_ssm:
    s_load_dwordx8 s[48:55], s[0:1], 0
    s_load_dwordx4 s[56:59], s[0:1], 32
    s_load_dwordx2 s[60:61], s[0:1], 48
    s_load_dwordx2 s[62:63], s[0:1], 104
    s_load_dwordx2 s[64:65], s[0:1], 120
    v_mov_b32 v172, v0
    v_lshrrev_b32 v169, 6, v0
    v_and_b32 v168, 63, v0
    v_readfirstlane_b32 s44, v169
    s_and_b32 s4, s3, 7
    s_lshr_b32 s5, s3, 3
    s_lshl_b32 s4, s4, 6
    s_lshl_b32 s5, s5, 1
    s_add_u32 s45, s4, s5
    s_lshr_b32 s4, s44, 1
    s_add_u32 s46, s45, s4
    s_mul_i32 s47, s44, 8704
    s_lshl_b32 s4, s45, 7
    v_add_lshl_u32 v169, v172, s4, 1
    s_lshl_b32 s5, s46, 1
    s_lshl_b32 s6, s45, 1
    v_mov_b32 v170, s5
    v_mov_b32 v171, s6
    s_waitcnt lgkmcnt(0)
    global_load_ushort v4, v170, s[58:59]
    global_load_ushort v0, v169, s[50:51]
    global_load_ushort v1, v169, s[52:53]
    global_load_ushort v2, v169, s[54:55]
    global_load_ushort v3, v169, s[56:57]
    global_load_dword v173, v171, s[60:61]
    s_mov_b32 s40, s64
    s_mov_b32 s41, s65
    s_mov_b32 s42, 0x10000000
    s_mov_b32 s43, 0x00020000
    s_mov_b32 s36, s62
    s_mov_b32 s37, s63
    s_mov_b32 s38, 0x400000
    s_mov_b32 s39, 0x00020000
    v_lshlrev_b32 v171, 4, v168
    s_lshl_b32 s6, s46, 12
    s_and_b32 s7, s44, 1
    s_lshl_b32 s7, s7, 11
    s_add_u32 s6, s6, s7
    s_add_u32 s6, s6, 35651584
    s_lshr_b32 s4, s44, 1
    s_mul_i32 s4, s4, 8320
    s_add_u32 s4, s4, s7
    s_add_u32 m0, s4, 34848
    s_nop 0
    buffer_load_dwordx4 v171, s[40:43], s6 offen lds
    buffer_load_dwordx4 v171, s[40:43], s6 offen offset:1024 lds
    s_add_u32 m0, s4, 39008
    s_sub_u32 s6, s6, 2
    buffer_load_dwordx4 v171, s[40:43], s6 offen lds
    buffer_load_dwordx4 v171, s[40:43], s6 offen offset:1024 lds
    v_mov_b32 v8, 0
    v_mov_b32 v9, 0
    v_mov_b32 v10, 0
    v_mov_b32 v11, 0
    s_lshr_b32 s4, s44, 1
    s_mul_i32 s5, s4, 4608
    s_add_u32 s5, s5, 55552
    s_mul_i32 s7, s4, 8320
    s_add_u32 s7, s7, 34816
    v_and_b32 v169, 31, v168
    v_lshlrev_b32 v169, 4, v169
    v_add_u32 v169, s5, v169
    ds_write_b128 v169, v[8:11]
    v_and_b32 v169, 1, v168
    v_lshlrev_b32 v169, 4, v169
    v_add_u32 v169, s7, v169
    ds_write_b128 v169, v[8:11]
    ds_write_b128 v169, v[8:11] offset:4160
    v_mov_b32 v174, s7
    s_waitcnt vmcnt(8)
    v_lshlrev_b32 v0, 16, v0
    s_waitcnt vmcnt(7)
    v_lshlrev_b32 v1, 16, v1
    s_waitcnt vmcnt(6)
    v_lshlrev_b32 v2, 16, v2
    s_waitcnt vmcnt(5)
    v_lshlrev_b32 v3, 16, v3
    v_lshlrev_b32 v4, 16, v4
    v_mul_f32 v169, 0x3fb8aa3b, v4
    v_mov_b32 v170, 0x3fb8aa3b
    v_fma_f32 v170, v4, v170, -v169
    v_fmac_f32 v170, 0x32a57060, v4
    v_exp_f32 v169, v169
    v_mul_f32 v170, 0x3f317218, v170
    v_fma_f32 v169, v169, v170, v169
    v_cvt_pk_bf16_f32 v169, v169, v169
    v_lshlrev_b32 v4, 16, v169
    v_mul_f32 v169, 0x3fb8aa3b, v0
    v_mov_b32 v170, 0x3fb8aa3b
    v_fma_f32 v170, v0, v170, -v169
    v_fmac_f32 v170, 0x32a57060, v0
    v_exp_f32 v169, v169
    v_mul_f32 v170, 0x3f317218, v170
    v_fma_f32 v169, v169, v170, v169
    v_cvt_pk_bf16_f32 v169, v169, v169
    v_lshlrev_b32 v0, 16, v169
    v_mul_f32 v0, v0, v4
    v_mul_f32 v0, 0xbfb8aa3b, v0
    v_mul_f32 v1, v1, v4
    v_mul_f32 v1, 0x3e22f983, v1
    v_mul_f32 v2, v2, v4
    v_add_f32 v2, v2, v2
    v_mul_f32 v3, v3, v4
    v_add_f32 v3, v3, v3
    v_lshlrev_b32 v5, 3, v168
    v_add_u32 v5, s47, v5
    v_and_b32 v169, 15, v168
    v_mul_u32_u24 v6, 528, v169
    v_lshrrev_b32 v169, 4, v168
    v_lshl_add_u32 v6, v169, 4, v6
    v_add_u32 v6, s47, v6
    v_mul_f32 v24, 0x41000000, v0
    v_mul_f32 v28, 0x41800000, v0
    v_mul_f32 v25, 0x41000000, v1
    v_mul_f32 v29, 0x41800000, v1
    v_exp_f32 v24, v24
    v_exp_f32 v28, v28
    v_fract_f32 v25, v25
    v_fract_f32 v29, v29
    v_cos_f32 v26, v25
    v_cos_f32 v30, v29
    v_sin_f32 v27, v25
    v_sin_f32 v31, v29
    v_mul_f32 v112, v24, v26
    v_mul_f32 v114, v28, v30
    v_mul_f32 v113, -v24, v27
    v_mul_f32 v115, -v28, v31
    v_mul_f32 v24, 0x42000000, v0
    v_mul_f32 v28, 0x42800000, v0
    v_mul_f32 v25, 0x42000000, v1
    v_mul_f32 v29, 0x42800000, v1
    v_exp_f32 v24, v24
    v_exp_f32 v28, v28
    v_fract_f32 v25, v25
    v_fract_f32 v29, v29
    v_cos_f32 v26, v25
    v_cos_f32 v30, v29
    v_sin_f32 v27, v25
    v_sin_f32 v31, v29
    v_mul_f32 v116, v24, v26
    v_mul_f32 v118, v28, v30
    v_mul_f32 v117, -v24, v27
    v_mul_f32 v119, -v28, v31
    v_mov_b32 v120, 1.0
    v_mov_b32 v121, 0
    v_cvt_pk_bf16_f32 v8, v120, v121
    v_lshlrev_b32 v10, 16, v8
    v_and_b32 v11, 0xffff0000, v8
    v_sub_f32 v10, v120, v10
    v_sub_f32 v11, v121, v11
    v_cvt_pk_bf16_f32 v64, v10, v11
    v_mov_b32 v9, v8
    ds_write_b64 v5, v[8:9] offset:0
    v_cvt_pk_bf16_f32 v12, v112, v113
    v_lshlrev_b32 v14, 16, v12
    v_and_b32 v15, 0xffff0000, v12
    v_sub_f32 v14, v112, v14
    v_sub_f32 v15, v113, v15
    v_cvt_pk_bf16_f32 v65, v14, v15
    v_mov_b32 v13, v12
    ds_write_b64 v5, v[12:13] offset:528
    v_cvt_pk_bf16_f32 v16, v114, v115
    v_lshlrev_b32 v18, 16, v16
    v_and_b32 v19, 0xffff0000, v16
    v_sub_f32 v18, v114, v18
    v_sub_f32 v19, v115, v19
    v_cvt_pk_bf16_f32 v66, v18, v19
    v_mov_b32 v17, v16
    ds_write_b64 v5, v[16:17] offset:1056
    v_cvt_pk_bf16_f32 v20, v116, v117
    v_lshlrev_b32 v22, 16, v20
    v_and_b32 v23, 0xffff0000, v20
    v_sub_f32 v22, v116, v22
    v_sub_f32 v23, v117, v23
    v_cvt_pk_bf16_f32 v68, v22, v23
    v_mov_b32 v21, v20
    ds_write_b64 v5, v[20:21] offset:2112
    v_mul_f32 v122, v114, v112
    v_mul_f32 v124, v116, v112
    v_mul_f32 v123, v114, v113
    v_mul_f32 v125, v116, v113
    v_fma_f32 v122, -v115, v113, v122
    v_fma_f32 v124, -v117, v113, v124
    v_fmac_f32 v123, v115, v112
    v_fmac_f32 v125, v117, v112
    v_cvt_pk_bf16_f32 v8, v122, v123
    v_lshlrev_b32 v10, 16, v8
    v_and_b32 v11, 0xffff0000, v8
    v_sub_f32 v10, v122, v10
    v_sub_f32 v11, v123, v11
    v_cvt_pk_bf16_f32 v67, v10, v11
    v_mov_b32 v9, v8
    ds_write_b64 v5, v[8:9] offset:1584
    v_cvt_pk_bf16_f32 v12, v124, v125
    v_lshlrev_b32 v14, 16, v12
    v_and_b32 v15, 0xffff0000, v12
    v_sub_f32 v14, v124, v14
    v_sub_f32 v15, v125, v15
    v_cvt_pk_bf16_f32 v69, v14, v15
    v_mov_b32 v13, v12
    ds_write_b64 v5, v[12:13] offset:2640
    v_mul_f32 v126, v116, v114
    v_mul_f32 v127, v116, v115
    v_fma_f32 v126, -v117, v115, v126
    v_fmac_f32 v127, v117, v114
    v_cvt_pk_bf16_f32 v16, v126, v127
    v_lshlrev_b32 v18, 16, v16
    v_and_b32 v19, 0xffff0000, v16
    v_sub_f32 v18, v126, v18
    v_sub_f32 v19, v127, v19
    v_cvt_pk_bf16_f32 v70, v18, v19
    v_mov_b32 v17, v16
    ds_write_b64 v5, v[16:17] offset:3168
    v_mul_f32 v122, v126, v112
    v_mul_f32 v123, v126, v113
    v_fma_f32 v122, -v127, v113, v122
    v_fmac_f32 v123, v127, v112
    v_cvt_pk_bf16_f32 v20, v122, v123
    v_lshlrev_b32 v22, 16, v20
    v_and_b32 v23, 0xffff0000, v20
    v_sub_f32 v22, v122, v22
    v_sub_f32 v23, v123, v23
    v_cvt_pk_bf16_f32 v71, v22, v23
    v_mov_b32 v21, v20
    ds_write_b64 v5, v[20:21] offset:3696
    v_cvt_pk_bf16_f32 v8, v118, v119
    v_lshlrev_b32 v10, 16, v8
    v_and_b32 v11, 0xffff0000, v8
    v_sub_f32 v10, v118, v10
    v_sub_f32 v11, v119, v11
    v_cvt_pk_bf16_f32 v72, v10, v11
    v_mov_b32 v9, v8
    ds_write_b64 v5, v[8:9] offset:4224
    v_mul_f32 v122, v118, v112
    v_mul_f32 v124, v118, v114
    v_mul_f32 v123, v118, v113
    v_mul_f32 v125, v118, v115
    v_fma_f32 v122, -v119, v113, v122
    v_fma_f32 v124, -v119, v115, v124
    v_fmac_f32 v123, v119, v112
    v_fmac_f32 v125, v119, v114
    v_cvt_pk_bf16_f32 v12, v122, v123
    v_lshlrev_b32 v14, 16, v12
    v_and_b32 v15, 0xffff0000, v12
    v_sub_f32 v14, v122, v14
    v_sub_f32 v15, v123, v15
    v_cvt_pk_bf16_f32 v73, v14, v15
    v_mov_b32 v13, v12
    ds_write_b64 v5, v[12:13] offset:4752
    v_cvt_pk_bf16_f32 v16, v124, v125
    v_lshlrev_b32 v18, 16, v16
    v_and_b32 v19, 0xffff0000, v16
    v_sub_f32 v18, v124, v18
    v_sub_f32 v19, v125, v19
    v_cvt_pk_bf16_f32 v74, v18, v19
    v_mov_b32 v17, v16
    ds_write_b64 v5, v[16:17] offset:5280
    v_mul_f32 v122, v124, v112
    v_mul_f32 v126, v118, v116
    v_mul_f32 v123, v124, v113
    v_mul_f32 v127, v118, v117
    v_fma_f32 v122, -v125, v113, v122
    v_fma_f32 v126, -v119, v117, v126
    v_fmac_f32 v123, v125, v112
    v_fmac_f32 v127, v119, v116
    v_cvt_pk_bf16_f32 v20, v122, v123
    v_lshlrev_b32 v22, 16, v20
    v_and_b32 v23, 0xffff0000, v20
    v_sub_f32 v22, v122, v22
    v_sub_f32 v23, v123, v23
    v_cvt_pk_bf16_f32 v75, v22, v23
    v_mov_b32 v21, v20
    ds_write_b64 v5, v[20:21] offset:5808
    v_cvt_pk_bf16_f32 v8, v126, v127
    v_lshlrev_b32 v10, 16, v8
    v_and_b32 v11, 0xffff0000, v8
    v_sub_f32 v10, v126, v10
    v_sub_f32 v11, v127, v11
    v_cvt_pk_bf16_f32 v76, v10, v11
    v_mov_b32 v9, v8
    ds_write_b64 v5, v[8:9] offset:6336
    v_mul_f32 v122, v126, v112
    v_mul_f32 v124, v126, v114
    v_mul_f32 v123, v126, v113
    v_mul_f32 v125, v126, v115
    v_fma_f32 v122, -v127, v113, v122
    v_fma_f32 v124, -v127, v115, v124
    v_fmac_f32 v123, v127, v112
    v_fmac_f32 v125, v127, v114
    v_cvt_pk_bf16_f32 v12, v122, v123
    v_lshlrev_b32 v14, 16, v12
    v_and_b32 v15, 0xffff0000, v12
    v_sub_f32 v14, v122, v14
    v_sub_f32 v15, v123, v15
    v_cvt_pk_bf16_f32 v77, v14, v15
    v_mov_b32 v13, v12
    ds_write_b64 v5, v[12:13] offset:6864
    v_cvt_pk_bf16_f32 v16, v124, v125
    v_lshlrev_b32 v18, 16, v16
    v_and_b32 v19, 0xffff0000, v16
    v_sub_f32 v18, v124, v18
    v_sub_f32 v19, v125, v19
    v_cvt_pk_bf16_f32 v78, v18, v19
    v_mov_b32 v17, v16
    ds_write_b64 v5, v[16:17] offset:7392
    v_mul_f32 v122, v124, v112
    v_mul_f32 v123, v124, v113
    v_fma_f32 v122, -v125, v113, v122
    v_fmac_f32 v123, v125, v112
    v_cvt_pk_bf16_f32 v20, v122, v123
    v_lshlrev_b32 v22, 16, v20
    v_and_b32 v23, 0xffff0000, v20
    v_sub_f32 v22, v122, v22
    v_sub_f32 v23, v123, v23
    v_cvt_pk_bf16_f32 v79, v22, v23
    v_mov_b32 v21, v20
    ds_write_b64 v5, v[20:21] offset:7920
    ds_read_b128 v[32:35], v6 offset:0
    ds_read_b128 v[36:39], v6 offset:64
    ds_read_b128 v[40:43], v6 offset:128
    ds_read_b128 v[44:47], v6 offset:192
    ds_read_b128 v[48:51], v6 offset:256
    ds_read_b128 v[52:55], v6 offset:320
    ds_read_b128 v[56:59], v6 offset:384
    ds_read_b128 v[60:63], v6 offset:448
    v_mov_b32 v8, v64
    v_mov_b32 v9, v64
    ds_write_b64 v5, v[8:9] offset:0
    v_mov_b32 v12, v65
    v_mov_b32 v13, v65
    ds_write_b64 v5, v[12:13] offset:528
    v_mov_b32 v16, v66
    v_mov_b32 v17, v66
    ds_write_b64 v5, v[16:17] offset:1056
    v_mov_b32 v20, v67
    v_mov_b32 v21, v67
    ds_write_b64 v5, v[20:21] offset:1584
    v_mov_b32 v8, v68
    v_mov_b32 v9, v68
    ds_write_b64 v5, v[8:9] offset:2112
    v_mov_b32 v12, v69
    v_mov_b32 v13, v69
    ds_write_b64 v5, v[12:13] offset:2640
    v_mov_b32 v16, v70
    v_mov_b32 v17, v70
    ds_write_b64 v5, v[16:17] offset:3168
    v_mov_b32 v20, v71
    v_mov_b32 v21, v71
    ds_write_b64 v5, v[20:21] offset:3696
    v_mov_b32 v8, v72
    v_mov_b32 v9, v72
    ds_write_b64 v5, v[8:9] offset:4224
    v_mov_b32 v12, v73
    v_mov_b32 v13, v73
    ds_write_b64 v5, v[12:13] offset:4752
    v_mov_b32 v16, v74
    v_mov_b32 v17, v74
    ds_write_b64 v5, v[16:17] offset:5280
    v_mov_b32 v20, v75
    v_mov_b32 v21, v75
    ds_write_b64 v5, v[20:21] offset:5808
    v_mov_b32 v8, v76
    v_mov_b32 v9, v76
    ds_write_b64 v5, v[8:9] offset:6336
    v_mov_b32 v12, v77
    v_mov_b32 v13, v77
    ds_write_b64 v5, v[12:13] offset:6864
    v_mov_b32 v16, v78
    v_mov_b32 v17, v78
    ds_write_b64 v5, v[16:17] offset:7392
    v_mov_b32 v20, v79
    v_mov_b32 v21, v79
    ds_write_b64 v5, v[20:21] offset:7920
    ds_read_b128 v[136:139], v6 offset:0
    ds_read_b128 v[140:143], v6 offset:64
    ds_read_b128 v[144:147], v6 offset:128
    ds_read_b128 v[148:151], v6 offset:192
    ds_read_b128 v[152:155], v6 offset:256
    ds_read_b128 v[156:159], v6 offset:320
    ds_read_b128 v[160:163], v6 offset:384
    ds_read_b128 v[164:167], v6 offset:448
    v_mul_f32 v24, 0x3f800000, v0
    v_mul_f32 v28, 0x40000000, v0
    v_mul_f32 v25, 0x3f800000, v1
    v_mul_f32 v29, 0x40000000, v1
    v_exp_f32 v24, v24
    v_exp_f32 v28, v28
    v_fract_f32 v25, v25
    v_fract_f32 v29, v29
    v_cos_f32 v26, v25
    v_cos_f32 v30, v29
    v_sin_f32 v27, v25
    v_sin_f32 v31, v29
    v_mul_f32 v112, v24, v26
    v_mul_f32 v114, v28, v30
    v_mul_f32 v113, v24, v27
    v_mul_f32 v115, v28, v31
    v_mul_f32 v24, 0x40800000, v0
    v_mul_f32 v28, 0x43000000, v0
    v_mul_f32 v25, 0x40800000, v1
    v_mul_f32 v29, 0x43000000, v1
    v_exp_f32 v24, v24
    v_exp_f32 v28, v28
    v_fract_f32 v25, v25
    v_fract_f32 v29, v29
    v_cos_f32 v26, v25
    v_cos_f32 v30, v29
    v_sin_f32 v27, v25
    v_sin_f32 v31, v29
    v_mul_f32 v116, v24, v26
    v_mul_f32 v126, v28, v30
    v_mul_f32 v117, v24, v27
    v_mul_f32 v127, v28, v31
    v_mul_f32 v120, v126, v2
    v_mul_f32 v121, v126, v3
    v_fma_f32 v120, -v127, v3, v120
    v_fmac_f32 v121, v127, v2
    v_cvt_pk_bf16_f32 v8, v2, v3
    v_lshlrev_b32 v10, 16, v8
    v_and_b32 v11, 0xffff0000, v8
    v_sub_f32 v10, v2, v10
    v_sub_f32 v11, v3, v11
    v_cvt_pk_bf16_f32 v9, v10, v11
    ds_write_b64 v5, v[8:9] offset:0
    v_mul_f32 v122, v2, v112
    v_mul_f32 v124, v2, v114
    v_mul_f32 v123, v2, v113
    v_mul_f32 v125, v2, v115
    v_fma_f32 v122, -v3, v113, v122
    v_fma_f32 v124, -v3, v115, v124
    v_fmac_f32 v123, v3, v112
    v_fmac_f32 v125, v3, v114
    v_cvt_pk_bf16_f32 v12, v122, v123
    v_lshlrev_b32 v14, 16, v12
    v_and_b32 v15, 0xffff0000, v12
    v_sub_f32 v14, v122, v14
    v_sub_f32 v15, v123, v15
    v_cvt_pk_bf16_f32 v13, v14, v15
    ds_write_b64 v5, v[12:13] offset:2112
    v_cvt_pk_bf16_f32 v16, v124, v125
    v_lshlrev_b32 v18, 16, v16
    v_and_b32 v19, 0xffff0000, v16
    v_sub_f32 v18, v124, v18
    v_sub_f32 v19, v125, v19
    v_cvt_pk_bf16_f32 v17, v18, v19
    ds_write_b64 v5, v[16:17] offset:528
    v_mul_f32 v122, v124, v112
    v_mul_f32 v126, v2, v116
    v_mul_f32 v123, v124, v113
    v_mul_f32 v127, v2, v117
    v_fma_f32 v122, -v125, v113, v122
    v_fma_f32 v126, -v3, v117, v126
    v_fmac_f32 v123, v125, v112
    v_fmac_f32 v127, v3, v116
    v_cvt_pk_bf16_f32 v20, v122, v123
    v_lshlrev_b32 v22, 16, v20
    v_and_b32 v23, 0xffff0000, v20
    v_sub_f32 v22, v122, v22
    v_sub_f32 v23, v123, v23
    v_cvt_pk_bf16_f32 v21, v22, v23
    ds_write_b64 v5, v[20:21] offset:2640
    v_cvt_pk_bf16_f32 v8, v126, v127
    v_lshlrev_b32 v10, 16, v8
    v_and_b32 v11, 0xffff0000, v8
    v_sub_f32 v10, v126, v10
    v_sub_f32 v11, v127, v11
    v_cvt_pk_bf16_f32 v9, v10, v11
    ds_write_b64 v5, v[8:9] offset:1056
    v_mul_f32 v122, v126, v112
    v_mul_f32 v124, v126, v114
    v_mul_f32 v123, v126, v113
    v_mul_f32 v125, v126, v115
    v_fma_f32 v122, -v127, v113, v122
    v_fma_f32 v124, -v127, v115, v124
    v_fmac_f32 v123, v127, v112
    v_fmac_f32 v125, v127, v114
    v_cvt_pk_bf16_f32 v12, v122, v123
    v_lshlrev_b32 v14, 16, v12
    v_and_b32 v15, 0xffff0000, v12
    v_sub_f32 v14, v122, v14
    v_sub_f32 v15, v123, v15
    v_cvt_pk_bf16_f32 v13, v14, v15
    ds_write_b64 v5, v[12:13] offset:3168
    v_cvt_pk_bf16_f32 v16, v124, v125
    v_lshlrev_b32 v18, 16, v16
    v_and_b32 v19, 0xffff0000, v16
    v_sub_f32 v18, v124, v18
    v_sub_f32 v19, v125, v19
    v_cvt_pk_bf16_f32 v17, v18, v19
    ds_write_b64 v5, v[16:17] offset:1584
    v_mul_f32 v122, v124, v112
    v_mul_f32 v123, v124, v113
    v_fma_f32 v122, -v125, v113, v122
    v_fmac_f32 v123, v125, v112
    v_cvt_pk_bf16_f32 v20, v122, v123
    v_lshlrev_b32 v22, 16, v20
    v_and_b32 v23, 0xffff0000, v20
    v_sub_f32 v22, v122, v22
    v_sub_f32 v23, v123, v23
    v_cvt_pk_bf16_f32 v21, v22, v23
    ds_write_b64 v5, v[20:21] offset:3696
    v_cvt_pk_bf16_f32 v8, v120, v121
    v_lshlrev_b32 v10, 16, v8
    v_and_b32 v11, 0xffff0000, v8
    v_sub_f32 v10, v120, v10
    v_sub_f32 v11, v121, v11
    v_cvt_pk_bf16_f32 v9, v10, v11
    ds_write_b64 v5, v[8:9] offset:4224
    v_mul_f32 v122, v120, v112
    v_mul_f32 v124, v120, v114
    v_mul_f32 v123, v120, v113
    v_mul_f32 v125, v120, v115
    v_fma_f32 v122, -v121, v113, v122
    v_fma_f32 v124, -v121, v115, v124
    v_fmac_f32 v123, v121, v112
    v_fmac_f32 v125, v121, v114
    v_cvt_pk_bf16_f32 v12, v122, v123
    v_lshlrev_b32 v14, 16, v12
    v_and_b32 v15, 0xffff0000, v12
    v_sub_f32 v14, v122, v14
    v_sub_f32 v15, v123, v15
    v_cvt_pk_bf16_f32 v13, v14, v15
    ds_write_b64 v5, v[12:13] offset:6336
    v_cvt_pk_bf16_f32 v16, v124, v125
    v_lshlrev_b32 v18, 16, v16
    v_and_b32 v19, 0xffff0000, v16
    v_sub_f32 v18, v124, v18
    v_sub_f32 v19, v125, v19
    v_cvt_pk_bf16_f32 v17, v18, v19
    ds_write_b64 v5, v[16:17] offset:4752
    v_mul_f32 v122, v124, v112
    v_mul_f32 v126, v120, v116
    v_mul_f32 v123, v124, v113
    v_mul_f32 v127, v120, v117
    v_fma_f32 v122, -v125, v113, v122
    v_fma_f32 v126, -v121, v117, v126
    v_fmac_f32 v123, v125, v112
    v_fmac_f32 v127, v121, v116
    v_cvt_pk_bf16_f32 v20, v122, v123
    v_lshlrev_b32 v22, 16, v20
    v_and_b32 v23, 0xffff0000, v20
    v_sub_f32 v22, v122, v22
    v_sub_f32 v23, v123, v23
    v_cvt_pk_bf16_f32 v21, v22, v23
    ds_write_b64 v5, v[20:21] offset:6864
    v_cvt_pk_bf16_f32 v8, v126, v127
    v_lshlrev_b32 v10, 16, v8
    v_and_b32 v11, 0xffff0000, v8
    v_sub_f32 v10, v126, v10
    v_sub_f32 v11, v127, v11
    v_cvt_pk_bf16_f32 v9, v10, v11
    ds_write_b64 v5, v[8:9] offset:5280
    v_mul_f32 v122, v126, v112
    v_mul_f32 v124, v126, v114
    v_mul_f32 v123, v126, v113
    v_mul_f32 v125, v126, v115
    v_fma_f32 v122, -v127, v113, v122
    v_fma_f32 v124, -v127, v115, v124
    v_fmac_f32 v123, v127, v112
    v_fmac_f32 v125, v127, v114
    v_cvt_pk_bf16_f32 v12, v122, v123
    v_lshlrev_b32 v14, 16, v12
    v_and_b32 v15, 0xffff0000, v12
    v_sub_f32 v14, v122, v14
    v_sub_f32 v15, v123, v15
    v_cvt_pk_bf16_f32 v13, v14, v15
    ds_write_b64 v5, v[12:13] offset:7392
    v_cvt_pk_bf16_f32 v16, v124, v125
    v_lshlrev_b32 v18, 16, v16
    v_and_b32 v19, 0xffff0000, v16
    v_sub_f32 v18, v124, v18
    v_sub_f32 v19, v125, v19
    v_cvt_pk_bf16_f32 v17, v18, v19
    ds_write_b64 v5, v[16:17] offset:5808
    v_mul_f32 v122, v124, v112
    v_mul_f32 v123, v124, v113
    v_fma_f32 v122, -v125, v113, v122
    v_fmac_f32 v123, v125, v112
    v_cvt_pk_bf16_f32 v20, v122, v123
    v_lshlrev_b32 v22, 16, v20
    v_and_b32 v23, 0xffff0000, v20
    v_sub_f32 v22, v122, v22
    v_sub_f32 v23, v123, v23
    v_cvt_pk_bf16_f32 v21, v22, v23
    ds_write_b64 v5, v[20:21] offset:7920
    ds_read_b128 v[64:67], v6 offset:0
    ds_read_b128 v[68:71], v6 offset:64
    ds_read_b128 v[72:75], v6 offset:128
    ds_read_b128 v[76:79], v6 offset:192
    ds_read_b128 v[80:83], v6 offset:256
    ds_read_b128 v[84:87], v6 offset:320
    ds_read_b128 v[88:91], v6 offset:384
    ds_read_b128 v[92:95], v6 offset:448
    v_mul_f32 v24, 0x43800000, v0
    v_mul_f32 v25, 0x43800000, v1
    v_exp_f32 v24, v24
    v_fract_f32 v25, v25
    v_cos_f32 v26, v25
    v_sin_f32 v27, v25
    v_mul_f32 v126, v24, v26
    v_mul_f32 v127, v24, v27
    s_waitcnt lgkmcnt(7)
    v_mfma_f32_16x16x32_bf16 v[96:99], v[64:67], v[32:35], 0
    v_mul_f32 v120, v126, v2
    v_mul_f32 v121, v126, v3
    v_fma_f32 v120, -v127, v3, v120
    v_fmac_f32 v121, v127, v2
    v_cvt_pk_bf16_f32 v8, v120, v121
    v_lshlrev_b32 v10, 16, v8
    v_and_b32 v11, 0xffff0000, v8
    v_sub_f32 v10, v120, v10
    v_mfma_f32_16x16x32_bf16 v[96:99], v[64:67], v[136:139], v[96:99]
    v_sub_f32 v11, v121, v11
    v_cvt_pk_bf16_f32 v9, v10, v11
    ds_write_b64 v5, v[8:9] offset:0
    v_mul_f32 v122, v120, v114
    v_mul_f32 v124, v120, v116
    v_mul_f32 v123, v120, v115
    v_mul_f32 v125, v120, v117
    v_fma_f32 v122, -v121, v115, v122
    s_waitcnt lgkmcnt(7)
    v_mfma_f32_16x16x32_bf16 v[96:99], v[68:71], v[36:39], v[96:99]
    v_fma_f32 v124, -v121, v117, v124
    v_fmac_f32 v123, v121, v114
    v_fmac_f32 v125, v121, v116
    v_cvt_pk_bf16_f32 v12, v122, v123
    v_lshlrev_b32 v14, 16, v12
    v_and_b32 v15, 0xffff0000, v12
    v_sub_f32 v14, v122, v14
    v_sub_f32 v15, v123, v15
    v_mfma_f32_16x16x32_bf16 v[96:99], v[68:71], v[140:143], v[96:99]
    v_cvt_pk_bf16_f32 v13, v14, v15
    ds_write_b64 v5, v[12:13] offset:528
    v_cvt_pk_bf16_f32 v16, v124, v125
    v_lshlrev_b32 v18, 16, v16
    v_and_b32 v19, 0xffff0000, v16
    v_sub_f32 v18, v124, v18
    v_sub_f32 v19, v125, v19
    v_cvt_pk_bf16_f32 v17, v18, v19
    s_waitcnt lgkmcnt(7)
    v_mfma_f32_16x16x32_bf16 v[96:99], v[72:75], v[40:43], v[96:99]
    ds_write_b64 v5, v[16:17] offset:1056
    v_mul_f32 v122, v124, v114
    v_mul_f32 v123, v124, v115
    v_fma_f32 v122, -v125, v115, v122
    v_fmac_f32 v123, v125, v114
    v_cvt_pk_bf16_f32 v20, v122, v123
    v_lshlrev_b32 v22, 16, v20
    v_and_b32 v23, 0xffff0000, v20
    v_mfma_f32_16x16x32_bf16 v[96:99], v[72:75], v[144:147], v[96:99]
    v_sub_f32 v22, v122, v22
    v_sub_f32 v23, v123, v23
    v_cvt_pk_bf16_f32 v21, v22, v23
    ds_write_b64 v5, v[20:21] offset:1584
    v_mul_f32 v28, 0x43c00000, v0
    v_mul_f32 v29, 0x43c00000, v1
    v_exp_f32 v28, v28
    v_fract_f32 v29, v29
    s_waitcnt lgkmcnt(8)
    v_mfma_f32_16x16x32_bf16 v[96:99], v[76:79], v[44:47], v[96:99]
    v_cos_f32 v30, v29
    v_sin_f32 v31, v29
    v_mul_f32 v126, v28, v30
    v_mul_f32 v127, v28, v31
    v_mul_f32 v120, v126, v2
    v_mul_f32 v121, v126, v3
    v_fma_f32 v120, -v127, v3, v120
    v_fmac_f32 v121, v127, v2
    v_mfma_f32_16x16x32_bf16 v[96:99], v[76:79], v[148:151], v[96:99]
    v_cvt_pk_bf16_f32 v8, v120, v121
    v_lshlrev_b32 v10, 16, v8
    v_and_b32 v11, 0xffff0000, v8
    v_sub_f32 v10, v120, v10
    v_sub_f32 v11, v121, v11
    v_cvt_pk_bf16_f32 v9, v10, v11
    ds_write_b64 v5, v[8:9] offset:2112
    v_mul_f32 v122, v120, v114
    s_waitcnt lgkmcnt(8)
    v_mfma_f32_16x16x32_bf16 v[96:99], v[80:83], v[48:51], v[96:99]
    v_mul_f32 v124, v120, v116
    v_mul_f32 v123, v120, v115
    v_mul_f32 v125, v120, v117
    v_fma_f32 v122, -v121, v115, v122
    v_fma_f32 v124, -v121, v117, v124
    v_fmac_f32 v123, v121, v114
    v_fmac_f32 v125, v121, v116
    v_cvt_pk_bf16_f32 v12, v122, v123
    v_mfma_f32_16x16x32_bf16 v[96:99], v[80:83], v[152:155], v[96:99]
    v_lshlrev_b32 v14, 16, v12
    v_and_b32 v15, 0xffff0000, v12
    v_sub_f32 v14, v122, v14
    v_sub_f32 v15, v123, v15
    v_cvt_pk_bf16_f32 v13, v14, v15
    ds_write_b64 v5, v[12:13] offset:2640
    v_cvt_pk_bf16_f32 v16, v124, v125
    v_lshlrev_b32 v18, 16, v16
    s_waitcnt lgkmcnt(8)
    v_mfma_f32_16x16x32_bf16 v[96:99], v[84:87], v[52:55], v[96:99]
    v_and_b32 v19, 0xffff0000, v16
    v_sub_f32 v18, v124, v18
    v_sub_f32 v19, v125, v19
    v_cvt_pk_bf16_f32 v17, v18, v19
    ds_write_b64 v5, v[16:17] offset:3168
    v_mul_f32 v122, v124, v114
    v_mul_f32 v123, v124, v115
    v_fma_f32 v122, -v125, v115, v122
    v_mfma_f32_16x16x32_bf16 v[96:99], v[84:87], v[156:159], v[96:99]
    v_fmac_f32 v123, v125, v114
    v_cvt_pk_bf16_f32 v20, v122, v123
    v_lshlrev_b32 v22, 16, v20
    v_and_b32 v23, 0xffff0000, v20
    v_sub_f32 v22, v122, v22
    v_sub_f32 v23, v123, v23
    v_cvt_pk_bf16_f32 v21, v22, v23
    ds_write_b64 v5, v[20:21] offset:3696
    s_waitcnt lgkmcnt(9)
    v_mfma_f32_16x16x32_bf16 v[96:99], v[88:91], v[56:59], v[96:99]
    v_mul_f32 v24, 0x45000000, v0
    v_mul_f32 v25, 0x45000000, v1
    v_exp_f32 v24, v24
    v_fract_f32 v25, v25
    v_cos_f32 v26, v25
    v_sin_f32 v27, v25
    v_mul_f32 v126, v24, v26
    v_mul_f32 v127, v24, v27
    v_mfma_f32_16x16x32_bf16 v[96:99], v[88:91], v[160:163], v[96:99]
    v_mul_f32 v120, v126, v2
    v_mul_f32 v121, v126, v3
    v_fma_f32 v120, -v127, v3, v120
    v_fmac_f32 v121, v127, v2
    v_cvt_pk_bf16_f32 v8, v120, v121
    v_lshlrev_b32 v10, 16, v8
    v_and_b32 v11, 0xffff0000, v8
    v_sub_f32 v10, v120, v10
    s_waitcnt lgkmcnt(8)
    v_mfma_f32_16x16x32_bf16 v[96:99], v[92:95], v[60:63], v[96:99]
    v_sub_f32 v11, v121, v11
    v_cvt_pk_bf16_f32 v9, v10, v11
    ds_write_b64 v5, v[8:9] offset:4224
    v_mfma_f32_16x16x32_bf16 v[96:99], v[92:95], v[164:167], v[96:99]
    ds_read_b128 v[64:67], v6 offset:0
    ds_read_b128 v[68:71], v6 offset:64
    ds_read_b128 v[72:75], v6 offset:128
    ds_read_b128 v[76:79], v6 offset:192
    ds_read_b128 v[80:83], v6 offset:256
    ds_read_b128 v[84:87], v6 offset:320
    ds_read_b128 v[88:91], v6 offset:384
    ds_read_b128 v[92:95], v6 offset:448
    v_mul_f32 v28, 0x43000000, v0
    v_mul_f32 v24, 0x43800000, v0
    v_mul_f32 v29, 0x43000000, v1
    v_mul_f32 v25, 0x43800000, v1
    v_exp_f32 v28, v28
    v_exp_f32 v24, v24
    v_fract_f32 v29, v29
    v_fract_f32 v25, v25
    v_cos_f32 v30, v29
    v_cos_f32 v26, v25
    v_sin_f32 v31, v29
    v_sin_f32 v27, v25
    v_mul_f32 v112, v28, v30
    v_mul_f32 v114, v24, v26
    s_waitcnt lgkmcnt(7)
    v_mfma_f32_16x16x32_bf16 v[104:107], v[64:67], v[32:35], 0
    v_mul_f32 v113, v28, v31
    v_mul_f32 v115, v24, v27
    v_mul_f32 v28, 0x44000000, v0
    v_mul_f32 v29, 0x44000000, v1
    v_exp_f32 v28, v28
    v_fract_f32 v29, v29
    v_cos_f32 v30, v29
    v_sin_f32 v31, v29
    v_mul_f32 v126, v28, v30
    v_mul_f32 v127, v28, v31
    v_mul_f32 v120, v126, v2
    v_mul_f32 v121, v126, v3
    v_fma_f32 v120, -v127, v3, v120
    v_fmac_f32 v121, v127, v2
    v_mfma_f32_16x16x32_bf16 v[104:107], v[64:67], v[136:139], v[104:107]
    v_cvt_pk_bf16_f32 v12, v120, v121
    v_lshlrev_b32 v14, 16, v12
    v_and_b32 v15, 0xffff0000, v12
    v_sub_f32 v14, v120, v14
    v_sub_f32 v15, v121, v15
    v_cvt_pk_bf16_f32 v13, v14, v15
    ds_write_b64 v5, v[12:13] offset:0
    v_mul_f32 v122, v120, v112
    v_mul_f32 v124, v120, v114
    v_mul_f32 v123, v120, v113
    v_mul_f32 v125, v120, v115
    v_fma_f32 v122, -v121, v113, v122
    v_fma_f32 v124, -v121, v115, v124
    v_fmac_f32 v123, v121, v112
    s_waitcnt lgkmcnt(7)
    v_mfma_f32_16x16x32_bf16 v[104:107], v[68:71], v[36:39], v[104:107]
    v_fmac_f32 v125, v121, v114
    v_cvt_pk_bf16_f32 v16, v122, v123
    v_lshlrev_b32 v18, 16, v16
    v_and_b32 v19, 0xffff0000, v16
    v_sub_f32 v18, v122, v18
    v_sub_f32 v19, v123, v19
    v_cvt_pk_bf16_f32 v17, v18, v19
    ds_write_b64 v5, v[16:17] offset:528
    v_cvt_pk_bf16_f32 v20, v124, v125
    v_lshlrev_b32 v22, 16, v20
    v_and_b32 v23, 0xffff0000, v20
    v_sub_f32 v22, v124, v22
    v_sub_f32 v23, v125, v23
    v_cvt_pk_bf16_f32 v21, v22, v23
    v_mfma_f32_16x16x32_bf16 v[104:107], v[68:71], v[140:143], v[104:107]
    ds_write_b64 v5, v[20:21] offset:1056
    v_mul_f32 v122, v124, v112
    v_mul_f32 v123, v124, v113
    v_fma_f32 v122, -v125, v113, v122
    v_fmac_f32 v123, v125, v112
    v_cvt_pk_bf16_f32 v8, v122, v123
    v_lshlrev_b32 v10, 16, v8
    v_and_b32 v11, 0xffff0000, v8
    v_sub_f32 v10, v122, v10
    v_sub_f32 v11, v123, v11
    v_cvt_pk_bf16_f32 v9, v10, v11
    ds_write_b64 v5, v[8:9] offset:1584
    v_mul_f32 v24, 0x44010000, v0
    v_mul_f32 v25, 0x44010000, v1
    s_waitcnt lgkmcnt(9)
    v_mfma_f32_16x16x32_bf16 v[104:107], v[72:75], v[40:43], v[104:107]
    v_exp_f32 v24, v24
    v_fract_f32 v25, v25
    v_cos_f32 v26, v25
    v_sin_f32 v27, v25
    v_mul_f32 v126, v24, v26
    v_mul_f32 v127, v24, v27
    v_mul_f32 v120, v126, v2
    v_mul_f32 v121, v126, v3
    v_fma_f32 v120, -v127, v3, v120
    v_fmac_f32 v121, v127, v2
    v_cvt_pk_bf16_f32 v12, v120, v121
    v_lshlrev_b32 v14, 16, v12
    v_and_b32 v15, 0xffff0000, v12
    v_sub_f32 v14, v120, v14
    v_mfma_f32_16x16x32_bf16 v[104:107], v[72:75], v[144:147], v[104:107]
    v_sub_f32 v15, v121, v15
    v_cvt_pk_bf16_f32 v13, v14, v15
    ds_write_b64 v5, v[12:13] offset:2112
    v_mul_f32 v122, v120, v112
    v_mul_f32 v124, v120, v114
    v_mul_f32 v123, v120, v113
    v_mul_f32 v125, v120, v115
    v_fma_f32 v122, -v121, v113, v122
    v_fma_f32 v124, -v121, v115, v124
    v_fmac_f32 v123, v121, v112
    v_fmac_f32 v125, v121, v114
    v_cvt_pk_bf16_f32 v16, v122, v123
    v_lshlrev_b32 v18, 16, v16
    v_and_b32 v19, 0xffff0000, v16
    s_waitcnt lgkmcnt(9)
    v_mfma_f32_16x16x32_bf16 v[104:107], v[76:79], v[44:47], v[104:107]
    v_sub_f32 v18, v122, v18
    v_sub_f32 v19, v123, v19
    v_cvt_pk_bf16_f32 v17, v18, v19
    ds_write_b64 v5, v[16:17] offset:2640
    v_cvt_pk_bf16_f32 v20, v124, v125
    v_lshlrev_b32 v22, 16, v20
    v_and_b32 v23, 0xffff0000, v20
    v_sub_f32 v22, v124, v22
    v_sub_f32 v23, v125, v23
    v_cvt_pk_bf16_f32 v21, v22, v23
    ds_write_b64 v5, v[20:21] offset:3168
    v_mul_f32 v122, v124, v112
    v_mul_f32 v123, v124, v113
    v_fma_f32 v122, -v125, v113, v122
    v_mfma_f32_16x16x32_bf16 v[104:107], v[76:79], v[148:151], v[104:107]
    v_fmac_f32 v123, v125, v112
    v_cvt_pk_bf16_f32 v8, v122, v123
    v_lshlrev_b32 v10, 16, v8
    v_and_b32 v11, 0xffff0000, v8
    v_sub_f32 v10, v122, v10
    v_sub_f32 v11, v123, v11
    v_cvt_pk_bf16_f32 v9, v10, v11
    ds_write_b64 v5, v[8:9] offset:3696
    v_mul_f32 v28, 0x44800000, v0
    v_mul_f32 v29, 0x44800000, v1
    v_exp_f32 v28, v28
    v_fract_f32 v29, v29
    v_cos_f32 v30, v29
    v_sin_f32 v31, v29
    s_waitcnt lgkmcnt(11)
    v_mfma_f32_16x16x32_bf16 v[104:107], v[80:83], v[48:51], v[104:107]
    v_mul_f32 v126, v28, v30
    v_mul_f32 v127, v28, v31
    v_mul_f32 v120, v126, v2
    v_mul_f32 v121, v126, v3
    v_fma_f32 v120, -v127, v3, v120
    v_fmac_f32 v121, v127, v2
    v_cvt_pk_bf16_f32 v12, v120, v121
    v_lshlrev_b32 v14, 16, v12
    v_and_b32 v15, 0xffff0000, v12
    v_sub_f32 v14, v120, v14
    v_sub_f32 v15, v121, v15
    v_cvt_pk_bf16_f32 v13, v14, v15
    ds_write_b64 v5, v[12:13] offset:4224
    v_mul_f32 v122, v120, v112
    v_mfma_f32_16x16x32_bf16 v[104:107], v[80:83], v[152:155], v[104:107]
    v_mul_f32 v124, v120, v114
    v_mul_f32 v123, v120, v113
    v_mul_f32 v125, v120, v115
    v_fma_f32 v122, -v121, v113, v122
    v_fma_f32 v124, -v121, v115, v124
    v_fmac_f32 v123, v121, v112
    v_fmac_f32 v125, v121, v114
    v_cvt_pk_bf16_f32 v16, v122, v123
    v_lshlrev_b32 v18, 16, v16
    v_and_b32 v19, 0xffff0000, v16
    v_sub_f32 v18, v122, v18
    v_sub_f32 v19, v123, v19
    v_cvt_pk_bf16_f32 v17, v18, v19
    ds_write_b64 v5, v[16:17] offset:4752
    s_waitcnt lgkmcnt(12)
    v_mfma_f32_16x16x32_bf16 v[104:107], v[84:87], v[52:55], v[104:107]
    v_cvt_pk_bf16_f32 v20, v124, v125
    v_lshlrev_b32 v22, 16, v20
    v_and_b32 v23, 0xffff0000, v20
    v_sub_f32 v22, v124, v22
    v_sub_f32 v23, v125, v23
    v_cvt_pk_bf16_f32 v21, v22, v23
    ds_write_b64 v5, v[20:21] offset:5280
    v_mul_f32 v122, v124, v112
    v_mul_f32 v123, v124, v113
    v_fma_f32 v122, -v125, v113, v122
    v_fmac_f32 v123, v125, v112
    v_cvt_pk_bf16_f32 v8, v122, v123
    v_lshlrev_b32 v10, 16, v8
    v_and_b32 v11, 0xffff0000, v8
    v_mfma_f32_16x16x32_bf16 v[104:107], v[84:87], v[156:159], v[104:107]
    v_sub_f32 v10, v122, v10
    v_sub_f32 v11, v123, v11
    v_cvt_pk_bf16_f32 v9, v10, v11
    ds_write_b64 v5, v[8:9] offset:5808
    v_mul_f32 v24, 0x44c00000, v0
    v_mul_f32 v25, 0x44c00000, v1
    v_exp_f32 v24, v24
    v_fract_f32 v25, v25
    v_cos_f32 v26, v25
    v_sin_f32 v27, v25
    v_mul_f32 v126, v24, v26
    v_mul_f32 v127, v24, v27
    v_mul_f32 v120, v126, v2
    v_mul_f32 v121, v126, v3
    s_waitcnt lgkmcnt(13)
    v_mfma_f32_16x16x32_bf16 v[104:107], v[88:91], v[56:59], v[104:107]
    v_fma_f32 v120, -v127, v3, v120
    v_fmac_f32 v121, v127, v2
    v_cvt_pk_bf16_f32 v12, v120, v121
    v_lshlrev_b32 v14, 16, v12
    v_and_b32 v15, 0xffff0000, v12
    v_sub_f32 v14, v120, v14
    v_sub_f32 v15, v121, v15
    v_cvt_pk_bf16_f32 v13, v14, v15
    ds_write_b64 v5, v[12:13] offset:6336
    v_mul_f32 v122, v120, v112
    v_mul_f32 v124, v120, v114
    v_mul_f32 v123, v120, v113
    v_mul_f32 v125, v120, v115
    v_fma_f32 v122, -v121, v113, v122
    v_mfma_f32_16x16x32_bf16 v[104:107], v[88:91], v[160:163], v[104:107]
    v_fma_f32 v124, -v121, v115, v124
    v_fmac_f32 v123, v121, v112
    v_fmac_f32 v125, v121, v114
    v_cvt_pk_bf16_f32 v16, v122, v123
    v_lshlrev_b32 v18, 16, v16
    v_and_b32 v19, 0xffff0000, v16
    v_sub_f32 v18, v122, v18
    v_sub_f32 v19, v123, v19
    v_cvt_pk_bf16_f32 v17, v18, v19
    ds_write_b64 v5, v[16:17] offset:6864
    v_cvt_pk_bf16_f32 v20, v124, v125
    v_lshlrev_b32 v22, 16, v20
    v_and_b32 v23, 0xffff0000, v20
    v_sub_f32 v22, v124, v22
    s_waitcnt lgkmcnt(14)
    v_mfma_f32_16x16x32_bf16 v[104:107], v[92:95], v[60:63], v[104:107]
    v_sub_f32 v23, v125, v23
    v_cvt_pk_bf16_f32 v21, v22, v23
    ds_write_b64 v5, v[20:21] offset:7392
    v_mul_f32 v122, v124, v112
    v_mul_f32 v123, v124, v113
    v_fma_f32 v122, -v125, v113, v122
    v_fmac_f32 v123, v125, v112
    v_cvt_pk_bf16_f32 v8, v122, v123
    v_lshlrev_b32 v10, 16, v8
    v_and_b32 v11, 0xffff0000, v8
    v_sub_f32 v10, v122, v10
    v_sub_f32 v11, v123, v11
    v_cvt_pk_bf16_f32 v9, v10, v11
    ds_write_b64 v5, v[8:9] offset:7920
    v_mfma_f32_16x16x32_bf16 v[104:107], v[92:95], v[164:167], v[104:107]
    ds_read_b128 v[64:67], v6 offset:0
    ds_read_b128 v[68:71], v6 offset:64
    ds_read_b128 v[72:75], v6 offset:128
    ds_read_b128 v[76:79], v6 offset:192
    ds_read_b128 v[80:83], v6 offset:256
    ds_read_b128 v[84:87], v6 offset:320
    ds_read_b128 v[88:91], v6 offset:384
    ds_read_b128 v[92:95], v6 offset:448
    s_waitcnt lgkmcnt(7)
    v_mfma_f32_16x16x32_bf16 v[100:103], v[64:67], v[32:35], 0
    v_mfma_f32_16x16x32_bf16 v[100:103], v[64:67], v[136:139], v[100:103]
    s_waitcnt lgkmcnt(6)
    v_mfma_f32_16x16x32_bf16 v[100:103], v[68:71], v[36:39], v[100:103]
    v_mfma_f32_16x16x32_bf16 v[100:103], v[68:71], v[140:143], v[100:103]
    s_waitcnt lgkmcnt(5)
    v_mfma_f32_16x16x32_bf16 v[100:103], v[72:75], v[40:43], v[100:103]
    v_mfma_f32_16x16x32_bf16 v[100:103], v[72:75], v[144:147], v[100:103]
    s_waitcnt lgkmcnt(4)
    v_mfma_f32_16x16x32_bf16 v[100:103], v[76:79], v[44:47], v[100:103]
    v_mfma_f32_16x16x32_bf16 v[100:103], v[76:79], v[148:151], v[100:103]
    s_waitcnt lgkmcnt(3)
    v_mfma_f32_16x16x32_bf16 v[100:103], v[80:83], v[48:51], v[100:103]
    v_mfma_f32_16x16x32_bf16 v[100:103], v[80:83], v[152:155], v[100:103]
    s_waitcnt lgkmcnt(2)
    v_mfma_f32_16x16x32_bf16 v[100:103], v[84:87], v[52:55], v[100:103]
    v_mfma_f32_16x16x32_bf16 v[100:103], v[84:87], v[156:159], v[100:103]
    s_waitcnt lgkmcnt(1)
    v_mfma_f32_16x16x32_bf16 v[100:103], v[88:91], v[56:59], v[100:103]
    v_mfma_f32_16x16x32_bf16 v[100:103], v[88:91], v[160:163], v[100:103]
    s_waitcnt lgkmcnt(0)
    v_mfma_f32_16x16x32_bf16 v[100:103], v[92:95], v[60:63], v[100:103]
    v_mfma_f32_16x16x32_bf16 v[100:103], v[92:95], v[164:167], v[100:103]
    v_and_b32 v169, 15, v168
    v_lshlrev_b32 v169, 5, v169
    v_add_u32 v169, s47, v169
    v_lshrrev_b32 v170, 5, v168
    v_bfe_u32 v171, v168, 4, 1
    v_lshl_add_u32 v7, v170, 9, v169
    v_lshl_add_u32 v7, v171, 2, v7
    ds_write_b32 v7, v96 offset:0
    ds_write_b32 v7, v97 offset:8
    ds_write_b32 v7, v98 offset:16
    ds_write_b32 v7, v99 offset:24
    v_mul_u32_u24 v175, 7, v170
    v_add_u32 v175, 4, v175
    v_lshlrev_b32 v175, v175, v171
    v_lshl_add_u32 v7, v170, 11, v169
    v_add_u32 v7, v7, v175
    ds_write_b32 v7, v100 offset:2048
    ds_write_b32 v7, v101 offset:2560
    ds_write_b32 v7, v102 offset:3072
    ds_write_b32 v7, v103 offset:3584
    v_mul_u32_u24 v7, 7168, v170
    v_lshl_add_u32 v7, v171, 9, v7
    v_add_u32 v7, v7, v169
    s_mov_b32 exec_hi, 0xffff
    ds_write_b32 v7, v104 offset:1024
    ds_write_b32 v7, v105 offset:1032
    ds_write_b32 v7, v106 offset:1040
    ds_write_b32 v7, v107 offset:1048
    s_mov_b32 exec_hi, -1
    s_waitcnt vmcnt(0) lgkmcnt(0)
    s_barrier
    v_mov_b32 v169, 0
    ds_write_b16 v174, v169 offset:4192
    s_lshr_b32 s4, s44, 1
    s_mul_i32 s5, s4, 17408
    s_mul_i32 s6, s4, 4608
    s_add_u32 s6, s6, 51456
    v_and_b32 v169, 127, v172
    v_lshlrev_b32 v170, 1, v169
    v_lshl_add_u32 v171, v169, 2, s6
    v_sub_u32 v8, 2047, v170
    v_cvt_f32_u32 v8, v8
    v_sub_u32 v9, 2046, v170
    v_cvt_f32_u32 v9, v9
    v_sub_u32 v10, 1791, v170
    v_cvt_f32_u32 v10, v10
    v_sub_u32 v11, 1790, v170
    v_cvt_f32_u32 v11, v11
    v_sub_u32 v12, 1535, v170
    v_cvt_f32_u32 v12, v12
    v_sub_u32 v13, 1534, v170
    v_cvt_f32_u32 v13, v13
    v_sub_u32 v14, 1279, v170
    v_cvt_f32_u32 v14, v14
    v_sub_u32 v15, 1278, v170
    v_cvt_f32_u32 v15, v15
    v_sub_u32 v16, 1023, v170
    v_cvt_f32_u32 v16, v16
    v_sub_u32 v17, 1022, v170
    v_cvt_f32_u32 v17, v17
    v_sub_u32 v18, 767, v170
    v_cvt_f32_u32 v18, v18
    v_sub_u32 v19, 766, v170
    v_cvt_f32_u32 v19, v19
    v_sub_u32 v20, 511, v170
    v_cvt_f32_u32 v20, v20
    v_sub_u32 v21, 510, v170
    v_cvt_f32_u32 v21, v21
    v_sub_u32 v22, 255, v170
    v_cvt_f32_u32 v22, v22
    v_sub_u32 v23, 254, v170
    v_cvt_f32_u32 v23, v23
    v_cvt_pk_bf16_f32 v175, v8, v9
    v_lshlrev_b32 v8, 16, v175
    v_and_b32 v9, 0xffff0000, v175
    v_cvt_pk_bf16_f32 v175, v10, v11
    v_lshlrev_b32 v10, 16, v175
    v_and_b32 v11, 0xffff0000, v175
    v_cvt_pk_bf16_f32 v175, v12, v13
    v_lshlrev_b32 v12, 16, v175
    v_and_b32 v13, 0xffff0000, v175
    v_cvt_pk_bf16_f32 v175, v14, v15
    v_lshlrev_b32 v14, 16, v175
    v_and_b32 v15, 0xffff0000, v175
    v_cvt_pk_bf16_f32 v175, v16, v17
    v_lshlrev_b32 v16, 16, v175
    v_and_b32 v17, 0xffff0000, v175
    v_cvt_pk_bf16_f32 v175, v18, v19
    v_lshlrev_b32 v18, 16, v175
    v_and_b32 v19, 0xffff0000, v175
    v_cvt_pk_bf16_f32 v175, v20, v21
    v_lshlrev_b32 v20, 16, v175
    v_and_b32 v21, 0xffff0000, v175
    v_cvt_pk_bf16_f32 v175, v22, v23
    v_lshlrev_b32 v22, 16, v175
    v_and_b32 v23, 0xffff0000, v175
    v_cvt_u32_f32 v8, v8
    v_lshl_add_u32 v8, v8, 2, s5
    ds_read2st64_b32 v[32:33], v8 offset0:0 offset1:34
    v_cvt_u32_f32 v9, v9
    v_lshl_add_u32 v9, v9, 2, s5
    ds_read2st64_b32 v[34:35], v9 offset0:0 offset1:34
    v_cvt_u32_f32 v10, v10
    v_lshl_add_u32 v10, v10, 2, s5
    ds_read2st64_b32 v[36:37], v10 offset0:0 offset1:34
    v_cvt_u32_f32 v11, v11
    v_lshl_add_u32 v11, v11, 2, s5
    ds_read2st64_b32 v[38:39], v11 offset0:0 offset1:34
    v_cvt_u32_f32 v12, v12
    v_lshl_add_u32 v12, v12, 2, s5
    ds_read2st64_b32 v[40:41], v12 offset0:0 offset1:34
    v_cvt_u32_f32 v13, v13
    v_lshl_add_u32 v13, v13, 2, s5
    ds_read2st64_b32 v[42:43], v13 offset0:0 offset1:34
    v_cvt_u32_f32 v14, v14
    v_lshl_add_u32 v14, v14, 2, s5
    ds_read2st64_b32 v[44:45], v14 offset0:0 offset1:34
    v_cvt_u32_f32 v15, v15
    v_lshl_add_u32 v15, v15, 2, s5
    ds_read2st64_b32 v[46:47], v15 offset0:0 offset1:34
    v_cvt_u32_f32 v16, v16
    v_lshl_add_u32 v16, v16, 2, s5
    ds_read2st64_b32 v[48:49], v16 offset0:0 offset1:34
    v_cvt_u32_f32 v17, v17
    v_lshl_add_u32 v17, v17, 2, s5
    ds_read2st64_b32 v[50:51], v17 offset0:0 offset1:34
    v_cvt_u32_f32 v18, v18
    v_lshl_add_u32 v18, v18, 2, s5
    ds_read2st64_b32 v[52:53], v18 offset0:0 offset1:34
    v_cvt_u32_f32 v19, v19
    v_lshl_add_u32 v19, v19, 2, s5
    ds_read2st64_b32 v[54:55], v19 offset0:0 offset1:34
    v_cvt_u32_f32 v20, v20
    v_lshl_add_u32 v20, v20, 2, s5
    ds_read2st64_b32 v[56:57], v20 offset0:0 offset1:34
    v_cvt_u32_f32 v21, v21
    v_lshl_add_u32 v21, v21, 2, s5
    ds_read2st64_b32 v[58:59], v21 offset0:0 offset1:34
    v_cvt_u32_f32 v22, v22
    v_lshl_add_u32 v22, v22, 2, s5
    ds_read2st64_b32 v[60:61], v22 offset0:0 offset1:34
    v_cvt_u32_f32 v23, v23
    v_lshl_add_u32 v23, v23, 2, s5
    ds_read2st64_b32 v[62:63], v23 offset0:0 offset1:34
    s_waitcnt lgkmcnt(15)
    v_add_f32 v32, v32, v33
    s_waitcnt lgkmcnt(14)
    v_add_f32 v34, v34, v35
    s_waitcnt lgkmcnt(13)
    v_add_f32 v36, v36, v37
    s_waitcnt lgkmcnt(12)
    v_add_f32 v38, v38, v39
    s_waitcnt lgkmcnt(11)
    v_add_f32 v40, v40, v41
    s_waitcnt lgkmcnt(10)
    v_add_f32 v42, v42, v43
    s_waitcnt lgkmcnt(9)
    v_add_f32 v44, v44, v45
    s_waitcnt lgkmcnt(8)
    v_add_f32 v46, v46, v47
    s_waitcnt lgkmcnt(7)
    v_add_f32 v48, v48, v49
    s_waitcnt lgkmcnt(6)
    v_add_f32 v50, v50, v51
    s_waitcnt lgkmcnt(5)
    v_add_f32 v52, v52, v53
    s_waitcnt lgkmcnt(4)
    v_add_f32 v54, v54, v55
    s_waitcnt lgkmcnt(3)
    v_add_f32 v56, v56, v57
    s_waitcnt lgkmcnt(2)
    v_add_f32 v58, v58, v59
    s_waitcnt lgkmcnt(1)
    v_add_f32 v60, v60, v61
    s_waitcnt lgkmcnt(0)
    v_add_f32 v62, v62, v63
    v_cvt_pk_bf16_f32 v8, v32, v34
    v_cvt_pk_bf16_f32 v9, v36, v38
    v_cvt_pk_bf16_f32 v10, v40, v42
    v_cvt_pk_bf16_f32 v11, v44, v46
    v_cvt_pk_bf16_f32 v12, v48, v50
    v_cvt_pk_bf16_f32 v13, v52, v54
    v_cvt_pk_bf16_f32 v14, v56, v58
    v_cvt_pk_bf16_f32 v15, v60, v62
    ds_write_b32 v171, v8 offset:0
    ds_write_b32 v171, v9 offset:512
    ds_write_b32 v171, v10 offset:1024
    ds_write_b32 v171, v11 offset:1536
    ds_write_b32 v171, v12 offset:2048
    ds_write_b32 v171, v13 offset:2560
    ds_write_b32 v171, v14 offset:3072
    ds_write_b32 v171, v15 offset:3584
    s_waitcnt lgkmcnt(0)
    s_barrier
    s_and_b32 s7, s44, 1
    s_lshl_b32 s7, s7, 8
    s_mul_i32 s5, s4, 8320
    s_add_u32 s5, s5, 34816
    s_add_u32 s5, s5, s7
    s_add_u32 s6, s6, 480
    s_add_u32 s6, s6, s7
    v_and_b32 v171, 15, v168
    v_lshrrev_b32 v175, 4, v168
    v_add_u32 v169, 2, v171
    v_and_b32 v169, 0x1e, v169
    v_lshlrev_b32 v160, 1, v169
    v_lshl_add_u32 v160, v175, 4, v160
    v_and_b32 v169, 1, v171
    v_xor_b32 v169, 1, v169
    v_mul_u32_u24 v169, 4160, v169
    v_add3_u32 v160, v160, v169, s5
    v_add_u32 v161, 1024, v160
    v_add_u32 v162, 2048, v160
    v_add_u32 v163, 3072, v160
    v_lshlrev_b32 v170, 4, v175
    v_lshlrev_b32 v171, 5, v171
    v_sub_u32 v170, v170, v171
    v_add_u32 v170, s6, v170
    ds_read2_b32 v[0:1], v160 offset0:0 offset1:1
    ds_read2_b32 v[2:3], v160 offset0:2 offset1:3
    ds_read_b128 v[32:35], v170 offset:3584
    ds_read2_b32 v[4:5], v160 offset0:128 offset1:129
    ds_read2_b32 v[6:7], v160 offset0:130 offset1:131
    ds_read_b128 v[36:39], v170 offset:3072
    ds_read2_b32 v[8:9], v161 offset0:0 offset1:1
    ds_read2_b32 v[10:11], v161 offset0:2 offset1:3
    ds_read_b128 v[40:43], v170 offset:2560
    ds_read2_b32 v[12:13], v161 offset0:128 offset1:129
    ds_read2_b32 v[14:15], v161 offset0:130 offset1:131
    ds_read_b128 v[44:47], v170 offset:2048
    ds_read2_b32 v[16:17], v162 offset0:0 offset1:1
    ds_read2_b32 v[18:19], v162 offset0:2 offset1:3
    ds_read_b128 v[48:51], v170 offset:1536
    ds_read2_b32 v[20:21], v162 offset0:128 offset1:129
    ds_read2_b32 v[22:23], v162 offset0:130 offset1:131
    ds_read_b128 v[52:55], v170 offset:1024
    ds_read2_b32 v[24:25], v163 offset0:0 offset1:1
    ds_read2_b32 v[26:27], v163 offset0:2 offset1:3
    ds_read_b128 v[56:59], v170 offset:512
    ds_read2_b32 v[28:29], v163 offset0:128 offset1:129
    ds_read2_b32 v[30:31], v163 offset0:130 offset1:131
    ds_read_b128 v[60:63], v170 offset:0
    s_waitcnt lgkmcnt(15)
    v_mfma_f32_16x16x32_bf16 v[128:131], v[0:3], v[32:35], 0
    v_mfma_f32_16x16x32_bf16 v[132:135], v[0:3], v[36:39], 0
    v_mfma_f32_16x16x32_bf16 v[132:135], v[4:7], v[32:35], v[132:135]
    v_mfma_f32_16x16x32_bf16 v[136:139], v[4:7], v[36:39], 0
    v_mfma_f32_16x16x32_bf16 v[136:139], v[0:3], v[40:43], v[136:139]
    v_mfma_f32_16x16x32_bf16 v[140:143], v[4:7], v[40:43], 0
    v_mfma_f32_16x16x32_bf16 v[136:139], v[8:11], v[32:35], v[136:139]
    v_mfma_f32_16x16x32_bf16 v[140:143], v[8:11], v[36:39], v[140:143]
    v_mfma_f32_16x16x32_bf16 v[144:147], v[8:11], v[40:43], 0
    s_waitcnt lgkmcnt(12)
    v_mfma_f32_16x16x32_bf16 v[140:143], v[0:3], v[44:47], v[140:143]
    v_mfma_f32_16x16x32_bf16 v[144:147], v[4:7], v[44:47], v[144:147]
    v_mfma_f32_16x16x32_bf16 v[148:151], v[8:11], v[44:47], 0
    v_mfma_f32_16x16x32_bf16 v[140:143], v[12:15], v[32:35], v[140:143]
    ds_read2_b32 v[64:65], v160 offset0:16 offset1:17
    v_mfma_f32_16x16x32_bf16 v[144:147], v[12:15], v[36:39], v[144:147]
    ds_read2_b32 v[66:67], v160 offset0:18 offset1:19
    v_mfma_f32_16x16x32_bf16 v[148:151], v[12:15], v[40:43], v[148:151]
    ds_read_b128 v[96:99], v170 offset:3648
    v_mfma_f32_16x16x32_bf16 v[152:155], v[12:15], v[44:47], 0
    ds_read2_b32 v[68:69], v160 offset0:144 offset1:145
    s_waitcnt lgkmcnt(13)
    v_mfma_f32_16x16x32_bf16 v[144:147], v[0:3], v[48:51], v[144:147]
    ds_read2_b32 v[70:71], v160 offset0:146 offset1:147
    v_mfma_f32_16x16x32_bf16 v[148:151], v[4:7], v[48:51], v[148:151]
    ds_read_b128 v[100:103], v170 offset:3136
    v_mfma_f32_16x16x32_bf16 v[152:155], v[8:11], v[48:51], v[152:155]
    ds_read2_b32 v[72:73], v161 offset0:16 offset1:17
    v_mfma_f32_16x16x32_bf16 v[156:159], v[12:15], v[48:51], 0
    ds_read2_b32 v[74:75], v161 offset0:18 offset1:19
    v_mfma_f32_16x16x32_bf16 v[144:147], v[16:19], v[32:35], v[144:147]
    ds_read_b128 v[104:107], v170 offset:2624
    v_mfma_f32_16x16x32_bf16 v[148:151], v[16:19], v[36:39], v[148:151]
    ds_read2_b32 v[76:77], v161 offset0:144 offset1:145
    v_mfma_f32_16x16x32_bf16 v[152:155], v[16:19], v[40:43], v[152:155]
    ds_read2_b32 v[78:79], v161 offset0:146 offset1:147
    v_mfma_f32_16x16x32_bf16 v[156:159], v[16:19], v[44:47], v[156:159]
    ds_read_b128 v[108:111], v170 offset:2112
    s_waitcnt lgkmcnt(15)
    v_mfma_f32_16x16x32_bf16 v[148:151], v[0:3], v[52:55], v[148:151]
    ds_read2_b32 v[80:81], v162 offset0:16 offset1:17
    v_mfma_f32_16x16x32_bf16 v[152:155], v[4:7], v[52:55], v[152:155]
    ds_read2_b32 v[82:83], v162 offset0:18 offset1:19
    v_mfma_f32_16x16x32_bf16 v[156:159], v[8:11], v[52:55], v[156:159]
    ds_read_b128 v[112:115], v170 offset:1600
    v_mfma_f32_16x16x32_bf16 v[148:151], v[20:23], v[32:35], v[148:151]
    ds_read2_b32 v[84:85], v162 offset0:144 offset1:145
    v_mfma_f32_16x16x32_bf16 v[152:155], v[20:23], v[36:39], v[152:155]
    ds_read2_b32 v[86:87], v162 offset0:146 offset1:147
    v_mfma_f32_16x16x32_bf16 v[156:159], v[20:23], v[40:43], v[156:159]
    ds_read_b128 v[116:119], v170 offset:1088
    v_mfma_f32_16x16x32_bf16 v[152:155], v[0:3], v[56:59], v[152:155]
    ds_read2_b32 v[88:89], v163 offset0:16 offset1:17
    v_mfma_f32_16x16x32_bf16 v[156:159], v[4:7], v[56:59], v[156:159]
    ds_read2_b32 v[90:91], v163 offset0:18 offset1:19
    v_mfma_f32_16x16x32_bf16 v[152:155], v[24:27], v[32:35], v[152:155]
    ds_read_b128 v[120:123], v170 offset:576
    v_mfma_f32_16x16x32_bf16 v[156:159], v[24:27], v[36:39], v[156:159]
    ds_read2_b32 v[92:93], v163 offset0:144 offset1:145
    s_waitcnt lgkmcnt(15)
    v_mfma_f32_16x16x32_bf16 v[156:159], v[0:3], v[60:63], v[156:159]
    ds_read2_b32 v[94:95], v163 offset0:146 offset1:147
    v_mfma_f32_16x16x32_bf16 v[156:159], v[28:31], v[32:35], v[156:159]
    ds_read_b128 v[124:127], v170 offset:64
    v_mfma_f32_16x16x32_bf16 v[128:131], v[64:67], v[96:99], v[128:131]
    v_mfma_f32_16x16x32_bf16 v[132:135], v[64:67], v[100:103], v[132:135]
    v_mfma_f32_16x16x32_bf16 v[132:135], v[68:71], v[96:99], v[132:135]
    v_mfma_f32_16x16x32_bf16 v[136:139], v[68:71], v[100:103], v[136:139]
    s_waitcnt lgkmcnt(15)
    v_mfma_f32_16x16x32_bf16 v[136:139], v[64:67], v[104:107], v[136:139]
    v_mfma_f32_16x16x32_bf16 v[140:143], v[68:71], v[104:107], v[140:143]
    v_mfma_f32_16x16x32_bf16 v[136:139], v[72:75], v[96:99], v[136:139]
    v_mfma_f32_16x16x32_bf16 v[140:143], v[72:75], v[100:103], v[140:143]
    v_mfma_f32_16x16x32_bf16 v[144:147], v[72:75], v[104:107], v[144:147]
    s_waitcnt lgkmcnt(12)
    v_mfma_f32_16x16x32_bf16 v[140:143], v[64:67], v[108:111], v[140:143]
    v_mfma_f32_16x16x32_bf16 v[144:147], v[68:71], v[108:111], v[144:147]
    v_mfma_f32_16x16x32_bf16 v[148:151], v[72:75], v[108:111], v[148:151]
    v_mfma_f32_16x16x32_bf16 v[140:143], v[76:79], v[96:99], v[140:143]
    ds_read2_b32 v[0:1], v160 offset0:32 offset1:33
    v_mfma_f32_16x16x32_bf16 v[144:147], v[76:79], v[100:103], v[144:147]
    ds_read2_b32 v[2:3], v160 offset0:34 offset1:35
    v_mfma_f32_16x16x32_bf16 v[148:151], v[76:79], v[104:107], v[148:151]
    ds_read_b128 v[32:35], v170 offset:3712
    v_mfma_f32_16x16x32_bf16 v[152:155], v[76:79], v[108:111], v[152:155]
    ds_read2_b32 v[4:5], v160 offset0:160 offset1:161
    s_waitcnt lgkmcnt(13)
    v_mfma_f32_16x16x32_bf16 v[144:147], v[64:67], v[112:115], v[144:147]
    ds_read2_b32 v[6:7], v160 offset0:162 offset1:163
    v_mfma_f32_16x16x32_bf16 v[148:151], v[68:71], v[112:115], v[148:151]
    ds_read_b128 v[36:39], v170 offset:3200
    v_mfma_f32_16x16x32_bf16 v[152:155], v[72:75], v[112:115], v[152:155]
    ds_read2_b32 v[8:9], v161 offset0:32 offset1:33
    v_mfma_f32_16x16x32_bf16 v[156:159], v[76:79], v[112:115], v[156:159]
    ds_read2_b32 v[10:11], v161 offset0:34 offset1:35
    v_mfma_f32_16x16x32_bf16 v[144:147], v[80:83], v[96:99], v[144:147]
    ds_read_b128 v[40:43], v170 offset:2688
    v_mfma_f32_16x16x32_bf16 v[148:151], v[80:83], v[100:103], v[148:151]
    ds_read2_b32 v[12:13], v161 offset0:160 offset1:161
    v_mfma_f32_16x16x32_bf16 v[152:155], v[80:83], v[104:107], v[152:155]
    ds_read2_b32 v[14:15], v161 offset0:162 offset1:163
    v_mfma_f32_16x16x32_bf16 v[156:159], v[80:83], v[108:111], v[156:159]
    ds_read_b128 v[44:47], v170 offset:2176
    s_waitcnt lgkmcnt(15)
    v_mfma_f32_16x16x32_bf16 v[148:151], v[64:67], v[116:119], v[148:151]
    ds_read2_b32 v[16:17], v162 offset0:32 offset1:33
    v_mfma_f32_16x16x32_bf16 v[152:155], v[68:71], v[116:119], v[152:155]
    ds_read2_b32 v[18:19], v162 offset0:34 offset1:35
    v_mfma_f32_16x16x32_bf16 v[156:159], v[72:75], v[116:119], v[156:159]
    ds_read_b128 v[48:51], v170 offset:1664
    v_mfma_f32_16x16x32_bf16 v[148:151], v[84:87], v[96:99], v[148:151]
    ds_read2_b32 v[20:21], v162 offset0:160 offset1:161
    v_mfma_f32_16x16x32_bf16 v[152:155], v[84:87], v[100:103], v[152:155]
    ds_read2_b32 v[22:23], v162 offset0:162 offset1:163
    v_mfma_f32_16x16x32_bf16 v[156:159], v[84:87], v[104:107], v[156:159]
    ds_read_b128 v[52:55], v170 offset:1152
    v_mfma_f32_16x16x32_bf16 v[152:155], v[64:67], v[120:123], v[152:155]
    ds_read2_b32 v[24:25], v163 offset0:32 offset1:33
    v_mfma_f32_16x16x32_bf16 v[156:159], v[68:71], v[120:123], v[156:159]
    ds_read2_b32 v[26:27], v163 offset0:34 offset1:35
    v_mfma_f32_16x16x32_bf16 v[152:155], v[88:91], v[96:99], v[152:155]
    ds_read_b128 v[56:59], v170 offset:640
    v_mfma_f32_16x16x32_bf16 v[156:159], v[88:91], v[100:103], v[156:159]
    ds_read2_b32 v[28:29], v163 offset0:160 offset1:161
    s_waitcnt lgkmcnt(15)
    v_mfma_f32_16x16x32_bf16 v[156:159], v[64:67], v[124:127], v[156:159]
    ds_read2_b32 v[30:31], v163 offset0:162 offset1:163
    v_mfma_f32_16x16x32_bf16 v[156:159], v[92:95], v[96:99], v[156:159]
    ds_read_b128 v[60:63], v170 offset:128
    v_mfma_f32_16x16x32_bf16 v[128:131], v[0:3], v[32:35], v[128:131]
    v_mfma_f32_16x16x32_bf16 v[132:135], v[0:3], v[36:39], v[132:135]
    v_mfma_f32_16x16x32_bf16 v[132:135], v[4:7], v[32:35], v[132:135]
    v_mfma_f32_16x16x32_bf16 v[136:139], v[4:7], v[36:39], v[136:139]
    s_waitcnt lgkmcnt(15)
    v_mfma_f32_16x16x32_bf16 v[136:139], v[0:3], v[40:43], v[136:139]
    v_mfma_f32_16x16x32_bf16 v[140:143], v[4:7], v[40:43], v[140:143]
    v_mfma_f32_16x16x32_bf16 v[136:139], v[8:11], v[32:35], v[136:139]
    v_mfma_f32_16x16x32_bf16 v[140:143], v[8:11], v[36:39], v[140:143]
    v_mfma_f32_16x16x32_bf16 v[144:147], v[8:11], v[40:43], v[144:147]
    s_waitcnt lgkmcnt(12)
    v_mfma_f32_16x16x32_bf16 v[140:143], v[0:3], v[44:47], v[140:143]
    v_mfma_f32_16x16x32_bf16 v[144:147], v[4:7], v[44:47], v[144:147]
    v_mfma_f32_16x16x32_bf16 v[148:151], v[8:11], v[44:47], v[148:151]
    v_mfma_f32_16x16x32_bf16 v[140:143], v[12:15], v[32:35], v[140:143]
    ds_read2_b32 v[64:65], v160 offset0:48 offset1:49
    v_mfma_f32_16x16x32_bf16 v[144:147], v[12:15], v[36:39], v[144:147]
    ds_read2_b32 v[66:67], v160 offset0:50 offset1:51
    v_mfma_f32_16x16x32_bf16 v[148:151], v[12:15], v[40:43], v[148:151]
    ds_read_b128 v[96:99], v170 offset:3776
    v_mfma_f32_16x16x32_bf16 v[152:155], v[12:15], v[44:47], v[152:155]
    ds_read2_b32 v[68:69], v160 offset0:176 offset1:177
    s_waitcnt lgkmcnt(13)
    v_mfma_f32_16x16x32_bf16 v[144:147], v[0:3], v[48:51], v[144:147]
    ds_read2_b32 v[70:71], v160 offset0:178 offset1:179
    v_mfma_f32_16x16x32_bf16 v[148:151], v[4:7], v[48:51], v[148:151]
    ds_read_b128 v[100:103], v170 offset:3264
    v_mfma_f32_16x16x32_bf16 v[152:155], v[8:11], v[48:51], v[152:155]
    ds_read2_b32 v[72:73], v161 offset0:48 offset1:49
    v_mfma_f32_16x16x32_bf16 v[156:159], v[12:15], v[48:51], v[156:159]
    ds_read2_b32 v[74:75], v161 offset0:50 offset1:51
    v_mfma_f32_16x16x32_bf16 v[144:147], v[16:19], v[32:35], v[144:147]
    ds_read_b128 v[104:107], v170 offset:2752
    v_mfma_f32_16x16x32_bf16 v[148:151], v[16:19], v[36:39], v[148:151]
    ds_read2_b32 v[76:77], v161 offset0:176 offset1:177
    v_mfma_f32_16x16x32_bf16 v[152:155], v[16:19], v[40:43], v[152:155]
    ds_read2_b32 v[78:79], v161 offset0:178 offset1:179
    v_mfma_f32_16x16x32_bf16 v[156:159], v[16:19], v[44:47], v[156:159]
    ds_read_b128 v[108:111], v170 offset:2240
    s_waitcnt lgkmcnt(15)
    v_mfma_f32_16x16x32_bf16 v[148:151], v[0:3], v[52:55], v[148:151]
    ds_read2_b32 v[80:81], v162 offset0:48 offset1:49
    v_mfma_f32_16x16x32_bf16 v[152:155], v[4:7], v[52:55], v[152:155]
    ds_read2_b32 v[82:83], v162 offset0:50 offset1:51
    v_mfma_f32_16x16x32_bf16 v[156:159], v[8:11], v[52:55], v[156:159]
    ds_read_b128 v[112:115], v170 offset:1728
    v_mfma_f32_16x16x32_bf16 v[148:151], v[20:23], v[32:35], v[148:151]
    ds_read2_b32 v[84:85], v162 offset0:176 offset1:177
    v_mfma_f32_16x16x32_bf16 v[152:155], v[20:23], v[36:39], v[152:155]
    ds_read2_b32 v[86:87], v162 offset0:178 offset1:179
    v_mfma_f32_16x16x32_bf16 v[156:159], v[20:23], v[40:43], v[156:159]
    ds_read_b128 v[116:119], v170 offset:1216
    v_mfma_f32_16x16x32_bf16 v[152:155], v[0:3], v[56:59], v[152:155]
    ds_read2_b32 v[88:89], v163 offset0:48 offset1:49
    v_mfma_f32_16x16x32_bf16 v[156:159], v[4:7], v[56:59], v[156:159]
    ds_read2_b32 v[90:91], v163 offset0:50 offset1:51
    v_mfma_f32_16x16x32_bf16 v[152:155], v[24:27], v[32:35], v[152:155]
    ds_read_b128 v[120:123], v170 offset:704
    v_mfma_f32_16x16x32_bf16 v[156:159], v[24:27], v[36:39], v[156:159]
    ds_read2_b32 v[92:93], v163 offset0:176 offset1:177
    s_waitcnt lgkmcnt(15)
    v_mfma_f32_16x16x32_bf16 v[156:159], v[0:3], v[60:63], v[156:159]
    ds_read2_b32 v[94:95], v163 offset0:178 offset1:179
    v_mfma_f32_16x16x32_bf16 v[156:159], v[28:31], v[32:35], v[156:159]
    ds_read_b128 v[124:127], v170 offset:192
    v_mfma_f32_16x16x32_bf16 v[128:131], v[64:67], v[96:99], v[128:131]
    v_mfma_f32_16x16x32_bf16 v[132:135], v[64:67], v[100:103], v[132:135]
    v_mfma_f32_16x16x32_bf16 v[132:135], v[68:71], v[96:99], v[132:135]
    v_mfma_f32_16x16x32_bf16 v[136:139], v[68:71], v[100:103], v[136:139]
    s_waitcnt lgkmcnt(15)
    v_mfma_f32_16x16x32_bf16 v[136:139], v[64:67], v[104:107], v[136:139]
    v_mfma_f32_16x16x32_bf16 v[140:143], v[68:71], v[104:107], v[140:143]
    v_mfma_f32_16x16x32_bf16 v[136:139], v[72:75], v[96:99], v[136:139]
    v_mfma_f32_16x16x32_bf16 v[140:143], v[72:75], v[100:103], v[140:143]
    v_mfma_f32_16x16x32_bf16 v[144:147], v[72:75], v[104:107], v[144:147]
    s_waitcnt lgkmcnt(12)
    v_mfma_f32_16x16x32_bf16 v[140:143], v[64:67], v[108:111], v[140:143]
    v_mfma_f32_16x16x32_bf16 v[144:147], v[68:71], v[108:111], v[144:147]
    v_mfma_f32_16x16x32_bf16 v[148:151], v[72:75], v[108:111], v[148:151]
    v_mfma_f32_16x16x32_bf16 v[140:143], v[76:79], v[96:99], v[140:143]
    v_mfma_f32_16x16x32_bf16 v[144:147], v[76:79], v[100:103], v[144:147]
    v_mfma_f32_16x16x32_bf16 v[148:151], v[76:79], v[104:107], v[148:151]
    v_mfma_f32_16x16x32_bf16 v[152:155], v[76:79], v[108:111], v[152:155]
    s_waitcnt lgkmcnt(9)
    v_mfma_f32_16x16x32_bf16 v[144:147], v[64:67], v[112:115], v[144:147]
    v_mfma_f32_16x16x32_bf16 v[148:151], v[68:71], v[112:115], v[148:151]
    v_mfma_f32_16x16x32_bf16 v[152:155], v[72:75], v[112:115], v[152:155]
    v_mfma_f32_16x16x32_bf16 v[156:159], v[76:79], v[112:115], v[156:159]
    v_mfma_f32_16x16x32_bf16 v[144:147], v[80:83], v[96:99], v[144:147]
    v_mfma_f32_16x16x32_bf16 v[148:151], v[80:83], v[100:103], v[148:151]
    v_mfma_f32_16x16x32_bf16 v[152:155], v[80:83], v[104:107], v[152:155]
    v_mfma_f32_16x16x32_bf16 v[156:159], v[80:83], v[108:111], v[156:159]
    s_waitcnt lgkmcnt(6)
    v_mfma_f32_16x16x32_bf16 v[148:151], v[64:67], v[116:119], v[148:151]
    v_mfma_f32_16x16x32_bf16 v[152:155], v[68:71], v[116:119], v[152:155]
    v_mfma_f32_16x16x32_bf16 v[156:159], v[72:75], v[116:119], v[156:159]
    v_mfma_f32_16x16x32_bf16 v[148:151], v[84:87], v[96:99], v[148:151]
    v_mfma_f32_16x16x32_bf16 v[152:155], v[84:87], v[100:103], v[152:155]
    v_mfma_f32_16x16x32_bf16 v[156:159], v[84:87], v[104:107], v[156:159]
    s_waitcnt lgkmcnt(3)
    v_mfma_f32_16x16x32_bf16 v[152:155], v[64:67], v[120:123], v[152:155]
    v_mfma_f32_16x16x32_bf16 v[156:159], v[68:71], v[120:123], v[156:159]
    v_mfma_f32_16x16x32_bf16 v[152:155], v[88:91], v[96:99], v[152:155]
    v_mfma_f32_16x16x32_bf16 v[156:159], v[88:91], v[100:103], v[156:159]
    s_waitcnt lgkmcnt(0)
    v_mfma_f32_16x16x32_bf16 v[156:159], v[64:67], v[124:127], v[156:159]
    v_mfma_f32_16x16x32_bf16 v[156:159], v[92:95], v[96:99], v[156:159]
    v_and_b32 v171, 15, v168
    v_lshlrev_b32 v171, 6, v171
    v_lshl_add_u32 v171, v175, 4, v171
    v_add_u32 v171, s47, v171
    ds_write_b128 v171, v[128:131] offset:0
    ds_write_b128 v171, v[132:135] offset:1024
    ds_write_b128 v171, v[136:139] offset:2048
    ds_write_b128 v171, v[140:143] offset:3072
    ds_write_b128 v171, v[144:147] offset:4096
    ds_write_b128 v171, v[148:151] offset:5120
    ds_write_b128 v171, v[152:155] offset:6144
    ds_write_b128 v171, v[156:159] offset:7168
    s_waitcnt lgkmcnt(0)
    s_barrier
    v_lshlrev_b32 v169, 2, v172
    ds_read2st64_b32 v[0:1], v169 offset0:0 offset1:34
    ds_read2st64_b32 v[2:3], v169 offset0:68 offset1:102
    ds_read2st64_b32 v[4:5], v169 offset0:4 offset1:38
    ds_read2st64_b32 v[6:7], v169 offset0:72 offset1:106
    ds_read2st64_b32 v[8:9], v169 offset0:8 offset1:42
    ds_read2st64_b32 v[10:11], v169 offset0:76 offset1:110
    ds_read2st64_b32 v[12:13], v169 offset0:12 offset1:46
    ds_read2st64_b32 v[14:15], v169 offset0:80 offset1:114
    ds_read2st64_b32 v[16:17], v169 offset0:16 offset1:50
    ds_read2st64_b32 v[18:19], v169 offset0:84 offset1:118
    ds_read2st64_b32 v[20:21], v169 offset0:20 offset1:54
    ds_read2st64_b32 v[22:23], v169 offset0:88 offset1:122
    ds_read2st64_b32 v[24:25], v169 offset0:24 offset1:58
    ds_read2st64_b32 v[26:27], v169 offset0:92 offset1:126
    ds_read2st64_b32 v[28:29], v169 offset0:28 offset1:62
    ds_read2st64_b32 v[30:31], v169 offset0:96 offset1:130
    v_lshlrev_b32 v170, 1, v172
    ds_read_u16 v64, v170 offset:34848
    ds_read_u16 v65, v170 offset:43168
    ds_read_u16 v66, v170 offset:35360
    ds_read_u16 v67, v170 offset:43680
    ds_read_u16 v68, v170 offset:35872
    ds_read_u16 v69, v170 offset:44192
    ds_read_u16 v70, v170 offset:36384
    ds_read_u16 v71, v170 offset:44704
    ds_read_u16 v72, v170 offset:36896
    ds_read_u16 v73, v170 offset:45216
    ds_read_u16 v74, v170 offset:37408
    ds_read_u16 v75, v170 offset:45728
    ds_read_u16 v76, v170 offset:37920
    ds_read_u16 v77, v170 offset:46240
    ds_read_u16 v78, v170 offset:38432
    ds_read_u16 v79, v170 offset:46752
    v_and_b32 v174, 0xffff0000, v173
    v_lshlrev_b32 v173, 16, v173
    v_lshlrev_b32 v171, 11, v172
    s_lshl_b32 s6, s45, 1
    s_waitcnt lgkmcnt(15)
    v_add_f32 v0, v0, v1
    v_add_f32 v2, v2, v3
    v_cvt_pk_bf16_f32 v0, v0, v2
    v_lshlrev_b32 v32, 16, v64
    s_waitcnt lgkmcnt(14)
    v_lshlrev_b32 v33, 16, v65
    v_mul_f32 v32, v32, v173
    v_mul_f32 v33, v33, v174
    v_cvt_pk_bf16_f32 v32, v32, v33
    v_lshlrev_b32 v1, 16, v0
    v_and_b32 v2, 0xffff0000, v0
    v_lshlrev_b32 v33, 16, v32
    v_and_b32 v34, 0xffff0000, v32
    v_add_f32 v1, v1, v33
    v_add_f32 v2, v2, v34
    v_cvt_pk_bf16_f32 v0, v1, v2
    buffer_store_dword v0, v171, s[36:39], s6 offen
    v_add_f32 v4, v4, v5
    v_add_f32 v6, v6, v7
    v_cvt_pk_bf16_f32 v4, v4, v6
    s_waitcnt lgkmcnt(13)
    v_lshlrev_b32 v36, 16, v66
    s_waitcnt lgkmcnt(12)
    v_lshlrev_b32 v37, 16, v67
    v_mul_f32 v36, v36, v173
    v_mul_f32 v37, v37, v174
    v_cvt_pk_bf16_f32 v36, v36, v37
    v_lshlrev_b32 v5, 16, v4
    v_and_b32 v6, 0xffff0000, v4
    v_lshlrev_b32 v37, 16, v36
    v_and_b32 v38, 0xffff0000, v36
    v_add_f32 v5, v5, v37
    v_add_f32 v6, v6, v38
    v_cvt_pk_bf16_f32 v4, v5, v6
    s_add_u32 s6, s6, 524288
    buffer_store_dword v4, v171, s[36:39], s6 offen
    v_add_f32 v8, v8, v9
    v_add_f32 v10, v10, v11
    v_cvt_pk_bf16_f32 v8, v8, v10
    s_waitcnt lgkmcnt(11)
    v_lshlrev_b32 v40, 16, v68
    s_waitcnt lgkmcnt(10)
    v_lshlrev_b32 v41, 16, v69
    v_mul_f32 v40, v40, v173
    v_mul_f32 v41, v41, v174
    v_cvt_pk_bf16_f32 v40, v40, v41
    v_lshlrev_b32 v9, 16, v8
    v_and_b32 v10, 0xffff0000, v8
    v_lshlrev_b32 v41, 16, v40
    v_and_b32 v42, 0xffff0000, v40
    v_add_f32 v9, v9, v41
    v_add_f32 v10, v10, v42
    v_cvt_pk_bf16_f32 v8, v9, v10
    s_add_u32 s6, s6, 524288
    buffer_store_dword v8, v171, s[36:39], s6 offen
    v_add_f32 v12, v12, v13
    v_add_f32 v14, v14, v15
    v_cvt_pk_bf16_f32 v12, v12, v14
    s_waitcnt lgkmcnt(9)
    v_lshlrev_b32 v44, 16, v70
    s_waitcnt lgkmcnt(8)
    v_lshlrev_b32 v45, 16, v71
    v_mul_f32 v44, v44, v173
    v_mul_f32 v45, v45, v174
    v_cvt_pk_bf16_f32 v44, v44, v45
    v_lshlrev_b32 v13, 16, v12
    v_and_b32 v14, 0xffff0000, v12
    v_lshlrev_b32 v45, 16, v44
    v_and_b32 v46, 0xffff0000, v44
    v_add_f32 v13, v13, v45
    v_add_f32 v14, v14, v46
    v_cvt_pk_bf16_f32 v12, v13, v14
    s_add_u32 s6, s6, 524288
    buffer_store_dword v12, v171, s[36:39], s6 offen
    v_add_f32 v16, v16, v17
    v_add_f32 v18, v18, v19
    v_cvt_pk_bf16_f32 v16, v16, v18
    s_waitcnt lgkmcnt(7)
    v_lshlrev_b32 v48, 16, v72
    s_waitcnt lgkmcnt(6)
    v_lshlrev_b32 v49, 16, v73
    v_mul_f32 v48, v48, v173
    v_mul_f32 v49, v49, v174
    v_cvt_pk_bf16_f32 v48, v48, v49
    v_lshlrev_b32 v17, 16, v16
    v_and_b32 v18, 0xffff0000, v16
    v_lshlrev_b32 v49, 16, v48
    v_and_b32 v50, 0xffff0000, v48
    v_add_f32 v17, v17, v49
    v_add_f32 v18, v18, v50
    v_cvt_pk_bf16_f32 v16, v17, v18
    s_add_u32 s6, s6, 524288
    buffer_store_dword v16, v171, s[36:39], s6 offen
    v_add_f32 v20, v20, v21
    v_add_f32 v22, v22, v23
    v_cvt_pk_bf16_f32 v20, v20, v22
    s_waitcnt lgkmcnt(5)
    v_lshlrev_b32 v52, 16, v74
    s_waitcnt lgkmcnt(4)
    v_lshlrev_b32 v53, 16, v75
    v_mul_f32 v52, v52, v173
    v_mul_f32 v53, v53, v174
    v_cvt_pk_bf16_f32 v52, v52, v53
    v_lshlrev_b32 v21, 16, v20
    v_and_b32 v22, 0xffff0000, v20
    v_lshlrev_b32 v53, 16, v52
    v_and_b32 v54, 0xffff0000, v52
    v_add_f32 v21, v21, v53
    v_add_f32 v22, v22, v54
    v_cvt_pk_bf16_f32 v20, v21, v22
    s_add_u32 s6, s6, 524288
    buffer_store_dword v20, v171, s[36:39], s6 offen
    v_add_f32 v24, v24, v25
    v_add_f32 v26, v26, v27
    v_cvt_pk_bf16_f32 v24, v24, v26
    s_waitcnt lgkmcnt(3)
    v_lshlrev_b32 v56, 16, v76
    s_waitcnt lgkmcnt(2)
    v_lshlrev_b32 v57, 16, v77
    v_mul_f32 v56, v56, v173
    v_mul_f32 v57, v57, v174
    v_cvt_pk_bf16_f32 v56, v56, v57
    v_lshlrev_b32 v25, 16, v24
    v_and_b32 v26, 0xffff0000, v24
    v_lshlrev_b32 v57, 16, v56
    v_and_b32 v58, 0xffff0000, v56
    v_add_f32 v25, v25, v57
    v_add_f32 v26, v26, v58
    v_cvt_pk_bf16_f32 v24, v25, v26
    s_add_u32 s6, s6, 524288
    buffer_store_dword v24, v171, s[36:39], s6 offen
    v_add_f32 v28, v28, v29
    v_add_f32 v30, v30, v31
    v_cvt_pk_bf16_f32 v28, v28, v30
    s_waitcnt lgkmcnt(1)
    v_lshlrev_b32 v60, 16, v78
    s_waitcnt lgkmcnt(0)
    v_lshlrev_b32 v61, 16, v79
    v_mul_f32 v60, v60, v173
    v_mul_f32 v61, v61, v174
    v_cvt_pk_bf16_f32 v60, v60, v61
    v_lshlrev_b32 v29, 16, v28
    v_and_b32 v30, 0xffff0000, v28
    v_lshlrev_b32 v61, 16, v60
    v_and_b32 v62, 0xffff0000, v60
    v_add_f32 v29, v29, v61
    v_add_f32 v30, v30, v62
    v_cvt_pk_bf16_f32 v28, v29, v30
    s_add_u32 s6, s6, 524288
    buffer_store_dword v28, v171, s[36:39], s6 offen
    s_endpgm
k3_kernel_done:
    s_endpgm
.section .rodata,"a"
.p2align 6
.amdhsa_kernel k1_kernel
  .amdhsa_next_free_vgpr 256
  .amdhsa_next_free_sgpr 102
  .amdhsa_accum_offset 256
  .amdhsa_group_segment_fixed_size 0
  .amdhsa_kernarg_size 128
  .amdhsa_user_sgpr_count 2
  .amdhsa_user_sgpr_kernarg_segment_ptr 1
  .amdhsa_system_sgpr_workgroup_id_x 1
.end_amdhsa_kernel
.p2align 6
.amdhsa_kernel k2_kernel
  .amdhsa_next_free_vgpr 256
  .amdhsa_next_free_sgpr 100
  .amdhsa_accum_offset 256
  .amdhsa_group_segment_fixed_size 0
  .amdhsa_kernarg_size 128
  .amdhsa_user_sgpr_count 2
  .amdhsa_user_sgpr_kernarg_segment_ptr 1
  .amdhsa_system_sgpr_workgroup_id_x 1
.end_amdhsa_kernel
.p2align 6
.amdhsa_kernel k3_kernel
  .amdhsa_next_free_vgpr 176
  .amdhsa_next_free_sgpr 100
  .amdhsa_accum_offset 176
  .amdhsa_group_segment_fixed_size 0
  .amdhsa_kernarg_size 128
  .amdhsa_user_sgpr_count 2
  .amdhsa_user_sgpr_kernarg_segment_ptr 1
  .amdhsa_system_sgpr_workgroup_id_x 1
.end_amdhsa_kernel
```
